```python
import torch

def _softmax(x, axis=-1):
    return torch.softmax(x, dim=axis)
def _gelu(x):
    return torch.nn.functional.gelu(x, approximate="tanh")
def _silu(x):
    return torch.nn.functional.silu(x)
def _sigmoid(x):
    return torch.sigmoid(x)
def _layernorm(x, axis=-1, eps=1e-5):
    m = x.mean(dim=axis, keepdim=True)
    v = x.var(dim=axis, keepdim=True, unbiased=False)
    return (x - m) / torch.sqrt(v + eps)
def _scatter_add(tgt, idx, src, axis=0):
    return tgt.clone().index_add_(axis, idx, src)
def _segment_sum(src, seg, n):
    out = torch.zeros((n,) + src.shape[1:], dtype=src.dtype)
    return out.index_add_(0, seg, src)
def _pad(x, pw):
    flat = tuple(v for pair in reversed(pw) for v in pair)
    return torch.nn.functional.pad(x, flat)

kernel_name = 'sequential_preLN__linear_kernel_hedgehog__dense_activation_silu__prompt'

def setup_inputs():

    _w = (lambda a: (lambda t: t.to(torch.bfloat16) if t.is_floating_point() else t)(torch.as_tensor(a)))
    def _A_setup():
        B, S, D, H = 1, 2048, 640, 32
        Dh = D // H
        return {
            "x": _w((lambda *s: torch.randn(*s, dtype=torch.bfloat16) * 0.05)(B, S, D)),
            "wqkv": _w((lambda *s: torch.randn(*s, dtype=torch.bfloat16) * 0.2)(D, 3 * D)),
            "w_phi": _w((lambda *s: torch.randn(*s, dtype=torch.bfloat16) * 0.2)(H, Dh, Dh) * (Dh ** -0.5)),
            "wo": _w((lambda *s: torch.randn(*s, dtype=torch.bfloat16) * 0.05)(D, D)),
        }
    _A_in = _A_setup()

    def _B_setup():
        B, S, D, F = 1, 2048, 640, 1728
        return {
            "x": _w((lambda *s: torch.randn(*s, dtype=torch.bfloat16) * 0.05)(B, S, D)),
            "w1": _w((lambda *s: torch.randn(*s, dtype=torch.bfloat16) * 1.6)(D, F) * (D ** -0.5)),
            "w2": _w((lambda *s: torch.randn(*s, dtype=torch.bfloat16) * 0.2)(F, D) * (F ** -0.5)),
        }
    _B_in = _B_setup()

    return {
        "A_x": _A_in["x"],
        "A_wqkv": _A_in["wqkv"],
        "A_w_phi": _A_in["w_phi"],
        "A_wo": _A_in["wo"],
        "B_x": _B_in["x"],
        "B_w1": _B_in["w1"],
        "B_w2": _B_in["w2"],
    }

def reference(A_x, A_wqkv, A_w_phi, A_wo, B_x, B_w1, B_w2):
    def _A_ref(x, wqkv, w_phi, wo):
        B, S, D = x.shape
        H = 32; Dh = D // H
        qkv = (lambda x, *d: x.permute(*d))((x @ wqkv).reshape(B, S, 3, H, Dh), 2, 0, 3, 1, 4)
        q, k, v = qkv[0], qkv[1], qkv[2]
        pq = torch.einsum("bhsd,hdf->bhsf", q, w_phi)
        pk = torch.einsum("bhsd,hdf->bhsf", k, w_phi)
        phi_q = torch.concatenate([_softmax(pq, axis=-1), _softmax(-pq, axis=-1)], axis=-1)
        phi_k = torch.concatenate([_softmax(pk, axis=-1), _softmax(-pk, axis=-1)], axis=-1)
        kv = torch.einsum("bhsf,bhsd->bhfd", phi_k, v)
        z  = torch.einsum("bhsf->bhf", phi_k)
        num = torch.einsum("bhqf,bhfd->bhqd", phi_q, kv)
        den = torch.einsum("bhqf,bhf->bhq", phi_q, z)[..., None] + 1e-6
        o = num / den
        return (lambda x, *d: x.permute(*d))(o, 0, 2, 1, 3).reshape(B, S, D) @ wo

    def _B_ref(x, w1, w2):
        h = torch.einsum("bsd,df->bsf", x, w1)
        h = _silu(h)
        out = torch.einsum("bsf,fd->bsd", h, w2)
        return out

    x = A_x
    h = x + _A_ref(_layernorm(x, axis=-1), A_wqkv, A_w_phi, A_wo)
    h2 = h + _B_ref(_layernorm(h, axis=-1), B_w1, B_w2)
    return h2
```

```asm
; @launch kernel=z_kernel grid=(512,1,1) block=(256,1,1) lds=0
; @launch kernel=k1n_kernel grid=(256,1,1) block=(640,1,1) lds=132096
; @launch kernel=k2n_kernel grid=(256,1,1) block=(512,1,1) lds=144384
; @launch kernel=k4_kernel grid=(224,1,1) block=(640,1,1) lds=132096
; @launch kernel=k5_kernel grid=(256,1,1) block=(512,1,1) lds=110592
.amdgcn_target "amdgcn-amd-amdhsa--gfx950"
.text
.globl z_kernel
.p2align 8
.type z_kernel,@function
z_kernel:
    s_cmp_ge_u32 s2, 512
    s_cbranch_scc1 z_kernel_end
    s_load_dwordx16 s[64:79], s[0:1], 0
    s_load_dwordx4 s[80:83], s[0:1], 64
    s_waitcnt lgkmcnt(0)
    s_add_u32 s8, s82, 16777216
    s_addc_u32 s9, s83, 0
    s_and_b32 s9, s9, 0xffff
    s_mov_b32 s10, 393216
    s_mov_b32 s11, 0x00020000
    s_mov_b32 s12, s64
    s_and_b32 s13, s65, 0xffff
    s_mov_b32 s14, 2621440
    s_mov_b32 s15, 0x00020000
    s_add_u32 s16, s82, 18874368
    s_addc_u32 s17, s83, 0
    s_and_b32 s17, s17, 0xffff
    s_mov_b32 s18, 16384
    s_mov_b32 s19, 0x00020000
    v_lshrrev_b32 v1, 6, v0
    v_and_b32 v2, 63, v0
    s_lshl_b32 s3, s2, 2
    v_add_u32 v1, s3, v1
    v_mul_u32_u24 v3, 0x500, v1
    v_mul_u32_u24 v4, 20, v2
    v_add_u32 v3, v3, v4
    buffer_load_dwordx4 v[8:11], v3, s[12:15], 0 offen
    buffer_load_dword v12, v3, s[12:15], 0 offen offset:16
    s_lshl_b32 s3, s2, 8
    v_add_u32 v5, s3, v0
    v_lshlrev_b32 v5, 4, v5
    v_mov_b32 v28, 0
    v_mov_b32 v29, 0
    v_mov_b32 v30, 0
    v_mov_b32 v31, 0
    buffer_store_dwordx4 v[28:31], v5, s[8:11], 0 offen
    s_add_u32 s24, s82, 18939904
    s_addc_u32 s25, s83, 0
    s_and_b32 s25, s25, 0xffff
    s_mov_b32 s26, 16384
    s_mov_b32 s27, 0x00020000
    buffer_store_dwordx4 v[28:31], v5, s[24:27], 0 offen
    s_waitcnt vmcnt(2)
    v_lshlrev_b32 v16, 16, v8
    v_and_b32 v17, 0xffff0000, v8
    v_lshlrev_b32 v18, 16, v9
    v_and_b32 v19, 0xffff0000, v9
    v_lshlrev_b32 v20, 16, v10
    v_and_b32 v21, 0xffff0000, v10
    v_lshlrev_b32 v22, 16, v11
    v_and_b32 v23, 0xffff0000, v11
    v_lshlrev_b32 v24, 16, v12
    v_and_b32 v25, 0xffff0000, v12
    v_add_f32 v6, v16, v17
    v_add_f32 v6, v6, v18
    v_add_f32 v6, v6, v19
    v_add_f32 v6, v6, v20
    v_add_f32 v6, v6, v21
    v_add_f32 v6, v6, v22
    v_add_f32 v6, v6, v23
    v_add_f32 v6, v6, v24
    v_add_f32 v6, v6, v25
    s_nop 1
    v_add_f32_dpp v6, v6, v6 quad_perm:[1,0,3,2] row_mask:0xf bank_mask:0xf
    s_nop 1
    v_add_f32_dpp v6, v6, v6 quad_perm:[2,3,0,1] row_mask:0xf bank_mask:0xf
    s_nop 1
    v_add_f32_dpp v6, v6, v6 row_half_mirror row_mask:0xf bank_mask:0xf
    s_nop 1
    v_add_f32_dpp v6, v6, v6 row_mirror row_mask:0xf bank_mask:0xf
    s_nop 1
    v_readlane_b32 s20, v6, 0
    v_readlane_b32 s21, v6, 16
    v_readlane_b32 s22, v6, 32
    v_readlane_b32 s23, v6, 48
    s_nop 1
    v_mov_b32 v6, s20
    v_add_f32 v6, s21, v6
    v_add_f32 v6, s22, v6
    v_add_f32 v6, s23, v6
    v_mul_f32 v6, 0x3acccccd, v6
    v_sub_f32 v7, v16, v6
    v_mul_f32 v13, v7, v7
    v_sub_f32 v7, v17, v6
    v_fmac_f32 v13, v7, v7
    v_sub_f32 v7, v18, v6
    v_fmac_f32 v13, v7, v7
    v_sub_f32 v7, v19, v6
    v_fmac_f32 v13, v7, v7
    v_sub_f32 v7, v20, v6
    v_fmac_f32 v13, v7, v7
    v_sub_f32 v7, v21, v6
    v_fmac_f32 v13, v7, v7
    v_sub_f32 v7, v22, v6
    v_fmac_f32 v13, v7, v7
    v_sub_f32 v7, v23, v6
    v_fmac_f32 v13, v7, v7
    v_sub_f32 v7, v24, v6
    v_fmac_f32 v13, v7, v7
    v_sub_f32 v7, v25, v6
    v_fmac_f32 v13, v7, v7
    s_nop 1
    v_add_f32_dpp v13, v13, v13 quad_perm:[1,0,3,2] row_mask:0xf bank_mask:0xf
    s_nop 1
    v_add_f32_dpp v13, v13, v13 quad_perm:[2,3,0,1] row_mask:0xf bank_mask:0xf
    s_nop 1
    v_add_f32_dpp v13, v13, v13 row_half_mirror row_mask:0xf bank_mask:0xf
    s_nop 1
    v_add_f32_dpp v13, v13, v13 row_mirror row_mask:0xf bank_mask:0xf
    s_nop 1
    v_readlane_b32 s20, v13, 0
    v_readlane_b32 s21, v13, 16
    v_readlane_b32 s22, v13, 32
    v_readlane_b32 s23, v13, 48
    s_nop 1
    v_mov_b32 v13, s20
    v_add_f32 v13, s21, v13
    v_add_f32 v13, s22, v13
    v_add_f32 v13, s23, v13
    v_mul_f32 v13, 0x3acccccd, v13
    v_cvt_pk_bf16_f32 v6, v6, v6
    v_lshlrev_b32 v6, 16, v6
    v_cvt_pk_bf16_f32 v13, v13, v13
    v_lshlrev_b32 v13, 16, v13
    v_add_f32 v13, 0x3727c5ac, v13
    v_cvt_pk_bf16_f32 v13, v13, v13
    v_lshlrev_b32 v13, 16, v13
    v_sqrt_f32 v13, v13
    s_nop 0
    v_cvt_pk_bf16_f32 v13, v13, v13
    v_lshlrev_b32 v13, 16, v13
    v_rcp_f32 v7, v13
    v_lshlrev_b32 v1, 3, v1
    v_cmp_eq_u32 vcc, 0, v2
    s_and_saveexec_b64 s[30:31], vcc
    buffer_store_dwordx2 v[6:7], v1, s[16:19], 0 offen
z_kernel_end:
    s_endpgm

.globl k1n_kernel
.p2align 8
.type k1n_kernel,@function
k1n_kernel:
    s_cmp_ge_u32 s2, 256
    s_cbranch_scc1 k1n_kernel_end
    s_load_dwordx16 s[64:79], s[0:1], 0
    s_load_dwordx4 s[80:83], s[0:1], 64
    v_and_b32 v1, 63, v0
    v_lshrrev_b32 v2, 6, v0
    s_nop 0
    v_readfirstlane_b32 s26, v2
    s_nop 1
    s_waitcnt lgkmcnt(0)
    s_mov_b32 s8, s64
    s_and_b32 s9, s65, 0xffff
    s_mov_b32 s10, 2621440
    s_mov_b32 s11, 0x00020000
    s_mov_b32 s12, s66
    s_and_b32 s13, s67, 0xffff
    s_mov_b32 s14, 2457600
    s_mov_b32 s15, 0x00020000
    s_add_u32 s16, s82, 67108864
    s_addc_u32 s17, s83, 0
    s_and_b32 s17, s17, 0xffff
    s_mov_b32 s18, 8388608
    s_mov_b32 s19, 0x00020000
    s_mov_b32 s20, s68
    s_and_b32 s21, s69, 0xffff
    s_mov_b32 s22, 25600
    s_mov_b32 s23, 0x00020000
    s_add_u32 s44, s82, 16777216
    s_addc_u32 s45, s83, 0
    s_and_b32 s45, s45, 0xffff
    s_mov_b32 s46, 393216
    s_mov_b32 s47, 0x00020000
    s_and_b32 s29, s2, 7
    s_lshr_b32 s30, s2, 3
    s_lshl_b32 s24, s29, 1
    s_lshr_b32 s31, s30, 4
    s_add_u32 s24, s24, s31
    s_mov_b32 s41, s24
    s_and_b32 s36, s30, 15
    s_mov_b32 s25, 0
    s_mul_i32 s24, s24, 128
    s_add_u32 s48, s82, 18874368
    s_addc_u32 s49, s83, 0
    s_and_b32 s49, s49, 0xffff
    s_mov_b32 s50, 16384
    s_mov_b32 s51, 0x00020000
    s_cmp_ge_u32 s26, 8
    s_cbranch_scc1 k1n_kernel_bl
    s_barrier
    s_cmp_ge_u32 s26, 4
    s_cbranch_scc1 k1n_kernel_nm
    s_lshr_b32 s27, s26, 1
    s_and_b32 s28, s26, 1
    s_mul_i32 s27, s27, 64
    s_mul_i32 s28, s28, 64
    v_and_b32 v8, 15, v1
    v_lshrrev_b32 v9, 4, v1
    v_lshrrev_b32 v10, 1, v1
    v_and_b32 v10, 7, v10
    v_xor_b32 v10, v10, v9
    v_lshlrev_b32 v10, 4, v10
    v_add_u32 v11, s27, v8
    v_lshlrev_b32 v11, 7, v11
    v_add_u32 v2, v11, v10
    v_xor_b32 v3, 64, v2
    v_lshrrev_b32 v10, 2, v8
    v_and_b32 v11, 3, v1
    v_lshl_add_u32 v12, v9, 3, v10
    v_lshlrev_b32 v12, 8, v12
    v_and_b32 v13, 1, v11
    v_lshl_add_u32 v12, v13, 3, v12
    v_lshrrev_b32 v13, 1, v11
    v_lshl_add_u32 v12, v13, 4, v12
    v_and_b32 v13, 1, v9
    s_lshr_b32 s29, s28, 6
    v_xor_b32 v13, s29, v13
    v_lshl_add_u32 v12, v13, 7, v12
    v_xor_b32 v13, 0, v10
    v_lshl_add_u32 v4, v13, 5, v12
    v_xor_b32 v13, 1, v10
    v_lshl_add_u32 v5, v13, 5, v12
    v_xor_b32 v13, 2, v10
    v_lshl_add_u32 v6, v13, 5, v12
    v_xor_b32 v13, 3, v10
    v_lshl_add_u32 v7, v13, 5, v12
    v_mov_b32 v80, 0
    v_mov_b32 v81, 0
    v_mov_b32 v82, 0
    v_mov_b32 v83, 0
    v_mov_b32 v84, 0
    v_mov_b32 v85, 0
    v_mov_b32 v86, 0
    v_mov_b32 v87, 0
    v_mov_b32 v88, 0
    v_mov_b32 v89, 0
    v_mov_b32 v90, 0
    v_mov_b32 v91, 0
    v_mov_b32 v92, 0
    v_mov_b32 v93, 0
    v_mov_b32 v94, 0
    v_mov_b32 v95, 0
    v_mov_b32 v96, 0
    v_mov_b32 v97, 0
    v_mov_b32 v98, 0
    v_mov_b32 v99, 0
    v_mov_b32 v100, 0
    v_mov_b32 v101, 0
    v_mov_b32 v102, 0
    v_mov_b32 v103, 0
    v_mov_b32 v104, 0
    v_mov_b32 v105, 0
    v_mov_b32 v106, 0
    v_mov_b32 v107, 0
    v_mov_b32 v108, 0
    v_mov_b32 v109, 0
    v_mov_b32 v110, 0
    v_mov_b32 v111, 0
    v_mov_b32 v112, 0
    v_mov_b32 v113, 0
    v_mov_b32 v114, 0
    v_mov_b32 v115, 0
    v_mov_b32 v116, 0
    v_mov_b32 v117, 0
    v_mov_b32 v118, 0
    v_mov_b32 v119, 0
    v_mov_b32 v120, 0
    v_mov_b32 v121, 0
    v_mov_b32 v122, 0
    v_mov_b32 v123, 0
    v_mov_b32 v124, 0
    v_mov_b32 v125, 0
    v_mov_b32 v126, 0
    v_mov_b32 v127, 0
    v_mov_b32 v128, 0
    v_mov_b32 v129, 0
    v_mov_b32 v130, 0
    v_mov_b32 v131, 0
    v_mov_b32 v132, 0
    v_mov_b32 v133, 0
    v_mov_b32 v134, 0
    v_mov_b32 v135, 0
    v_mov_b32 v136, 0
    v_mov_b32 v137, 0
    v_mov_b32 v138, 0
    v_mov_b32 v139, 0
    v_mov_b32 v140, 0
    v_mov_b32 v141, 0
    v_mov_b32 v142, 0
    v_mov_b32 v143, 0
    s_barrier
    v_add_u32 v8, 0, v2
    v_add_u32 v9, 16384, v4
    v_add_u32 v10, 16384, v5
    v_add_u32 v11, 16384, v6
    v_add_u32 v12, 16384, v7
    ds_read_b128 v[16:19], v8 offset:0
    ds_read_b128 v[20:23], v8 offset:2048
    ds_read_b128 v[24:27], v8 offset:4096
    ds_read_b128 v[28:31], v8 offset:6144
    ds_read_b64_tr_b16 v[48:49], v9 offset:0
    ds_read_b64_tr_b16 v[50:51], v9 offset:1024
    ds_read_b64_tr_b16 v[52:53], v10 offset:0
    ds_read_b64_tr_b16 v[54:55], v10 offset:1024
    ds_read_b64_tr_b16 v[56:57], v11 offset:0
    ds_read_b64_tr_b16 v[58:59], v11 offset:1024
    ds_read_b64_tr_b16 v[60:61], v12 offset:0
    ds_read_b64_tr_b16 v[62:63], v12 offset:1024
    v_add_u32 v8, 0, v3
    v_add_u32 v9, 16384, v4
    v_add_u32 v10, 16384, v5
    v_add_u32 v11, 16384, v6
    v_add_u32 v12, 16384, v7
    ds_read_b128 v[32:35], v8 offset:0
    ds_read_b128 v[36:39], v8 offset:2048
    ds_read_b128 v[40:43], v8 offset:4096
    ds_read_b128 v[44:47], v8 offset:6144
    ds_read_b64_tr_b16 v[64:65], v9 offset:8192
    ds_read_b64_tr_b16 v[66:67], v9 offset:9216
    ds_read_b64_tr_b16 v[68:69], v10 offset:8192
    ds_read_b64_tr_b16 v[70:71], v10 offset:9216
    ds_read_b64_tr_b16 v[72:73], v11 offset:8192
    ds_read_b64_tr_b16 v[74:75], v11 offset:9216
    ds_read_b64_tr_b16 v[76:77], v12 offset:8192
    ds_read_b64_tr_b16 v[78:79], v12 offset:9216
    s_waitcnt lgkmcnt(12)
    v_mfma_f32_16x16x32_bf16 v[80:83], v[48:51], v[16:19], v[80:83]
    v_mfma_f32_16x16x32_bf16 v[84:87], v[52:55], v[16:19], v[84:87]
    v_mfma_f32_16x16x32_bf16 v[88:91], v[56:59], v[16:19], v[88:91]
    v_mfma_f32_16x16x32_bf16 v[92:95], v[60:63], v[16:19], v[92:95]
    v_mfma_f32_16x16x32_bf16 v[96:99], v[48:51], v[20:23], v[96:99]
    v_mfma_f32_16x16x32_bf16 v[100:103], v[52:55], v[20:23], v[100:103]
    v_mfma_f32_16x16x32_bf16 v[104:107], v[56:59], v[20:23], v[104:107]
    v_mfma_f32_16x16x32_bf16 v[108:111], v[60:63], v[20:23], v[108:111]
    v_mfma_f32_16x16x32_bf16 v[112:115], v[48:51], v[24:27], v[112:115]
    v_mfma_f32_16x16x32_bf16 v[116:119], v[52:55], v[24:27], v[116:119]
    v_mfma_f32_16x16x32_bf16 v[120:123], v[56:59], v[24:27], v[120:123]
    v_mfma_f32_16x16x32_bf16 v[124:127], v[60:63], v[24:27], v[124:127]
    v_mfma_f32_16x16x32_bf16 v[128:131], v[48:51], v[28:31], v[128:131]
    v_mfma_f32_16x16x32_bf16 v[132:135], v[52:55], v[28:31], v[132:135]
    v_mfma_f32_16x16x32_bf16 v[136:139], v[56:59], v[28:31], v[136:139]
    v_mfma_f32_16x16x32_bf16 v[140:143], v[60:63], v[28:31], v[140:143]
    s_waitcnt lgkmcnt(0)
    s_barrier
    v_add_u32 v8, 32768, v2
    v_add_u32 v9, 49152, v4
    v_add_u32 v10, 49152, v5
    v_add_u32 v11, 49152, v6
    v_add_u32 v12, 49152, v7
    ds_read_b128 v[16:19], v8 offset:0
    ds_read_b128 v[20:23], v8 offset:2048
    ds_read_b128 v[24:27], v8 offset:4096
    ds_read_b128 v[28:31], v8 offset:6144
    ds_read_b64_tr_b16 v[48:49], v9 offset:0
    ds_read_b64_tr_b16 v[50:51], v9 offset:1024
    ds_read_b64_tr_b16 v[52:53], v10 offset:0
    ds_read_b64_tr_b16 v[54:55], v10 offset:1024
    ds_read_b64_tr_b16 v[56:57], v11 offset:0
    ds_read_b64_tr_b16 v[58:59], v11 offset:1024
    ds_read_b64_tr_b16 v[60:61], v12 offset:0
    ds_read_b64_tr_b16 v[62:63], v12 offset:1024
    v_mfma_f32_16x16x32_bf16 v[80:83], v[64:67], v[32:35], v[80:83]
    v_mfma_f32_16x16x32_bf16 v[84:87], v[68:71], v[32:35], v[84:87]
    v_mfma_f32_16x16x32_bf16 v[88:91], v[72:75], v[32:35], v[88:91]
    v_mfma_f32_16x16x32_bf16 v[92:95], v[76:79], v[32:35], v[92:95]
    v_mfma_f32_16x16x32_bf16 v[96:99], v[64:67], v[36:39], v[96:99]
    v_mfma_f32_16x16x32_bf16 v[100:103], v[68:71], v[36:39], v[100:103]
    v_mfma_f32_16x16x32_bf16 v[104:107], v[72:75], v[36:39], v[104:107]
    v_mfma_f32_16x16x32_bf16 v[108:111], v[76:79], v[36:39], v[108:111]
    v_mfma_f32_16x16x32_bf16 v[112:115], v[64:67], v[40:43], v[112:115]
    v_mfma_f32_16x16x32_bf16 v[116:119], v[68:71], v[40:43], v[116:119]
    v_mfma_f32_16x16x32_bf16 v[120:123], v[72:75], v[40:43], v[120:123]
    v_mfma_f32_16x16x32_bf16 v[124:127], v[76:79], v[40:43], v[124:127]
    v_mfma_f32_16x16x32_bf16 v[128:131], v[64:67], v[44:47], v[128:131]
    v_mfma_f32_16x16x32_bf16 v[132:135], v[68:71], v[44:47], v[132:135]
    v_mfma_f32_16x16x32_bf16 v[136:139], v[72:75], v[44:47], v[136:139]
    v_mfma_f32_16x16x32_bf16 v[140:143], v[76:79], v[44:47], v[140:143]
    v_add_u32 v8, 32768, v3
    v_add_u32 v9, 49152, v4
    v_add_u32 v10, 49152, v5
    v_add_u32 v11, 49152, v6
    v_add_u32 v12, 49152, v7
    ds_read_b128 v[32:35], v8 offset:0
    ds_read_b128 v[36:39], v8 offset:2048
    ds_read_b128 v[40:43], v8 offset:4096
    ds_read_b128 v[44:47], v8 offset:6144
    ds_read_b64_tr_b16 v[64:65], v9 offset:8192
    ds_read_b64_tr_b16 v[66:67], v9 offset:9216
    ds_read_b64_tr_b16 v[68:69], v10 offset:8192
    ds_read_b64_tr_b16 v[70:71], v10 offset:9216
    ds_read_b64_tr_b16 v[72:73], v11 offset:8192
    ds_read_b64_tr_b16 v[74:75], v11 offset:9216
    ds_read_b64_tr_b16 v[76:77], v12 offset:8192
    ds_read_b64_tr_b16 v[78:79], v12 offset:9216
    s_waitcnt lgkmcnt(12)
    v_mfma_f32_16x16x32_bf16 v[80:83], v[48:51], v[16:19], v[80:83]
    v_mfma_f32_16x16x32_bf16 v[84:87], v[52:55], v[16:19], v[84:87]
    v_mfma_f32_16x16x32_bf16 v[88:91], v[56:59], v[16:19], v[88:91]
    v_mfma_f32_16x16x32_bf16 v[92:95], v[60:63], v[16:19], v[92:95]
    v_mfma_f32_16x16x32_bf16 v[96:99], v[48:51], v[20:23], v[96:99]
    v_mfma_f32_16x16x32_bf16 v[100:103], v[52:55], v[20:23], v[100:103]
    v_mfma_f32_16x16x32_bf16 v[104:107], v[56:59], v[20:23], v[104:107]
    v_mfma_f32_16x16x32_bf16 v[108:111], v[60:63], v[20:23], v[108:111]
    v_mfma_f32_16x16x32_bf16 v[112:115], v[48:51], v[24:27], v[112:115]
    v_mfma_f32_16x16x32_bf16 v[116:119], v[52:55], v[24:27], v[116:119]
    v_mfma_f32_16x16x32_bf16 v[120:123], v[56:59], v[24:27], v[120:123]
    v_mfma_f32_16x16x32_bf16 v[124:127], v[60:63], v[24:27], v[124:127]
    v_mfma_f32_16x16x32_bf16 v[128:131], v[48:51], v[28:31], v[128:131]
    v_mfma_f32_16x16x32_bf16 v[132:135], v[52:55], v[28:31], v[132:135]
    v_mfma_f32_16x16x32_bf16 v[136:139], v[56:59], v[28:31], v[136:139]
    v_mfma_f32_16x16x32_bf16 v[140:143], v[60:63], v[28:31], v[140:143]
    s_waitcnt lgkmcnt(0)
    s_barrier
    v_add_u32 v8, 65536, v2
    v_add_u32 v9, 81920, v4
    v_add_u32 v10, 81920, v5
    v_add_u32 v11, 81920, v6
    v_add_u32 v12, 81920, v7
    ds_read_b128 v[16:19], v8 offset:0
    ds_read_b128 v[20:23], v8 offset:2048
    ds_read_b128 v[24:27], v8 offset:4096
    ds_read_b128 v[28:31], v8 offset:6144
    ds_read_b64_tr_b16 v[48:49], v9 offset:0
    ds_read_b64_tr_b16 v[50:51], v9 offset:1024
    ds_read_b64_tr_b16 v[52:53], v10 offset:0
    ds_read_b64_tr_b16 v[54:55], v10 offset:1024
    ds_read_b64_tr_b16 v[56:57], v11 offset:0
    ds_read_b64_tr_b16 v[58:59], v11 offset:1024
    ds_read_b64_tr_b16 v[60:61], v12 offset:0
    ds_read_b64_tr_b16 v[62:63], v12 offset:1024
    v_mfma_f32_16x16x32_bf16 v[80:83], v[64:67], v[32:35], v[80:83]
    v_mfma_f32_16x16x32_bf16 v[84:87], v[68:71], v[32:35], v[84:87]
    v_mfma_f32_16x16x32_bf16 v[88:91], v[72:75], v[32:35], v[88:91]
    v_mfma_f32_16x16x32_bf16 v[92:95], v[76:79], v[32:35], v[92:95]
    v_mfma_f32_16x16x32_bf16 v[96:99], v[64:67], v[36:39], v[96:99]
    v_mfma_f32_16x16x32_bf16 v[100:103], v[68:71], v[36:39], v[100:103]
    v_mfma_f32_16x16x32_bf16 v[104:107], v[72:75], v[36:39], v[104:107]
    v_mfma_f32_16x16x32_bf16 v[108:111], v[76:79], v[36:39], v[108:111]
    v_mfma_f32_16x16x32_bf16 v[112:115], v[64:67], v[40:43], v[112:115]
    v_mfma_f32_16x16x32_bf16 v[116:119], v[68:71], v[40:43], v[116:119]
    v_mfma_f32_16x16x32_bf16 v[120:123], v[72:75], v[40:43], v[120:123]
    v_mfma_f32_16x16x32_bf16 v[124:127], v[76:79], v[40:43], v[124:127]
    v_mfma_f32_16x16x32_bf16 v[128:131], v[64:67], v[44:47], v[128:131]
    v_mfma_f32_16x16x32_bf16 v[132:135], v[68:71], v[44:47], v[132:135]
    v_mfma_f32_16x16x32_bf16 v[136:139], v[72:75], v[44:47], v[136:139]
    v_mfma_f32_16x16x32_bf16 v[140:143], v[76:79], v[44:47], v[140:143]
    v_add_u32 v8, 65536, v3
    v_add_u32 v9, 81920, v4
    v_add_u32 v10, 81920, v5
    v_add_u32 v11, 81920, v6
    v_add_u32 v12, 81920, v7
    ds_read_b128 v[32:35], v8 offset:0
    ds_read_b128 v[36:39], v8 offset:2048
    ds_read_b128 v[40:43], v8 offset:4096
    ds_read_b128 v[44:47], v8 offset:6144
    ds_read_b64_tr_b16 v[64:65], v9 offset:8192
    ds_read_b64_tr_b16 v[66:67], v9 offset:9216
    ds_read_b64_tr_b16 v[68:69], v10 offset:8192
    ds_read_b64_tr_b16 v[70:71], v10 offset:9216
    ds_read_b64_tr_b16 v[72:73], v11 offset:8192
    ds_read_b64_tr_b16 v[74:75], v11 offset:9216
    ds_read_b64_tr_b16 v[76:77], v12 offset:8192
    ds_read_b64_tr_b16 v[78:79], v12 offset:9216
    s_waitcnt lgkmcnt(12)
    v_mfma_f32_16x16x32_bf16 v[80:83], v[48:51], v[16:19], v[80:83]
    v_mfma_f32_16x16x32_bf16 v[84:87], v[52:55], v[16:19], v[84:87]
    v_mfma_f32_16x16x32_bf16 v[88:91], v[56:59], v[16:19], v[88:91]
    v_mfma_f32_16x16x32_bf16 v[92:95], v[60:63], v[16:19], v[92:95]
    v_mfma_f32_16x16x32_bf16 v[96:99], v[48:51], v[20:23], v[96:99]
    v_mfma_f32_16x16x32_bf16 v[100:103], v[52:55], v[20:23], v[100:103]
    v_mfma_f32_16x16x32_bf16 v[104:107], v[56:59], v[20:23], v[104:107]
    v_mfma_f32_16x16x32_bf16 v[108:111], v[60:63], v[20:23], v[108:111]
    v_mfma_f32_16x16x32_bf16 v[112:115], v[48:51], v[24:27], v[112:115]
    v_mfma_f32_16x16x32_bf16 v[116:119], v[52:55], v[24:27], v[116:119]
    v_mfma_f32_16x16x32_bf16 v[120:123], v[56:59], v[24:27], v[120:123]
    v_mfma_f32_16x16x32_bf16 v[124:127], v[60:63], v[24:27], v[124:127]
    v_mfma_f32_16x16x32_bf16 v[128:131], v[48:51], v[28:31], v[128:131]
    v_mfma_f32_16x16x32_bf16 v[132:135], v[52:55], v[28:31], v[132:135]
    v_mfma_f32_16x16x32_bf16 v[136:139], v[56:59], v[28:31], v[136:139]
    v_mfma_f32_16x16x32_bf16 v[140:143], v[60:63], v[28:31], v[140:143]
    s_waitcnt lgkmcnt(0)
    s_barrier
    v_add_u32 v8, 98304, v2
    v_add_u32 v9, 114688, v4
    v_add_u32 v10, 114688, v5
    v_add_u32 v11, 114688, v6
    v_add_u32 v12, 114688, v7
    ds_read_b128 v[16:19], v8 offset:0
    ds_read_b128 v[20:23], v8 offset:2048
    ds_read_b128 v[24:27], v8 offset:4096
    ds_read_b128 v[28:31], v8 offset:6144
    ds_read_b64_tr_b16 v[48:49], v9 offset:0
    ds_read_b64_tr_b16 v[50:51], v9 offset:1024
    ds_read_b64_tr_b16 v[52:53], v10 offset:0
    ds_read_b64_tr_b16 v[54:55], v10 offset:1024
    ds_read_b64_tr_b16 v[56:57], v11 offset:0
    ds_read_b64_tr_b16 v[58:59], v11 offset:1024
    ds_read_b64_tr_b16 v[60:61], v12 offset:0
    ds_read_b64_tr_b16 v[62:63], v12 offset:1024
    v_mfma_f32_16x16x32_bf16 v[80:83], v[64:67], v[32:35], v[80:83]
    v_mfma_f32_16x16x32_bf16 v[84:87], v[68:71], v[32:35], v[84:87]
    v_mfma_f32_16x16x32_bf16 v[88:91], v[72:75], v[32:35], v[88:91]
    v_mfma_f32_16x16x32_bf16 v[92:95], v[76:79], v[32:35], v[92:95]
    v_mfma_f32_16x16x32_bf16 v[96:99], v[64:67], v[36:39], v[96:99]
    v_mfma_f32_16x16x32_bf16 v[100:103], v[68:71], v[36:39], v[100:103]
    v_mfma_f32_16x16x32_bf16 v[104:107], v[72:75], v[36:39], v[104:107]
    v_mfma_f32_16x16x32_bf16 v[108:111], v[76:79], v[36:39], v[108:111]
    v_mfma_f32_16x16x32_bf16 v[112:115], v[64:67], v[40:43], v[112:115]
    v_mfma_f32_16x16x32_bf16 v[116:119], v[68:71], v[40:43], v[116:119]
    v_mfma_f32_16x16x32_bf16 v[120:123], v[72:75], v[40:43], v[120:123]
    v_mfma_f32_16x16x32_bf16 v[124:127], v[76:79], v[40:43], v[124:127]
    v_mfma_f32_16x16x32_bf16 v[128:131], v[64:67], v[44:47], v[128:131]
    v_mfma_f32_16x16x32_bf16 v[132:135], v[68:71], v[44:47], v[132:135]
    v_mfma_f32_16x16x32_bf16 v[136:139], v[72:75], v[44:47], v[136:139]
    v_mfma_f32_16x16x32_bf16 v[140:143], v[76:79], v[44:47], v[140:143]
    v_add_u32 v8, 98304, v3
    v_add_u32 v9, 114688, v4
    v_add_u32 v10, 114688, v5
    v_add_u32 v11, 114688, v6
    v_add_u32 v12, 114688, v7
    ds_read_b128 v[32:35], v8 offset:0
    ds_read_b128 v[36:39], v8 offset:2048
    ds_read_b128 v[40:43], v8 offset:4096
    ds_read_b128 v[44:47], v8 offset:6144
    ds_read_b64_tr_b16 v[64:65], v9 offset:8192
    ds_read_b64_tr_b16 v[66:67], v9 offset:9216
    ds_read_b64_tr_b16 v[68:69], v10 offset:8192
    ds_read_b64_tr_b16 v[70:71], v10 offset:9216
    ds_read_b64_tr_b16 v[72:73], v11 offset:8192
    ds_read_b64_tr_b16 v[74:75], v11 offset:9216
    ds_read_b64_tr_b16 v[76:77], v12 offset:8192
    ds_read_b64_tr_b16 v[78:79], v12 offset:9216
    s_waitcnt lgkmcnt(12)
    v_mfma_f32_16x16x32_bf16 v[80:83], v[48:51], v[16:19], v[80:83]
    v_mfma_f32_16x16x32_bf16 v[84:87], v[52:55], v[16:19], v[84:87]
    v_mfma_f32_16x16x32_bf16 v[88:91], v[56:59], v[16:19], v[88:91]
    v_mfma_f32_16x16x32_bf16 v[92:95], v[60:63], v[16:19], v[92:95]
    v_mfma_f32_16x16x32_bf16 v[96:99], v[48:51], v[20:23], v[96:99]
    v_mfma_f32_16x16x32_bf16 v[100:103], v[52:55], v[20:23], v[100:103]
    v_mfma_f32_16x16x32_bf16 v[104:107], v[56:59], v[20:23], v[104:107]
    v_mfma_f32_16x16x32_bf16 v[108:111], v[60:63], v[20:23], v[108:111]
    v_mfma_f32_16x16x32_bf16 v[112:115], v[48:51], v[24:27], v[112:115]
    v_mfma_f32_16x16x32_bf16 v[116:119], v[52:55], v[24:27], v[116:119]
    v_mfma_f32_16x16x32_bf16 v[120:123], v[56:59], v[24:27], v[120:123]
    v_mfma_f32_16x16x32_bf16 v[124:127], v[60:63], v[24:27], v[124:127]
    v_mfma_f32_16x16x32_bf16 v[128:131], v[48:51], v[28:31], v[128:131]
    v_mfma_f32_16x16x32_bf16 v[132:135], v[52:55], v[28:31], v[132:135]
    v_mfma_f32_16x16x32_bf16 v[136:139], v[56:59], v[28:31], v[136:139]
    v_mfma_f32_16x16x32_bf16 v[140:143], v[60:63], v[28:31], v[140:143]
    s_waitcnt lgkmcnt(0)
    s_barrier
    v_add_u32 v8, 0, v2
    v_add_u32 v9, 16384, v4
    v_add_u32 v10, 16384, v5
    v_add_u32 v11, 16384, v6
    v_add_u32 v12, 16384, v7
    ds_read_b128 v[16:19], v8 offset:0
    ds_read_b128 v[20:23], v8 offset:2048
    ds_read_b128 v[24:27], v8 offset:4096
    ds_read_b128 v[28:31], v8 offset:6144
    ds_read_b64_tr_b16 v[48:49], v9 offset:0
    ds_read_b64_tr_b16 v[50:51], v9 offset:1024
    ds_read_b64_tr_b16 v[52:53], v10 offset:0
    ds_read_b64_tr_b16 v[54:55], v10 offset:1024
    ds_read_b64_tr_b16 v[56:57], v11 offset:0
    ds_read_b64_tr_b16 v[58:59], v11 offset:1024
    ds_read_b64_tr_b16 v[60:61], v12 offset:0
    ds_read_b64_tr_b16 v[62:63], v12 offset:1024
    v_mfma_f32_16x16x32_bf16 v[80:83], v[64:67], v[32:35], v[80:83]
    v_mfma_f32_16x16x32_bf16 v[84:87], v[68:71], v[32:35], v[84:87]
    v_mfma_f32_16x16x32_bf16 v[88:91], v[72:75], v[32:35], v[88:91]
    v_mfma_f32_16x16x32_bf16 v[92:95], v[76:79], v[32:35], v[92:95]
    v_mfma_f32_16x16x32_bf16 v[96:99], v[64:67], v[36:39], v[96:99]
    v_mfma_f32_16x16x32_bf16 v[100:103], v[68:71], v[36:39], v[100:103]
    v_mfma_f32_16x16x32_bf16 v[104:107], v[72:75], v[36:39], v[104:107]
    v_mfma_f32_16x16x32_bf16 v[108:111], v[76:79], v[36:39], v[108:111]
    v_mfma_f32_16x16x32_bf16 v[112:115], v[64:67], v[40:43], v[112:115]
    v_mfma_f32_16x16x32_bf16 v[116:119], v[68:71], v[40:43], v[116:119]
    v_mfma_f32_16x16x32_bf16 v[120:123], v[72:75], v[40:43], v[120:123]
    v_mfma_f32_16x16x32_bf16 v[124:127], v[76:79], v[40:43], v[124:127]
    v_mfma_f32_16x16x32_bf16 v[128:131], v[64:67], v[44:47], v[128:131]
    v_mfma_f32_16x16x32_bf16 v[132:135], v[68:71], v[44:47], v[132:135]
    v_mfma_f32_16x16x32_bf16 v[136:139], v[72:75], v[44:47], v[136:139]
    v_mfma_f32_16x16x32_bf16 v[140:143], v[76:79], v[44:47], v[140:143]
    v_add_u32 v8, 0, v3
    v_add_u32 v9, 16384, v4
    v_add_u32 v10, 16384, v5
    v_add_u32 v11, 16384, v6
    v_add_u32 v12, 16384, v7
    ds_read_b128 v[32:35], v8 offset:0
    ds_read_b128 v[36:39], v8 offset:2048
    ds_read_b128 v[40:43], v8 offset:4096
    ds_read_b128 v[44:47], v8 offset:6144
    ds_read_b64_tr_b16 v[64:65], v9 offset:8192
    ds_read_b64_tr_b16 v[66:67], v9 offset:9216
    ds_read_b64_tr_b16 v[68:69], v10 offset:8192
    ds_read_b64_tr_b16 v[70:71], v10 offset:9216
    ds_read_b64_tr_b16 v[72:73], v11 offset:8192
    ds_read_b64_tr_b16 v[74:75], v11 offset:9216
    ds_read_b64_tr_b16 v[76:77], v12 offset:8192
    ds_read_b64_tr_b16 v[78:79], v12 offset:9216
    s_waitcnt lgkmcnt(12)
    v_mfma_f32_16x16x32_bf16 v[80:83], v[48:51], v[16:19], v[80:83]
    v_mfma_f32_16x16x32_bf16 v[84:87], v[52:55], v[16:19], v[84:87]
    v_mfma_f32_16x16x32_bf16 v[88:91], v[56:59], v[16:19], v[88:91]
    v_mfma_f32_16x16x32_bf16 v[92:95], v[60:63], v[16:19], v[92:95]
    v_mfma_f32_16x16x32_bf16 v[96:99], v[48:51], v[20:23], v[96:99]
    v_mfma_f32_16x16x32_bf16 v[100:103], v[52:55], v[20:23], v[100:103]
    v_mfma_f32_16x16x32_bf16 v[104:107], v[56:59], v[20:23], v[104:107]
    v_mfma_f32_16x16x32_bf16 v[108:111], v[60:63], v[20:23], v[108:111]
    v_mfma_f32_16x16x32_bf16 v[112:115], v[48:51], v[24:27], v[112:115]
    v_mfma_f32_16x16x32_bf16 v[116:119], v[52:55], v[24:27], v[116:119]
    v_mfma_f32_16x16x32_bf16 v[120:123], v[56:59], v[24:27], v[120:123]
    v_mfma_f32_16x16x32_bf16 v[124:127], v[60:63], v[24:27], v[124:127]
    v_mfma_f32_16x16x32_bf16 v[128:131], v[48:51], v[28:31], v[128:131]
    v_mfma_f32_16x16x32_bf16 v[132:135], v[52:55], v[28:31], v[132:135]
    v_mfma_f32_16x16x32_bf16 v[136:139], v[56:59], v[28:31], v[136:139]
    v_mfma_f32_16x16x32_bf16 v[140:143], v[60:63], v[28:31], v[140:143]
    s_waitcnt lgkmcnt(0)
    s_barrier
    v_add_u32 v8, 32768, v2
    v_add_u32 v9, 49152, v4
    v_add_u32 v10, 49152, v5
    v_add_u32 v11, 49152, v6
    v_add_u32 v12, 49152, v7
    ds_read_b128 v[16:19], v8 offset:0
    ds_read_b128 v[20:23], v8 offset:2048
    ds_read_b128 v[24:27], v8 offset:4096
    ds_read_b128 v[28:31], v8 offset:6144
    ds_read_b64_tr_b16 v[48:49], v9 offset:0
    ds_read_b64_tr_b16 v[50:51], v9 offset:1024
    ds_read_b64_tr_b16 v[52:53], v10 offset:0
    ds_read_b64_tr_b16 v[54:55], v10 offset:1024
    ds_read_b64_tr_b16 v[56:57], v11 offset:0
    ds_read_b64_tr_b16 v[58:59], v11 offset:1024
    ds_read_b64_tr_b16 v[60:61], v12 offset:0
    ds_read_b64_tr_b16 v[62:63], v12 offset:1024
    v_mfma_f32_16x16x32_bf16 v[80:83], v[64:67], v[32:35], v[80:83]
    v_mfma_f32_16x16x32_bf16 v[84:87], v[68:71], v[32:35], v[84:87]
    v_mfma_f32_16x16x32_bf16 v[88:91], v[72:75], v[32:35], v[88:91]
    v_mfma_f32_16x16x32_bf16 v[92:95], v[76:79], v[32:35], v[92:95]
    v_mfma_f32_16x16x32_bf16 v[96:99], v[64:67], v[36:39], v[96:99]
    v_mfma_f32_16x16x32_bf16 v[100:103], v[68:71], v[36:39], v[100:103]
    v_mfma_f32_16x16x32_bf16 v[104:107], v[72:75], v[36:39], v[104:107]
    v_mfma_f32_16x16x32_bf16 v[108:111], v[76:79], v[36:39], v[108:111]
    v_mfma_f32_16x16x32_bf16 v[112:115], v[64:67], v[40:43], v[112:115]
    v_mfma_f32_16x16x32_bf16 v[116:119], v[68:71], v[40:43], v[116:119]
    v_mfma_f32_16x16x32_bf16 v[120:123], v[72:75], v[40:43], v[120:123]
    v_mfma_f32_16x16x32_bf16 v[124:127], v[76:79], v[40:43], v[124:127]
    v_mfma_f32_16x16x32_bf16 v[128:131], v[64:67], v[44:47], v[128:131]
    v_mfma_f32_16x16x32_bf16 v[132:135], v[68:71], v[44:47], v[132:135]
    v_mfma_f32_16x16x32_bf16 v[136:139], v[72:75], v[44:47], v[136:139]
    v_mfma_f32_16x16x32_bf16 v[140:143], v[76:79], v[44:47], v[140:143]
    v_add_u32 v8, 32768, v3
    v_add_u32 v9, 49152, v4
    v_add_u32 v10, 49152, v5
    v_add_u32 v11, 49152, v6
    v_add_u32 v12, 49152, v7
    ds_read_b128 v[32:35], v8 offset:0
    ds_read_b128 v[36:39], v8 offset:2048
    ds_read_b128 v[40:43], v8 offset:4096
    ds_read_b128 v[44:47], v8 offset:6144
    ds_read_b64_tr_b16 v[64:65], v9 offset:8192
    ds_read_b64_tr_b16 v[66:67], v9 offset:9216
    ds_read_b64_tr_b16 v[68:69], v10 offset:8192
    ds_read_b64_tr_b16 v[70:71], v10 offset:9216
    ds_read_b64_tr_b16 v[72:73], v11 offset:8192
    ds_read_b64_tr_b16 v[74:75], v11 offset:9216
    ds_read_b64_tr_b16 v[76:77], v12 offset:8192
    ds_read_b64_tr_b16 v[78:79], v12 offset:9216
    s_waitcnt lgkmcnt(12)
    v_mfma_f32_16x16x32_bf16 v[80:83], v[48:51], v[16:19], v[80:83]
    v_mfma_f32_16x16x32_bf16 v[84:87], v[52:55], v[16:19], v[84:87]
    v_mfma_f32_16x16x32_bf16 v[88:91], v[56:59], v[16:19], v[88:91]
    v_mfma_f32_16x16x32_bf16 v[92:95], v[60:63], v[16:19], v[92:95]
    v_mfma_f32_16x16x32_bf16 v[96:99], v[48:51], v[20:23], v[96:99]
    v_mfma_f32_16x16x32_bf16 v[100:103], v[52:55], v[20:23], v[100:103]
    v_mfma_f32_16x16x32_bf16 v[104:107], v[56:59], v[20:23], v[104:107]
    v_mfma_f32_16x16x32_bf16 v[108:111], v[60:63], v[20:23], v[108:111]
    v_mfma_f32_16x16x32_bf16 v[112:115], v[48:51], v[24:27], v[112:115]
    v_mfma_f32_16x16x32_bf16 v[116:119], v[52:55], v[24:27], v[116:119]
    v_mfma_f32_16x16x32_bf16 v[120:123], v[56:59], v[24:27], v[120:123]
    v_mfma_f32_16x16x32_bf16 v[124:127], v[60:63], v[24:27], v[124:127]
    v_mfma_f32_16x16x32_bf16 v[128:131], v[48:51], v[28:31], v[128:131]
    v_mfma_f32_16x16x32_bf16 v[132:135], v[52:55], v[28:31], v[132:135]
    v_mfma_f32_16x16x32_bf16 v[136:139], v[56:59], v[28:31], v[136:139]
    v_mfma_f32_16x16x32_bf16 v[140:143], v[60:63], v[28:31], v[140:143]
    s_waitcnt lgkmcnt(0)
    s_barrier
    v_add_u32 v8, 65536, v2
    v_add_u32 v9, 81920, v4
    v_add_u32 v10, 81920, v5
    v_add_u32 v11, 81920, v6
    v_add_u32 v12, 81920, v7
    ds_read_b128 v[16:19], v8 offset:0
    ds_read_b128 v[20:23], v8 offset:2048
    ds_read_b128 v[24:27], v8 offset:4096
    ds_read_b128 v[28:31], v8 offset:6144
    ds_read_b64_tr_b16 v[48:49], v9 offset:0
    ds_read_b64_tr_b16 v[50:51], v9 offset:1024
    ds_read_b64_tr_b16 v[52:53], v10 offset:0
    ds_read_b64_tr_b16 v[54:55], v10 offset:1024
    ds_read_b64_tr_b16 v[56:57], v11 offset:0
    ds_read_b64_tr_b16 v[58:59], v11 offset:1024
    ds_read_b64_tr_b16 v[60:61], v12 offset:0
    ds_read_b64_tr_b16 v[62:63], v12 offset:1024
    v_mfma_f32_16x16x32_bf16 v[80:83], v[64:67], v[32:35], v[80:83]
    v_mfma_f32_16x16x32_bf16 v[84:87], v[68:71], v[32:35], v[84:87]
    v_mfma_f32_16x16x32_bf16 v[88:91], v[72:75], v[32:35], v[88:91]
    v_mfma_f32_16x16x32_bf16 v[92:95], v[76:79], v[32:35], v[92:95]
    v_mfma_f32_16x16x32_bf16 v[96:99], v[64:67], v[36:39], v[96:99]
    v_mfma_f32_16x16x32_bf16 v[100:103], v[68:71], v[36:39], v[100:103]
    v_mfma_f32_16x16x32_bf16 v[104:107], v[72:75], v[36:39], v[104:107]
    v_mfma_f32_16x16x32_bf16 v[108:111], v[76:79], v[36:39], v[108:111]
    v_mfma_f32_16x16x32_bf16 v[112:115], v[64:67], v[40:43], v[112:115]
    v_mfma_f32_16x16x32_bf16 v[116:119], v[68:71], v[40:43], v[116:119]
    v_mfma_f32_16x16x32_bf16 v[120:123], v[72:75], v[40:43], v[120:123]
    v_mfma_f32_16x16x32_bf16 v[124:127], v[76:79], v[40:43], v[124:127]
    v_mfma_f32_16x16x32_bf16 v[128:131], v[64:67], v[44:47], v[128:131]
    v_mfma_f32_16x16x32_bf16 v[132:135], v[68:71], v[44:47], v[132:135]
    v_mfma_f32_16x16x32_bf16 v[136:139], v[72:75], v[44:47], v[136:139]
    v_mfma_f32_16x16x32_bf16 v[140:143], v[76:79], v[44:47], v[140:143]
    v_add_u32 v8, 65536, v3
    v_add_u32 v9, 81920, v4
    v_add_u32 v10, 81920, v5
    v_add_u32 v11, 81920, v6
    v_add_u32 v12, 81920, v7
    ds_read_b128 v[32:35], v8 offset:0
    ds_read_b128 v[36:39], v8 offset:2048
    ds_read_b128 v[40:43], v8 offset:4096
    ds_read_b128 v[44:47], v8 offset:6144
    ds_read_b64_tr_b16 v[64:65], v9 offset:8192
    ds_read_b64_tr_b16 v[66:67], v9 offset:9216
    ds_read_b64_tr_b16 v[68:69], v10 offset:8192
    ds_read_b64_tr_b16 v[70:71], v10 offset:9216
    ds_read_b64_tr_b16 v[72:73], v11 offset:8192
    ds_read_b64_tr_b16 v[74:75], v11 offset:9216
    ds_read_b64_tr_b16 v[76:77], v12 offset:8192
    ds_read_b64_tr_b16 v[78:79], v12 offset:9216
    s_waitcnt lgkmcnt(12)
    v_mfma_f32_16x16x32_bf16 v[80:83], v[48:51], v[16:19], v[80:83]
    v_mfma_f32_16x16x32_bf16 v[84:87], v[52:55], v[16:19], v[84:87]
    v_mfma_f32_16x16x32_bf16 v[88:91], v[56:59], v[16:19], v[88:91]
    v_mfma_f32_16x16x32_bf16 v[92:95], v[60:63], v[16:19], v[92:95]
    v_mfma_f32_16x16x32_bf16 v[96:99], v[48:51], v[20:23], v[96:99]
    v_mfma_f32_16x16x32_bf16 v[100:103], v[52:55], v[20:23], v[100:103]
    v_mfma_f32_16x16x32_bf16 v[104:107], v[56:59], v[20:23], v[104:107]
    v_mfma_f32_16x16x32_bf16 v[108:111], v[60:63], v[20:23], v[108:111]
    v_mfma_f32_16x16x32_bf16 v[112:115], v[48:51], v[24:27], v[112:115]
    v_mfma_f32_16x16x32_bf16 v[116:119], v[52:55], v[24:27], v[116:119]
    v_mfma_f32_16x16x32_bf16 v[120:123], v[56:59], v[24:27], v[120:123]
    v_mfma_f32_16x16x32_bf16 v[124:127], v[60:63], v[24:27], v[124:127]
    v_mfma_f32_16x16x32_bf16 v[128:131], v[48:51], v[28:31], v[128:131]
    v_mfma_f32_16x16x32_bf16 v[132:135], v[52:55], v[28:31], v[132:135]
    v_mfma_f32_16x16x32_bf16 v[136:139], v[56:59], v[28:31], v[136:139]
    v_mfma_f32_16x16x32_bf16 v[140:143], v[60:63], v[28:31], v[140:143]
    s_waitcnt lgkmcnt(0)
    s_barrier
    v_add_u32 v8, 98304, v2
    v_add_u32 v9, 114688, v4
    v_add_u32 v10, 114688, v5
    v_add_u32 v11, 114688, v6
    v_add_u32 v12, 114688, v7
    ds_read_b128 v[16:19], v8 offset:0
    ds_read_b128 v[20:23], v8 offset:2048
    ds_read_b128 v[24:27], v8 offset:4096
    ds_read_b128 v[28:31], v8 offset:6144
    ds_read_b64_tr_b16 v[48:49], v9 offset:0
    ds_read_b64_tr_b16 v[50:51], v9 offset:1024
    ds_read_b64_tr_b16 v[52:53], v10 offset:0
    ds_read_b64_tr_b16 v[54:55], v10 offset:1024
    ds_read_b64_tr_b16 v[56:57], v11 offset:0
    ds_read_b64_tr_b16 v[58:59], v11 offset:1024
    ds_read_b64_tr_b16 v[60:61], v12 offset:0
    ds_read_b64_tr_b16 v[62:63], v12 offset:1024
    v_mfma_f32_16x16x32_bf16 v[80:83], v[64:67], v[32:35], v[80:83]
    v_mfma_f32_16x16x32_bf16 v[84:87], v[68:71], v[32:35], v[84:87]
    v_mfma_f32_16x16x32_bf16 v[88:91], v[72:75], v[32:35], v[88:91]
    v_mfma_f32_16x16x32_bf16 v[92:95], v[76:79], v[32:35], v[92:95]
    v_mfma_f32_16x16x32_bf16 v[96:99], v[64:67], v[36:39], v[96:99]
    v_mfma_f32_16x16x32_bf16 v[100:103], v[68:71], v[36:39], v[100:103]
    v_mfma_f32_16x16x32_bf16 v[104:107], v[72:75], v[36:39], v[104:107]
    v_mfma_f32_16x16x32_bf16 v[108:111], v[76:79], v[36:39], v[108:111]
    v_mfma_f32_16x16x32_bf16 v[112:115], v[64:67], v[40:43], v[112:115]
    v_mfma_f32_16x16x32_bf16 v[116:119], v[68:71], v[40:43], v[116:119]
    v_mfma_f32_16x16x32_bf16 v[120:123], v[72:75], v[40:43], v[120:123]
    v_mfma_f32_16x16x32_bf16 v[124:127], v[76:79], v[40:43], v[124:127]
    v_mfma_f32_16x16x32_bf16 v[128:131], v[64:67], v[44:47], v[128:131]
    v_mfma_f32_16x16x32_bf16 v[132:135], v[68:71], v[44:47], v[132:135]
    v_mfma_f32_16x16x32_bf16 v[136:139], v[72:75], v[44:47], v[136:139]
    v_mfma_f32_16x16x32_bf16 v[140:143], v[76:79], v[44:47], v[140:143]
    v_add_u32 v8, 98304, v3
    v_add_u32 v9, 114688, v4
    v_add_u32 v10, 114688, v5
    v_add_u32 v11, 114688, v6
    v_add_u32 v12, 114688, v7
    ds_read_b128 v[32:35], v8 offset:0
    ds_read_b128 v[36:39], v8 offset:2048
    ds_read_b128 v[40:43], v8 offset:4096
    ds_read_b128 v[44:47], v8 offset:6144
    ds_read_b64_tr_b16 v[64:65], v9 offset:8192
    ds_read_b64_tr_b16 v[66:67], v9 offset:9216
    ds_read_b64_tr_b16 v[68:69], v10 offset:8192
    ds_read_b64_tr_b16 v[70:71], v10 offset:9216
    ds_read_b64_tr_b16 v[72:73], v11 offset:8192
    ds_read_b64_tr_b16 v[74:75], v11 offset:9216
    ds_read_b64_tr_b16 v[76:77], v12 offset:8192
    ds_read_b64_tr_b16 v[78:79], v12 offset:9216
    s_waitcnt lgkmcnt(12)
    v_mfma_f32_16x16x32_bf16 v[80:83], v[48:51], v[16:19], v[80:83]
    v_mfma_f32_16x16x32_bf16 v[84:87], v[52:55], v[16:19], v[84:87]
    v_mfma_f32_16x16x32_bf16 v[88:91], v[56:59], v[16:19], v[88:91]
    v_mfma_f32_16x16x32_bf16 v[92:95], v[60:63], v[16:19], v[92:95]
    v_mfma_f32_16x16x32_bf16 v[96:99], v[48:51], v[20:23], v[96:99]
    v_mfma_f32_16x16x32_bf16 v[100:103], v[52:55], v[20:23], v[100:103]
    v_mfma_f32_16x16x32_bf16 v[104:107], v[56:59], v[20:23], v[104:107]
    v_mfma_f32_16x16x32_bf16 v[108:111], v[60:63], v[20:23], v[108:111]
    v_mfma_f32_16x16x32_bf16 v[112:115], v[48:51], v[24:27], v[112:115]
    v_mfma_f32_16x16x32_bf16 v[116:119], v[52:55], v[24:27], v[116:119]
    v_mfma_f32_16x16x32_bf16 v[120:123], v[56:59], v[24:27], v[120:123]
    v_mfma_f32_16x16x32_bf16 v[124:127], v[60:63], v[24:27], v[124:127]
    v_mfma_f32_16x16x32_bf16 v[128:131], v[48:51], v[28:31], v[128:131]
    v_mfma_f32_16x16x32_bf16 v[132:135], v[52:55], v[28:31], v[132:135]
    v_mfma_f32_16x16x32_bf16 v[136:139], v[56:59], v[28:31], v[136:139]
    v_mfma_f32_16x16x32_bf16 v[140:143], v[60:63], v[28:31], v[140:143]
    s_waitcnt lgkmcnt(0)
    s_barrier
    v_add_u32 v8, 0, v2
    v_add_u32 v9, 16384, v4
    v_add_u32 v10, 16384, v5
    v_add_u32 v11, 16384, v6
    v_add_u32 v12, 16384, v7
    ds_read_b128 v[16:19], v8 offset:0
    ds_read_b128 v[20:23], v8 offset:2048
    ds_read_b128 v[24:27], v8 offset:4096
    ds_read_b128 v[28:31], v8 offset:6144
    ds_read_b64_tr_b16 v[48:49], v9 offset:0
    ds_read_b64_tr_b16 v[50:51], v9 offset:1024
    ds_read_b64_tr_b16 v[52:53], v10 offset:0
    ds_read_b64_tr_b16 v[54:55], v10 offset:1024
    ds_read_b64_tr_b16 v[56:57], v11 offset:0
    ds_read_b64_tr_b16 v[58:59], v11 offset:1024
    ds_read_b64_tr_b16 v[60:61], v12 offset:0
    ds_read_b64_tr_b16 v[62:63], v12 offset:1024
    v_mfma_f32_16x16x32_bf16 v[80:83], v[64:67], v[32:35], v[80:83]
    v_mfma_f32_16x16x32_bf16 v[84:87], v[68:71], v[32:35], v[84:87]
    v_mfma_f32_16x16x32_bf16 v[88:91], v[72:75], v[32:35], v[88:91]
    v_mfma_f32_16x16x32_bf16 v[92:95], v[76:79], v[32:35], v[92:95]
    v_mfma_f32_16x16x32_bf16 v[96:99], v[64:67], v[36:39], v[96:99]
    v_mfma_f32_16x16x32_bf16 v[100:103], v[68:71], v[36:39], v[100:103]
    v_mfma_f32_16x16x32_bf16 v[104:107], v[72:75], v[36:39], v[104:107]
    v_mfma_f32_16x16x32_bf16 v[108:111], v[76:79], v[36:39], v[108:111]
    v_mfma_f32_16x16x32_bf16 v[112:115], v[64:67], v[40:43], v[112:115]
    v_mfma_f32_16x16x32_bf16 v[116:119], v[68:71], v[40:43], v[116:119]
    v_mfma_f32_16x16x32_bf16 v[120:123], v[72:75], v[40:43], v[120:123]
    v_mfma_f32_16x16x32_bf16 v[124:127], v[76:79], v[40:43], v[124:127]
    v_mfma_f32_16x16x32_bf16 v[128:131], v[64:67], v[44:47], v[128:131]
    v_mfma_f32_16x16x32_bf16 v[132:135], v[68:71], v[44:47], v[132:135]
    v_mfma_f32_16x16x32_bf16 v[136:139], v[72:75], v[44:47], v[136:139]
    v_mfma_f32_16x16x32_bf16 v[140:143], v[76:79], v[44:47], v[140:143]
    v_add_u32 v8, 0, v3
    v_add_u32 v9, 16384, v4
    v_add_u32 v10, 16384, v5
    v_add_u32 v11, 16384, v6
    v_add_u32 v12, 16384, v7
    ds_read_b128 v[32:35], v8 offset:0
    ds_read_b128 v[36:39], v8 offset:2048
    ds_read_b128 v[40:43], v8 offset:4096
    ds_read_b128 v[44:47], v8 offset:6144
    ds_read_b64_tr_b16 v[64:65], v9 offset:8192
    ds_read_b64_tr_b16 v[66:67], v9 offset:9216
    ds_read_b64_tr_b16 v[68:69], v10 offset:8192
    ds_read_b64_tr_b16 v[70:71], v10 offset:9216
    ds_read_b64_tr_b16 v[72:73], v11 offset:8192
    ds_read_b64_tr_b16 v[74:75], v11 offset:9216
    ds_read_b64_tr_b16 v[76:77], v12 offset:8192
    ds_read_b64_tr_b16 v[78:79], v12 offset:9216
    s_waitcnt lgkmcnt(12)
    v_mfma_f32_16x16x32_bf16 v[80:83], v[48:51], v[16:19], v[80:83]
    v_mfma_f32_16x16x32_bf16 v[84:87], v[52:55], v[16:19], v[84:87]
    v_mfma_f32_16x16x32_bf16 v[88:91], v[56:59], v[16:19], v[88:91]
    v_mfma_f32_16x16x32_bf16 v[92:95], v[60:63], v[16:19], v[92:95]
    v_mfma_f32_16x16x32_bf16 v[96:99], v[48:51], v[20:23], v[96:99]
    v_mfma_f32_16x16x32_bf16 v[100:103], v[52:55], v[20:23], v[100:103]
    v_mfma_f32_16x16x32_bf16 v[104:107], v[56:59], v[20:23], v[104:107]
    v_mfma_f32_16x16x32_bf16 v[108:111], v[60:63], v[20:23], v[108:111]
    v_mfma_f32_16x16x32_bf16 v[112:115], v[48:51], v[24:27], v[112:115]
    v_mfma_f32_16x16x32_bf16 v[116:119], v[52:55], v[24:27], v[116:119]
    v_mfma_f32_16x16x32_bf16 v[120:123], v[56:59], v[24:27], v[120:123]
    v_mfma_f32_16x16x32_bf16 v[124:127], v[60:63], v[24:27], v[124:127]
    v_mfma_f32_16x16x32_bf16 v[128:131], v[48:51], v[28:31], v[128:131]
    v_mfma_f32_16x16x32_bf16 v[132:135], v[52:55], v[28:31], v[132:135]
    v_mfma_f32_16x16x32_bf16 v[136:139], v[56:59], v[28:31], v[136:139]
    v_mfma_f32_16x16x32_bf16 v[140:143], v[60:63], v[28:31], v[140:143]
    s_waitcnt lgkmcnt(0)
    s_barrier
    v_add_u32 v8, 32768, v2
    v_add_u32 v9, 49152, v4
    v_add_u32 v10, 49152, v5
    v_add_u32 v11, 49152, v6
    v_add_u32 v12, 49152, v7
    ds_read_b128 v[16:19], v8 offset:0
    ds_read_b128 v[20:23], v8 offset:2048
    ds_read_b128 v[24:27], v8 offset:4096
    ds_read_b128 v[28:31], v8 offset:6144
    ds_read_b64_tr_b16 v[48:49], v9 offset:0
    ds_read_b64_tr_b16 v[50:51], v9 offset:1024
    ds_read_b64_tr_b16 v[52:53], v10 offset:0
    ds_read_b64_tr_b16 v[54:55], v10 offset:1024
    ds_read_b64_tr_b16 v[56:57], v11 offset:0
    ds_read_b64_tr_b16 v[58:59], v11 offset:1024
    ds_read_b64_tr_b16 v[60:61], v12 offset:0
    ds_read_b64_tr_b16 v[62:63], v12 offset:1024
    v_mfma_f32_16x16x32_bf16 v[80:83], v[64:67], v[32:35], v[80:83]
    v_mfma_f32_16x16x32_bf16 v[84:87], v[68:71], v[32:35], v[84:87]
    v_mfma_f32_16x16x32_bf16 v[88:91], v[72:75], v[32:35], v[88:91]
    v_mfma_f32_16x16x32_bf16 v[92:95], v[76:79], v[32:35], v[92:95]
    v_mfma_f32_16x16x32_bf16 v[96:99], v[64:67], v[36:39], v[96:99]
    v_mfma_f32_16x16x32_bf16 v[100:103], v[68:71], v[36:39], v[100:103]
    v_mfma_f32_16x16x32_bf16 v[104:107], v[72:75], v[36:39], v[104:107]
    v_mfma_f32_16x16x32_bf16 v[108:111], v[76:79], v[36:39], v[108:111]
    v_mfma_f32_16x16x32_bf16 v[112:115], v[64:67], v[40:43], v[112:115]
    v_mfma_f32_16x16x32_bf16 v[116:119], v[68:71], v[40:43], v[116:119]
    v_mfma_f32_16x16x32_bf16 v[120:123], v[72:75], v[40:43], v[120:123]
    v_mfma_f32_16x16x32_bf16 v[124:127], v[76:79], v[40:43], v[124:127]
    v_mfma_f32_16x16x32_bf16 v[128:131], v[64:67], v[44:47], v[128:131]
    v_mfma_f32_16x16x32_bf16 v[132:135], v[68:71], v[44:47], v[132:135]
    v_mfma_f32_16x16x32_bf16 v[136:139], v[72:75], v[44:47], v[136:139]
    v_mfma_f32_16x16x32_bf16 v[140:143], v[76:79], v[44:47], v[140:143]
    v_add_u32 v8, 32768, v3
    v_add_u32 v9, 49152, v4
    v_add_u32 v10, 49152, v5
    v_add_u32 v11, 49152, v6
    v_add_u32 v12, 49152, v7
    ds_read_b128 v[32:35], v8 offset:0
    ds_read_b128 v[36:39], v8 offset:2048
    ds_read_b128 v[40:43], v8 offset:4096
    ds_read_b128 v[44:47], v8 offset:6144
    ds_read_b64_tr_b16 v[64:65], v9 offset:8192
    ds_read_b64_tr_b16 v[66:67], v9 offset:9216
    ds_read_b64_tr_b16 v[68:69], v10 offset:8192
    ds_read_b64_tr_b16 v[70:71], v10 offset:9216
    ds_read_b64_tr_b16 v[72:73], v11 offset:8192
    ds_read_b64_tr_b16 v[74:75], v11 offset:9216
    ds_read_b64_tr_b16 v[76:77], v12 offset:8192
    ds_read_b64_tr_b16 v[78:79], v12 offset:9216
    s_waitcnt lgkmcnt(12)
    v_mfma_f32_16x16x32_bf16 v[80:83], v[48:51], v[16:19], v[80:83]
    v_mfma_f32_16x16x32_bf16 v[84:87], v[52:55], v[16:19], v[84:87]
    v_mfma_f32_16x16x32_bf16 v[88:91], v[56:59], v[16:19], v[88:91]
    v_mfma_f32_16x16x32_bf16 v[92:95], v[60:63], v[16:19], v[92:95]
    v_mfma_f32_16x16x32_bf16 v[96:99], v[48:51], v[20:23], v[96:99]
    v_mfma_f32_16x16x32_bf16 v[100:103], v[52:55], v[20:23], v[100:103]
    v_mfma_f32_16x16x32_bf16 v[104:107], v[56:59], v[20:23], v[104:107]
    v_mfma_f32_16x16x32_bf16 v[108:111], v[60:63], v[20:23], v[108:111]
    v_mfma_f32_16x16x32_bf16 v[112:115], v[48:51], v[24:27], v[112:115]
    v_mfma_f32_16x16x32_bf16 v[116:119], v[52:55], v[24:27], v[116:119]
    v_mfma_f32_16x16x32_bf16 v[120:123], v[56:59], v[24:27], v[120:123]
    v_mfma_f32_16x16x32_bf16 v[124:127], v[60:63], v[24:27], v[124:127]
    v_mfma_f32_16x16x32_bf16 v[128:131], v[48:51], v[28:31], v[128:131]
    v_mfma_f32_16x16x32_bf16 v[132:135], v[52:55], v[28:31], v[132:135]
    v_mfma_f32_16x16x32_bf16 v[136:139], v[56:59], v[28:31], v[136:139]
    v_mfma_f32_16x16x32_bf16 v[140:143], v[60:63], v[28:31], v[140:143]
    s_waitcnt lgkmcnt(0)
    v_mfma_f32_16x16x32_bf16 v[80:83], v[64:67], v[32:35], v[80:83]
    v_mfma_f32_16x16x32_bf16 v[84:87], v[68:71], v[32:35], v[84:87]
    v_mfma_f32_16x16x32_bf16 v[88:91], v[72:75], v[32:35], v[88:91]
    v_mfma_f32_16x16x32_bf16 v[92:95], v[76:79], v[32:35], v[92:95]
    v_mfma_f32_16x16x32_bf16 v[96:99], v[64:67], v[36:39], v[96:99]
    v_mfma_f32_16x16x32_bf16 v[100:103], v[68:71], v[36:39], v[100:103]
    v_mfma_f32_16x16x32_bf16 v[104:107], v[72:75], v[36:39], v[104:107]
    v_mfma_f32_16x16x32_bf16 v[108:111], v[76:79], v[36:39], v[108:111]
    v_mfma_f32_16x16x32_bf16 v[112:115], v[64:67], v[40:43], v[112:115]
    v_mfma_f32_16x16x32_bf16 v[116:119], v[68:71], v[40:43], v[116:119]
    v_mfma_f32_16x16x32_bf16 v[120:123], v[72:75], v[40:43], v[120:123]
    v_mfma_f32_16x16x32_bf16 v[124:127], v[76:79], v[40:43], v[124:127]
    v_mfma_f32_16x16x32_bf16 v[128:131], v[64:67], v[44:47], v[128:131]
    v_mfma_f32_16x16x32_bf16 v[132:135], v[68:71], v[44:47], v[132:135]
    v_mfma_f32_16x16x32_bf16 v[136:139], v[72:75], v[44:47], v[136:139]
    v_mfma_f32_16x16x32_bf16 v[140:143], v[76:79], v[44:47], v[140:143]
    s_nop 15
    s_branch k1n_kernel_epi
k1n_kernel_nm:
    v_subrev_u32 v2, 256, v0
    v_lshrrev_b32 v3, 3, v2
    v_and_b32 v4, 7, v2
    v_add_u32 v5, s24, v3
    s_mov_b32 s30, 1280
    v_mul_lo_u32 v5, v5, s30
    v_lshl_add_u32 v5, v4, 4, v5
    v_add_u32 v6, 40960, v5
    v_add_u32 v7, 81920, v5
    v_add_u32 v8, 122880, v5
    v_lshrrev_b32 v9, 1, v3
    v_and_b32 v9, 7, v9
    v_xor_b32 v9, v9, v4
    v_lshlrev_b32 v9, 4, v9
    v_lshl_add_u32 v9, v3, 7, v9
    v_add_u32 v10, s24, v3
    v_lshlrev_b32 v10, 3, v10
    buffer_load_dwordx2 v[16:17], v10, s[48:51], 0 offen offset:0
    buffer_load_dwordx2 v[18:19], v10, s[48:51], 0 offen offset:256
    buffer_load_dwordx2 v[20:21], v10, s[48:51], 0 offen offset:512
    buffer_load_dwordx2 v[22:23], v10, s[48:51], 0 offen offset:768
    buffer_load_dwordx4 v[32:35], v5, s[8:11], 0 offen offset:0
    buffer_load_dwordx4 v[36:39], v6, s[8:11], 0 offen offset:0
    buffer_load_dwordx4 v[40:43], v7, s[8:11], 0 offen offset:0
    buffer_load_dwordx4 v[44:47], v8, s[8:11], 0 offen offset:0
    buffer_load_dwordx4 v[48:51], v5, s[8:11], 0 offen offset:128
    buffer_load_dwordx4 v[52:55], v6, s[8:11], 0 offen offset:128
    buffer_load_dwordx4 v[56:59], v7, s[8:11], 0 offen offset:128
    buffer_load_dwordx4 v[60:63], v8, s[8:11], 0 offen offset:128
    s_waitcnt lgkmcnt(0)
    s_waitcnt vmcnt(4)
    v_lshlrev_b32 v11, 16, v32
    v_and_b32 v12, 0xffff0000, v32
    v_sub_f32 v11, v11, v16
    v_sub_f32 v12, v12, v16
    v_cvt_pk_bf16_f32 v13, v11, v12
    v_lshlrev_b32 v11, 16, v13
    v_and_b32 v12, 0xffff0000, v13
    v_mul_f32 v11, v11, v17
    v_mul_f32 v12, v12, v17
    v_cvt_pk_bf16_f32 v32, v11, v12
    v_lshlrev_b32 v11, 16, v33
    v_and_b32 v12, 0xffff0000, v33
    v_sub_f32 v11, v11, v16
    v_sub_f32 v12, v12, v16
    v_cvt_pk_bf16_f32 v13, v11, v12
    v_lshlrev_b32 v11, 16, v13
    v_and_b32 v12, 0xffff0000, v13
    v_mul_f32 v11, v11, v17
    v_mul_f32 v12, v12, v17
    v_cvt_pk_bf16_f32 v33, v11, v12
    v_lshlrev_b32 v11, 16, v34
    v_and_b32 v12, 0xffff0000, v34
    v_sub_f32 v11, v11, v16
    v_sub_f32 v12, v12, v16
    v_cvt_pk_bf16_f32 v13, v11, v12
    v_lshlrev_b32 v11, 16, v13
    v_and_b32 v12, 0xffff0000, v13
    v_mul_f32 v11, v11, v17
    v_mul_f32 v12, v12, v17
    v_cvt_pk_bf16_f32 v34, v11, v12
    v_lshlrev_b32 v11, 16, v35
    v_and_b32 v12, 0xffff0000, v35
    v_sub_f32 v11, v11, v16
    v_sub_f32 v12, v12, v16
    v_cvt_pk_bf16_f32 v13, v11, v12
    v_lshlrev_b32 v11, 16, v13
    v_and_b32 v12, 0xffff0000, v13
    v_mul_f32 v11, v11, v17
    v_mul_f32 v12, v12, v17
    v_cvt_pk_bf16_f32 v35, v11, v12
    v_add_u32 v14, 0, v9
    ds_write_b128 v14, v[32:35]
    v_lshlrev_b32 v11, 16, v36
    v_and_b32 v12, 0xffff0000, v36
    v_sub_f32 v11, v11, v18
    v_sub_f32 v12, v12, v18
    v_cvt_pk_bf16_f32 v13, v11, v12
    v_lshlrev_b32 v11, 16, v13
    v_and_b32 v12, 0xffff0000, v13
    v_mul_f32 v11, v11, v19
    v_mul_f32 v12, v12, v19
    v_cvt_pk_bf16_f32 v36, v11, v12
    v_lshlrev_b32 v11, 16, v37
    v_and_b32 v12, 0xffff0000, v37
    v_sub_f32 v11, v11, v18
    v_sub_f32 v12, v12, v18
    v_cvt_pk_bf16_f32 v13, v11, v12
    v_lshlrev_b32 v11, 16, v13
    v_and_b32 v12, 0xffff0000, v13
    v_mul_f32 v11, v11, v19
    v_mul_f32 v12, v12, v19
    v_cvt_pk_bf16_f32 v37, v11, v12
    v_lshlrev_b32 v11, 16, v38
    v_and_b32 v12, 0xffff0000, v38
    v_sub_f32 v11, v11, v18
    v_sub_f32 v12, v12, v18
    v_cvt_pk_bf16_f32 v13, v11, v12
    v_lshlrev_b32 v11, 16, v13
    v_and_b32 v12, 0xffff0000, v13
    v_mul_f32 v11, v11, v19
    v_mul_f32 v12, v12, v19
    v_cvt_pk_bf16_f32 v38, v11, v12
    v_lshlrev_b32 v11, 16, v39
    v_and_b32 v12, 0xffff0000, v39
    v_sub_f32 v11, v11, v18
    v_sub_f32 v12, v12, v18
    v_cvt_pk_bf16_f32 v13, v11, v12
    v_lshlrev_b32 v11, 16, v13
    v_and_b32 v12, 0xffff0000, v13
    v_mul_f32 v11, v11, v19
    v_mul_f32 v12, v12, v19
    v_cvt_pk_bf16_f32 v39, v11, v12
    v_add_u32 v14, 4096, v9
    ds_write_b128 v14, v[36:39]
    v_lshlrev_b32 v11, 16, v40
    v_and_b32 v12, 0xffff0000, v40
    v_sub_f32 v11, v11, v20
    v_sub_f32 v12, v12, v20
    v_cvt_pk_bf16_f32 v13, v11, v12
    v_lshlrev_b32 v11, 16, v13
    v_and_b32 v12, 0xffff0000, v13
    v_mul_f32 v11, v11, v21
    v_mul_f32 v12, v12, v21
    v_cvt_pk_bf16_f32 v40, v11, v12
    v_lshlrev_b32 v11, 16, v41
    v_and_b32 v12, 0xffff0000, v41
    v_sub_f32 v11, v11, v20
    v_sub_f32 v12, v12, v20
    v_cvt_pk_bf16_f32 v13, v11, v12
    v_lshlrev_b32 v11, 16, v13
    v_and_b32 v12, 0xffff0000, v13
    v_mul_f32 v11, v11, v21
    v_mul_f32 v12, v12, v21
    v_cvt_pk_bf16_f32 v41, v11, v12
    v_lshlrev_b32 v11, 16, v42
    v_and_b32 v12, 0xffff0000, v42
    v_sub_f32 v11, v11, v20
    v_sub_f32 v12, v12, v20
    v_cvt_pk_bf16_f32 v13, v11, v12
    v_lshlrev_b32 v11, 16, v13
    v_and_b32 v12, 0xffff0000, v13
    v_mul_f32 v11, v11, v21
    v_mul_f32 v12, v12, v21
    v_cvt_pk_bf16_f32 v42, v11, v12
    v_lshlrev_b32 v11, 16, v43
    v_and_b32 v12, 0xffff0000, v43
    v_sub_f32 v11, v11, v20
    v_sub_f32 v12, v12, v20
    v_cvt_pk_bf16_f32 v13, v11, v12
    v_lshlrev_b32 v11, 16, v13
    v_and_b32 v12, 0xffff0000, v13
    v_mul_f32 v11, v11, v21
    v_mul_f32 v12, v12, v21
    v_cvt_pk_bf16_f32 v43, v11, v12
    v_add_u32 v14, 8192, v9
    ds_write_b128 v14, v[40:43]
    v_lshlrev_b32 v11, 16, v44
    v_and_b32 v12, 0xffff0000, v44
    v_sub_f32 v11, v11, v22
    v_sub_f32 v12, v12, v22
    v_cvt_pk_bf16_f32 v13, v11, v12
    v_lshlrev_b32 v11, 16, v13
    v_and_b32 v12, 0xffff0000, v13
    v_mul_f32 v11, v11, v23
    v_mul_f32 v12, v12, v23
    v_cvt_pk_bf16_f32 v44, v11, v12
    v_lshlrev_b32 v11, 16, v45
    v_and_b32 v12, 0xffff0000, v45
    v_sub_f32 v11, v11, v22
    v_sub_f32 v12, v12, v22
    v_cvt_pk_bf16_f32 v13, v11, v12
    v_lshlrev_b32 v11, 16, v13
    v_and_b32 v12, 0xffff0000, v13
    v_mul_f32 v11, v11, v23
    v_mul_f32 v12, v12, v23
    v_cvt_pk_bf16_f32 v45, v11, v12
    v_lshlrev_b32 v11, 16, v46
    v_and_b32 v12, 0xffff0000, v46
    v_sub_f32 v11, v11, v22
    v_sub_f32 v12, v12, v22
    v_cvt_pk_bf16_f32 v13, v11, v12
    v_lshlrev_b32 v11, 16, v13
    v_and_b32 v12, 0xffff0000, v13
    v_mul_f32 v11, v11, v23
    v_mul_f32 v12, v12, v23
    v_cvt_pk_bf16_f32 v46, v11, v12
    v_lshlrev_b32 v11, 16, v47
    v_and_b32 v12, 0xffff0000, v47
    v_sub_f32 v11, v11, v22
    v_sub_f32 v12, v12, v22
    v_cvt_pk_bf16_f32 v13, v11, v12
    v_lshlrev_b32 v11, 16, v13
    v_and_b32 v12, 0xffff0000, v13
    v_mul_f32 v11, v11, v23
    v_mul_f32 v12, v12, v23
    v_cvt_pk_bf16_f32 v47, v11, v12
    v_add_u32 v14, 12288, v9
    ds_write_b128 v14, v[44:47]
    s_waitcnt lgkmcnt(0)
    buffer_load_dwordx4 v[32:35], v5, s[8:11], 0 offen offset:256
    buffer_load_dwordx4 v[36:39], v6, s[8:11], 0 offen offset:256
    buffer_load_dwordx4 v[40:43], v7, s[8:11], 0 offen offset:256
    buffer_load_dwordx4 v[44:47], v8, s[8:11], 0 offen offset:256
    s_waitcnt vmcnt(4)
    v_lshlrev_b32 v11, 16, v48
    v_and_b32 v12, 0xffff0000, v48
    v_sub_f32 v11, v11, v16
    v_sub_f32 v12, v12, v16
    v_cvt_pk_bf16_f32 v13, v11, v12
    v_lshlrev_b32 v11, 16, v13
    v_and_b32 v12, 0xffff0000, v13
    v_mul_f32 v11, v11, v17
    v_mul_f32 v12, v12, v17
    v_cvt_pk_bf16_f32 v48, v11, v12
    v_lshlrev_b32 v11, 16, v49
    v_and_b32 v12, 0xffff0000, v49
    v_sub_f32 v11, v11, v16
    v_sub_f32 v12, v12, v16
    v_cvt_pk_bf16_f32 v13, v11, v12
    v_lshlrev_b32 v11, 16, v13
    v_and_b32 v12, 0xffff0000, v13
    v_mul_f32 v11, v11, v17
    v_mul_f32 v12, v12, v17
    v_cvt_pk_bf16_f32 v49, v11, v12
    v_lshlrev_b32 v11, 16, v50
    v_and_b32 v12, 0xffff0000, v50
    v_sub_f32 v11, v11, v16
    v_sub_f32 v12, v12, v16
    v_cvt_pk_bf16_f32 v13, v11, v12
    v_lshlrev_b32 v11, 16, v13
    v_and_b32 v12, 0xffff0000, v13
    v_mul_f32 v11, v11, v17
    v_mul_f32 v12, v12, v17
    v_cvt_pk_bf16_f32 v50, v11, v12
    v_lshlrev_b32 v11, 16, v51
    v_and_b32 v12, 0xffff0000, v51
    v_sub_f32 v11, v11, v16
    v_sub_f32 v12, v12, v16
    v_cvt_pk_bf16_f32 v13, v11, v12
    v_lshlrev_b32 v11, 16, v13
    v_and_b32 v12, 0xffff0000, v13
    v_mul_f32 v11, v11, v17
    v_mul_f32 v12, v12, v17
    v_cvt_pk_bf16_f32 v51, v11, v12
    v_add_u32 v14, 32768, v9
    ds_write_b128 v14, v[48:51]
    v_lshlrev_b32 v11, 16, v52
    v_and_b32 v12, 0xffff0000, v52
    v_sub_f32 v11, v11, v18
    v_sub_f32 v12, v12, v18
    v_cvt_pk_bf16_f32 v13, v11, v12
    v_lshlrev_b32 v11, 16, v13
    v_and_b32 v12, 0xffff0000, v13
    v_mul_f32 v11, v11, v19
    v_mul_f32 v12, v12, v19
    v_cvt_pk_bf16_f32 v52, v11, v12
    v_lshlrev_b32 v11, 16, v53
    v_and_b32 v12, 0xffff0000, v53
    v_sub_f32 v11, v11, v18
    v_sub_f32 v12, v12, v18
    v_cvt_pk_bf16_f32 v13, v11, v12
    v_lshlrev_b32 v11, 16, v13
    v_and_b32 v12, 0xffff0000, v13
    v_mul_f32 v11, v11, v19
    v_mul_f32 v12, v12, v19
    v_cvt_pk_bf16_f32 v53, v11, v12
    v_lshlrev_b32 v11, 16, v54
    v_and_b32 v12, 0xffff0000, v54
    v_sub_f32 v11, v11, v18
    v_sub_f32 v12, v12, v18
    v_cvt_pk_bf16_f32 v13, v11, v12
    v_lshlrev_b32 v11, 16, v13
    v_and_b32 v12, 0xffff0000, v13
    v_mul_f32 v11, v11, v19
    v_mul_f32 v12, v12, v19
    v_cvt_pk_bf16_f32 v54, v11, v12
    v_lshlrev_b32 v11, 16, v55
    v_and_b32 v12, 0xffff0000, v55
    v_sub_f32 v11, v11, v18
    v_sub_f32 v12, v12, v18
    v_cvt_pk_bf16_f32 v13, v11, v12
    v_lshlrev_b32 v11, 16, v13
    v_and_b32 v12, 0xffff0000, v13
    v_mul_f32 v11, v11, v19
    v_mul_f32 v12, v12, v19
    v_cvt_pk_bf16_f32 v55, v11, v12
    v_add_u32 v14, 36864, v9
    ds_write_b128 v14, v[52:55]
    v_lshlrev_b32 v11, 16, v56
    v_and_b32 v12, 0xffff0000, v56
    v_sub_f32 v11, v11, v20
    v_sub_f32 v12, v12, v20
    v_cvt_pk_bf16_f32 v13, v11, v12
    v_lshlrev_b32 v11, 16, v13
    v_and_b32 v12, 0xffff0000, v13
    v_mul_f32 v11, v11, v21
    v_mul_f32 v12, v12, v21
    v_cvt_pk_bf16_f32 v56, v11, v12
    v_lshlrev_b32 v11, 16, v57
    v_and_b32 v12, 0xffff0000, v57
    v_sub_f32 v11, v11, v20
    v_sub_f32 v12, v12, v20
    v_cvt_pk_bf16_f32 v13, v11, v12
    v_lshlrev_b32 v11, 16, v13
    v_and_b32 v12, 0xffff0000, v13
    v_mul_f32 v11, v11, v21
    v_mul_f32 v12, v12, v21
    v_cvt_pk_bf16_f32 v57, v11, v12
    v_lshlrev_b32 v11, 16, v58
    v_and_b32 v12, 0xffff0000, v58
    v_sub_f32 v11, v11, v20
    v_sub_f32 v12, v12, v20
    v_cvt_pk_bf16_f32 v13, v11, v12
    v_lshlrev_b32 v11, 16, v13
    v_and_b32 v12, 0xffff0000, v13
    v_mul_f32 v11, v11, v21
    v_mul_f32 v12, v12, v21
    v_cvt_pk_bf16_f32 v58, v11, v12
    v_lshlrev_b32 v11, 16, v59
    v_and_b32 v12, 0xffff0000, v59
    v_sub_f32 v11, v11, v20
    v_sub_f32 v12, v12, v20
    v_cvt_pk_bf16_f32 v13, v11, v12
    v_lshlrev_b32 v11, 16, v13
    v_and_b32 v12, 0xffff0000, v13
    v_mul_f32 v11, v11, v21
    v_mul_f32 v12, v12, v21
    v_cvt_pk_bf16_f32 v59, v11, v12
    v_add_u32 v14, 40960, v9
    ds_write_b128 v14, v[56:59]
    v_lshlrev_b32 v11, 16, v60
    v_and_b32 v12, 0xffff0000, v60
    v_sub_f32 v11, v11, v22
    v_sub_f32 v12, v12, v22
    v_cvt_pk_bf16_f32 v13, v11, v12
    v_lshlrev_b32 v11, 16, v13
    v_and_b32 v12, 0xffff0000, v13
    v_mul_f32 v11, v11, v23
    v_mul_f32 v12, v12, v23
    v_cvt_pk_bf16_f32 v60, v11, v12
    v_lshlrev_b32 v11, 16, v61
    v_and_b32 v12, 0xffff0000, v61
    v_sub_f32 v11, v11, v22
    v_sub_f32 v12, v12, v22
    v_cvt_pk_bf16_f32 v13, v11, v12
    v_lshlrev_b32 v11, 16, v13
    v_and_b32 v12, 0xffff0000, v13
    v_mul_f32 v11, v11, v23
    v_mul_f32 v12, v12, v23
    v_cvt_pk_bf16_f32 v61, v11, v12
    v_lshlrev_b32 v11, 16, v62
    v_and_b32 v12, 0xffff0000, v62
    v_sub_f32 v11, v11, v22
    v_sub_f32 v12, v12, v22
    v_cvt_pk_bf16_f32 v13, v11, v12
    v_lshlrev_b32 v11, 16, v13
    v_and_b32 v12, 0xffff0000, v13
    v_mul_f32 v11, v11, v23
    v_mul_f32 v12, v12, v23
    v_cvt_pk_bf16_f32 v62, v11, v12
    v_lshlrev_b32 v11, 16, v63
    v_and_b32 v12, 0xffff0000, v63
    v_sub_f32 v11, v11, v22
    v_sub_f32 v12, v12, v22
    v_cvt_pk_bf16_f32 v13, v11, v12
    v_lshlrev_b32 v11, 16, v13
    v_and_b32 v12, 0xffff0000, v13
    v_mul_f32 v11, v11, v23
    v_mul_f32 v12, v12, v23
    v_cvt_pk_bf16_f32 v63, v11, v12
    v_add_u32 v14, 45056, v9
    ds_write_b128 v14, v[60:63]
    s_waitcnt lgkmcnt(0)
    buffer_load_dwordx4 v[48:51], v5, s[8:11], 0 offen offset:384
    buffer_load_dwordx4 v[52:55], v6, s[8:11], 0 offen offset:384
    buffer_load_dwordx4 v[56:59], v7, s[8:11], 0 offen offset:384
    buffer_load_dwordx4 v[60:63], v8, s[8:11], 0 offen offset:384
    s_waitcnt vmcnt(4)
    v_lshlrev_b32 v11, 16, v32
    v_and_b32 v12, 0xffff0000, v32
    v_sub_f32 v11, v11, v16
    v_sub_f32 v12, v12, v16
    v_cvt_pk_bf16_f32 v13, v11, v12
    v_lshlrev_b32 v11, 16, v13
    v_and_b32 v12, 0xffff0000, v13
    v_mul_f32 v11, v11, v17
    v_mul_f32 v12, v12, v17
    v_cvt_pk_bf16_f32 v32, v11, v12
    v_lshlrev_b32 v11, 16, v33
    v_and_b32 v12, 0xffff0000, v33
    v_sub_f32 v11, v11, v16
    v_sub_f32 v12, v12, v16
    v_cvt_pk_bf16_f32 v13, v11, v12
    v_lshlrev_b32 v11, 16, v13
    v_and_b32 v12, 0xffff0000, v13
    v_mul_f32 v11, v11, v17
    v_mul_f32 v12, v12, v17
    v_cvt_pk_bf16_f32 v33, v11, v12
    v_lshlrev_b32 v11, 16, v34
    v_and_b32 v12, 0xffff0000, v34
    v_sub_f32 v11, v11, v16
    v_sub_f32 v12, v12, v16
    v_cvt_pk_bf16_f32 v13, v11, v12
    v_lshlrev_b32 v11, 16, v13
    v_and_b32 v12, 0xffff0000, v13
    v_mul_f32 v11, v11, v17
    v_mul_f32 v12, v12, v17
    v_cvt_pk_bf16_f32 v34, v11, v12
    v_lshlrev_b32 v11, 16, v35
    v_and_b32 v12, 0xffff0000, v35
    v_sub_f32 v11, v11, v16
    v_sub_f32 v12, v12, v16
    v_cvt_pk_bf16_f32 v13, v11, v12
    v_lshlrev_b32 v11, 16, v13
    v_and_b32 v12, 0xffff0000, v13
    v_mul_f32 v11, v11, v17
    v_mul_f32 v12, v12, v17
    v_cvt_pk_bf16_f32 v35, v11, v12
    v_add_u32 v14, 65536, v9
    ds_write_b128 v14, v[32:35]
    v_lshlrev_b32 v11, 16, v36
    v_and_b32 v12, 0xffff0000, v36
    v_sub_f32 v11, v11, v18
    v_sub_f32 v12, v12, v18
    v_cvt_pk_bf16_f32 v13, v11, v12
    v_lshlrev_b32 v11, 16, v13
    v_and_b32 v12, 0xffff0000, v13
    v_mul_f32 v11, v11, v19
    v_mul_f32 v12, v12, v19
    v_cvt_pk_bf16_f32 v36, v11, v12
    v_lshlrev_b32 v11, 16, v37
    v_and_b32 v12, 0xffff0000, v37
    v_sub_f32 v11, v11, v18
    v_sub_f32 v12, v12, v18
    v_cvt_pk_bf16_f32 v13, v11, v12
    v_lshlrev_b32 v11, 16, v13
    v_and_b32 v12, 0xffff0000, v13
    v_mul_f32 v11, v11, v19
    v_mul_f32 v12, v12, v19
    v_cvt_pk_bf16_f32 v37, v11, v12
    v_lshlrev_b32 v11, 16, v38
    v_and_b32 v12, 0xffff0000, v38
    v_sub_f32 v11, v11, v18
    v_sub_f32 v12, v12, v18
    v_cvt_pk_bf16_f32 v13, v11, v12
    v_lshlrev_b32 v11, 16, v13
    v_and_b32 v12, 0xffff0000, v13
    v_mul_f32 v11, v11, v19
    v_mul_f32 v12, v12, v19
    v_cvt_pk_bf16_f32 v38, v11, v12
    v_lshlrev_b32 v11, 16, v39
    v_and_b32 v12, 0xffff0000, v39
    v_sub_f32 v11, v11, v18
    v_sub_f32 v12, v12, v18
    v_cvt_pk_bf16_f32 v13, v11, v12
    v_lshlrev_b32 v11, 16, v13
    v_and_b32 v12, 0xffff0000, v13
    v_mul_f32 v11, v11, v19
    v_mul_f32 v12, v12, v19
    v_cvt_pk_bf16_f32 v39, v11, v12
    v_add_u32 v14, 69632, v9
    ds_write_b128 v14, v[36:39]
    v_lshlrev_b32 v11, 16, v40
    v_and_b32 v12, 0xffff0000, v40
    v_sub_f32 v11, v11, v20
    v_sub_f32 v12, v12, v20
    v_cvt_pk_bf16_f32 v13, v11, v12
    v_lshlrev_b32 v11, 16, v13
    v_and_b32 v12, 0xffff0000, v13
    v_mul_f32 v11, v11, v21
    v_mul_f32 v12, v12, v21
    v_cvt_pk_bf16_f32 v40, v11, v12
    v_lshlrev_b32 v11, 16, v41
    v_and_b32 v12, 0xffff0000, v41
    v_sub_f32 v11, v11, v20
    v_sub_f32 v12, v12, v20
    v_cvt_pk_bf16_f32 v13, v11, v12
    v_lshlrev_b32 v11, 16, v13
    v_and_b32 v12, 0xffff0000, v13
    v_mul_f32 v11, v11, v21
    v_mul_f32 v12, v12, v21
    v_cvt_pk_bf16_f32 v41, v11, v12
    v_lshlrev_b32 v11, 16, v42
    v_and_b32 v12, 0xffff0000, v42
    v_sub_f32 v11, v11, v20
    v_sub_f32 v12, v12, v20
    v_cvt_pk_bf16_f32 v13, v11, v12
    v_lshlrev_b32 v11, 16, v13
    v_and_b32 v12, 0xffff0000, v13
    v_mul_f32 v11, v11, v21
    v_mul_f32 v12, v12, v21
    v_cvt_pk_bf16_f32 v42, v11, v12
    v_lshlrev_b32 v11, 16, v43
    v_and_b32 v12, 0xffff0000, v43
    v_sub_f32 v11, v11, v20
    v_sub_f32 v12, v12, v20
    v_cvt_pk_bf16_f32 v13, v11, v12
    v_lshlrev_b32 v11, 16, v13
    v_and_b32 v12, 0xffff0000, v13
    v_mul_f32 v11, v11, v21
    v_mul_f32 v12, v12, v21
    v_cvt_pk_bf16_f32 v43, v11, v12
    v_add_u32 v14, 73728, v9
    ds_write_b128 v14, v[40:43]
    v_lshlrev_b32 v11, 16, v44
    v_and_b32 v12, 0xffff0000, v44
    v_sub_f32 v11, v11, v22
    v_sub_f32 v12, v12, v22
    v_cvt_pk_bf16_f32 v13, v11, v12
    v_lshlrev_b32 v11, 16, v13
    v_and_b32 v12, 0xffff0000, v13
    v_mul_f32 v11, v11, v23
    v_mul_f32 v12, v12, v23
    v_cvt_pk_bf16_f32 v44, v11, v12
    v_lshlrev_b32 v11, 16, v45
    v_and_b32 v12, 0xffff0000, v45
    v_sub_f32 v11, v11, v22
    v_sub_f32 v12, v12, v22
    v_cvt_pk_bf16_f32 v13, v11, v12
    v_lshlrev_b32 v11, 16, v13
    v_and_b32 v12, 0xffff0000, v13
    v_mul_f32 v11, v11, v23
    v_mul_f32 v12, v12, v23
    v_cvt_pk_bf16_f32 v45, v11, v12
    v_lshlrev_b32 v11, 16, v46
    v_and_b32 v12, 0xffff0000, v46
    v_sub_f32 v11, v11, v22
    v_sub_f32 v12, v12, v22
    v_cvt_pk_bf16_f32 v13, v11, v12
    v_lshlrev_b32 v11, 16, v13
    v_and_b32 v12, 0xffff0000, v13
    v_mul_f32 v11, v11, v23
    v_mul_f32 v12, v12, v23
    v_cvt_pk_bf16_f32 v46, v11, v12
    v_lshlrev_b32 v11, 16, v47
    v_and_b32 v12, 0xffff0000, v47
    v_sub_f32 v11, v11, v22
    v_sub_f32 v12, v12, v22
    v_cvt_pk_bf16_f32 v13, v11, v12
    v_lshlrev_b32 v11, 16, v13
    v_and_b32 v12, 0xffff0000, v13
    v_mul_f32 v11, v11, v23
    v_mul_f32 v12, v12, v23
    v_cvt_pk_bf16_f32 v47, v11, v12
    v_add_u32 v14, 77824, v9
    ds_write_b128 v14, v[44:47]
    s_waitcnt lgkmcnt(0)
    buffer_load_dwordx4 v[32:35], v5, s[8:11], 0 offen offset:512
    buffer_load_dwordx4 v[36:39], v6, s[8:11], 0 offen offset:512
    buffer_load_dwordx4 v[40:43], v7, s[8:11], 0 offen offset:512
    buffer_load_dwordx4 v[44:47], v8, s[8:11], 0 offen offset:512
    s_waitcnt lgkmcnt(0)
    s_barrier
    s_waitcnt vmcnt(4)
    v_lshlrev_b32 v11, 16, v48
    v_and_b32 v12, 0xffff0000, v48
    v_sub_f32 v11, v11, v16
    v_sub_f32 v12, v12, v16
    v_cvt_pk_bf16_f32 v13, v11, v12
    v_lshlrev_b32 v11, 16, v13
    v_and_b32 v12, 0xffff0000, v13
    v_mul_f32 v11, v11, v17
    v_mul_f32 v12, v12, v17
    v_cvt_pk_bf16_f32 v48, v11, v12
    v_lshlrev_b32 v11, 16, v49
    v_and_b32 v12, 0xffff0000, v49
    v_sub_f32 v11, v11, v16
    v_sub_f32 v12, v12, v16
    v_cvt_pk_bf16_f32 v13, v11, v12
    v_lshlrev_b32 v11, 16, v13
    v_and_b32 v12, 0xffff0000, v13
    v_mul_f32 v11, v11, v17
    v_mul_f32 v12, v12, v17
    v_cvt_pk_bf16_f32 v49, v11, v12
    v_lshlrev_b32 v11, 16, v50
    v_and_b32 v12, 0xffff0000, v50
    v_sub_f32 v11, v11, v16
    v_sub_f32 v12, v12, v16
    v_cvt_pk_bf16_f32 v13, v11, v12
    v_lshlrev_b32 v11, 16, v13
    v_and_b32 v12, 0xffff0000, v13
    v_mul_f32 v11, v11, v17
    v_mul_f32 v12, v12, v17
    v_cvt_pk_bf16_f32 v50, v11, v12
    v_lshlrev_b32 v11, 16, v51
    v_and_b32 v12, 0xffff0000, v51
    v_sub_f32 v11, v11, v16
    v_sub_f32 v12, v12, v16
    v_cvt_pk_bf16_f32 v13, v11, v12
    v_lshlrev_b32 v11, 16, v13
    v_and_b32 v12, 0xffff0000, v13
    v_mul_f32 v11, v11, v17
    v_mul_f32 v12, v12, v17
    v_cvt_pk_bf16_f32 v51, v11, v12
    v_add_u32 v14, 98304, v9
    ds_write_b128 v14, v[48:51]
    v_lshlrev_b32 v11, 16, v52
    v_and_b32 v12, 0xffff0000, v52
    v_sub_f32 v11, v11, v18
    v_sub_f32 v12, v12, v18
    v_cvt_pk_bf16_f32 v13, v11, v12
    v_lshlrev_b32 v11, 16, v13
    v_and_b32 v12, 0xffff0000, v13
    v_mul_f32 v11, v11, v19
    v_mul_f32 v12, v12, v19
    v_cvt_pk_bf16_f32 v52, v11, v12
    v_lshlrev_b32 v11, 16, v53
    v_and_b32 v12, 0xffff0000, v53
    v_sub_f32 v11, v11, v18
    v_sub_f32 v12, v12, v18
    v_cvt_pk_bf16_f32 v13, v11, v12
    v_lshlrev_b32 v11, 16, v13
    v_and_b32 v12, 0xffff0000, v13
    v_mul_f32 v11, v11, v19
    v_mul_f32 v12, v12, v19
    v_cvt_pk_bf16_f32 v53, v11, v12
    v_lshlrev_b32 v11, 16, v54
    v_and_b32 v12, 0xffff0000, v54
    v_sub_f32 v11, v11, v18
    v_sub_f32 v12, v12, v18
    v_cvt_pk_bf16_f32 v13, v11, v12
    v_lshlrev_b32 v11, 16, v13
    v_and_b32 v12, 0xffff0000, v13
    v_mul_f32 v11, v11, v19
    v_mul_f32 v12, v12, v19
    v_cvt_pk_bf16_f32 v54, v11, v12
    v_lshlrev_b32 v11, 16, v55
    v_and_b32 v12, 0xffff0000, v55
    v_sub_f32 v11, v11, v18
    v_sub_f32 v12, v12, v18
    v_cvt_pk_bf16_f32 v13, v11, v12
    v_lshlrev_b32 v11, 16, v13
    v_and_b32 v12, 0xffff0000, v13
    v_mul_f32 v11, v11, v19
    v_mul_f32 v12, v12, v19
    v_cvt_pk_bf16_f32 v55, v11, v12
    v_add_u32 v14, 102400, v9
    ds_write_b128 v14, v[52:55]
    v_lshlrev_b32 v11, 16, v56
    v_and_b32 v12, 0xffff0000, v56
    v_sub_f32 v11, v11, v20
    v_sub_f32 v12, v12, v20
    v_cvt_pk_bf16_f32 v13, v11, v12
    v_lshlrev_b32 v11, 16, v13
    v_and_b32 v12, 0xffff0000, v13
    v_mul_f32 v11, v11, v21
    v_mul_f32 v12, v12, v21
    v_cvt_pk_bf16_f32 v56, v11, v12
    v_lshlrev_b32 v11, 16, v57
    v_and_b32 v12, 0xffff0000, v57
    v_sub_f32 v11, v11, v20
    v_sub_f32 v12, v12, v20
    v_cvt_pk_bf16_f32 v13, v11, v12
    v_lshlrev_b32 v11, 16, v13
    v_and_b32 v12, 0xffff0000, v13
    v_mul_f32 v11, v11, v21
    v_mul_f32 v12, v12, v21
    v_cvt_pk_bf16_f32 v57, v11, v12
    v_lshlrev_b32 v11, 16, v58
    v_and_b32 v12, 0xffff0000, v58
    v_sub_f32 v11, v11, v20
    v_sub_f32 v12, v12, v20
    v_cvt_pk_bf16_f32 v13, v11, v12
    v_lshlrev_b32 v11, 16, v13
    v_and_b32 v12, 0xffff0000, v13
    v_mul_f32 v11, v11, v21
    v_mul_f32 v12, v12, v21
    v_cvt_pk_bf16_f32 v58, v11, v12
    v_lshlrev_b32 v11, 16, v59
    v_and_b32 v12, 0xffff0000, v59
    v_sub_f32 v11, v11, v20
    v_sub_f32 v12, v12, v20
    v_cvt_pk_bf16_f32 v13, v11, v12
    v_lshlrev_b32 v11, 16, v13
    v_and_b32 v12, 0xffff0000, v13
    v_mul_f32 v11, v11, v21
    v_mul_f32 v12, v12, v21
    v_cvt_pk_bf16_f32 v59, v11, v12
    v_add_u32 v14, 106496, v9
    ds_write_b128 v14, v[56:59]
    v_lshlrev_b32 v11, 16, v60
    v_and_b32 v12, 0xffff0000, v60
    v_sub_f32 v11, v11, v22
    v_sub_f32 v12, v12, v22
    v_cvt_pk_bf16_f32 v13, v11, v12
    v_lshlrev_b32 v11, 16, v13
    v_and_b32 v12, 0xffff0000, v13
    v_mul_f32 v11, v11, v23
    v_mul_f32 v12, v12, v23
    v_cvt_pk_bf16_f32 v60, v11, v12
    v_lshlrev_b32 v11, 16, v61
    v_and_b32 v12, 0xffff0000, v61
    v_sub_f32 v11, v11, v22
    v_sub_f32 v12, v12, v22
    v_cvt_pk_bf16_f32 v13, v11, v12
    v_lshlrev_b32 v11, 16, v13
    v_and_b32 v12, 0xffff0000, v13
    v_mul_f32 v11, v11, v23
    v_mul_f32 v12, v12, v23
    v_cvt_pk_bf16_f32 v61, v11, v12
    v_lshlrev_b32 v11, 16, v62
    v_and_b32 v12, 0xffff0000, v62
    v_sub_f32 v11, v11, v22
    v_sub_f32 v12, v12, v22
    v_cvt_pk_bf16_f32 v13, v11, v12
    v_lshlrev_b32 v11, 16, v13
    v_and_b32 v12, 0xffff0000, v13
    v_mul_f32 v11, v11, v23
    v_mul_f32 v12, v12, v23
    v_cvt_pk_bf16_f32 v62, v11, v12
    v_lshlrev_b32 v11, 16, v63
    v_and_b32 v12, 0xffff0000, v63
    v_sub_f32 v11, v11, v22
    v_sub_f32 v12, v12, v22
    v_cvt_pk_bf16_f32 v13, v11, v12
    v_lshlrev_b32 v11, 16, v13
    v_and_b32 v12, 0xffff0000, v13
    v_mul_f32 v11, v11, v23
    v_mul_f32 v12, v12, v23
    v_cvt_pk_bf16_f32 v63, v11, v12
    v_add_u32 v14, 110592, v9
    ds_write_b128 v14, v[60:63]
    s_waitcnt lgkmcnt(0)
    buffer_load_dwordx4 v[48:51], v5, s[8:11], 0 offen offset:640
    buffer_load_dwordx4 v[52:55], v6, s[8:11], 0 offen offset:640
    buffer_load_dwordx4 v[56:59], v7, s[8:11], 0 offen offset:640
    buffer_load_dwordx4 v[60:63], v8, s[8:11], 0 offen offset:640
    s_waitcnt lgkmcnt(0)
    s_barrier
    s_waitcnt vmcnt(4)
    v_lshlrev_b32 v11, 16, v32
    v_and_b32 v12, 0xffff0000, v32
    v_sub_f32 v11, v11, v16
    v_sub_f32 v12, v12, v16
    v_cvt_pk_bf16_f32 v13, v11, v12
    v_lshlrev_b32 v11, 16, v13
    v_and_b32 v12, 0xffff0000, v13
    v_mul_f32 v11, v11, v17
    v_mul_f32 v12, v12, v17
    v_cvt_pk_bf16_f32 v32, v11, v12
    v_lshlrev_b32 v11, 16, v33
    v_and_b32 v12, 0xffff0000, v33
    v_sub_f32 v11, v11, v16
    v_sub_f32 v12, v12, v16
    v_cvt_pk_bf16_f32 v13, v11, v12
    v_lshlrev_b32 v11, 16, v13
    v_and_b32 v12, 0xffff0000, v13
    v_mul_f32 v11, v11, v17
    v_mul_f32 v12, v12, v17
    v_cvt_pk_bf16_f32 v33, v11, v12
    v_lshlrev_b32 v11, 16, v34
    v_and_b32 v12, 0xffff0000, v34
    v_sub_f32 v11, v11, v16
    v_sub_f32 v12, v12, v16
    v_cvt_pk_bf16_f32 v13, v11, v12
    v_lshlrev_b32 v11, 16, v13
    v_and_b32 v12, 0xffff0000, v13
    v_mul_f32 v11, v11, v17
    v_mul_f32 v12, v12, v17
    v_cvt_pk_bf16_f32 v34, v11, v12
    v_lshlrev_b32 v11, 16, v35
    v_and_b32 v12, 0xffff0000, v35
    v_sub_f32 v11, v11, v16
    v_sub_f32 v12, v12, v16
    v_cvt_pk_bf16_f32 v13, v11, v12
    v_lshlrev_b32 v11, 16, v13
    v_and_b32 v12, 0xffff0000, v13
    v_mul_f32 v11, v11, v17
    v_mul_f32 v12, v12, v17
    v_cvt_pk_bf16_f32 v35, v11, v12
    v_add_u32 v14, 0, v9
    ds_write_b128 v14, v[32:35]
    v_lshlrev_b32 v11, 16, v36
    v_and_b32 v12, 0xffff0000, v36
    v_sub_f32 v11, v11, v18
    v_sub_f32 v12, v12, v18
    v_cvt_pk_bf16_f32 v13, v11, v12
    v_lshlrev_b32 v11, 16, v13
    v_and_b32 v12, 0xffff0000, v13
    v_mul_f32 v11, v11, v19
    v_mul_f32 v12, v12, v19
    v_cvt_pk_bf16_f32 v36, v11, v12
    v_lshlrev_b32 v11, 16, v37
    v_and_b32 v12, 0xffff0000, v37
    v_sub_f32 v11, v11, v18
    v_sub_f32 v12, v12, v18
    v_cvt_pk_bf16_f32 v13, v11, v12
    v_lshlrev_b32 v11, 16, v13
    v_and_b32 v12, 0xffff0000, v13
    v_mul_f32 v11, v11, v19
    v_mul_f32 v12, v12, v19
    v_cvt_pk_bf16_f32 v37, v11, v12
    v_lshlrev_b32 v11, 16, v38
    v_and_b32 v12, 0xffff0000, v38
    v_sub_f32 v11, v11, v18
    v_sub_f32 v12, v12, v18
    v_cvt_pk_bf16_f32 v13, v11, v12
    v_lshlrev_b32 v11, 16, v13
    v_and_b32 v12, 0xffff0000, v13
    v_mul_f32 v11, v11, v19
    v_mul_f32 v12, v12, v19
    v_cvt_pk_bf16_f32 v38, v11, v12
    v_lshlrev_b32 v11, 16, v39
    v_and_b32 v12, 0xffff0000, v39
    v_sub_f32 v11, v11, v18
    v_sub_f32 v12, v12, v18
    v_cvt_pk_bf16_f32 v13, v11, v12
    v_lshlrev_b32 v11, 16, v13
    v_and_b32 v12, 0xffff0000, v13
    v_mul_f32 v11, v11, v19
    v_mul_f32 v12, v12, v19
    v_cvt_pk_bf16_f32 v39, v11, v12
    v_add_u32 v14, 4096, v9
    ds_write_b128 v14, v[36:39]
    v_lshlrev_b32 v11, 16, v40
    v_and_b32 v12, 0xffff0000, v40
    v_sub_f32 v11, v11, v20
    v_sub_f32 v12, v12, v20
    v_cvt_pk_bf16_f32 v13, v11, v12
    v_lshlrev_b32 v11, 16, v13
    v_and_b32 v12, 0xffff0000, v13
    v_mul_f32 v11, v11, v21
    v_mul_f32 v12, v12, v21
    v_cvt_pk_bf16_f32 v40, v11, v12
    v_lshlrev_b32 v11, 16, v41
    v_and_b32 v12, 0xffff0000, v41
    v_sub_f32 v11, v11, v20
    v_sub_f32 v12, v12, v20
    v_cvt_pk_bf16_f32 v13, v11, v12
    v_lshlrev_b32 v11, 16, v13
    v_and_b32 v12, 0xffff0000, v13
    v_mul_f32 v11, v11, v21
    v_mul_f32 v12, v12, v21
    v_cvt_pk_bf16_f32 v41, v11, v12
    v_lshlrev_b32 v11, 16, v42
    v_and_b32 v12, 0xffff0000, v42
    v_sub_f32 v11, v11, v20
    v_sub_f32 v12, v12, v20
    v_cvt_pk_bf16_f32 v13, v11, v12
    v_lshlrev_b32 v11, 16, v13
    v_and_b32 v12, 0xffff0000, v13
    v_mul_f32 v11, v11, v21
    v_mul_f32 v12, v12, v21
    v_cvt_pk_bf16_f32 v42, v11, v12
    v_lshlrev_b32 v11, 16, v43
    v_and_b32 v12, 0xffff0000, v43
    v_sub_f32 v11, v11, v20
    v_sub_f32 v12, v12, v20
    v_cvt_pk_bf16_f32 v13, v11, v12
    v_lshlrev_b32 v11, 16, v13
    v_and_b32 v12, 0xffff0000, v13
    v_mul_f32 v11, v11, v21
    v_mul_f32 v12, v12, v21
    v_cvt_pk_bf16_f32 v43, v11, v12
    v_add_u32 v14, 8192, v9
    ds_write_b128 v14, v[40:43]
    v_lshlrev_b32 v11, 16, v44
    v_and_b32 v12, 0xffff0000, v44
    v_sub_f32 v11, v11, v22
    v_sub_f32 v12, v12, v22
    v_cvt_pk_bf16_f32 v13, v11, v12
    v_lshlrev_b32 v11, 16, v13
    v_and_b32 v12, 0xffff0000, v13
    v_mul_f32 v11, v11, v23
    v_mul_f32 v12, v12, v23
    v_cvt_pk_bf16_f32 v44, v11, v12
    v_lshlrev_b32 v11, 16, v45
    v_and_b32 v12, 0xffff0000, v45
    v_sub_f32 v11, v11, v22
    v_sub_f32 v12, v12, v22
    v_cvt_pk_bf16_f32 v13, v11, v12
    v_lshlrev_b32 v11, 16, v13
    v_and_b32 v12, 0xffff0000, v13
    v_mul_f32 v11, v11, v23
    v_mul_f32 v12, v12, v23
    v_cvt_pk_bf16_f32 v45, v11, v12
    v_lshlrev_b32 v11, 16, v46
    v_and_b32 v12, 0xffff0000, v46
    v_sub_f32 v11, v11, v22
    v_sub_f32 v12, v12, v22
    v_cvt_pk_bf16_f32 v13, v11, v12
    v_lshlrev_b32 v11, 16, v13
    v_and_b32 v12, 0xffff0000, v13
    v_mul_f32 v11, v11, v23
    v_mul_f32 v12, v12, v23
    v_cvt_pk_bf16_f32 v46, v11, v12
    v_lshlrev_b32 v11, 16, v47
    v_and_b32 v12, 0xffff0000, v47
    v_sub_f32 v11, v11, v22
    v_sub_f32 v12, v12, v22
    v_cvt_pk_bf16_f32 v13, v11, v12
    v_lshlrev_b32 v11, 16, v13
    v_and_b32 v12, 0xffff0000, v13
    v_mul_f32 v11, v11, v23
    v_mul_f32 v12, v12, v23
    v_cvt_pk_bf16_f32 v47, v11, v12
    v_add_u32 v14, 12288, v9
    ds_write_b128 v14, v[44:47]
    s_waitcnt lgkmcnt(0)
    buffer_load_dwordx4 v[32:35], v5, s[8:11], 0 offen offset:768
    buffer_load_dwordx4 v[36:39], v6, s[8:11], 0 offen offset:768
    buffer_load_dwordx4 v[40:43], v7, s[8:11], 0 offen offset:768
    buffer_load_dwordx4 v[44:47], v8, s[8:11], 0 offen offset:768
    s_waitcnt lgkmcnt(0)
    s_barrier
    s_waitcnt vmcnt(4)
    v_lshlrev_b32 v11, 16, v48
    v_and_b32 v12, 0xffff0000, v48
    v_sub_f32 v11, v11, v16
    v_sub_f32 v12, v12, v16
    v_cvt_pk_bf16_f32 v13, v11, v12
    v_lshlrev_b32 v11, 16, v13
    v_and_b32 v12, 0xffff0000, v13
    v_mul_f32 v11, v11, v17
    v_mul_f32 v12, v12, v17
    v_cvt_pk_bf16_f32 v48, v11, v12
    v_lshlrev_b32 v11, 16, v49
    v_and_b32 v12, 0xffff0000, v49
    v_sub_f32 v11, v11, v16
    v_sub_f32 v12, v12, v16
    v_cvt_pk_bf16_f32 v13, v11, v12
    v_lshlrev_b32 v11, 16, v13
    v_and_b32 v12, 0xffff0000, v13
    v_mul_f32 v11, v11, v17
    v_mul_f32 v12, v12, v17
    v_cvt_pk_bf16_f32 v49, v11, v12
    v_lshlrev_b32 v11, 16, v50
    v_and_b32 v12, 0xffff0000, v50
    v_sub_f32 v11, v11, v16
    v_sub_f32 v12, v12, v16
    v_cvt_pk_bf16_f32 v13, v11, v12
    v_lshlrev_b32 v11, 16, v13
    v_and_b32 v12, 0xffff0000, v13
    v_mul_f32 v11, v11, v17
    v_mul_f32 v12, v12, v17
    v_cvt_pk_bf16_f32 v50, v11, v12
    v_lshlrev_b32 v11, 16, v51
    v_and_b32 v12, 0xffff0000, v51
    v_sub_f32 v11, v11, v16
    v_sub_f32 v12, v12, v16
    v_cvt_pk_bf16_f32 v13, v11, v12
    v_lshlrev_b32 v11, 16, v13
    v_and_b32 v12, 0xffff0000, v13
    v_mul_f32 v11, v11, v17
    v_mul_f32 v12, v12, v17
    v_cvt_pk_bf16_f32 v51, v11, v12
    v_add_u32 v14, 32768, v9
    ds_write_b128 v14, v[48:51]
    v_lshlrev_b32 v11, 16, v52
    v_and_b32 v12, 0xffff0000, v52
    v_sub_f32 v11, v11, v18
    v_sub_f32 v12, v12, v18
    v_cvt_pk_bf16_f32 v13, v11, v12
    v_lshlrev_b32 v11, 16, v13
    v_and_b32 v12, 0xffff0000, v13
    v_mul_f32 v11, v11, v19
    v_mul_f32 v12, v12, v19
    v_cvt_pk_bf16_f32 v52, v11, v12
    v_lshlrev_b32 v11, 16, v53
    v_and_b32 v12, 0xffff0000, v53
    v_sub_f32 v11, v11, v18
    v_sub_f32 v12, v12, v18
    v_cvt_pk_bf16_f32 v13, v11, v12
    v_lshlrev_b32 v11, 16, v13
    v_and_b32 v12, 0xffff0000, v13
    v_mul_f32 v11, v11, v19
    v_mul_f32 v12, v12, v19
    v_cvt_pk_bf16_f32 v53, v11, v12
    v_lshlrev_b32 v11, 16, v54
    v_and_b32 v12, 0xffff0000, v54
    v_sub_f32 v11, v11, v18
    v_sub_f32 v12, v12, v18
    v_cvt_pk_bf16_f32 v13, v11, v12
    v_lshlrev_b32 v11, 16, v13
    v_and_b32 v12, 0xffff0000, v13
    v_mul_f32 v11, v11, v19
    v_mul_f32 v12, v12, v19
    v_cvt_pk_bf16_f32 v54, v11, v12
    v_lshlrev_b32 v11, 16, v55
    v_and_b32 v12, 0xffff0000, v55
    v_sub_f32 v11, v11, v18
    v_sub_f32 v12, v12, v18
    v_cvt_pk_bf16_f32 v13, v11, v12
    v_lshlrev_b32 v11, 16, v13
    v_and_b32 v12, 0xffff0000, v13
    v_mul_f32 v11, v11, v19
    v_mul_f32 v12, v12, v19
    v_cvt_pk_bf16_f32 v55, v11, v12
    v_add_u32 v14, 36864, v9
    ds_write_b128 v14, v[52:55]
    v_lshlrev_b32 v11, 16, v56
    v_and_b32 v12, 0xffff0000, v56
    v_sub_f32 v11, v11, v20
    v_sub_f32 v12, v12, v20
    v_cvt_pk_bf16_f32 v13, v11, v12
    v_lshlrev_b32 v11, 16, v13
    v_and_b32 v12, 0xffff0000, v13
    v_mul_f32 v11, v11, v21
    v_mul_f32 v12, v12, v21
    v_cvt_pk_bf16_f32 v56, v11, v12
    v_lshlrev_b32 v11, 16, v57
    v_and_b32 v12, 0xffff0000, v57
    v_sub_f32 v11, v11, v20
    v_sub_f32 v12, v12, v20
    v_cvt_pk_bf16_f32 v13, v11, v12
    v_lshlrev_b32 v11, 16, v13
    v_and_b32 v12, 0xffff0000, v13
    v_mul_f32 v11, v11, v21
    v_mul_f32 v12, v12, v21
    v_cvt_pk_bf16_f32 v57, v11, v12
    v_lshlrev_b32 v11, 16, v58
    v_and_b32 v12, 0xffff0000, v58
    v_sub_f32 v11, v11, v20
    v_sub_f32 v12, v12, v20
    v_cvt_pk_bf16_f32 v13, v11, v12
    v_lshlrev_b32 v11, 16, v13
    v_and_b32 v12, 0xffff0000, v13
    v_mul_f32 v11, v11, v21
    v_mul_f32 v12, v12, v21
    v_cvt_pk_bf16_f32 v58, v11, v12
    v_lshlrev_b32 v11, 16, v59
    v_and_b32 v12, 0xffff0000, v59
    v_sub_f32 v11, v11, v20
    v_sub_f32 v12, v12, v20
    v_cvt_pk_bf16_f32 v13, v11, v12
    v_lshlrev_b32 v11, 16, v13
    v_and_b32 v12, 0xffff0000, v13
    v_mul_f32 v11, v11, v21
    v_mul_f32 v12, v12, v21
    v_cvt_pk_bf16_f32 v59, v11, v12
    v_add_u32 v14, 40960, v9
    ds_write_b128 v14, v[56:59]
    v_lshlrev_b32 v11, 16, v60
    v_and_b32 v12, 0xffff0000, v60
    v_sub_f32 v11, v11, v22
    v_sub_f32 v12, v12, v22
    v_cvt_pk_bf16_f32 v13, v11, v12
    v_lshlrev_b32 v11, 16, v13
    v_and_b32 v12, 0xffff0000, v13
    v_mul_f32 v11, v11, v23
    v_mul_f32 v12, v12, v23
    v_cvt_pk_bf16_f32 v60, v11, v12
    v_lshlrev_b32 v11, 16, v61
    v_and_b32 v12, 0xffff0000, v61
    v_sub_f32 v11, v11, v22
    v_sub_f32 v12, v12, v22
    v_cvt_pk_bf16_f32 v13, v11, v12
    v_lshlrev_b32 v11, 16, v13
    v_and_b32 v12, 0xffff0000, v13
    v_mul_f32 v11, v11, v23
    v_mul_f32 v12, v12, v23
    v_cvt_pk_bf16_f32 v61, v11, v12
    v_lshlrev_b32 v11, 16, v62
    v_and_b32 v12, 0xffff0000, v62
    v_sub_f32 v11, v11, v22
    v_sub_f32 v12, v12, v22
    v_cvt_pk_bf16_f32 v13, v11, v12
    v_lshlrev_b32 v11, 16, v13
    v_and_b32 v12, 0xffff0000, v13
    v_mul_f32 v11, v11, v23
    v_mul_f32 v12, v12, v23
    v_cvt_pk_bf16_f32 v62, v11, v12
    v_lshlrev_b32 v11, 16, v63
    v_and_b32 v12, 0xffff0000, v63
    v_sub_f32 v11, v11, v22
    v_sub_f32 v12, v12, v22
    v_cvt_pk_bf16_f32 v13, v11, v12
    v_lshlrev_b32 v11, 16, v13
    v_and_b32 v12, 0xffff0000, v13
    v_mul_f32 v11, v11, v23
    v_mul_f32 v12, v12, v23
    v_cvt_pk_bf16_f32 v63, v11, v12
    v_add_u32 v14, 45056, v9
    ds_write_b128 v14, v[60:63]
    s_waitcnt lgkmcnt(0)
    buffer_load_dwordx4 v[48:51], v5, s[8:11], 0 offen offset:896
    buffer_load_dwordx4 v[52:55], v6, s[8:11], 0 offen offset:896
    buffer_load_dwordx4 v[56:59], v7, s[8:11], 0 offen offset:896
    buffer_load_dwordx4 v[60:63], v8, s[8:11], 0 offen offset:896
    s_waitcnt lgkmcnt(0)
    s_barrier
    s_waitcnt vmcnt(4)
    v_lshlrev_b32 v11, 16, v32
    v_and_b32 v12, 0xffff0000, v32
    v_sub_f32 v11, v11, v16
    v_sub_f32 v12, v12, v16
    v_cvt_pk_bf16_f32 v13, v11, v12
    v_lshlrev_b32 v11, 16, v13
    v_and_b32 v12, 0xffff0000, v13
    v_mul_f32 v11, v11, v17
    v_mul_f32 v12, v12, v17
    v_cvt_pk_bf16_f32 v32, v11, v12
    v_lshlrev_b32 v11, 16, v33
    v_and_b32 v12, 0xffff0000, v33
    v_sub_f32 v11, v11, v16
    v_sub_f32 v12, v12, v16
    v_cvt_pk_bf16_f32 v13, v11, v12
    v_lshlrev_b32 v11, 16, v13
    v_and_b32 v12, 0xffff0000, v13
    v_mul_f32 v11, v11, v17
    v_mul_f32 v12, v12, v17
    v_cvt_pk_bf16_f32 v33, v11, v12
    v_lshlrev_b32 v11, 16, v34
    v_and_b32 v12, 0xffff0000, v34
    v_sub_f32 v11, v11, v16
    v_sub_f32 v12, v12, v16
    v_cvt_pk_bf16_f32 v13, v11, v12
    v_lshlrev_b32 v11, 16, v13
    v_and_b32 v12, 0xffff0000, v13
    v_mul_f32 v11, v11, v17
    v_mul_f32 v12, v12, v17
    v_cvt_pk_bf16_f32 v34, v11, v12
    v_lshlrev_b32 v11, 16, v35
    v_and_b32 v12, 0xffff0000, v35
    v_sub_f32 v11, v11, v16
    v_sub_f32 v12, v12, v16
    v_cvt_pk_bf16_f32 v13, v11, v12
    v_lshlrev_b32 v11, 16, v13
    v_and_b32 v12, 0xffff0000, v13
    v_mul_f32 v11, v11, v17
    v_mul_f32 v12, v12, v17
    v_cvt_pk_bf16_f32 v35, v11, v12
    v_add_u32 v14, 65536, v9
    ds_write_b128 v14, v[32:35]
    v_lshlrev_b32 v11, 16, v36
    v_and_b32 v12, 0xffff0000, v36
    v_sub_f32 v11, v11, v18
    v_sub_f32 v12, v12, v18
    v_cvt_pk_bf16_f32 v13, v11, v12
    v_lshlrev_b32 v11, 16, v13
    v_and_b32 v12, 0xffff0000, v13
    v_mul_f32 v11, v11, v19
    v_mul_f32 v12, v12, v19
    v_cvt_pk_bf16_f32 v36, v11, v12
    v_lshlrev_b32 v11, 16, v37
    v_and_b32 v12, 0xffff0000, v37
    v_sub_f32 v11, v11, v18
    v_sub_f32 v12, v12, v18
    v_cvt_pk_bf16_f32 v13, v11, v12
    v_lshlrev_b32 v11, 16, v13
    v_and_b32 v12, 0xffff0000, v13
    v_mul_f32 v11, v11, v19
    v_mul_f32 v12, v12, v19
    v_cvt_pk_bf16_f32 v37, v11, v12
    v_lshlrev_b32 v11, 16, v38
    v_and_b32 v12, 0xffff0000, v38
    v_sub_f32 v11, v11, v18
    v_sub_f32 v12, v12, v18
    v_cvt_pk_bf16_f32 v13, v11, v12
    v_lshlrev_b32 v11, 16, v13
    v_and_b32 v12, 0xffff0000, v13
    v_mul_f32 v11, v11, v19
    v_mul_f32 v12, v12, v19
    v_cvt_pk_bf16_f32 v38, v11, v12
    v_lshlrev_b32 v11, 16, v39
    v_and_b32 v12, 0xffff0000, v39
    v_sub_f32 v11, v11, v18
    v_sub_f32 v12, v12, v18
    v_cvt_pk_bf16_f32 v13, v11, v12
    v_lshlrev_b32 v11, 16, v13
    v_and_b32 v12, 0xffff0000, v13
    v_mul_f32 v11, v11, v19
    v_mul_f32 v12, v12, v19
    v_cvt_pk_bf16_f32 v39, v11, v12
    v_add_u32 v14, 69632, v9
    ds_write_b128 v14, v[36:39]
    v_lshlrev_b32 v11, 16, v40
    v_and_b32 v12, 0xffff0000, v40
    v_sub_f32 v11, v11, v20
    v_sub_f32 v12, v12, v20
    v_cvt_pk_bf16_f32 v13, v11, v12
    v_lshlrev_b32 v11, 16, v13
    v_and_b32 v12, 0xffff0000, v13
    v_mul_f32 v11, v11, v21
    v_mul_f32 v12, v12, v21
    v_cvt_pk_bf16_f32 v40, v11, v12
    v_lshlrev_b32 v11, 16, v41
    v_and_b32 v12, 0xffff0000, v41
    v_sub_f32 v11, v11, v20
    v_sub_f32 v12, v12, v20
    v_cvt_pk_bf16_f32 v13, v11, v12
    v_lshlrev_b32 v11, 16, v13
    v_and_b32 v12, 0xffff0000, v13
    v_mul_f32 v11, v11, v21
    v_mul_f32 v12, v12, v21
    v_cvt_pk_bf16_f32 v41, v11, v12
    v_lshlrev_b32 v11, 16, v42
    v_and_b32 v12, 0xffff0000, v42
    v_sub_f32 v11, v11, v20
    v_sub_f32 v12, v12, v20
    v_cvt_pk_bf16_f32 v13, v11, v12
    v_lshlrev_b32 v11, 16, v13
    v_and_b32 v12, 0xffff0000, v13
    v_mul_f32 v11, v11, v21
    v_mul_f32 v12, v12, v21
    v_cvt_pk_bf16_f32 v42, v11, v12
    v_lshlrev_b32 v11, 16, v43
    v_and_b32 v12, 0xffff0000, v43
    v_sub_f32 v11, v11, v20
    v_sub_f32 v12, v12, v20
    v_cvt_pk_bf16_f32 v13, v11, v12
    v_lshlrev_b32 v11, 16, v13
    v_and_b32 v12, 0xffff0000, v13
    v_mul_f32 v11, v11, v21
    v_mul_f32 v12, v12, v21
    v_cvt_pk_bf16_f32 v43, v11, v12
    v_add_u32 v14, 73728, v9
    ds_write_b128 v14, v[40:43]
    v_lshlrev_b32 v11, 16, v44
    v_and_b32 v12, 0xffff0000, v44
    v_sub_f32 v11, v11, v22
    v_sub_f32 v12, v12, v22
    v_cvt_pk_bf16_f32 v13, v11, v12
    v_lshlrev_b32 v11, 16, v13
    v_and_b32 v12, 0xffff0000, v13
    v_mul_f32 v11, v11, v23
    v_mul_f32 v12, v12, v23
    v_cvt_pk_bf16_f32 v44, v11, v12
    v_lshlrev_b32 v11, 16, v45
    v_and_b32 v12, 0xffff0000, v45
    v_sub_f32 v11, v11, v22
    v_sub_f32 v12, v12, v22
    v_cvt_pk_bf16_f32 v13, v11, v12
    v_lshlrev_b32 v11, 16, v13
    v_and_b32 v12, 0xffff0000, v13
    v_mul_f32 v11, v11, v23
    v_mul_f32 v12, v12, v23
    v_cvt_pk_bf16_f32 v45, v11, v12
    v_lshlrev_b32 v11, 16, v46
    v_and_b32 v12, 0xffff0000, v46
    v_sub_f32 v11, v11, v22
    v_sub_f32 v12, v12, v22
    v_cvt_pk_bf16_f32 v13, v11, v12
    v_lshlrev_b32 v11, 16, v13
    v_and_b32 v12, 0xffff0000, v13
    v_mul_f32 v11, v11, v23
    v_mul_f32 v12, v12, v23
    v_cvt_pk_bf16_f32 v46, v11, v12
    v_lshlrev_b32 v11, 16, v47
    v_and_b32 v12, 0xffff0000, v47
    v_sub_f32 v11, v11, v22
    v_sub_f32 v12, v12, v22
    v_cvt_pk_bf16_f32 v13, v11, v12
    v_lshlrev_b32 v11, 16, v13
    v_and_b32 v12, 0xffff0000, v13
    v_mul_f32 v11, v11, v23
    v_mul_f32 v12, v12, v23
    v_cvt_pk_bf16_f32 v47, v11, v12
    v_add_u32 v14, 77824, v9
    ds_write_b128 v14, v[44:47]
    s_waitcnt lgkmcnt(0)
    buffer_load_dwordx4 v[32:35], v5, s[8:11], 0 offen offset:1024
    buffer_load_dwordx4 v[36:39], v6, s[8:11], 0 offen offset:1024
    buffer_load_dwordx4 v[40:43], v7, s[8:11], 0 offen offset:1024
    buffer_load_dwordx4 v[44:47], v8, s[8:11], 0 offen offset:1024
    s_waitcnt lgkmcnt(0)
    s_barrier
    s_waitcnt vmcnt(4)
    v_lshlrev_b32 v11, 16, v48
    v_and_b32 v12, 0xffff0000, v48
    v_sub_f32 v11, v11, v16
    v_sub_f32 v12, v12, v16
    v_cvt_pk_bf16_f32 v13, v11, v12
    v_lshlrev_b32 v11, 16, v13
    v_and_b32 v12, 0xffff0000, v13
    v_mul_f32 v11, v11, v17
    v_mul_f32 v12, v12, v17
    v_cvt_pk_bf16_f32 v48, v11, v12
    v_lshlrev_b32 v11, 16, v49
    v_and_b32 v12, 0xffff0000, v49
    v_sub_f32 v11, v11, v16
    v_sub_f32 v12, v12, v16
    v_cvt_pk_bf16_f32 v13, v11, v12
    v_lshlrev_b32 v11, 16, v13
    v_and_b32 v12, 0xffff0000, v13
    v_mul_f32 v11, v11, v17
    v_mul_f32 v12, v12, v17
    v_cvt_pk_bf16_f32 v49, v11, v12
    v_lshlrev_b32 v11, 16, v50
    v_and_b32 v12, 0xffff0000, v50
    v_sub_f32 v11, v11, v16
    v_sub_f32 v12, v12, v16
    v_cvt_pk_bf16_f32 v13, v11, v12
    v_lshlrev_b32 v11, 16, v13
    v_and_b32 v12, 0xffff0000, v13
    v_mul_f32 v11, v11, v17
    v_mul_f32 v12, v12, v17
    v_cvt_pk_bf16_f32 v50, v11, v12
    v_lshlrev_b32 v11, 16, v51
    v_and_b32 v12, 0xffff0000, v51
    v_sub_f32 v11, v11, v16
    v_sub_f32 v12, v12, v16
    v_cvt_pk_bf16_f32 v13, v11, v12
    v_lshlrev_b32 v11, 16, v13
    v_and_b32 v12, 0xffff0000, v13
    v_mul_f32 v11, v11, v17
    v_mul_f32 v12, v12, v17
    v_cvt_pk_bf16_f32 v51, v11, v12
    v_add_u32 v14, 98304, v9
    ds_write_b128 v14, v[48:51]
    v_lshlrev_b32 v11, 16, v52
    v_and_b32 v12, 0xffff0000, v52
    v_sub_f32 v11, v11, v18
    v_sub_f32 v12, v12, v18
    v_cvt_pk_bf16_f32 v13, v11, v12
    v_lshlrev_b32 v11, 16, v13
    v_and_b32 v12, 0xffff0000, v13
    v_mul_f32 v11, v11, v19
    v_mul_f32 v12, v12, v19
    v_cvt_pk_bf16_f32 v52, v11, v12
    v_lshlrev_b32 v11, 16, v53
    v_and_b32 v12, 0xffff0000, v53
    v_sub_f32 v11, v11, v18
    v_sub_f32 v12, v12, v18
    v_cvt_pk_bf16_f32 v13, v11, v12
    v_lshlrev_b32 v11, 16, v13
    v_and_b32 v12, 0xffff0000, v13
    v_mul_f32 v11, v11, v19
    v_mul_f32 v12, v12, v19
    v_cvt_pk_bf16_f32 v53, v11, v12
    v_lshlrev_b32 v11, 16, v54
    v_and_b32 v12, 0xffff0000, v54
    v_sub_f32 v11, v11, v18
    v_sub_f32 v12, v12, v18
    v_cvt_pk_bf16_f32 v13, v11, v12
    v_lshlrev_b32 v11, 16, v13
    v_and_b32 v12, 0xffff0000, v13
    v_mul_f32 v11, v11, v19
    v_mul_f32 v12, v12, v19
    v_cvt_pk_bf16_f32 v54, v11, v12
    v_lshlrev_b32 v11, 16, v55
    v_and_b32 v12, 0xffff0000, v55
    v_sub_f32 v11, v11, v18
    v_sub_f32 v12, v12, v18
    v_cvt_pk_bf16_f32 v13, v11, v12
    v_lshlrev_b32 v11, 16, v13
    v_and_b32 v12, 0xffff0000, v13
    v_mul_f32 v11, v11, v19
    v_mul_f32 v12, v12, v19
    v_cvt_pk_bf16_f32 v55, v11, v12
    v_add_u32 v14, 102400, v9
    ds_write_b128 v14, v[52:55]
    v_lshlrev_b32 v11, 16, v56
    v_and_b32 v12, 0xffff0000, v56
    v_sub_f32 v11, v11, v20
    v_sub_f32 v12, v12, v20
    v_cvt_pk_bf16_f32 v13, v11, v12
    v_lshlrev_b32 v11, 16, v13
    v_and_b32 v12, 0xffff0000, v13
    v_mul_f32 v11, v11, v21
    v_mul_f32 v12, v12, v21
    v_cvt_pk_bf16_f32 v56, v11, v12
    v_lshlrev_b32 v11, 16, v57
    v_and_b32 v12, 0xffff0000, v57
    v_sub_f32 v11, v11, v20
    v_sub_f32 v12, v12, v20
    v_cvt_pk_bf16_f32 v13, v11, v12
    v_lshlrev_b32 v11, 16, v13
    v_and_b32 v12, 0xffff0000, v13
    v_mul_f32 v11, v11, v21
    v_mul_f32 v12, v12, v21
    v_cvt_pk_bf16_f32 v57, v11, v12
    v_lshlrev_b32 v11, 16, v58
    v_and_b32 v12, 0xffff0000, v58
    v_sub_f32 v11, v11, v20
    v_sub_f32 v12, v12, v20
    v_cvt_pk_bf16_f32 v13, v11, v12
    v_lshlrev_b32 v11, 16, v13
    v_and_b32 v12, 0xffff0000, v13
    v_mul_f32 v11, v11, v21
    v_mul_f32 v12, v12, v21
    v_cvt_pk_bf16_f32 v58, v11, v12
    v_lshlrev_b32 v11, 16, v59
    v_and_b32 v12, 0xffff0000, v59
    v_sub_f32 v11, v11, v20
    v_sub_f32 v12, v12, v20
    v_cvt_pk_bf16_f32 v13, v11, v12
    v_lshlrev_b32 v11, 16, v13
    v_and_b32 v12, 0xffff0000, v13
    v_mul_f32 v11, v11, v21
    v_mul_f32 v12, v12, v21
    v_cvt_pk_bf16_f32 v59, v11, v12
    v_add_u32 v14, 106496, v9
    ds_write_b128 v14, v[56:59]
    v_lshlrev_b32 v11, 16, v60
    v_and_b32 v12, 0xffff0000, v60
    v_sub_f32 v11, v11, v22
    v_sub_f32 v12, v12, v22
    v_cvt_pk_bf16_f32 v13, v11, v12
    v_lshlrev_b32 v11, 16, v13
    v_and_b32 v12, 0xffff0000, v13
    v_mul_f32 v11, v11, v23
    v_mul_f32 v12, v12, v23
    v_cvt_pk_bf16_f32 v60, v11, v12
    v_lshlrev_b32 v11, 16, v61
    v_and_b32 v12, 0xffff0000, v61
    v_sub_f32 v11, v11, v22
    v_sub_f32 v12, v12, v22
    v_cvt_pk_bf16_f32 v13, v11, v12
    v_lshlrev_b32 v11, 16, v13
    v_and_b32 v12, 0xffff0000, v13
    v_mul_f32 v11, v11, v23
    v_mul_f32 v12, v12, v23
    v_cvt_pk_bf16_f32 v61, v11, v12
    v_lshlrev_b32 v11, 16, v62
    v_and_b32 v12, 0xffff0000, v62
    v_sub_f32 v11, v11, v22
    v_sub_f32 v12, v12, v22
    v_cvt_pk_bf16_f32 v13, v11, v12
    v_lshlrev_b32 v11, 16, v13
    v_and_b32 v12, 0xffff0000, v13
    v_mul_f32 v11, v11, v23
    v_mul_f32 v12, v12, v23
    v_cvt_pk_bf16_f32 v62, v11, v12
    v_lshlrev_b32 v11, 16, v63
    v_and_b32 v12, 0xffff0000, v63
    v_sub_f32 v11, v11, v22
    v_sub_f32 v12, v12, v22
    v_cvt_pk_bf16_f32 v13, v11, v12
    v_lshlrev_b32 v11, 16, v13
    v_and_b32 v12, 0xffff0000, v13
    v_mul_f32 v11, v11, v23
    v_mul_f32 v12, v12, v23
    v_cvt_pk_bf16_f32 v63, v11, v12
    v_add_u32 v14, 110592, v9
    ds_write_b128 v14, v[60:63]
    s_waitcnt lgkmcnt(0)
    buffer_load_dwordx4 v[48:51], v5, s[8:11], 0 offen offset:1152
    buffer_load_dwordx4 v[52:55], v6, s[8:11], 0 offen offset:1152
    buffer_load_dwordx4 v[56:59], v7, s[8:11], 0 offen offset:1152
    buffer_load_dwordx4 v[60:63], v8, s[8:11], 0 offen offset:1152
    s_waitcnt lgkmcnt(0)
    s_barrier
    s_waitcnt vmcnt(4)
    v_lshlrev_b32 v11, 16, v32
    v_and_b32 v12, 0xffff0000, v32
    v_sub_f32 v11, v11, v16
    v_sub_f32 v12, v12, v16
    v_cvt_pk_bf16_f32 v13, v11, v12
    v_lshlrev_b32 v11, 16, v13
    v_and_b32 v12, 0xffff0000, v13
    v_mul_f32 v11, v11, v17
    v_mul_f32 v12, v12, v17
    v_cvt_pk_bf16_f32 v32, v11, v12
    v_lshlrev_b32 v11, 16, v33
    v_and_b32 v12, 0xffff0000, v33
    v_sub_f32 v11, v11, v16
    v_sub_f32 v12, v12, v16
    v_cvt_pk_bf16_f32 v13, v11, v12
    v_lshlrev_b32 v11, 16, v13
    v_and_b32 v12, 0xffff0000, v13
    v_mul_f32 v11, v11, v17
    v_mul_f32 v12, v12, v17
    v_cvt_pk_bf16_f32 v33, v11, v12
    v_lshlrev_b32 v11, 16, v34
    v_and_b32 v12, 0xffff0000, v34
    v_sub_f32 v11, v11, v16
    v_sub_f32 v12, v12, v16
    v_cvt_pk_bf16_f32 v13, v11, v12
    v_lshlrev_b32 v11, 16, v13
    v_and_b32 v12, 0xffff0000, v13
    v_mul_f32 v11, v11, v17
    v_mul_f32 v12, v12, v17
    v_cvt_pk_bf16_f32 v34, v11, v12
    v_lshlrev_b32 v11, 16, v35
    v_and_b32 v12, 0xffff0000, v35
    v_sub_f32 v11, v11, v16
    v_sub_f32 v12, v12, v16
    v_cvt_pk_bf16_f32 v13, v11, v12
    v_lshlrev_b32 v11, 16, v13
    v_and_b32 v12, 0xffff0000, v13
    v_mul_f32 v11, v11, v17
    v_mul_f32 v12, v12, v17
    v_cvt_pk_bf16_f32 v35, v11, v12
    v_add_u32 v14, 0, v9
    ds_write_b128 v14, v[32:35]
    v_lshlrev_b32 v11, 16, v36
    v_and_b32 v12, 0xffff0000, v36
    v_sub_f32 v11, v11, v18
    v_sub_f32 v12, v12, v18
    v_cvt_pk_bf16_f32 v13, v11, v12
    v_lshlrev_b32 v11, 16, v13
    v_and_b32 v12, 0xffff0000, v13
    v_mul_f32 v11, v11, v19
    v_mul_f32 v12, v12, v19
    v_cvt_pk_bf16_f32 v36, v11, v12
    v_lshlrev_b32 v11, 16, v37
    v_and_b32 v12, 0xffff0000, v37
    v_sub_f32 v11, v11, v18
    v_sub_f32 v12, v12, v18
    v_cvt_pk_bf16_f32 v13, v11, v12
    v_lshlrev_b32 v11, 16, v13
    v_and_b32 v12, 0xffff0000, v13
    v_mul_f32 v11, v11, v19
    v_mul_f32 v12, v12, v19
    v_cvt_pk_bf16_f32 v37, v11, v12
    v_lshlrev_b32 v11, 16, v38
    v_and_b32 v12, 0xffff0000, v38
    v_sub_f32 v11, v11, v18
    v_sub_f32 v12, v12, v18
    v_cvt_pk_bf16_f32 v13, v11, v12
    v_lshlrev_b32 v11, 16, v13
    v_and_b32 v12, 0xffff0000, v13
    v_mul_f32 v11, v11, v19
    v_mul_f32 v12, v12, v19
    v_cvt_pk_bf16_f32 v38, v11, v12
    v_lshlrev_b32 v11, 16, v39
    v_and_b32 v12, 0xffff0000, v39
    v_sub_f32 v11, v11, v18
    v_sub_f32 v12, v12, v18
    v_cvt_pk_bf16_f32 v13, v11, v12
    v_lshlrev_b32 v11, 16, v13
    v_and_b32 v12, 0xffff0000, v13
    v_mul_f32 v11, v11, v19
    v_mul_f32 v12, v12, v19
    v_cvt_pk_bf16_f32 v39, v11, v12
    v_add_u32 v14, 4096, v9
    ds_write_b128 v14, v[36:39]
    v_lshlrev_b32 v11, 16, v40
    v_and_b32 v12, 0xffff0000, v40
    v_sub_f32 v11, v11, v20
    v_sub_f32 v12, v12, v20
    v_cvt_pk_bf16_f32 v13, v11, v12
    v_lshlrev_b32 v11, 16, v13
    v_and_b32 v12, 0xffff0000, v13
    v_mul_f32 v11, v11, v21
    v_mul_f32 v12, v12, v21
    v_cvt_pk_bf16_f32 v40, v11, v12
    v_lshlrev_b32 v11, 16, v41
    v_and_b32 v12, 0xffff0000, v41
    v_sub_f32 v11, v11, v20
    v_sub_f32 v12, v12, v20
    v_cvt_pk_bf16_f32 v13, v11, v12
    v_lshlrev_b32 v11, 16, v13
    v_and_b32 v12, 0xffff0000, v13
    v_mul_f32 v11, v11, v21
    v_mul_f32 v12, v12, v21
    v_cvt_pk_bf16_f32 v41, v11, v12
    v_lshlrev_b32 v11, 16, v42
    v_and_b32 v12, 0xffff0000, v42
    v_sub_f32 v11, v11, v20
    v_sub_f32 v12, v12, v20
    v_cvt_pk_bf16_f32 v13, v11, v12
    v_lshlrev_b32 v11, 16, v13
    v_and_b32 v12, 0xffff0000, v13
    v_mul_f32 v11, v11, v21
    v_mul_f32 v12, v12, v21
    v_cvt_pk_bf16_f32 v42, v11, v12
    v_lshlrev_b32 v11, 16, v43
    v_and_b32 v12, 0xffff0000, v43
    v_sub_f32 v11, v11, v20
    v_sub_f32 v12, v12, v20
    v_cvt_pk_bf16_f32 v13, v11, v12
    v_lshlrev_b32 v11, 16, v13
    v_and_b32 v12, 0xffff0000, v13
    v_mul_f32 v11, v11, v21
    v_mul_f32 v12, v12, v21
    v_cvt_pk_bf16_f32 v43, v11, v12
    v_add_u32 v14, 8192, v9
    ds_write_b128 v14, v[40:43]
    v_lshlrev_b32 v11, 16, v44
    v_and_b32 v12, 0xffff0000, v44
    v_sub_f32 v11, v11, v22
    v_sub_f32 v12, v12, v22
    v_cvt_pk_bf16_f32 v13, v11, v12
    v_lshlrev_b32 v11, 16, v13
    v_and_b32 v12, 0xffff0000, v13
    v_mul_f32 v11, v11, v23
    v_mul_f32 v12, v12, v23
    v_cvt_pk_bf16_f32 v44, v11, v12
    v_lshlrev_b32 v11, 16, v45
    v_and_b32 v12, 0xffff0000, v45
    v_sub_f32 v11, v11, v22
    v_sub_f32 v12, v12, v22
    v_cvt_pk_bf16_f32 v13, v11, v12
    v_lshlrev_b32 v11, 16, v13
    v_and_b32 v12, 0xffff0000, v13
    v_mul_f32 v11, v11, v23
    v_mul_f32 v12, v12, v23
    v_cvt_pk_bf16_f32 v45, v11, v12
    v_lshlrev_b32 v11, 16, v46
    v_and_b32 v12, 0xffff0000, v46
    v_sub_f32 v11, v11, v22
    v_sub_f32 v12, v12, v22
    v_cvt_pk_bf16_f32 v13, v11, v12
    v_lshlrev_b32 v11, 16, v13
    v_and_b32 v12, 0xffff0000, v13
    v_mul_f32 v11, v11, v23
    v_mul_f32 v12, v12, v23
    v_cvt_pk_bf16_f32 v46, v11, v12
    v_lshlrev_b32 v11, 16, v47
    v_and_b32 v12, 0xffff0000, v47
    v_sub_f32 v11, v11, v22
    v_sub_f32 v12, v12, v22
    v_cvt_pk_bf16_f32 v13, v11, v12
    v_lshlrev_b32 v11, 16, v13
    v_and_b32 v12, 0xffff0000, v13
    v_mul_f32 v11, v11, v23
    v_mul_f32 v12, v12, v23
    v_cvt_pk_bf16_f32 v47, v11, v12
    v_add_u32 v14, 12288, v9
    ds_write_b128 v14, v[44:47]
    s_waitcnt lgkmcnt(0)
    s_barrier
    s_waitcnt vmcnt(0)
    v_lshlrev_b32 v11, 16, v48
    v_and_b32 v12, 0xffff0000, v48
    v_sub_f32 v11, v11, v16
    v_sub_f32 v12, v12, v16
    v_cvt_pk_bf16_f32 v13, v11, v12
    v_lshlrev_b32 v11, 16, v13
    v_and_b32 v12, 0xffff0000, v13
    v_mul_f32 v11, v11, v17
    v_mul_f32 v12, v12, v17
    v_cvt_pk_bf16_f32 v48, v11, v12
    v_lshlrev_b32 v11, 16, v49
    v_and_b32 v12, 0xffff0000, v49
    v_sub_f32 v11, v11, v16
    v_sub_f32 v12, v12, v16
    v_cvt_pk_bf16_f32 v13, v11, v12
    v_lshlrev_b32 v11, 16, v13
    v_and_b32 v12, 0xffff0000, v13
    v_mul_f32 v11, v11, v17
    v_mul_f32 v12, v12, v17
    v_cvt_pk_bf16_f32 v49, v11, v12
    v_lshlrev_b32 v11, 16, v50
    v_and_b32 v12, 0xffff0000, v50
    v_sub_f32 v11, v11, v16
    v_sub_f32 v12, v12, v16
    v_cvt_pk_bf16_f32 v13, v11, v12
    v_lshlrev_b32 v11, 16, v13
    v_and_b32 v12, 0xffff0000, v13
    v_mul_f32 v11, v11, v17
    v_mul_f32 v12, v12, v17
    v_cvt_pk_bf16_f32 v50, v11, v12
    v_lshlrev_b32 v11, 16, v51
    v_and_b32 v12, 0xffff0000, v51
    v_sub_f32 v11, v11, v16
    v_sub_f32 v12, v12, v16
    v_cvt_pk_bf16_f32 v13, v11, v12
    v_lshlrev_b32 v11, 16, v13
    v_and_b32 v12, 0xffff0000, v13
    v_mul_f32 v11, v11, v17
    v_mul_f32 v12, v12, v17
    v_cvt_pk_bf16_f32 v51, v11, v12
    v_add_u32 v14, 32768, v9
    ds_write_b128 v14, v[48:51]
    v_lshlrev_b32 v11, 16, v52
    v_and_b32 v12, 0xffff0000, v52
    v_sub_f32 v11, v11, v18
    v_sub_f32 v12, v12, v18
    v_cvt_pk_bf16_f32 v13, v11, v12
    v_lshlrev_b32 v11, 16, v13
    v_and_b32 v12, 0xffff0000, v13
    v_mul_f32 v11, v11, v19
    v_mul_f32 v12, v12, v19
    v_cvt_pk_bf16_f32 v52, v11, v12
    v_lshlrev_b32 v11, 16, v53
    v_and_b32 v12, 0xffff0000, v53
    v_sub_f32 v11, v11, v18
    v_sub_f32 v12, v12, v18
    v_cvt_pk_bf16_f32 v13, v11, v12
    v_lshlrev_b32 v11, 16, v13
    v_and_b32 v12, 0xffff0000, v13
    v_mul_f32 v11, v11, v19
    v_mul_f32 v12, v12, v19
    v_cvt_pk_bf16_f32 v53, v11, v12
    v_lshlrev_b32 v11, 16, v54
    v_and_b32 v12, 0xffff0000, v54
    v_sub_f32 v11, v11, v18
    v_sub_f32 v12, v12, v18
    v_cvt_pk_bf16_f32 v13, v11, v12
    v_lshlrev_b32 v11, 16, v13
    v_and_b32 v12, 0xffff0000, v13
    v_mul_f32 v11, v11, v19
    v_mul_f32 v12, v12, v19
    v_cvt_pk_bf16_f32 v54, v11, v12
    v_lshlrev_b32 v11, 16, v55
    v_and_b32 v12, 0xffff0000, v55
    v_sub_f32 v11, v11, v18
    v_sub_f32 v12, v12, v18
    v_cvt_pk_bf16_f32 v13, v11, v12
    v_lshlrev_b32 v11, 16, v13
    v_and_b32 v12, 0xffff0000, v13
    v_mul_f32 v11, v11, v19
    v_mul_f32 v12, v12, v19
    v_cvt_pk_bf16_f32 v55, v11, v12
    v_add_u32 v14, 36864, v9
    ds_write_b128 v14, v[52:55]
    v_lshlrev_b32 v11, 16, v56
    v_and_b32 v12, 0xffff0000, v56
    v_sub_f32 v11, v11, v20
    v_sub_f32 v12, v12, v20
    v_cvt_pk_bf16_f32 v13, v11, v12
    v_lshlrev_b32 v11, 16, v13
    v_and_b32 v12, 0xffff0000, v13
    v_mul_f32 v11, v11, v21
    v_mul_f32 v12, v12, v21
    v_cvt_pk_bf16_f32 v56, v11, v12
    v_lshlrev_b32 v11, 16, v57
    v_and_b32 v12, 0xffff0000, v57
    v_sub_f32 v11, v11, v20
    v_sub_f32 v12, v12, v20
    v_cvt_pk_bf16_f32 v13, v11, v12
    v_lshlrev_b32 v11, 16, v13
    v_and_b32 v12, 0xffff0000, v13
    v_mul_f32 v11, v11, v21
    v_mul_f32 v12, v12, v21
    v_cvt_pk_bf16_f32 v57, v11, v12
    v_lshlrev_b32 v11, 16, v58
    v_and_b32 v12, 0xffff0000, v58
    v_sub_f32 v11, v11, v20
    v_sub_f32 v12, v12, v20
    v_cvt_pk_bf16_f32 v13, v11, v12
    v_lshlrev_b32 v11, 16, v13
    v_and_b32 v12, 0xffff0000, v13
    v_mul_f32 v11, v11, v21
    v_mul_f32 v12, v12, v21
    v_cvt_pk_bf16_f32 v58, v11, v12
    v_lshlrev_b32 v11, 16, v59
    v_and_b32 v12, 0xffff0000, v59
    v_sub_f32 v11, v11, v20
    v_sub_f32 v12, v12, v20
    v_cvt_pk_bf16_f32 v13, v11, v12
    v_lshlrev_b32 v11, 16, v13
    v_and_b32 v12, 0xffff0000, v13
    v_mul_f32 v11, v11, v21
    v_mul_f32 v12, v12, v21
    v_cvt_pk_bf16_f32 v59, v11, v12
    v_add_u32 v14, 40960, v9
    ds_write_b128 v14, v[56:59]
    v_lshlrev_b32 v11, 16, v60
    v_and_b32 v12, 0xffff0000, v60
    v_sub_f32 v11, v11, v22
    v_sub_f32 v12, v12, v22
    v_cvt_pk_bf16_f32 v13, v11, v12
    v_lshlrev_b32 v11, 16, v13
    v_and_b32 v12, 0xffff0000, v13
    v_mul_f32 v11, v11, v23
    v_mul_f32 v12, v12, v23
    v_cvt_pk_bf16_f32 v60, v11, v12
    v_lshlrev_b32 v11, 16, v61
    v_and_b32 v12, 0xffff0000, v61
    v_sub_f32 v11, v11, v22
    v_sub_f32 v12, v12, v22
    v_cvt_pk_bf16_f32 v13, v11, v12
    v_lshlrev_b32 v11, 16, v13
    v_and_b32 v12, 0xffff0000, v13
    v_mul_f32 v11, v11, v23
    v_mul_f32 v12, v12, v23
    v_cvt_pk_bf16_f32 v61, v11, v12
    v_lshlrev_b32 v11, 16, v62
    v_and_b32 v12, 0xffff0000, v62
    v_sub_f32 v11, v11, v22
    v_sub_f32 v12, v12, v22
    v_cvt_pk_bf16_f32 v13, v11, v12
    v_lshlrev_b32 v11, 16, v13
    v_and_b32 v12, 0xffff0000, v13
    v_mul_f32 v11, v11, v23
    v_mul_f32 v12, v12, v23
    v_cvt_pk_bf16_f32 v62, v11, v12
    v_lshlrev_b32 v11, 16, v63
    v_and_b32 v12, 0xffff0000, v63
    v_sub_f32 v11, v11, v22
    v_sub_f32 v12, v12, v22
    v_cvt_pk_bf16_f32 v13, v11, v12
    v_lshlrev_b32 v11, 16, v13
    v_and_b32 v12, 0xffff0000, v13
    v_mul_f32 v11, v11, v23
    v_mul_f32 v12, v12, v23
    v_cvt_pk_bf16_f32 v63, v11, v12
    v_add_u32 v14, 45056, v9
    ds_write_b128 v14, v[60:63]
    s_waitcnt lgkmcnt(0)
    s_barrier
    s_waitcnt lgkmcnt(0)
    s_barrier
    s_waitcnt lgkmcnt(0)
    s_barrier
    s_branch k1n_kernel_epi
k1n_kernel_bl:
    s_sub_u32 s37, s26, 8
    s_lshl_b32 s30, s25, 1
    s_mov_b32 s31, 3840
    s_mul_i32 s29, s37, 1
    s_add_u32 s29, s29, 0
    s_lshr_b32 s32, s29, 1
    s_and_b32 s32, s32, 1
    s_lshl_b32 s32, s32, 2
    v_lshrrev_b32 v16, 4, v1
    v_add_u32 v17, s32, v16
    v_lshlrev_b32 v17, 1, v17
    v_and_b32 v18, 15, v1
    v_xor_b32 v17, v17, v18
    v_min_u32 v17, 14, v17
    v_mul_u32_u24 v18, 205, v17
    v_lshrrev_b32 v18, 10, v18
    v_mul_u32_u24 v19, 5, v18
    v_sub_u32 v19, v17, v19
    v_lshlrev_b32 v19, 4, v19
    v_mul_u32_u24 v18, 1280, v18
    s_mul_i32 s33, s36, 80
    v_add3_u32 v17, v18, v19, s33
    s_lshl_b32 s29, s29, 2
    v_add_u32 v16, s29, v16
    v_mul_lo_u32 v16, v16, s31
    v_add_u32 v2, v16, v17
    s_mul_i32 s29, s37, 1
    s_add_u32 s29, s29, 2
    s_lshr_b32 s32, s29, 1
    s_and_b32 s32, s32, 1
    s_lshl_b32 s32, s32, 2
    v_lshrrev_b32 v16, 4, v1
    v_add_u32 v17, s32, v16
    v_lshlrev_b32 v17, 1, v17
    v_and_b32 v18, 15, v1
    v_xor_b32 v17, v17, v18
    v_min_u32 v17, 14, v17
    v_mul_u32_u24 v18, 205, v17
    v_lshrrev_b32 v18, 10, v18
    v_mul_u32_u24 v19, 5, v18
    v_sub_u32 v19, v17, v19
    v_lshlrev_b32 v19, 4, v19
    v_mul_u32_u24 v18, 1280, v18
    s_mul_i32 s33, s36, 80
    v_add3_u32 v17, v18, v19, s33
    s_lshl_b32 s29, s29, 2
    v_add_u32 v16, s29, v16
    v_mul_lo_u32 v16, v16, s31
    v_add_u32 v3, v16, v17
    s_mul_i32 s29, s37, 1
    s_add_u32 s29, s29, 4
    s_lshr_b32 s32, s29, 1
    s_and_b32 s32, s32, 1
    s_lshl_b32 s32, s32, 2
    v_lshrrev_b32 v16, 4, v1
    v_add_u32 v17, s32, v16
    v_lshlrev_b32 v17, 1, v17
    v_and_b32 v18, 15, v1
    v_xor_b32 v17, v17, v18
    v_min_u32 v17, 14, v17
    v_mul_u32_u24 v18, 205, v17
    v_lshrrev_b32 v18, 10, v18
    v_mul_u32_u24 v19, 5, v18
    v_sub_u32 v19, v17, v19
    v_lshlrev_b32 v19, 4, v19
    v_mul_u32_u24 v18, 1280, v18
    s_mul_i32 s33, s36, 80
    v_add3_u32 v17, v18, v19, s33
    s_lshl_b32 s29, s29, 2
    v_add_u32 v16, s29, v16
    v_mul_lo_u32 v16, v16, s31
    v_add_u32 v4, v16, v17
    s_mul_i32 s29, s37, 1
    s_add_u32 s29, s29, 6
    s_lshr_b32 s32, s29, 1
    s_and_b32 s32, s32, 1
    s_lshl_b32 s32, s32, 2
    v_lshrrev_b32 v16, 4, v1
    v_add_u32 v17, s32, v16
    v_lshlrev_b32 v17, 1, v17
    v_and_b32 v18, 15, v1
    v_xor_b32 v17, v17, v18
    v_min_u32 v17, 14, v17
    v_mul_u32_u24 v18, 205, v17
    v_lshrrev_b32 v18, 10, v18
    v_mul_u32_u24 v19, 5, v18
    v_sub_u32 v19, v17, v19
    v_lshlrev_b32 v19, 4, v19
    v_mul_u32_u24 v18, 1280, v18
    s_mul_i32 s33, s36, 80
    v_add3_u32 v17, v18, v19, s33
    s_lshl_b32 s29, s29, 2
    v_add_u32 v16, s29, v16
    v_mul_lo_u32 v16, v16, s31
    v_add_u32 v5, v16, v17
    s_mul_i32 s29, s37, 1
    s_add_u32 s29, s29, 8
    s_lshr_b32 s32, s29, 1
    s_and_b32 s32, s32, 1
    s_lshl_b32 s32, s32, 2
    v_lshrrev_b32 v16, 4, v1
    v_add_u32 v17, s32, v16
    v_lshlrev_b32 v17, 1, v17
    v_and_b32 v18, 15, v1
    v_xor_b32 v17, v17, v18
    v_min_u32 v17, 14, v17
    v_mul_u32_u24 v18, 205, v17
    v_lshrrev_b32 v18, 10, v18
    v_mul_u32_u24 v19, 5, v18
    v_sub_u32 v19, v17, v19
    v_lshlrev_b32 v19, 4, v19
    v_mul_u32_u24 v18, 1280, v18
    s_mul_i32 s33, s36, 80
    v_add3_u32 v17, v18, v19, s33
    s_lshl_b32 s29, s29, 2
    v_add_u32 v16, s29, v16
    v_mul_lo_u32 v16, v16, s31
    v_add_u32 v6, v16, v17
    s_mul_i32 s29, s37, 1
    s_add_u32 s29, s29, 10
    s_lshr_b32 s32, s29, 1
    s_and_b32 s32, s32, 1
    s_lshl_b32 s32, s32, 2
    v_lshrrev_b32 v16, 4, v1
    v_add_u32 v17, s32, v16
    v_lshlrev_b32 v17, 1, v17
    v_and_b32 v18, 15, v1
    v_xor_b32 v17, v17, v18
    v_min_u32 v17, 14, v17
    v_mul_u32_u24 v18, 205, v17
    v_lshrrev_b32 v18, 10, v18
    v_mul_u32_u24 v19, 5, v18
    v_sub_u32 v19, v17, v19
    v_lshlrev_b32 v19, 4, v19
    v_mul_u32_u24 v18, 1280, v18
    s_mul_i32 s33, s36, 80
    v_add3_u32 v17, v18, v19, s33
    s_lshl_b32 s29, s29, 2
    v_add_u32 v16, s29, v16
    v_mul_lo_u32 v16, v16, s31
    v_add_u32 v7, v16, v17
    s_mul_i32 s29, s37, 1
    s_add_u32 s29, s29, 12
    s_lshr_b32 s32, s29, 1
    s_and_b32 s32, s32, 1
    s_lshl_b32 s32, s32, 2
    v_lshrrev_b32 v16, 4, v1
    v_add_u32 v17, s32, v16
    v_lshlrev_b32 v17, 1, v17
    v_and_b32 v18, 15, v1
    v_xor_b32 v17, v17, v18
    v_min_u32 v17, 14, v17
    v_mul_u32_u24 v18, 205, v17
    v_lshrrev_b32 v18, 10, v18
    v_mul_u32_u24 v19, 5, v18
    v_sub_u32 v19, v17, v19
    v_lshlrev_b32 v19, 4, v19
    v_mul_u32_u24 v18, 1280, v18
    s_mul_i32 s33, s36, 80
    v_add3_u32 v17, v18, v19, s33
    s_lshl_b32 s29, s29, 2
    v_add_u32 v16, s29, v16
    v_mul_lo_u32 v16, v16, s31
    v_add_u32 v8, v16, v17
    s_mul_i32 s29, s37, 1
    s_add_u32 s29, s29, 14
    s_lshr_b32 s32, s29, 1
    s_and_b32 s32, s32, 1
    s_lshl_b32 s32, s32, 2
    v_lshrrev_b32 v16, 4, v1
    v_add_u32 v17, s32, v16
    v_lshlrev_b32 v17, 1, v17
    v_and_b32 v18, 15, v1
    v_xor_b32 v17, v17, v18
    v_min_u32 v17, 14, v17
    v_mul_u32_u24 v18, 205, v17
    v_lshrrev_b32 v18, 10, v18
    v_mul_u32_u24 v19, 5, v18
    v_sub_u32 v19, v17, v19
    v_lshlrev_b32 v19, 4, v19
    v_mul_u32_u24 v18, 1280, v18
    s_mul_i32 s33, s36, 80
    v_add3_u32 v17, v18, v19, s33
    s_lshl_b32 s29, s29, 2
    v_add_u32 v16, s29, v16
    v_mul_lo_u32 v16, v16, s31
    v_add_u32 v9, v16, v17
    s_add_u32 s29, s37, 0
    s_lshl_b32 m0, s29, 10
    s_add_u32 m0, m0, 16384
    s_nop 0
    buffer_load_dwordx4 v2, s[12:15], 0 offen lds
    v_add_u32 v2, 245760, v2
    s_add_u32 s29, s37, 2
    s_lshl_b32 m0, s29, 10
    s_add_u32 m0, m0, 16384
    s_nop 0
    buffer_load_dwordx4 v3, s[12:15], 0 offen lds
    v_add_u32 v3, 245760, v3
    s_add_u32 s29, s37, 4
    s_lshl_b32 m0, s29, 10
    s_add_u32 m0, m0, 16384
    s_nop 0
    buffer_load_dwordx4 v4, s[12:15], 0 offen lds
    v_add_u32 v4, 245760, v4
    s_add_u32 s29, s37, 6
    s_lshl_b32 m0, s29, 10
    s_add_u32 m0, m0, 16384
    s_nop 0
    buffer_load_dwordx4 v5, s[12:15], 0 offen lds
    v_add_u32 v5, 245760, v5
    s_add_u32 s29, s37, 8
    s_lshl_b32 m0, s29, 10
    s_add_u32 m0, m0, 16384
    s_nop 0
    buffer_load_dwordx4 v6, s[12:15], 0 offen lds
    v_add_u32 v6, 245760, v6
    s_add_u32 s29, s37, 10
    s_lshl_b32 m0, s29, 10
    s_add_u32 m0, m0, 16384
    s_nop 0
    buffer_load_dwordx4 v7, s[12:15], 0 offen lds
    v_add_u32 v7, 245760, v7
    s_add_u32 s29, s37, 12
    s_lshl_b32 m0, s29, 10
    s_add_u32 m0, m0, 16384
    s_nop 0
    buffer_load_dwordx4 v8, s[12:15], 0 offen lds
    v_add_u32 v8, 245760, v8
    s_add_u32 s29, s37, 14
    s_lshl_b32 m0, s29, 10
    s_add_u32 m0, m0, 16384
    s_nop 0
    buffer_load_dwordx4 v9, s[12:15], 0 offen lds
    v_add_u32 v9, 245760, v9
    s_add_u32 s29, s37, 0
    s_lshl_b32 m0, s29, 10
    s_add_u32 m0, m0, 49152
    s_nop 0
    buffer_load_dwordx4 v2, s[12:15], 0 offen lds
    v_add_u32 v2, 245760, v2
    s_add_u32 s29, s37, 2
    s_lshl_b32 m0, s29, 10
    s_add_u32 m0, m0, 49152
    s_nop 0
    buffer_load_dwordx4 v3, s[12:15], 0 offen lds
    v_add_u32 v3, 245760, v3
    s_add_u32 s29, s37, 4
    s_lshl_b32 m0, s29, 10
    s_add_u32 m0, m0, 49152
    s_nop 0
    buffer_load_dwordx4 v4, s[12:15], 0 offen lds
    v_add_u32 v4, 245760, v4
    s_add_u32 s29, s37, 6
    s_lshl_b32 m0, s29, 10
    s_add_u32 m0, m0, 49152
    s_nop 0
    buffer_load_dwordx4 v5, s[12:15], 0 offen lds
    v_add_u32 v5, 245760, v5
    s_add_u32 s29, s37, 8
    s_lshl_b32 m0, s29, 10
    s_add_u32 m0, m0, 49152
    s_nop 0
    buffer_load_dwordx4 v6, s[12:15], 0 offen lds
    v_add_u32 v6, 245760, v6
    s_add_u32 s29, s37, 10
    s_lshl_b32 m0, s29, 10
    s_add_u32 m0, m0, 49152
    s_nop 0
    buffer_load_dwordx4 v7, s[12:15], 0 offen lds
    v_add_u32 v7, 245760, v7
    s_add_u32 s29, s37, 12
    s_lshl_b32 m0, s29, 10
    s_add_u32 m0, m0, 49152
    s_nop 0
    buffer_load_dwordx4 v8, s[12:15], 0 offen lds
    v_add_u32 v8, 245760, v8
    s_add_u32 s29, s37, 14
    s_lshl_b32 m0, s29, 10
    s_add_u32 m0, m0, 49152
    s_nop 0
    buffer_load_dwordx4 v9, s[12:15], 0 offen lds
    v_add_u32 v9, 245760, v9
    s_add_u32 s29, s37, 0
    s_lshl_b32 m0, s29, 10
    s_add_u32 m0, m0, 81920
    s_nop 0
    buffer_load_dwordx4 v2, s[12:15], 0 offen lds
    v_add_u32 v2, 245760, v2
    s_add_u32 s29, s37, 2
    s_lshl_b32 m0, s29, 10
    s_add_u32 m0, m0, 81920
    s_nop 0
    buffer_load_dwordx4 v3, s[12:15], 0 offen lds
    v_add_u32 v3, 245760, v3
    s_add_u32 s29, s37, 4
    s_lshl_b32 m0, s29, 10
    s_add_u32 m0, m0, 81920
    s_nop 0
    buffer_load_dwordx4 v4, s[12:15], 0 offen lds
    v_add_u32 v4, 245760, v4
    s_add_u32 s29, s37, 6
    s_lshl_b32 m0, s29, 10
    s_add_u32 m0, m0, 81920
    s_nop 0
    buffer_load_dwordx4 v5, s[12:15], 0 offen lds
    v_add_u32 v5, 245760, v5
    s_add_u32 s29, s37, 8
    s_lshl_b32 m0, s29, 10
    s_add_u32 m0, m0, 81920
    s_nop 0
    buffer_load_dwordx4 v6, s[12:15], 0 offen lds
    v_add_u32 v6, 245760, v6
    s_add_u32 s29, s37, 10
    s_lshl_b32 m0, s29, 10
    s_add_u32 m0, m0, 81920
    s_nop 0
    buffer_load_dwordx4 v7, s[12:15], 0 offen lds
    v_add_u32 v7, 245760, v7
    s_add_u32 s29, s37, 12
    s_lshl_b32 m0, s29, 10
    s_add_u32 m0, m0, 81920
    s_nop 0
    buffer_load_dwordx4 v8, s[12:15], 0 offen lds
    v_add_u32 v8, 245760, v8
    s_add_u32 s29, s37, 14
    s_lshl_b32 m0, s29, 10
    s_add_u32 m0, m0, 81920
    s_nop 0
    buffer_load_dwordx4 v9, s[12:15], 0 offen lds
    v_add_u32 v9, 245760, v9
    s_barrier
    s_waitcnt vmcnt(16)
    s_barrier
    s_add_u32 s29, s37, 0
    s_lshl_b32 m0, s29, 10
    s_add_u32 m0, m0, 114688
    s_nop 0
    buffer_load_dwordx4 v2, s[12:15], 0 offen lds
    v_add_u32 v2, 245760, v2
    s_add_u32 s29, s37, 2
    s_lshl_b32 m0, s29, 10
    s_add_u32 m0, m0, 114688
    s_nop 0
    buffer_load_dwordx4 v3, s[12:15], 0 offen lds
    v_add_u32 v3, 245760, v3
    s_add_u32 s29, s37, 4
    s_lshl_b32 m0, s29, 10
    s_add_u32 m0, m0, 114688
    s_nop 0
    buffer_load_dwordx4 v4, s[12:15], 0 offen lds
    v_add_u32 v4, 245760, v4
    s_add_u32 s29, s37, 6
    s_lshl_b32 m0, s29, 10
    s_add_u32 m0, m0, 114688
    s_nop 0
    buffer_load_dwordx4 v5, s[12:15], 0 offen lds
    v_add_u32 v5, 245760, v5
    s_add_u32 s29, s37, 8
    s_lshl_b32 m0, s29, 10
    s_add_u32 m0, m0, 114688
    s_nop 0
    buffer_load_dwordx4 v6, s[12:15], 0 offen lds
    v_add_u32 v6, 245760, v6
    s_add_u32 s29, s37, 10
    s_lshl_b32 m0, s29, 10
    s_add_u32 m0, m0, 114688
    s_nop 0
    buffer_load_dwordx4 v7, s[12:15], 0 offen lds
    v_add_u32 v7, 245760, v7
    s_add_u32 s29, s37, 12
    s_lshl_b32 m0, s29, 10
    s_add_u32 m0, m0, 114688
    s_nop 0
    buffer_load_dwordx4 v8, s[12:15], 0 offen lds
    v_add_u32 v8, 245760, v8
    s_add_u32 s29, s37, 14
    s_lshl_b32 m0, s29, 10
    s_add_u32 m0, m0, 114688
    s_nop 0
    buffer_load_dwordx4 v9, s[12:15], 0 offen lds
    v_add_u32 v9, 245760, v9
    s_waitcnt vmcnt(16)
    s_barrier
    s_add_u32 s29, s37, 0
    s_lshl_b32 m0, s29, 10
    s_add_u32 m0, m0, 16384
    s_nop 0
    buffer_load_dwordx4 v2, s[12:15], 0 offen lds
    v_add_u32 v2, 245760, v2
    s_add_u32 s29, s37, 2
    s_lshl_b32 m0, s29, 10
    s_add_u32 m0, m0, 16384
    s_nop 0
    buffer_load_dwordx4 v3, s[12:15], 0 offen lds
    v_add_u32 v3, 245760, v3
    s_add_u32 s29, s37, 4
    s_lshl_b32 m0, s29, 10
    s_add_u32 m0, m0, 16384
    s_nop 0
    buffer_load_dwordx4 v4, s[12:15], 0 offen lds
    v_add_u32 v4, 245760, v4
    s_add_u32 s29, s37, 6
    s_lshl_b32 m0, s29, 10
    s_add_u32 m0, m0, 16384
    s_nop 0
    buffer_load_dwordx4 v5, s[12:15], 0 offen lds
    v_add_u32 v5, 245760, v5
    s_add_u32 s29, s37, 8
    s_lshl_b32 m0, s29, 10
    s_add_u32 m0, m0, 16384
    s_nop 0
    buffer_load_dwordx4 v6, s[12:15], 0 offen lds
    v_add_u32 v6, 245760, v6
    s_add_u32 s29, s37, 10
    s_lshl_b32 m0, s29, 10
    s_add_u32 m0, m0, 16384
    s_nop 0
    buffer_load_dwordx4 v7, s[12:15], 0 offen lds
    v_add_u32 v7, 245760, v7
    s_add_u32 s29, s37, 12
    s_lshl_b32 m0, s29, 10
    s_add_u32 m0, m0, 16384
    s_nop 0
    buffer_load_dwordx4 v8, s[12:15], 0 offen lds
    v_add_u32 v8, 245760, v8
    s_add_u32 s29, s37, 14
    s_lshl_b32 m0, s29, 10
    s_add_u32 m0, m0, 16384
    s_nop 0
    buffer_load_dwordx4 v9, s[12:15], 0 offen lds
    v_add_u32 v9, 245760, v9
    s_waitcnt vmcnt(16)
    s_barrier
    s_add_u32 s29, s37, 0
    s_lshl_b32 m0, s29, 10
    s_add_u32 m0, m0, 49152
    s_nop 0
    buffer_load_dwordx4 v2, s[12:15], 0 offen lds
    v_add_u32 v2, 245760, v2
    s_add_u32 s29, s37, 2
    s_lshl_b32 m0, s29, 10
    s_add_u32 m0, m0, 49152
    s_nop 0
    buffer_load_dwordx4 v3, s[12:15], 0 offen lds
    v_add_u32 v3, 245760, v3
    s_add_u32 s29, s37, 4
    s_lshl_b32 m0, s29, 10
    s_add_u32 m0, m0, 49152
    s_nop 0
    buffer_load_dwordx4 v4, s[12:15], 0 offen lds
    v_add_u32 v4, 245760, v4
    s_add_u32 s29, s37, 6
    s_lshl_b32 m0, s29, 10
    s_add_u32 m0, m0, 49152
    s_nop 0
    buffer_load_dwordx4 v5, s[12:15], 0 offen lds
    v_add_u32 v5, 245760, v5
    s_add_u32 s29, s37, 8
    s_lshl_b32 m0, s29, 10
    s_add_u32 m0, m0, 49152
    s_nop 0
    buffer_load_dwordx4 v6, s[12:15], 0 offen lds
    v_add_u32 v6, 245760, v6
    s_add_u32 s29, s37, 10
    s_lshl_b32 m0, s29, 10
    s_add_u32 m0, m0, 49152
    s_nop 0
    buffer_load_dwordx4 v7, s[12:15], 0 offen lds
    v_add_u32 v7, 245760, v7
    s_add_u32 s29, s37, 12
    s_lshl_b32 m0, s29, 10
    s_add_u32 m0, m0, 49152
    s_nop 0
    buffer_load_dwordx4 v8, s[12:15], 0 offen lds
    v_add_u32 v8, 245760, v8
    s_add_u32 s29, s37, 14
    s_lshl_b32 m0, s29, 10
    s_add_u32 m0, m0, 49152
    s_nop 0
    buffer_load_dwordx4 v9, s[12:15], 0 offen lds
    v_add_u32 v9, 245760, v9
    s_waitcnt vmcnt(16)
    s_barrier
    s_add_u32 s29, s37, 0
    s_lshl_b32 m0, s29, 10
    s_add_u32 m0, m0, 81920
    s_nop 0
    buffer_load_dwordx4 v2, s[12:15], 0 offen lds
    v_add_u32 v2, 245760, v2
    s_add_u32 s29, s37, 2
    s_lshl_b32 m0, s29, 10
    s_add_u32 m0, m0, 81920
    s_nop 0
    buffer_load_dwordx4 v3, s[12:15], 0 offen lds
    v_add_u32 v3, 245760, v3
    s_add_u32 s29, s37, 4
    s_lshl_b32 m0, s29, 10
    s_add_u32 m0, m0, 81920
    s_nop 0
    buffer_load_dwordx4 v4, s[12:15], 0 offen lds
    v_add_u32 v4, 245760, v4
    s_add_u32 s29, s37, 6
    s_lshl_b32 m0, s29, 10
    s_add_u32 m0, m0, 81920
    s_nop 0
    buffer_load_dwordx4 v5, s[12:15], 0 offen lds
    v_add_u32 v5, 245760, v5
    s_add_u32 s29, s37, 8
    s_lshl_b32 m0, s29, 10
    s_add_u32 m0, m0, 81920
    s_nop 0
    buffer_load_dwordx4 v6, s[12:15], 0 offen lds
    v_add_u32 v6, 245760, v6
    s_add_u32 s29, s37, 10
    s_lshl_b32 m0, s29, 10
    s_add_u32 m0, m0, 81920
    s_nop 0
    buffer_load_dwordx4 v7, s[12:15], 0 offen lds
    v_add_u32 v7, 245760, v7
    s_add_u32 s29, s37, 12
    s_lshl_b32 m0, s29, 10
    s_add_u32 m0, m0, 81920
    s_nop 0
    buffer_load_dwordx4 v8, s[12:15], 0 offen lds
    v_add_u32 v8, 245760, v8
    s_add_u32 s29, s37, 14
    s_lshl_b32 m0, s29, 10
    s_add_u32 m0, m0, 81920
    s_nop 0
    buffer_load_dwordx4 v9, s[12:15], 0 offen lds
    v_add_u32 v9, 245760, v9
    s_waitcnt vmcnt(16)
    s_barrier
    s_add_u32 s29, s37, 0
    s_lshl_b32 m0, s29, 10
    s_add_u32 m0, m0, 114688
    s_nop 0
    buffer_load_dwordx4 v2, s[12:15], 0 offen lds
    v_add_u32 v2, 245760, v2
    s_add_u32 s29, s37, 2
    s_lshl_b32 m0, s29, 10
    s_add_u32 m0, m0, 114688
    s_nop 0
    buffer_load_dwordx4 v3, s[12:15], 0 offen lds
    v_add_u32 v3, 245760, v3
    s_add_u32 s29, s37, 4
    s_lshl_b32 m0, s29, 10
    s_add_u32 m0, m0, 114688
    s_nop 0
    buffer_load_dwordx4 v4, s[12:15], 0 offen lds
    v_add_u32 v4, 245760, v4
    s_add_u32 s29, s37, 6
    s_lshl_b32 m0, s29, 10
    s_add_u32 m0, m0, 114688
    s_nop 0
    buffer_load_dwordx4 v5, s[12:15], 0 offen lds
    v_add_u32 v5, 245760, v5
    s_add_u32 s29, s37, 8
    s_lshl_b32 m0, s29, 10
    s_add_u32 m0, m0, 114688
    s_nop 0
    buffer_load_dwordx4 v6, s[12:15], 0 offen lds
    v_add_u32 v6, 245760, v6
    s_add_u32 s29, s37, 10
    s_lshl_b32 m0, s29, 10
    s_add_u32 m0, m0, 114688
    s_nop 0
    buffer_load_dwordx4 v7, s[12:15], 0 offen lds
    v_add_u32 v7, 245760, v7
    s_add_u32 s29, s37, 12
    s_lshl_b32 m0, s29, 10
    s_add_u32 m0, m0, 114688
    s_nop 0
    buffer_load_dwordx4 v8, s[12:15], 0 offen lds
    v_add_u32 v8, 245760, v8
    s_add_u32 s29, s37, 14
    s_lshl_b32 m0, s29, 10
    s_add_u32 m0, m0, 114688
    s_nop 0
    buffer_load_dwordx4 v9, s[12:15], 0 offen lds
    v_add_u32 v9, 245760, v9
    s_waitcnt vmcnt(16)
    s_barrier
    s_add_u32 s29, s37, 0
    s_lshl_b32 m0, s29, 10
    s_add_u32 m0, m0, 16384
    s_nop 0
    buffer_load_dwordx4 v2, s[12:15], 0 offen lds
    v_add_u32 v2, 245760, v2
    s_add_u32 s29, s37, 2
    s_lshl_b32 m0, s29, 10
    s_add_u32 m0, m0, 16384
    s_nop 0
    buffer_load_dwordx4 v3, s[12:15], 0 offen lds
    v_add_u32 v3, 245760, v3
    s_add_u32 s29, s37, 4
    s_lshl_b32 m0, s29, 10
    s_add_u32 m0, m0, 16384
    s_nop 0
    buffer_load_dwordx4 v4, s[12:15], 0 offen lds
    v_add_u32 v4, 245760, v4
    s_add_u32 s29, s37, 6
    s_lshl_b32 m0, s29, 10
    s_add_u32 m0, m0, 16384
    s_nop 0
    buffer_load_dwordx4 v5, s[12:15], 0 offen lds
    v_add_u32 v5, 245760, v5
    s_add_u32 s29, s37, 8
    s_lshl_b32 m0, s29, 10
    s_add_u32 m0, m0, 16384
    s_nop 0
    buffer_load_dwordx4 v6, s[12:15], 0 offen lds
    v_add_u32 v6, 245760, v6
    s_add_u32 s29, s37, 10
    s_lshl_b32 m0, s29, 10
    s_add_u32 m0, m0, 16384
    s_nop 0
    buffer_load_dwordx4 v7, s[12:15], 0 offen lds
    v_add_u32 v7, 245760, v7
    s_add_u32 s29, s37, 12
    s_lshl_b32 m0, s29, 10
    s_add_u32 m0, m0, 16384
    s_nop 0
    buffer_load_dwordx4 v8, s[12:15], 0 offen lds
    v_add_u32 v8, 245760, v8
    s_add_u32 s29, s37, 14
    s_lshl_b32 m0, s29, 10
    s_add_u32 m0, m0, 16384
    s_nop 0
    buffer_load_dwordx4 v9, s[12:15], 0 offen lds
    v_add_u32 v9, 245760, v9
    s_waitcnt vmcnt(16)
    s_barrier
    s_add_u32 s29, s37, 0
    s_lshl_b32 m0, s29, 10
    s_add_u32 m0, m0, 49152
    s_nop 0
    buffer_load_dwordx4 v2, s[12:15], 0 offen lds
    v_add_u32 v2, 245760, v2
    s_add_u32 s29, s37, 2
    s_lshl_b32 m0, s29, 10
    s_add_u32 m0, m0, 49152
    s_nop 0
    buffer_load_dwordx4 v3, s[12:15], 0 offen lds
    v_add_u32 v3, 245760, v3
    s_add_u32 s29, s37, 4
    s_lshl_b32 m0, s29, 10
    s_add_u32 m0, m0, 49152
    s_nop 0
    buffer_load_dwordx4 v4, s[12:15], 0 offen lds
    v_add_u32 v4, 245760, v4
    s_add_u32 s29, s37, 6
    s_lshl_b32 m0, s29, 10
    s_add_u32 m0, m0, 49152
    s_nop 0
    buffer_load_dwordx4 v5, s[12:15], 0 offen lds
    v_add_u32 v5, 245760, v5
    s_add_u32 s29, s37, 8
    s_lshl_b32 m0, s29, 10
    s_add_u32 m0, m0, 49152
    s_nop 0
    buffer_load_dwordx4 v6, s[12:15], 0 offen lds
    v_add_u32 v6, 245760, v6
    s_add_u32 s29, s37, 10
    s_lshl_b32 m0, s29, 10
    s_add_u32 m0, m0, 49152
    s_nop 0
    buffer_load_dwordx4 v7, s[12:15], 0 offen lds
    v_add_u32 v7, 245760, v7
    s_add_u32 s29, s37, 12
    s_lshl_b32 m0, s29, 10
    s_add_u32 m0, m0, 49152
    s_nop 0
    buffer_load_dwordx4 v8, s[12:15], 0 offen lds
    v_add_u32 v8, 245760, v8
    s_add_u32 s29, s37, 14
    s_lshl_b32 m0, s29, 10
    s_add_u32 m0, m0, 49152
    s_nop 0
    buffer_load_dwordx4 v9, s[12:15], 0 offen lds
    v_add_u32 v9, 245760, v9
    s_waitcnt vmcnt(16)
    s_barrier
    s_waitcnt vmcnt(8)
    s_barrier
    s_waitcnt vmcnt(0)
    s_barrier
k1n_kernel_epi:
    s_mul_i32 s37, s36, 1600
    v_lshlrev_b32 v3, 1, v0
    buffer_load_ushort v150, v3, s[20:23], s37 offen
    buffer_load_ushort v151, v3, s[20:23], s37 offen offset:800
    s_barrier
    v_lshlrev_b32 v2, 3, v0
    v_mov_b32 v4, 0
    v_mov_b32 v5, 0
    v_cmp_gt_u32 vcc, 512, v0
    s_and_saveexec_b64 s[30:31], vcc
    ds_write_b64 v2, v[4:5] offset:0
    s_mov_b64 exec, s[30:31]
    s_cmp_ge_u32 s26, 4
    s_cbranch_scc1 k1n_kernel_x1
    v_and_b32 v8, 15, v1
    v_lshrrev_b32 v9, 4, v1
    v_add_u32 v8, s27, v8
    v_mul_u32_u24 v8, 272, v8
    v_lshlrev_b32 v9, 3, v9
    s_lshl_b32 s29, s28, 1
    v_add3_u32 v8, v8, v9, s29
    v_cvt_pk_bf16_f32 v80, v80, v81
    v_cvt_pk_bf16_f32 v81, v82, v83
    ds_write_b64 v8, v[80:81] offset:4096
    v_cvt_pk_bf16_f32 v84, v84, v85
    v_cvt_pk_bf16_f32 v85, v86, v87
    ds_write_b64 v8, v[84:85] offset:4128
    v_cvt_pk_bf16_f32 v88, v88, v89
    v_cvt_pk_bf16_f32 v89, v90, v91
    ds_write_b64 v8, v[88:89] offset:4160
    v_cvt_pk_bf16_f32 v92, v92, v93
    v_cvt_pk_bf16_f32 v93, v94, v95
    ds_write_b64 v8, v[92:93] offset:4192
    v_cvt_pk_bf16_f32 v96, v96, v97
    v_cvt_pk_bf16_f32 v97, v98, v99
    ds_write_b64 v8, v[96:97] offset:8448
    v_cvt_pk_bf16_f32 v100, v100, v101
    v_cvt_pk_bf16_f32 v101, v102, v103
    ds_write_b64 v8, v[100:101] offset:8480
    v_cvt_pk_bf16_f32 v104, v104, v105
    v_cvt_pk_bf16_f32 v105, v106, v107
    ds_write_b64 v8, v[104:105] offset:8512
    v_cvt_pk_bf16_f32 v108, v108, v109
    v_cvt_pk_bf16_f32 v109, v110, v111
    ds_write_b64 v8, v[108:109] offset:8544
    v_cvt_pk_bf16_f32 v112, v112, v113
    v_cvt_pk_bf16_f32 v113, v114, v115
    ds_write_b64 v8, v[112:113] offset:12800
    v_cvt_pk_bf16_f32 v116, v116, v117
    v_cvt_pk_bf16_f32 v117, v118, v119
    ds_write_b64 v8, v[116:117] offset:12832
    v_cvt_pk_bf16_f32 v120, v120, v121
    v_cvt_pk_bf16_f32 v121, v122, v123
    ds_write_b64 v8, v[120:121] offset:12864
    v_cvt_pk_bf16_f32 v124, v124, v125
    v_cvt_pk_bf16_f32 v125, v126, v127
    ds_write_b64 v8, v[124:125] offset:12896
    v_cvt_pk_bf16_f32 v128, v128, v129
    v_cvt_pk_bf16_f32 v129, v130, v131
    ds_write_b64 v8, v[128:129] offset:17152
    v_cvt_pk_bf16_f32 v132, v132, v133
    v_cvt_pk_bf16_f32 v133, v134, v135
    ds_write_b64 v8, v[132:133] offset:17184
    v_cvt_pk_bf16_f32 v136, v136, v137
    v_cvt_pk_bf16_f32 v137, v138, v139
    ds_write_b64 v8, v[136:137] offset:17216
    v_cvt_pk_bf16_f32 v140, v140, v141
    v_cvt_pk_bf16_f32 v141, v142, v143
    ds_write_b64 v8, v[140:141] offset:17248
    s_waitcnt lgkmcnt(0)
k1n_kernel_x1:
    s_waitcnt lgkmcnt(0)
    s_barrier
    s_waitcnt vmcnt(0)
    v_mul_u32_u24 v3, 205, v0
    v_lshrrev_b32 v3, 12, v3
    v_mul_u32_u24 v4, 20, v3
    v_sub_u32 v4, v0, v4
    v_lshlrev_b32 v3, 6, v3
    v_lshl_add_u32 v3, v4, 1, v3
    v_cmp_gt_u32 vcc, 400, v0
    s_and_saveexec_b64 s[30:31], vcc
    ds_write_b16 v3, v150 offset:0
    ds_write_b16 v3, v151 offset:2048
    s_mov_b64 exec, s[30:31]
    s_waitcnt lgkmcnt(0)
    s_barrier
    v_and_b32 v2, 15, v1
    v_lshrrev_b32 v3, 4, v1
    v_lshrrev_b32 v4, 2, v2
    v_and_b32 v5, 3, v1
    s_cmp_ge_u32 s26, 8
    s_cbranch_scc1 k1n_kernel_x2
    v_lshl_add_u32 v7, v3, 3, v4
    v_lshlrev_b32 v7, 6, v7
    v_lshl_add_u32 v7, v5, 3, v7
    ds_read_b64_tr_b16 v[64:65], v7 offset:0
    ds_read_b64_tr_b16 v[66:67], v7 offset:256
    ds_read_b64_tr_b16 v[68:69], v7 offset:32
    ds_read_b64_tr_b16 v[70:71], v7 offset:288
    ds_read_b64_tr_b16 v[72:73], v7 offset:2048
    ds_read_b64_tr_b16 v[74:75], v7 offset:2304
    ds_read_b64_tr_b16 v[76:77], v7 offset:2080
    ds_read_b64_tr_b16 v[78:79], v7 offset:2336
    s_lshl_b32 s33, s26, 4
    v_add_u32 v8, s33, v2
    v_mul_u32_u24 v9, 272, v8
    v_lshl_add_u32 v9, v3, 4, v9
    v_mul_u32_u24 v10, 176, v8
    v_lshl_add_u32 v10, v3, 3, v10
    v_cmp_gt_u32 s[34:35], 16, v1
    ds_read_b64 v[80:81], v9 offset:4096
    ds_read_b64 v[82:83], v9 offset:4104
    ds_read_b64 v[84:85], v9 offset:4136
    ds_read_b64 v[86:87], v9 offset:4144
    ds_read_b64 v[88:89], v9 offset:4176
    ds_read_b64 v[90:91], v9 offset:4184
    ds_read_b64 v[92:93], v9 offset:4216
    ds_read_b64 v[94:95], v9 offset:4224
    s_waitcnt lgkmcnt(0)
    v_mfma_f32_16x16x32_bf16 v[96:99], v[64:67], v[80:83], 0
    v_mfma_f32_16x16x32_bf16 v[100:103], v[68:71], v[80:83], 0
    v_mfma_f32_16x16x32_bf16 v[104:107], v[72:75], v[84:87], 0
    v_mfma_f32_16x16x32_bf16 v[108:111], v[76:79], v[84:87], 0
    v_mfma_f32_16x16x32_bf16 v[112:115], v[64:67], v[88:91], 0
    v_mfma_f32_16x16x32_bf16 v[116:119], v[68:71], v[88:91], 0
    v_mfma_f32_16x16x32_bf16 v[120:123], v[72:75], v[92:95], 0
    v_mfma_f32_16x16x32_bf16 v[124:127], v[76:79], v[92:95], 0
    s_nop 7
    v_cvt_pk_bf16_f32 v96, v96, v97
    v_cvt_pk_bf16_f32 v97, v98, v99
    ds_write_b64 v10, v[96:97] offset:38976
    v_cvt_pk_bf16_f32 v100, v100, v101
    v_cvt_pk_bf16_f32 v101, v102, v103
    s_and_saveexec_b64 s[30:31], s[34:35]
    ds_write_b64 v10, v[100:101] offset:39008
    s_mov_b64 exec, s[30:31]
    v_cvt_pk_bf16_f32 v104, v104, v105
    v_cvt_pk_bf16_f32 v105, v106, v107
    ds_write_b64 v10, v[104:105] offset:39016
    v_cvt_pk_bf16_f32 v108, v108, v109
    v_cvt_pk_bf16_f32 v109, v110, v111
    s_and_saveexec_b64 s[30:31], s[34:35]
    ds_write_b64 v10, v[108:109] offset:39048
    s_mov_b64 exec, s[30:31]
    v_cvt_pk_bf16_f32 v112, v112, v113
    v_cvt_pk_bf16_f32 v113, v114, v115
    ds_write_b64 v10, v[112:113] offset:39056
    v_cvt_pk_bf16_f32 v116, v116, v117
    v_cvt_pk_bf16_f32 v117, v118, v119
    s_and_saveexec_b64 s[30:31], s[34:35]
    ds_write_b64 v10, v[116:117] offset:39088
    s_mov_b64 exec, s[30:31]
    v_cvt_pk_bf16_f32 v120, v120, v121
    v_cvt_pk_bf16_f32 v121, v122, v123
    ds_write_b64 v10, v[120:121] offset:39096
    v_cvt_pk_bf16_f32 v124, v124, v125
    v_cvt_pk_bf16_f32 v125, v126, v127
    s_and_saveexec_b64 s[30:31], s[34:35]
    ds_write_b64 v10, v[124:125] offset:39128
    s_mov_b64 exec, s[30:31]
k1n_kernel_x2:
    s_waitcnt lgkmcnt(0)
    s_barrier
    s_cmp_ge_u32 s26, 8
    s_cbranch_scc1 k1n_kernel_x3
    v_lshrrev_b32 v8, 2, v0
    v_and_b32 v9, 3, v0
    v_mul_u32_u24 v10, 176, v8
    v_mul_u32_u24 v11, 40, v9
    v_add_u32 v10, v10, v11
    ds_read_b64 v[16:17], v10 offset:38976
    ds_read_b64 v[18:19], v10 offset:38984
    ds_read_b64 v[20:21], v10 offset:38992
    ds_read_b64 v[22:23], v10 offset:39000
    ds_read_b64 v[24:25], v10 offset:39008
    v_and_b32 v13, 1, v9
    v_mul_u32_u24 v12, 160, v8
    v_mul_u32_u24 v14, 80, v13
    v_add_u32 v12, v12, v14
    v_add_u32 v12, 61568, v12
    v_add_u32 v14, s24, v8
    v_lshrrev_b32 v15, 4, v14
    v_lshlrev_b32 v15, 5, v15
    s_lshl_b32 s28, s36, 1
    v_add3_u32 v15, v15, v13, s28
    v_lshlrev_b32 v15, 11, v15
    v_and_b32 v14, 15, v14
    v_lshl_add_u32 v14, v14, 4, v15
    s_waitcnt lgkmcnt(0)
    v_and_b32 v33, 0xffff0000, v16
    v_lshlrev_b32 v32, 16, v16
    v_and_b32 v35, 0xffff0000, v17
    v_lshlrev_b32 v34, 16, v17
    v_and_b32 v37, 0xffff0000, v18
    v_lshlrev_b32 v36, 16, v18
    v_and_b32 v39, 0xffff0000, v19
    v_lshlrev_b32 v38, 16, v19
    v_and_b32 v41, 0xffff0000, v20
    v_lshlrev_b32 v40, 16, v20
    v_and_b32 v43, 0xffff0000, v21
    v_lshlrev_b32 v42, 16, v21
    v_and_b32 v45, 0xffff0000, v22
    v_lshlrev_b32 v44, 16, v22
    v_and_b32 v47, 0xffff0000, v23
    v_lshlrev_b32 v46, 16, v23
    v_and_b32 v49, 0xffff0000, v24
    v_lshlrev_b32 v48, 16, v24
    v_and_b32 v51, 0xffff0000, v25
    v_lshlrev_b32 v50, 16, v25
    v_max_f32 v28, v32, v33
    v_min_f32 v29, v32, v33
    v_max_f32 v30, v34, v35
    v_min_f32 v31, v34, v35
    v_max_f32 v28, v28, v36
    v_min_f32 v29, v29, v36
    v_max_f32 v30, v30, v37
    v_min_f32 v31, v31, v37
    v_max_f32 v28, v28, v38
    v_min_f32 v29, v29, v38
    v_max_f32 v30, v30, v39
    v_min_f32 v31, v31, v39
    v_max_f32 v28, v28, v40
    v_min_f32 v29, v29, v40
    v_max_f32 v30, v30, v41
    v_min_f32 v31, v31, v41
    v_max_f32 v28, v28, v42
    v_min_f32 v29, v29, v42
    v_max_f32 v30, v30, v43
    v_min_f32 v31, v31, v43
    v_max_f32 v28, v28, v44
    v_min_f32 v29, v29, v44
    v_max_f32 v30, v30, v45
    v_min_f32 v31, v31, v45
    v_max_f32 v28, v28, v46
    v_min_f32 v29, v29, v46
    v_max_f32 v30, v30, v47
    v_min_f32 v31, v31, v47
    v_max_f32 v28, v28, v48
    v_min_f32 v29, v29, v48
    v_max_f32 v30, v30, v49
    v_min_f32 v31, v31, v49
    v_max_f32 v28, v28, v50
    v_min_f32 v29, v29, v50
    v_max_f32 v30, v30, v51
    v_min_f32 v31, v31, v51
    v_max_f32 v28, v28, v30
    v_min_f32 v29, v29, v31
    s_mov_b32 s38, 1069066811
    v_sub_f32 v52, v32, v28
    v_sub_f32 v72, v29, v32
    v_sub_f32 v53, v33, v28
    v_sub_f32 v73, v29, v33
    v_sub_f32 v54, v34, v28
    v_sub_f32 v74, v29, v34
    v_sub_f32 v55, v35, v28
    v_sub_f32 v75, v29, v35
    v_sub_f32 v56, v36, v28
    v_sub_f32 v76, v29, v36
    v_sub_f32 v57, v37, v28
    v_sub_f32 v77, v29, v37
    v_sub_f32 v58, v38, v28
    v_sub_f32 v78, v29, v38
    v_sub_f32 v59, v39, v28
    v_sub_f32 v79, v29, v39
    v_sub_f32 v60, v40, v28
    v_sub_f32 v80, v29, v40
    v_sub_f32 v61, v41, v28
    v_sub_f32 v81, v29, v41
    v_sub_f32 v62, v42, v28
    v_sub_f32 v82, v29, v42
    v_sub_f32 v63, v43, v28
    v_sub_f32 v83, v29, v43
    v_sub_f32 v64, v44, v28
    v_sub_f32 v84, v29, v44
    v_sub_f32 v65, v45, v28
    v_sub_f32 v85, v29, v45
    v_sub_f32 v66, v46, v28
    v_sub_f32 v86, v29, v46
    v_sub_f32 v67, v47, v28
    v_sub_f32 v87, v29, v47
    v_sub_f32 v68, v48, v28
    v_sub_f32 v88, v29, v48
    v_sub_f32 v69, v49, v28
    v_sub_f32 v89, v29, v49
    v_sub_f32 v70, v50, v28
    v_sub_f32 v90, v29, v50
    v_sub_f32 v71, v51, v28
    v_sub_f32 v91, v29, v51
    v_mul_f32 v52, s38, v52
    v_mul_f32 v72, s38, v72
    v_mul_f32 v53, s38, v53
    v_mul_f32 v73, s38, v73
    v_mul_f32 v54, s38, v54
    v_mul_f32 v74, s38, v74
    v_mul_f32 v55, s38, v55
    v_mul_f32 v75, s38, v75
    v_mul_f32 v56, s38, v56
    v_mul_f32 v76, s38, v76
    v_mul_f32 v57, s38, v57
    v_mul_f32 v77, s38, v77
    v_mul_f32 v58, s38, v58
    v_mul_f32 v78, s38, v78
    v_mul_f32 v59, s38, v59
    v_mul_f32 v79, s38, v79
    v_mul_f32 v60, s38, v60
    v_mul_f32 v80, s38, v80
    v_mul_f32 v61, s38, v61
    v_mul_f32 v81, s38, v81
    v_mul_f32 v62, s38, v62
    v_mul_f32 v82, s38, v82
    v_mul_f32 v63, s38, v63
    v_mul_f32 v83, s38, v83
    v_mul_f32 v64, s38, v64
    v_mul_f32 v84, s38, v84
    v_mul_f32 v65, s38, v65
    v_mul_f32 v85, s38, v85
    v_mul_f32 v66, s38, v66
    v_mul_f32 v86, s38, v86
    v_mul_f32 v67, s38, v67
    v_mul_f32 v87, s38, v87
    v_mul_f32 v68, s38, v68
    v_mul_f32 v88, s38, v88
    v_mul_f32 v69, s38, v69
    v_mul_f32 v89, s38, v89
    v_mul_f32 v70, s38, v70
    v_mul_f32 v90, s38, v90
    v_mul_f32 v71, s38, v71
    v_mul_f32 v91, s38, v91
    v_exp_f32 v52, v52
    v_exp_f32 v72, v72
    v_exp_f32 v53, v53
    v_exp_f32 v73, v73
    v_exp_f32 v54, v54
    v_exp_f32 v74, v74
    v_exp_f32 v55, v55
    v_exp_f32 v75, v75
    v_exp_f32 v56, v56
    v_exp_f32 v76, v76
    v_exp_f32 v57, v57
    v_exp_f32 v77, v77
    v_exp_f32 v58, v58
    v_exp_f32 v78, v78
    v_exp_f32 v59, v59
    v_exp_f32 v79, v79
    v_exp_f32 v60, v60
    v_exp_f32 v80, v80
    v_exp_f32 v61, v61
    v_exp_f32 v81, v81
    v_exp_f32 v62, v62
    v_exp_f32 v82, v82
    v_exp_f32 v63, v63
    v_exp_f32 v83, v83
    v_exp_f32 v64, v64
    v_exp_f32 v84, v84
    v_exp_f32 v65, v65
    v_exp_f32 v85, v85
    v_exp_f32 v66, v66
    v_exp_f32 v86, v86
    v_exp_f32 v67, v67
    v_exp_f32 v87, v87
    v_exp_f32 v68, v68
    v_exp_f32 v88, v88
    v_exp_f32 v69, v69
    v_exp_f32 v89, v89
    v_exp_f32 v70, v70
    v_exp_f32 v90, v90
    v_exp_f32 v71, v71
    v_exp_f32 v91, v91
    s_nop 0
    v_add_f32 v28, v52, v53
    v_add_f32 v29, v72, v73
    v_add_f32 v30, v54, v55
    v_add_f32 v31, v74, v75
    v_add_f32 v28, v28, v56
    v_add_f32 v29, v29, v76
    v_add_f32 v30, v30, v57
    v_add_f32 v31, v31, v77
    v_add_f32 v28, v28, v58
    v_add_f32 v29, v29, v78
    v_add_f32 v30, v30, v59
    v_add_f32 v31, v31, v79
    v_add_f32 v28, v28, v60
    v_add_f32 v29, v29, v80
    v_add_f32 v30, v30, v61
    v_add_f32 v31, v31, v81
    v_add_f32 v28, v28, v62
    v_add_f32 v29, v29, v82
    v_add_f32 v30, v30, v63
    v_add_f32 v31, v31, v83
    v_add_f32 v28, v28, v64
    v_add_f32 v29, v29, v84
    v_add_f32 v30, v30, v65
    v_add_f32 v31, v31, v85
    v_add_f32 v28, v28, v66
    v_add_f32 v29, v29, v86
    v_add_f32 v30, v30, v67
    v_add_f32 v31, v31, v87
    v_add_f32 v28, v28, v68
    v_add_f32 v29, v29, v88
    v_add_f32 v30, v30, v69
    v_add_f32 v31, v31, v89
    v_add_f32 v28, v28, v70
    v_add_f32 v29, v29, v90
    v_add_f32 v30, v30, v71
    v_add_f32 v31, v31, v91
    v_add_f32 v28, v28, v30
    v_add_f32 v29, v29, v31
    v_rcp_f32 v30, v28
    v_rcp_f32 v31, v29
    s_nop 0
    v_mul_f32 v92, v52, v30
    v_mul_f32 v112, v72, v31
    v_mul_f32 v93, v53, v30
    v_mul_f32 v113, v73, v31
    v_mul_f32 v94, v54, v30
    v_mul_f32 v114, v74, v31
    v_mul_f32 v95, v55, v30
    v_mul_f32 v115, v75, v31
    v_mul_f32 v96, v56, v30
    v_mul_f32 v116, v76, v31
    v_mul_f32 v97, v57, v30
    v_mul_f32 v117, v77, v31
    v_mul_f32 v98, v58, v30
    v_mul_f32 v118, v78, v31
    v_mul_f32 v99, v59, v30
    v_mul_f32 v119, v79, v31
    v_mul_f32 v100, v60, v30
    v_mul_f32 v120, v80, v31
    v_mul_f32 v101, v61, v30
    v_mul_f32 v121, v81, v31
    v_mul_f32 v102, v62, v30
    v_mul_f32 v122, v82, v31
    v_mul_f32 v103, v63, v30
    v_mul_f32 v123, v83, v31
    v_mul_f32 v104, v64, v30
    v_mul_f32 v124, v84, v31
    v_mul_f32 v105, v65, v30
    v_mul_f32 v125, v85, v31
    v_mul_f32 v106, v66, v30
    v_mul_f32 v126, v86, v31
    v_mul_f32 v107, v67, v30
    v_mul_f32 v127, v87, v31
    v_mul_f32 v108, v68, v30
    v_mul_f32 v128, v88, v31
    v_mul_f32 v109, v69, v30
    v_mul_f32 v129, v89, v31
    v_mul_f32 v110, v70, v30
    v_mul_f32 v130, v90, v31
    v_mul_f32 v111, v71, v30
    v_mul_f32 v131, v91, v31
    v_fma_f32 v52, -v92, v28, v52
    v_fma_f32 v72, -v112, v29, v72
    v_fma_f32 v53, -v93, v28, v53
    v_fma_f32 v73, -v113, v29, v73
    v_fma_f32 v54, -v94, v28, v54
    v_fma_f32 v74, -v114, v29, v74
    v_fma_f32 v55, -v95, v28, v55
    v_fma_f32 v75, -v115, v29, v75
    v_fma_f32 v56, -v96, v28, v56
    v_fma_f32 v76, -v116, v29, v76
    v_fma_f32 v57, -v97, v28, v57
    v_fma_f32 v77, -v117, v29, v77
    v_fma_f32 v58, -v98, v28, v58
    v_fma_f32 v78, -v118, v29, v78
    v_fma_f32 v59, -v99, v28, v59
    v_fma_f32 v79, -v119, v29, v79
    v_fma_f32 v60, -v100, v28, v60
    v_fma_f32 v80, -v120, v29, v80
    v_fma_f32 v61, -v101, v28, v61
    v_fma_f32 v81, -v121, v29, v81
    v_fma_f32 v62, -v102, v28, v62
    v_fma_f32 v82, -v122, v29, v82
    v_fma_f32 v63, -v103, v28, v63
    v_fma_f32 v83, -v123, v29, v83
    v_fma_f32 v64, -v104, v28, v64
    v_fma_f32 v84, -v124, v29, v84
    v_fma_f32 v65, -v105, v28, v65
    v_fma_f32 v85, -v125, v29, v85
    v_fma_f32 v66, -v106, v28, v66
    v_fma_f32 v86, -v126, v29, v86
    v_fma_f32 v67, -v107, v28, v67
    v_fma_f32 v87, -v127, v29, v87
    v_fma_f32 v68, -v108, v28, v68
    v_fma_f32 v88, -v128, v29, v88
    v_fma_f32 v69, -v109, v28, v69
    v_fma_f32 v89, -v129, v29, v89
    v_fma_f32 v70, -v110, v28, v70
    v_fma_f32 v90, -v130, v29, v90
    v_fma_f32 v71, -v111, v28, v71
    v_fma_f32 v91, -v131, v29, v91
    v_fma_f32 v52, v52, v30, v92
    v_fma_f32 v72, v72, v31, v112
    v_fma_f32 v53, v53, v30, v93
    v_fma_f32 v73, v73, v31, v113
    v_fma_f32 v54, v54, v30, v94
    v_fma_f32 v74, v74, v31, v114
    v_fma_f32 v55, v55, v30, v95
    v_fma_f32 v75, v75, v31, v115
    v_fma_f32 v56, v56, v30, v96
    v_fma_f32 v76, v76, v31, v116
    v_fma_f32 v57, v57, v30, v97
    v_fma_f32 v77, v77, v31, v117
    v_fma_f32 v58, v58, v30, v98
    v_fma_f32 v78, v78, v31, v118
    v_fma_f32 v59, v59, v30, v99
    v_fma_f32 v79, v79, v31, v119
    v_fma_f32 v60, v60, v30, v100
    v_fma_f32 v80, v80, v31, v120
    v_fma_f32 v61, v61, v30, v101
    v_fma_f32 v81, v81, v31, v121
    v_fma_f32 v62, v62, v30, v102
    v_fma_f32 v82, v82, v31, v122
    v_fma_f32 v63, v63, v30, v103
    v_fma_f32 v83, v83, v31, v123
    v_fma_f32 v64, v64, v30, v104
    v_fma_f32 v84, v84, v31, v124
    v_fma_f32 v65, v65, v30, v105
    v_fma_f32 v85, v85, v31, v125
    v_fma_f32 v66, v66, v30, v106
    v_fma_f32 v86, v86, v31, v126
    v_fma_f32 v67, v67, v30, v107
    v_fma_f32 v87, v87, v31, v127
    v_fma_f32 v68, v68, v30, v108
    v_fma_f32 v88, v88, v31, v128
    v_fma_f32 v69, v69, v30, v109
    v_fma_f32 v89, v89, v31, v129
    v_fma_f32 v70, v70, v30, v110
    v_fma_f32 v90, v90, v31, v130
    v_fma_f32 v71, v71, v30, v111
    v_fma_f32 v91, v91, v31, v131
    v_cvt_pk_bf16_f32 v16, v52, v53
    v_cvt_pk_bf16_f32 v17, v54, v55
    v_cvt_pk_bf16_f32 v18, v56, v57
    v_cvt_pk_bf16_f32 v19, v58, v59
    v_cvt_pk_bf16_f32 v20, v60, v61
    v_cvt_pk_bf16_f32 v21, v62, v63
    v_cvt_pk_bf16_f32 v22, v64, v65
    v_cvt_pk_bf16_f32 v23, v66, v67
    v_cvt_pk_bf16_f32 v24, v68, v69
    v_cvt_pk_bf16_f32 v25, v70, v71
    v_cvt_pk_bf16_f32 v26, v72, v73
    v_cvt_pk_bf16_f32 v27, v74, v75
    v_cvt_pk_bf16_f32 v28, v76, v77
    v_cvt_pk_bf16_f32 v29, v78, v79
    v_cvt_pk_bf16_f32 v30, v80, v81
    v_cvt_pk_bf16_f32 v31, v82, v83
    v_cvt_pk_bf16_f32 v32, v84, v85
    v_cvt_pk_bf16_f32 v33, v86, v87
    v_cvt_pk_bf16_f32 v34, v88, v89
    v_cvt_pk_bf16_f32 v35, v90, v91
    v_mov_b32 v36, 0
    v_mov_b32 v37, 0
    v_mov_b32 v38, 0
    v_mov_b32 v39, 0
    v_cmp_gt_u32 vcc, 2, v9
    s_and_saveexec_b64 s[30:31], vcc
    v_add_u32 v13, 0, v14
    buffer_store_dwordx4 v[16:19], v13, s[16:19], 0 offen
    v_add_u32 v13, 256, v14
    buffer_store_dwordx4 v[20:23], v13, s[16:19], 0 offen
    v_add_u32 v13, 512, v14
    buffer_store_dwordx4 v[24:27], v13, s[16:19], 0 offen
    v_add_u32 v13, 768, v14
    buffer_store_dwordx4 v[28:31], v13, s[16:19], 0 offen
    v_add_u32 v13, 1024, v14
    buffer_store_dwordx4 v[32:35], v13, s[16:19], 0 offen
    v_add_u32 v13, 1280, v14
    buffer_store_dwordx4 v[36:39], v13, s[16:19], 0 offen
    v_add_u32 v13, 1536, v14
    buffer_store_dwordx4 v[36:39], v13, s[16:19], 0 offen
    v_add_u32 v13, 1792, v14
    buffer_store_dwordx4 v[36:39], v13, s[16:19], 0 offen
    s_andn2_b64 exec, s[30:31], exec
    ds_write_b128 v12, v[16:19] offset:0
    ds_write_b128 v12, v[20:23] offset:16
    ds_write_b128 v12, v[24:27] offset:32
    ds_write_b128 v12, v[28:31] offset:48
    ds_write_b128 v12, v[32:35] offset:64
    s_mov_b64 exec, s[30:31]
k1n_kernel_x3:
    s_waitcnt lgkmcnt(0)
    s_barrier
    s_cmp_ge_u32 s26, 4
    s_cbranch_scc1 k1n_kernel_x4
    s_and_b32 s33, s26, 1
    s_lshr_b32 s34, s26, 1
    v_lshl_add_u32 v8, v3, 3, v4
    v_mul_u32_u24 v9, 272, v8
    v_lshl_add_u32 v9, v5, 3, v9
    s_mul_i32 s35, s33, 40
    s_lshl_b32 s38, s34, 5
    s_add_u32 s35, s35, s38
    v_add_u32 v9, s35, v9
    v_mul_u32_u24 v10, 160, v8
    v_lshl_add_u32 v10, v5, 3, v10
    s_mul_i32 s35, s33, 80
    s_add_u32 s35, s35, 61568
    v_add_u32 v10, s35, v10
    v_cmp_le_u32 s[38:39], 4, v2
    s_cmp_eq_u32 s34, 1
    s_cselect_b64 s[38:39], s[38:39], 0
    v_mov_b32 v11, 0x3f803f80
    ds_read_b64_tr_b16 v[16:17], v9 offset:4256
    ds_read_b64_tr_b16 v[18:19], v9 offset:5344
    ds_read_b64_tr_b16 v[20:21], v10 offset:0
    ds_read_b64_tr_b16 v[22:23], v10 offset:640
    ds_read_b64_tr_b16 v[24:25], v10 offset:32
    ds_read_b64_tr_b16 v[26:27], v10 offset:672
    ds_read_b64_tr_b16 v[28:29], v10 offset:64
    ds_read_b64_tr_b16 v[30:31], v10 offset:704
    ds_read_b64_tr_b16 v[32:33], v9 offset:12960
    ds_read_b64_tr_b16 v[34:35], v9 offset:14048
    ds_read_b64_tr_b16 v[36:37], v10 offset:5120
    ds_read_b64_tr_b16 v[38:39], v10 offset:5760
    ds_read_b64_tr_b16 v[40:41], v10 offset:5152
    ds_read_b64_tr_b16 v[42:43], v10 offset:5792
    ds_read_b64_tr_b16 v[44:45], v10 offset:5184
    ds_read_b64_tr_b16 v[46:47], v10 offset:5824
    ds_read_b64_tr_b16 v[48:49], v9 offset:21664
    ds_read_b64_tr_b16 v[50:51], v9 offset:22752
    ds_read_b64_tr_b16 v[52:53], v10 offset:10240
    ds_read_b64_tr_b16 v[54:55], v10 offset:10880
    ds_read_b64_tr_b16 v[56:57], v10 offset:10272
    ds_read_b64_tr_b16 v[58:59], v10 offset:10912
    ds_read_b64_tr_b16 v[60:61], v10 offset:10304
    ds_read_b64_tr_b16 v[62:63], v10 offset:10944
    ds_read_b64_tr_b16 v[64:65], v9 offset:30368
    ds_read_b64_tr_b16 v[66:67], v9 offset:31456
    ds_read_b64_tr_b16 v[68:69], v10 offset:15360
    ds_read_b64_tr_b16 v[70:71], v10 offset:16000
    ds_read_b64_tr_b16 v[72:73], v10 offset:15392
    ds_read_b64_tr_b16 v[74:75], v10 offset:16032
    ds_read_b64_tr_b16 v[76:77], v10 offset:15424
    ds_read_b64_tr_b16 v[78:79], v10 offset:16064
    s_waitcnt lgkmcnt(0)
    v_cndmask_b32 v16, v16, v11, s[38:39]
    v_cndmask_b32 v17, v17, v11, s[38:39]
    v_cndmask_b32 v18, v18, v11, s[38:39]
    v_cndmask_b32 v19, v19, v11, s[38:39]
    v_cndmask_b32 v32, v32, v11, s[38:39]
    v_cndmask_b32 v33, v33, v11, s[38:39]
    v_cndmask_b32 v34, v34, v11, s[38:39]
    v_cndmask_b32 v35, v35, v11, s[38:39]
    v_cndmask_b32 v48, v48, v11, s[38:39]
    v_cndmask_b32 v49, v49, v11, s[38:39]
    v_cndmask_b32 v50, v50, v11, s[38:39]
    v_cndmask_b32 v51, v51, v11, s[38:39]
    v_cndmask_b32 v64, v64, v11, s[38:39]
    v_cndmask_b32 v65, v65, v11, s[38:39]
    v_cndmask_b32 v66, v66, v11, s[38:39]
    v_cndmask_b32 v67, v67, v11, s[38:39]
    s_nop 1
    v_mfma_f32_16x16x32_bf16 v[96:99], v[16:19], v[20:23], 0
    v_mfma_f32_16x16x32_bf16 v[100:103], v[16:19], v[24:27], 0
    v_mfma_f32_16x16x32_bf16 v[104:107], v[16:19], v[28:31], 0
    v_mfma_f32_16x16x32_bf16 v[96:99], v[32:35], v[36:39], v[96:99]
    v_mfma_f32_16x16x32_bf16 v[100:103], v[32:35], v[40:43], v[100:103]
    v_mfma_f32_16x16x32_bf16 v[104:107], v[32:35], v[44:47], v[104:107]
    v_mfma_f32_16x16x32_bf16 v[96:99], v[48:51], v[52:55], v[96:99]
    v_mfma_f32_16x16x32_bf16 v[100:103], v[48:51], v[56:59], v[100:103]
    v_mfma_f32_16x16x32_bf16 v[104:107], v[48:51], v[60:63], v[104:107]
    v_mfma_f32_16x16x32_bf16 v[96:99], v[64:67], v[68:71], v[96:99]
    v_mfma_f32_16x16x32_bf16 v[100:103], v[64:67], v[72:75], v[100:103]
    v_mfma_f32_16x16x32_bf16 v[104:107], v[64:67], v[76:79], v[104:107]
    s_nop 15
    s_lshl_b32 s35, s36, 1
    s_add_u32 s35, s35, s33
    s_mul_i32 s35, s35, 12288
    v_cmp_gt_u32 s[40:41], 8, v2
    v_cmp_eq_u32 s[42:43], 0, v3
    v_cmp_gt_u32 s[48:49], 2, v3
    s_cmp_eq_u32 s34, 0
    s_cselect_b64 s[42:43], -1, s[42:43]
    s_cselect_b64 s[48:49], -1, s[48:49]
    s_mov_b64 s[30:31], exec
    v_add_u32 v12, 0, v2
    v_lshrrev_b32 v13, 5, v12
    v_and_b32 v14, 31, v12
    v_lshrrev_b32 v15, 3, v14
    v_and_b32 v14, 7, v14
    s_lshl_b32 s38, s34, 4
    v_lshl_add_u32 v6, v3, 2, 0
    v_add_u32 v6, s38, v6
    v_cmp_eq_u32 vcc, 20, v6
    v_lshrrev_b32 v7, 4, v6
    v_lshl_add_u32 v7, v7, 1, v13
    v_add_u32 v8, 4, v13
    v_cndmask_b32 v7, v7, v8, vcc
    v_and_b32 v8, 15, v6
    v_cndmask_b32 v8, v8, 0, vcc
    v_lshl_add_u32 v8, v15, 4, v8
    v_lshl_add_u32 v7, v7, 6, v8
    v_lshlrev_b32 v7, 5, v7
    v_lshl_add_u32 v7, v14, 2, v7
    s_mov_b64 exec, s[48:49]
    buffer_atomic_add_f32 v96, v7, s[44:47], s35 offen
    s_mov_b64 exec, s[30:31]
    v_add_u32 v12, 0, v2
    v_lshrrev_b32 v13, 5, v12
    v_and_b32 v14, 31, v12
    v_lshrrev_b32 v15, 3, v14
    v_and_b32 v14, 7, v14
    s_lshl_b32 s38, s34, 4
    v_lshl_add_u32 v6, v3, 2, 1
    v_add_u32 v6, s38, v6
    v_cmp_eq_u32 vcc, 20, v6
    v_lshrrev_b32 v7, 4, v6
    v_lshl_add_u32 v7, v7, 1, v13
    v_add_u32 v8, 4, v13
    v_cndmask_b32 v7, v7, v8, vcc
    v_and_b32 v8, 15, v6
    v_cndmask_b32 v8, v8, 0, vcc
    v_lshl_add_u32 v8, v15, 4, v8
    v_lshl_add_u32 v7, v7, 6, v8
    v_lshlrev_b32 v7, 5, v7
    v_lshl_add_u32 v7, v14, 2, v7
    s_mov_b64 exec, s[42:43]
    buffer_atomic_add_f32 v97, v7, s[44:47], s35 offen
    s_mov_b64 exec, s[30:31]
    v_add_u32 v12, 0, v2
    v_lshrrev_b32 v13, 5, v12
    v_and_b32 v14, 31, v12
    v_lshrrev_b32 v15, 3, v14
    v_and_b32 v14, 7, v14
    s_lshl_b32 s38, s34, 4
    v_lshl_add_u32 v6, v3, 2, 2
    v_add_u32 v6, s38, v6
    v_cmp_eq_u32 vcc, 20, v6
    v_lshrrev_b32 v7, 4, v6
    v_lshl_add_u32 v7, v7, 1, v13
    v_add_u32 v8, 4, v13
    v_cndmask_b32 v7, v7, v8, vcc
    v_and_b32 v8, 15, v6
    v_cndmask_b32 v8, v8, 0, vcc
    v_lshl_add_u32 v8, v15, 4, v8
    v_lshl_add_u32 v7, v7, 6, v8
    v_lshlrev_b32 v7, 5, v7
    v_lshl_add_u32 v7, v14, 2, v7
    s_mov_b64 exec, s[42:43]
    buffer_atomic_add_f32 v98, v7, s[44:47], s35 offen
    s_mov_b64 exec, s[30:31]
    v_add_u32 v12, 0, v2
    v_lshrrev_b32 v13, 5, v12
    v_and_b32 v14, 31, v12
    v_lshrrev_b32 v15, 3, v14
    v_and_b32 v14, 7, v14
    s_lshl_b32 s38, s34, 4
    v_lshl_add_u32 v6, v3, 2, 3
    v_add_u32 v6, s38, v6
    v_cmp_eq_u32 vcc, 20, v6
    v_lshrrev_b32 v7, 4, v6
    v_lshl_add_u32 v7, v7, 1, v13
    v_add_u32 v8, 4, v13
    v_cndmask_b32 v7, v7, v8, vcc
    v_and_b32 v8, 15, v6
    v_cndmask_b32 v8, v8, 0, vcc
    v_lshl_add_u32 v8, v15, 4, v8
    v_lshl_add_u32 v7, v7, 6, v8
    v_lshlrev_b32 v7, 5, v7
    v_lshl_add_u32 v7, v14, 2, v7
    s_mov_b64 exec, s[42:43]
    buffer_atomic_add_f32 v99, v7, s[44:47], s35 offen
    s_mov_b64 exec, s[30:31]
    v_add_u32 v12, 16, v2
    v_lshrrev_b32 v13, 5, v12
    v_and_b32 v14, 31, v12
    v_lshrrev_b32 v15, 3, v14
    v_and_b32 v14, 7, v14
    s_lshl_b32 s38, s34, 4
    v_lshl_add_u32 v6, v3, 2, 0
    v_add_u32 v6, s38, v6
    v_cmp_eq_u32 vcc, 20, v6
    v_lshrrev_b32 v7, 4, v6
    v_lshl_add_u32 v7, v7, 1, v13
    v_add_u32 v8, 4, v13
    v_cndmask_b32 v7, v7, v8, vcc
    v_and_b32 v8, 15, v6
    v_cndmask_b32 v8, v8, 0, vcc
    v_lshl_add_u32 v8, v15, 4, v8
    v_lshl_add_u32 v7, v7, 6, v8
    v_lshlrev_b32 v7, 5, v7
    v_lshl_add_u32 v7, v14, 2, v7
    s_mov_b64 exec, s[48:49]
    buffer_atomic_add_f32 v100, v7, s[44:47], s35 offen
    s_mov_b64 exec, s[30:31]
    v_add_u32 v12, 16, v2
    v_lshrrev_b32 v13, 5, v12
    v_and_b32 v14, 31, v12
    v_lshrrev_b32 v15, 3, v14
    v_and_b32 v14, 7, v14
    s_lshl_b32 s38, s34, 4
    v_lshl_add_u32 v6, v3, 2, 1
    v_add_u32 v6, s38, v6
    v_cmp_eq_u32 vcc, 20, v6
    v_lshrrev_b32 v7, 4, v6
    v_lshl_add_u32 v7, v7, 1, v13
    v_add_u32 v8, 4, v13
    v_cndmask_b32 v7, v7, v8, vcc
    v_and_b32 v8, 15, v6
    v_cndmask_b32 v8, v8, 0, vcc
    v_lshl_add_u32 v8, v15, 4, v8
    v_lshl_add_u32 v7, v7, 6, v8
    v_lshlrev_b32 v7, 5, v7
    v_lshl_add_u32 v7, v14, 2, v7
    s_mov_b64 exec, s[42:43]
    buffer_atomic_add_f32 v101, v7, s[44:47], s35 offen
    s_mov_b64 exec, s[30:31]
    v_add_u32 v12, 16, v2
    v_lshrrev_b32 v13, 5, v12
    v_and_b32 v14, 31, v12
    v_lshrrev_b32 v15, 3, v14
    v_and_b32 v14, 7, v14
    s_lshl_b32 s38, s34, 4
    v_lshl_add_u32 v6, v3, 2, 2
    v_add_u32 v6, s38, v6
    v_cmp_eq_u32 vcc, 20, v6
    v_lshrrev_b32 v7, 4, v6
    v_lshl_add_u32 v7, v7, 1, v13
    v_add_u32 v8, 4, v13
    v_cndmask_b32 v7, v7, v8, vcc
    v_and_b32 v8, 15, v6
    v_cndmask_b32 v8, v8, 0, vcc
    v_lshl_add_u32 v8, v15, 4, v8
    v_lshl_add_u32 v7, v7, 6, v8
    v_lshlrev_b32 v7, 5, v7
    v_lshl_add_u32 v7, v14, 2, v7
    s_mov_b64 exec, s[42:43]
    buffer_atomic_add_f32 v102, v7, s[44:47], s35 offen
    s_mov_b64 exec, s[30:31]
    v_add_u32 v12, 16, v2
    v_lshrrev_b32 v13, 5, v12
    v_and_b32 v14, 31, v12
    v_lshrrev_b32 v15, 3, v14
    v_and_b32 v14, 7, v14
    s_lshl_b32 s38, s34, 4
    v_lshl_add_u32 v6, v3, 2, 3
    v_add_u32 v6, s38, v6
    v_cmp_eq_u32 vcc, 20, v6
    v_lshrrev_b32 v7, 4, v6
    v_lshl_add_u32 v7, v7, 1, v13
    v_add_u32 v8, 4, v13
    v_cndmask_b32 v7, v7, v8, vcc
    v_and_b32 v8, 15, v6
    v_cndmask_b32 v8, v8, 0, vcc
    v_lshl_add_u32 v8, v15, 4, v8
    v_lshl_add_u32 v7, v7, 6, v8
    v_lshlrev_b32 v7, 5, v7
    v_lshl_add_u32 v7, v14, 2, v7
    s_mov_b64 exec, s[42:43]
    buffer_atomic_add_f32 v103, v7, s[44:47], s35 offen
    s_mov_b64 exec, s[30:31]
    v_add_u32 v12, 32, v2
    v_lshrrev_b32 v13, 5, v12
    v_and_b32 v14, 31, v12
    v_lshrrev_b32 v15, 3, v14
    v_and_b32 v14, 7, v14
    s_lshl_b32 s38, s34, 4
    v_lshl_add_u32 v6, v3, 2, 0
    v_add_u32 v6, s38, v6
    v_cmp_eq_u32 vcc, 20, v6
    v_lshrrev_b32 v7, 4, v6
    v_lshl_add_u32 v7, v7, 1, v13
    v_add_u32 v8, 4, v13
    v_cndmask_b32 v7, v7, v8, vcc
    v_and_b32 v8, 15, v6
    v_cndmask_b32 v8, v8, 0, vcc
    v_lshl_add_u32 v8, v15, 4, v8
    v_lshl_add_u32 v7, v7, 6, v8
    v_lshlrev_b32 v7, 5, v7
    v_lshl_add_u32 v7, v14, 2, v7
    s_and_b64 exec, s[48:49], s[40:41]
    buffer_atomic_add_f32 v104, v7, s[44:47], s35 offen
    s_mov_b64 exec, s[30:31]
    v_add_u32 v12, 32, v2
    v_lshrrev_b32 v13, 5, v12
    v_and_b32 v14, 31, v12
    v_lshrrev_b32 v15, 3, v14
    v_and_b32 v14, 7, v14
    s_lshl_b32 s38, s34, 4
    v_lshl_add_u32 v6, v3, 2, 1
    v_add_u32 v6, s38, v6
    v_cmp_eq_u32 vcc, 20, v6
    v_lshrrev_b32 v7, 4, v6
    v_lshl_add_u32 v7, v7, 1, v13
    v_add_u32 v8, 4, v13
    v_cndmask_b32 v7, v7, v8, vcc
    v_and_b32 v8, 15, v6
    v_cndmask_b32 v8, v8, 0, vcc
    v_lshl_add_u32 v8, v15, 4, v8
    v_lshl_add_u32 v7, v7, 6, v8
    v_lshlrev_b32 v7, 5, v7
    v_lshl_add_u32 v7, v14, 2, v7
    s_and_b64 exec, s[42:43], s[40:41]
    buffer_atomic_add_f32 v105, v7, s[44:47], s35 offen
    s_mov_b64 exec, s[30:31]
    v_add_u32 v12, 32, v2
    v_lshrrev_b32 v13, 5, v12
    v_and_b32 v14, 31, v12
    v_lshrrev_b32 v15, 3, v14
    v_and_b32 v14, 7, v14
    s_lshl_b32 s38, s34, 4
    v_lshl_add_u32 v6, v3, 2, 2
    v_add_u32 v6, s38, v6
    v_cmp_eq_u32 vcc, 20, v6
    v_lshrrev_b32 v7, 4, v6
    v_lshl_add_u32 v7, v7, 1, v13
    v_add_u32 v8, 4, v13
    v_cndmask_b32 v7, v7, v8, vcc
    v_and_b32 v8, 15, v6
    v_cndmask_b32 v8, v8, 0, vcc
    v_lshl_add_u32 v8, v15, 4, v8
    v_lshl_add_u32 v7, v7, 6, v8
    v_lshlrev_b32 v7, 5, v7
    v_lshl_add_u32 v7, v14, 2, v7
    s_and_b64 exec, s[42:43], s[40:41]
    buffer_atomic_add_f32 v106, v7, s[44:47], s35 offen
    s_mov_b64 exec, s[30:31]
    v_add_u32 v12, 32, v2
    v_lshrrev_b32 v13, 5, v12
    v_and_b32 v14, 31, v12
    v_lshrrev_b32 v15, 3, v14
    v_and_b32 v14, 7, v14
    s_lshl_b32 s38, s34, 4
    v_lshl_add_u32 v6, v3, 2, 3
    v_add_u32 v6, s38, v6
    v_cmp_eq_u32 vcc, 20, v6
    v_lshrrev_b32 v7, 4, v6
    v_lshl_add_u32 v7, v7, 1, v13
    v_add_u32 v8, 4, v13
    v_cndmask_b32 v7, v7, v8, vcc
    v_and_b32 v8, 15, v6
    v_cndmask_b32 v8, v8, 0, vcc
    v_lshl_add_u32 v8, v15, 4, v8
    v_lshl_add_u32 v7, v7, 6, v8
    v_lshlrev_b32 v7, 5, v7
    v_lshl_add_u32 v7, v14, 2, v7
    s_and_b64 exec, s[42:43], s[40:41]
    buffer_atomic_add_f32 v107, v7, s[44:47], s35 offen
    s_mov_b64 exec, s[30:31]
k1n_kernel_x4:
k1n_kernel_end:
    s_endpgm

.globl k2n_kernel
.p2align 8
.type k2n_kernel,@function
k2n_kernel:
    s_cmp_ge_u32 s2, 256
    s_cbranch_scc1 k2n_kernel_end
    s_load_dwordx16 s[64:79], s[0:1], 0
    s_load_dwordx4 s[80:83], s[0:1], 64
    v_and_b32 v1, 63, v0
    v_lshrrev_b32 v2, 6, v0
    s_nop 0
    v_readfirstlane_b32 s26, v2
    s_nop 1
    s_waitcnt lgkmcnt(0)
    s_mov_b32 s12, s70
    s_and_b32 s13, s71, 0xffff
    s_mov_b32 s14, 819200
    s_mov_b32 s15, 0x00020000
    s_add_u32 s16, s82, 20971520
    s_addc_u32 s17, s83, 0
    s_and_b32 s17, s17, 0xffff
    s_mov_b32 s18, 2621440
    s_mov_b32 s19, 0x00020000
    s_mov_b32 s20, s64
    s_and_b32 s21, s65, 0xffff
    s_mov_b32 s22, 2621440
    s_mov_b32 s23, 0x00020000
    s_add_u32 s8, s82, 67108864
    s_addc_u32 s9, s83, 0
    s_and_b32 s9, s9, 0xffff
    s_mov_b32 s10, 8388608
    s_mov_b32 s11, 0x00020000
    s_add_u32 s44, s82, 16777216
    s_addc_u32 s45, s83, 0
    s_and_b32 s45, s45, 0xffff
    s_mov_b32 s46, 393216
    s_mov_b32 s47, 0x00020000
    s_and_b32 s29, s2, 7
    s_lshr_b32 s30, s2, 3
    s_mul_i32 s31, s29, 257
    s_lshr_b32 s31, s31, 8
    s_mul_i32 s32, s31, 1
    s_sub_u32 s32, s29, s32
    s_mul_i32 s33, s30, 65
    s_lshr_b32 s33, s33, 9
    s_mul_i32 s34, s33, 8
    s_sub_u32 s34, s30, s34
    s_mul_i32 s24, s31, 4
    s_add_u32 s24, s24, s33
    s_mul_i32 s25, s32, 8
    s_add_u32 s25, s25, s34
    s_mul_i32 s24, s24, 64
    s_mul_i32 s25, s25, 80
    v_mov_b32 v2, 0
    v_mov_b32 v3, 0
    v_mov_b32 v4, 0
    v_mov_b32 v5, 0
    s_cmp_lt_u32 s26, 4
    s_cbranch_scc1 k2n_kernel_noissue
    s_sub_u32 s40, s26, 4
    s_lshl_b32 s30, s25, 1
    s_mov_b32 s31, 1280
    s_add_u32 s29, s40, 0
    s_cmp_ge_u32 s29, 10
    s_cselect_b32 s29, s40, s29
    s_lshl_b32 s29, s29, 6
    v_add_u32 v16, s29, v1
    v_mul_u32_u24 v17, 205, v16
    v_lshrrev_b32 v17, 11, v17
    v_mul_u32_u24 v18, 10, v17
    v_sub_u32 v18, v16, v18
    v_and_b32 v19, 0x33, v17
    v_and_b32 v20, 4, v17
    v_lshlrev_b32 v20, 1, v20
    v_or_b32 v19, v19, v20
    v_and_b32 v20, 8, v17
    v_lshrrev_b32 v20, 1, v20
    v_or_b32 v19, v19, v20
    v_mul_lo_u32 v19, v19, s31
    v_lshlrev_b32 v18, 4, v18
    v_add3_u32 v2, v19, v18, s30
    s_add_u32 s29, s40, 4
    s_cmp_ge_u32 s29, 10
    s_cselect_b32 s29, s40, s29
    s_lshl_b32 s29, s29, 6
    v_add_u32 v16, s29, v1
    v_mul_u32_u24 v17, 205, v16
    v_lshrrev_b32 v17, 11, v17
    v_mul_u32_u24 v18, 10, v17
    v_sub_u32 v18, v16, v18
    v_and_b32 v19, 0x33, v17
    v_and_b32 v20, 4, v17
    v_lshlrev_b32 v20, 1, v20
    v_or_b32 v19, v19, v20
    v_and_b32 v20, 8, v17
    v_lshrrev_b32 v20, 1, v20
    v_or_b32 v19, v19, v20
    v_mul_lo_u32 v19, v19, s31
    v_lshlrev_b32 v18, 4, v18
    v_add3_u32 v3, v19, v18, s30
    s_add_u32 s29, s40, 8
    s_cmp_ge_u32 s29, 10
    s_cselect_b32 s29, s40, s29
    s_lshl_b32 s29, s29, 6
    v_add_u32 v16, s29, v1
    v_mul_u32_u24 v17, 205, v16
    v_lshrrev_b32 v17, 11, v17
    v_mul_u32_u24 v18, 10, v17
    v_sub_u32 v18, v16, v18
    v_and_b32 v19, 0x33, v17
    v_and_b32 v20, 4, v17
    v_lshlrev_b32 v20, 1, v20
    v_or_b32 v19, v19, v20
    v_and_b32 v20, 8, v17
    v_lshrrev_b32 v20, 1, v20
    v_or_b32 v19, v19, v20
    v_mul_lo_u32 v19, v19, s31
    v_lshlrev_b32 v18, 4, v18
    v_add3_u32 v4, v19, v18, s30
    s_add_u32 s29, s40, 0
    s_lshl_b32 m0, s29, 10
    s_add_u32 m0, m0, 82944
    s_nop 0
    buffer_load_dwordx4 v2, s[12:15], 0 offen lds
    v_add_u32 v2, 81920, v2
    s_add_u32 s29, s40, 4
    s_lshl_b32 m0, s29, 10
    s_add_u32 m0, m0, 82944
    s_nop 0
    buffer_load_dwordx4 v3, s[12:15], 0 offen lds
    v_add_u32 v3, 81920, v3
    s_add_u32 s29, s40, 8
    s_cmp_ge_u32 s29, 10
    s_cselect_b32 s29, s40, s29
    s_lshl_b32 m0, s29, 10
    s_add_u32 m0, m0, 82944
    s_nop 0
    buffer_load_dwordx4 v4, s[12:15], 0 offen lds
    v_add_u32 v4, 81920, v4
    s_add_u32 s29, s40, 0
    s_lshl_b32 m0, s29, 10
    s_add_u32 m0, m0, 93184
    s_nop 0
    buffer_load_dwordx4 v2, s[12:15], 0 offen lds
    v_add_u32 v2, 81920, v2
    s_add_u32 s29, s40, 4
    s_lshl_b32 m0, s29, 10
    s_add_u32 m0, m0, 93184
    s_nop 0
    buffer_load_dwordx4 v3, s[12:15], 0 offen lds
    v_add_u32 v3, 81920, v3
    s_add_u32 s29, s40, 8
    s_cmp_ge_u32 s29, 10
    s_cselect_b32 s29, s40, s29
    s_lshl_b32 m0, s29, 10
    s_add_u32 m0, m0, 93184
    s_nop 0
    buffer_load_dwordx4 v4, s[12:15], 0 offen lds
    v_add_u32 v4, 81920, v4
    s_add_u32 s29, s40, 0
    s_lshl_b32 m0, s29, 10
    s_add_u32 m0, m0, 103424
    s_nop 0
    buffer_load_dwordx4 v2, s[12:15], 0 offen lds
    v_add_u32 v2, 81920, v2
    s_add_u32 s29, s40, 4
    s_lshl_b32 m0, s29, 10
    s_add_u32 m0, m0, 103424
    s_nop 0
    buffer_load_dwordx4 v3, s[12:15], 0 offen lds
    v_add_u32 v3, 81920, v3
    s_add_u32 s29, s40, 8
    s_cmp_ge_u32 s29, 10
    s_cselect_b32 s29, s40, s29
    s_lshl_b32 m0, s29, 10
    s_add_u32 m0, m0, 103424
    s_nop 0
    buffer_load_dwordx4 v4, s[12:15], 0 offen lds
    v_add_u32 v4, 81920, v4
    s_add_u32 s29, s40, 0
    s_lshl_b32 m0, s29, 10
    s_add_u32 m0, m0, 113664
    s_nop 0
    buffer_load_dwordx4 v2, s[12:15], 0 offen lds
    v_add_u32 v2, 81920, v2
    s_add_u32 s29, s40, 4
    s_lshl_b32 m0, s29, 10
    s_add_u32 m0, m0, 113664
    s_nop 0
    buffer_load_dwordx4 v3, s[12:15], 0 offen lds
    v_add_u32 v3, 81920, v3
    s_add_u32 s29, s40, 8
    s_cmp_ge_u32 s29, 10
    s_cselect_b32 s29, s40, s29
    s_lshl_b32 m0, s29, 10
    s_add_u32 m0, m0, 113664
    s_nop 0
    buffer_load_dwordx4 v4, s[12:15], 0 offen lds
    v_add_u32 v4, 81920, v4
    s_add_u32 s29, s40, 0
    s_lshl_b32 m0, s29, 10
    s_add_u32 m0, m0, 123904
    s_nop 0
    buffer_load_dwordx4 v2, s[12:15], 0 offen lds
    v_add_u32 v2, 81920, v2
    s_add_u32 s29, s40, 4
    s_lshl_b32 m0, s29, 10
    s_add_u32 m0, m0, 123904
    s_nop 0
    buffer_load_dwordx4 v3, s[12:15], 0 offen lds
    v_add_u32 v3, 81920, v3
    s_add_u32 s29, s40, 8
    s_cmp_ge_u32 s29, 10
    s_cselect_b32 s29, s40, s29
    s_lshl_b32 m0, s29, 10
    s_add_u32 m0, m0, 123904
    s_nop 0
    buffer_load_dwordx4 v4, s[12:15], 0 offen lds
    v_add_u32 v4, 81920, v4
k2n_kernel_noissue:
    v_and_b32 v120, 15, v1
    v_lshrrev_b32 v121, 4, v1
    v_lshlrev_b32 v122, 8, v120
    v_lshl_add_u32 v122, v121, 5, v122
    v_add_u32 v123, 4096, v122
    v_lshlrev_b32 v124, 5, v121
    v_add_u32 v124, 5120, v124
    v_add_u32 v125, s24, v120
    v_mul_u32_u24 v125, 2560, v125
    v_lshl_add_u32 v125, v121, 4, v125
    v_add_u32 v126, 40960, v125
    v_add_u32 v127, 81920, v125
    v_add_u32 v128, 122880, v125
    v_mul_u32_u24 v129, 1296, v120
    v_lshl_add_u32 v129, v121, 3, v129
    v_cmp_gt_u32 s[34:35], 16, v1
    v_lshlrev_b32 v122, 4, v1
    v_lshlrev_b32 v124, 5, v1
    v_and_b32 v125, 48, v1
    v_lshlrev_b32 v125, 5, v125
    s_lshr_b32 s41, s24, 4
    s_lshl_b32 s36, s26, 2
    s_add_u32 s36, s36, 0
    s_mul_i32 s37, s36, 12288
    v_add_u32 v123, 0, v124
    buffer_load_dwordx4 v[16:19], v123, s[44:47], s37 offen
    buffer_load_dwordx4 v[20:23], v123, s[44:47], s37 offen offset:16
    v_add_u32 v123, 2048, v124
    buffer_load_dwordx4 v[24:27], v123, s[44:47], s37 offen
    buffer_load_dwordx4 v[28:31], v123, s[44:47], s37 offen offset:16
    v_add_u32 v123, 4096, v124
    buffer_load_dwordx4 v[32:35], v123, s[44:47], s37 offen
    buffer_load_dwordx4 v[36:39], v123, s[44:47], s37 offen offset:16
    v_add_u32 v123, 6144, v124
    buffer_load_dwordx4 v[40:43], v123, s[44:47], s37 offen
    buffer_load_dwordx4 v[44:47], v123, s[44:47], s37 offen offset:16
    v_add_u32 v123, 8192, v125
    buffer_load_dwordx4 v[48:51], v123, s[44:47], s37 offen
    buffer_load_dwordx4 v[52:55], v123, s[44:47], s37 offen offset:16
    v_add_u32 v123, 10240, v125
    buffer_load_dwordx4 v[56:59], v123, s[44:47], s37 offen
    buffer_load_dwordx4 v[60:63], v123, s[44:47], s37 offen offset:16
    s_add_u32 s38, s41, 0
    s_lshl_b32 s38, s38, 5
    s_add_u32 s38, s38, s36
    s_lshl_b32 s38, s38, 11
    buffer_load_dwordx4 a[0:3], v122, s[8:11], s38 offen offset:0
    buffer_load_dwordx4 a[4:7], v122, s[8:11], s38 offen offset:1024
    s_add_u32 s38, s41, 1
    s_lshl_b32 s38, s38, 5
    s_add_u32 s38, s38, s36
    s_lshl_b32 s38, s38, 11
    buffer_load_dwordx4 a[8:11], v122, s[8:11], s38 offen offset:0
    buffer_load_dwordx4 a[12:15], v122, s[8:11], s38 offen offset:1024
    s_add_u32 s38, s41, 2
    s_lshl_b32 s38, s38, 5
    s_add_u32 s38, s38, s36
    s_lshl_b32 s38, s38, 11
    buffer_load_dwordx4 a[16:19], v122, s[8:11], s38 offen offset:0
    buffer_load_dwordx4 a[20:23], v122, s[8:11], s38 offen offset:1024
    s_add_u32 s38, s41, 3
    s_lshl_b32 s38, s38, 5
    s_add_u32 s38, s38, s36
    s_lshl_b32 s38, s38, 11
    buffer_load_dwordx4 a[24:27], v122, s[8:11], s38 offen offset:0
    buffer_load_dwordx4 a[28:31], v122, s[8:11], s38 offen offset:1024
    s_lshl_b32 s36, s26, 2
    s_add_u32 s36, s36, 1
    s_mul_i32 s37, s36, 12288
    v_add_u32 v123, 0, v124
    buffer_load_dwordx4 v[64:67], v123, s[44:47], s37 offen
    buffer_load_dwordx4 v[68:71], v123, s[44:47], s37 offen offset:16
    v_add_u32 v123, 2048, v124
    buffer_load_dwordx4 v[72:75], v123, s[44:47], s37 offen
    buffer_load_dwordx4 v[76:79], v123, s[44:47], s37 offen offset:16
    v_add_u32 v123, 4096, v124
    buffer_load_dwordx4 v[80:83], v123, s[44:47], s37 offen
    buffer_load_dwordx4 v[84:87], v123, s[44:47], s37 offen offset:16
    v_add_u32 v123, 6144, v124
    buffer_load_dwordx4 v[88:91], v123, s[44:47], s37 offen
    buffer_load_dwordx4 v[92:95], v123, s[44:47], s37 offen offset:16
    v_add_u32 v123, 8192, v125
    buffer_load_dwordx4 v[96:99], v123, s[44:47], s37 offen
    buffer_load_dwordx4 v[100:103], v123, s[44:47], s37 offen offset:16
    v_add_u32 v123, 10240, v125
    buffer_load_dwordx4 v[104:107], v123, s[44:47], s37 offen
    buffer_load_dwordx4 v[108:111], v123, s[44:47], s37 offen offset:16
    s_add_u32 s38, s41, 0
    s_lshl_b32 s38, s38, 5
    s_add_u32 s38, s38, s36
    s_lshl_b32 s38, s38, 11
    buffer_load_dwordx4 a[32:35], v122, s[8:11], s38 offen offset:0
    buffer_load_dwordx4 a[36:39], v122, s[8:11], s38 offen offset:1024
    s_add_u32 s38, s41, 1
    s_lshl_b32 s38, s38, 5
    s_add_u32 s38, s38, s36
    s_lshl_b32 s38, s38, 11
    buffer_load_dwordx4 a[40:43], v122, s[8:11], s38 offen offset:0
    buffer_load_dwordx4 a[44:47], v122, s[8:11], s38 offen offset:1024
    s_add_u32 s38, s41, 2
    s_lshl_b32 s38, s38, 5
    s_add_u32 s38, s38, s36
    s_lshl_b32 s38, s38, 11
    buffer_load_dwordx4 a[48:51], v122, s[8:11], s38 offen offset:0
    buffer_load_dwordx4 a[52:55], v122, s[8:11], s38 offen offset:1024
    s_add_u32 s38, s41, 3
    s_lshl_b32 s38, s38, 5
    s_add_u32 s38, s38, s36
    s_lshl_b32 s38, s38, 11
    buffer_load_dwordx4 a[56:59], v122, s[8:11], s38 offen offset:0
    buffer_load_dwordx4 a[60:63], v122, s[8:11], s38 offen offset:1024
    s_waitcnt vmcnt(20)
    v_cvt_pk_bf16_f32 v16, v16, v17
    v_cvt_pk_bf16_f32 v17, v18, v19
    v_cvt_pk_bf16_f32 v18, v20, v21
    v_cvt_pk_bf16_f32 v19, v22, v23
    v_cvt_pk_bf16_f32 v24, v24, v25
    v_cvt_pk_bf16_f32 v25, v26, v27
    v_cvt_pk_bf16_f32 v26, v28, v29
    v_cvt_pk_bf16_f32 v27, v30, v31
    v_cvt_pk_bf16_f32 v32, v32, v33
    v_cvt_pk_bf16_f32 v33, v34, v35
    v_cvt_pk_bf16_f32 v34, v36, v37
    v_cvt_pk_bf16_f32 v35, v38, v39
    v_cvt_pk_bf16_f32 v40, v40, v41
    v_cvt_pk_bf16_f32 v41, v42, v43
    v_cvt_pk_bf16_f32 v42, v44, v45
    v_cvt_pk_bf16_f32 v43, v46, v47
    v_cvt_pk_bf16_f32 v48, v48, v49
    v_cvt_pk_bf16_f32 v49, v50, v51
    v_cvt_pk_bf16_f32 v50, v52, v53
    v_cvt_pk_bf16_f32 v51, v54, v55
    v_cvt_pk_bf16_f32 v56, v56, v57
    v_cvt_pk_bf16_f32 v57, v58, v59
    v_cvt_pk_bf16_f32 v58, v60, v61
    v_cvt_pk_bf16_f32 v59, v62, v63
    s_lshl_b32 s36, s26, 2
    s_add_u32 s36, s36, 0
    s_mul_i32 s39, s36, 40
    s_nop 0
    v_mfma_f32_16x16x32_bf16 v[132:135], v[16:19], a[0:3], 0
    v_mfma_f32_16x16x32_bf16 v[132:135], v[24:27], a[4:7], v[132:135]
    v_mfma_f32_16x16x32_bf16 v[136:139], v[32:35], a[0:3], 0
    v_mfma_f32_16x16x32_bf16 v[136:139], v[40:43], a[4:7], v[136:139]
    v_mfma_f32_16x16x32_bf16 v[140:143], v[48:51], a[0:3], 0
    v_mfma_f32_16x16x32_bf16 v[140:143], v[56:59], a[4:7], v[140:143]
    s_nop 7
    v_cvt_pk_bf16_f32 v144, v140, v140
    v_lshlrev_b32 v144, 16, v144
    v_add_f32 v144, 0x358637bd, v144
    v_cvt_pk_bf16_f32 v144, v144, v144
    v_lshlrev_b32 v144, 16, v144
    v_rcp_f32 v145, v144
    v_add_u32 v130, 0, v129
    v_add_u32 v130, s39, v130
    v_cvt_pk_bf16_f32 v132, v132, v132
    v_lshlrev_b32 v132, 16, v132
    v_cvt_pk_bf16_f32 v133, v133, v133
    v_lshlrev_b32 v133, 16, v133
    v_cvt_pk_bf16_f32 v134, v134, v134
    v_lshlrev_b32 v134, 16, v134
    v_cvt_pk_bf16_f32 v135, v135, v135
    v_lshlrev_b32 v135, 16, v135
    v_mul_f32 v146, v132, v145
    v_mul_f32 v147, v133, v145
    v_mul_f32 v148, v134, v145
    v_mul_f32 v149, v135, v145
    v_fma_f32 v132, -v146, v144, v132
    v_fma_f32 v133, -v147, v144, v133
    v_fma_f32 v134, -v148, v144, v134
    v_fma_f32 v135, -v149, v144, v135
    v_fma_f32 v132, v132, v145, v146
    v_fma_f32 v133, v133, v145, v147
    v_fma_f32 v134, v134, v145, v148
    v_fma_f32 v135, v135, v145, v149
    v_cvt_pk_bf16_f32 v132, v132, v133
    v_cvt_pk_bf16_f32 v133, v134, v135
    ds_write_b64 v130, v[132:133] offset:0
    v_cvt_pk_bf16_f32 v136, v136, v136
    v_lshlrev_b32 v136, 16, v136
    v_cvt_pk_bf16_f32 v137, v137, v137
    v_lshlrev_b32 v137, 16, v137
    v_cvt_pk_bf16_f32 v138, v138, v138
    v_lshlrev_b32 v138, 16, v138
    v_cvt_pk_bf16_f32 v139, v139, v139
    v_lshlrev_b32 v139, 16, v139
    v_mul_f32 v146, v136, v145
    v_mul_f32 v147, v137, v145
    v_mul_f32 v148, v138, v145
    v_mul_f32 v149, v139, v145
    v_fma_f32 v136, -v146, v144, v136
    v_fma_f32 v137, -v147, v144, v137
    v_fma_f32 v138, -v148, v144, v138
    v_fma_f32 v139, -v149, v144, v139
    v_fma_f32 v136, v136, v145, v146
    v_fma_f32 v137, v137, v145, v147
    v_fma_f32 v138, v138, v145, v148
    v_fma_f32 v139, v139, v145, v149
    v_cvt_pk_bf16_f32 v136, v136, v137
    v_cvt_pk_bf16_f32 v137, v138, v139
    s_and_saveexec_b64 s[30:31], s[34:35]
    ds_write_b64 v130, v[136:137] offset:32
    s_mov_b64 exec, s[30:31]
    v_mfma_f32_16x16x32_bf16 v[132:135], v[16:19], a[8:11], 0
    v_mfma_f32_16x16x32_bf16 v[132:135], v[24:27], a[12:15], v[132:135]
    v_mfma_f32_16x16x32_bf16 v[136:139], v[32:35], a[8:11], 0
    v_mfma_f32_16x16x32_bf16 v[136:139], v[40:43], a[12:15], v[136:139]
    v_mfma_f32_16x16x32_bf16 v[140:143], v[48:51], a[8:11], 0
    v_mfma_f32_16x16x32_bf16 v[140:143], v[56:59], a[12:15], v[140:143]
    s_nop 7
    v_cvt_pk_bf16_f32 v144, v140, v140
    v_lshlrev_b32 v144, 16, v144
    v_add_f32 v144, 0x358637bd, v144
    v_cvt_pk_bf16_f32 v144, v144, v144
    v_lshlrev_b32 v144, 16, v144
    v_rcp_f32 v145, v144
    v_add_u32 v130, 20736, v129
    v_add_u32 v130, s39, v130
    v_cvt_pk_bf16_f32 v132, v132, v132
    v_lshlrev_b32 v132, 16, v132
    v_cvt_pk_bf16_f32 v133, v133, v133
    v_lshlrev_b32 v133, 16, v133
    v_cvt_pk_bf16_f32 v134, v134, v134
    v_lshlrev_b32 v134, 16, v134
    v_cvt_pk_bf16_f32 v135, v135, v135
    v_lshlrev_b32 v135, 16, v135
    v_mul_f32 v146, v132, v145
    v_mul_f32 v147, v133, v145
    v_mul_f32 v148, v134, v145
    v_mul_f32 v149, v135, v145
    v_fma_f32 v132, -v146, v144, v132
    v_fma_f32 v133, -v147, v144, v133
    v_fma_f32 v134, -v148, v144, v134
    v_fma_f32 v135, -v149, v144, v135
    v_fma_f32 v132, v132, v145, v146
    v_fma_f32 v133, v133, v145, v147
    v_fma_f32 v134, v134, v145, v148
    v_fma_f32 v135, v135, v145, v149
    v_cvt_pk_bf16_f32 v132, v132, v133
    v_cvt_pk_bf16_f32 v133, v134, v135
    ds_write_b64 v130, v[132:133] offset:0
    v_cvt_pk_bf16_f32 v136, v136, v136
    v_lshlrev_b32 v136, 16, v136
    v_cvt_pk_bf16_f32 v137, v137, v137
    v_lshlrev_b32 v137, 16, v137
    v_cvt_pk_bf16_f32 v138, v138, v138
    v_lshlrev_b32 v138, 16, v138
    v_cvt_pk_bf16_f32 v139, v139, v139
    v_lshlrev_b32 v139, 16, v139
    v_mul_f32 v146, v136, v145
    v_mul_f32 v147, v137, v145
    v_mul_f32 v148, v138, v145
    v_mul_f32 v149, v139, v145
    v_fma_f32 v136, -v146, v144, v136
    v_fma_f32 v137, -v147, v144, v137
    v_fma_f32 v138, -v148, v144, v138
    v_fma_f32 v139, -v149, v144, v139
    v_fma_f32 v136, v136, v145, v146
    v_fma_f32 v137, v137, v145, v147
    v_fma_f32 v138, v138, v145, v148
    v_fma_f32 v139, v139, v145, v149
    v_cvt_pk_bf16_f32 v136, v136, v137
    v_cvt_pk_bf16_f32 v137, v138, v139
    s_and_saveexec_b64 s[30:31], s[34:35]
    ds_write_b64 v130, v[136:137] offset:32
    s_mov_b64 exec, s[30:31]
    v_mfma_f32_16x16x32_bf16 v[132:135], v[16:19], a[16:19], 0
    v_mfma_f32_16x16x32_bf16 v[132:135], v[24:27], a[20:23], v[132:135]
    v_mfma_f32_16x16x32_bf16 v[136:139], v[32:35], a[16:19], 0
    v_mfma_f32_16x16x32_bf16 v[136:139], v[40:43], a[20:23], v[136:139]
    v_mfma_f32_16x16x32_bf16 v[140:143], v[48:51], a[16:19], 0
    v_mfma_f32_16x16x32_bf16 v[140:143], v[56:59], a[20:23], v[140:143]
    s_nop 7
    v_cvt_pk_bf16_f32 v144, v140, v140
    v_lshlrev_b32 v144, 16, v144
    v_add_f32 v144, 0x358637bd, v144
    v_cvt_pk_bf16_f32 v144, v144, v144
    v_lshlrev_b32 v144, 16, v144
    v_rcp_f32 v145, v144
    v_add_u32 v130, 41472, v129
    v_add_u32 v130, s39, v130
    v_cvt_pk_bf16_f32 v132, v132, v132
    v_lshlrev_b32 v132, 16, v132
    v_cvt_pk_bf16_f32 v133, v133, v133
    v_lshlrev_b32 v133, 16, v133
    v_cvt_pk_bf16_f32 v134, v134, v134
    v_lshlrev_b32 v134, 16, v134
    v_cvt_pk_bf16_f32 v135, v135, v135
    v_lshlrev_b32 v135, 16, v135
    v_mul_f32 v146, v132, v145
    v_mul_f32 v147, v133, v145
    v_mul_f32 v148, v134, v145
    v_mul_f32 v149, v135, v145
    v_fma_f32 v132, -v146, v144, v132
    v_fma_f32 v133, -v147, v144, v133
    v_fma_f32 v134, -v148, v144, v134
    v_fma_f32 v135, -v149, v144, v135
    v_fma_f32 v132, v132, v145, v146
    v_fma_f32 v133, v133, v145, v147
    v_fma_f32 v134, v134, v145, v148
    v_fma_f32 v135, v135, v145, v149
    v_cvt_pk_bf16_f32 v132, v132, v133
    v_cvt_pk_bf16_f32 v133, v134, v135
    ds_write_b64 v130, v[132:133] offset:0
    v_cvt_pk_bf16_f32 v136, v136, v136
    v_lshlrev_b32 v136, 16, v136
    v_cvt_pk_bf16_f32 v137, v137, v137
    v_lshlrev_b32 v137, 16, v137
    v_cvt_pk_bf16_f32 v138, v138, v138
    v_lshlrev_b32 v138, 16, v138
    v_cvt_pk_bf16_f32 v139, v139, v139
    v_lshlrev_b32 v139, 16, v139
    v_mul_f32 v146, v136, v145
    v_mul_f32 v147, v137, v145
    v_mul_f32 v148, v138, v145
    v_mul_f32 v149, v139, v145
    v_fma_f32 v136, -v146, v144, v136
    v_fma_f32 v137, -v147, v144, v137
    v_fma_f32 v138, -v148, v144, v138
    v_fma_f32 v139, -v149, v144, v139
    v_fma_f32 v136, v136, v145, v146
    v_fma_f32 v137, v137, v145, v147
    v_fma_f32 v138, v138, v145, v148
    v_fma_f32 v139, v139, v145, v149
    v_cvt_pk_bf16_f32 v136, v136, v137
    v_cvt_pk_bf16_f32 v137, v138, v139
    s_and_saveexec_b64 s[30:31], s[34:35]
    ds_write_b64 v130, v[136:137] offset:32
    s_mov_b64 exec, s[30:31]
    v_mfma_f32_16x16x32_bf16 v[132:135], v[16:19], a[24:27], 0
    v_mfma_f32_16x16x32_bf16 v[132:135], v[24:27], a[28:31], v[132:135]
    v_mfma_f32_16x16x32_bf16 v[136:139], v[32:35], a[24:27], 0
    v_mfma_f32_16x16x32_bf16 v[136:139], v[40:43], a[28:31], v[136:139]
    v_mfma_f32_16x16x32_bf16 v[140:143], v[48:51], a[24:27], 0
    v_mfma_f32_16x16x32_bf16 v[140:143], v[56:59], a[28:31], v[140:143]
    s_nop 7
    v_cvt_pk_bf16_f32 v144, v140, v140
    v_lshlrev_b32 v144, 16, v144
    v_add_f32 v144, 0x358637bd, v144
    v_cvt_pk_bf16_f32 v144, v144, v144
    v_lshlrev_b32 v144, 16, v144
    v_rcp_f32 v145, v144
    v_add_u32 v130, 62208, v129
    v_add_u32 v130, s39, v130
    v_cvt_pk_bf16_f32 v132, v132, v132
    v_lshlrev_b32 v132, 16, v132
    v_cvt_pk_bf16_f32 v133, v133, v133
    v_lshlrev_b32 v133, 16, v133
    v_cvt_pk_bf16_f32 v134, v134, v134
    v_lshlrev_b32 v134, 16, v134
    v_cvt_pk_bf16_f32 v135, v135, v135
    v_lshlrev_b32 v135, 16, v135
    v_mul_f32 v146, v132, v145
    v_mul_f32 v147, v133, v145
    v_mul_f32 v148, v134, v145
    v_mul_f32 v149, v135, v145
    v_fma_f32 v132, -v146, v144, v132
    v_fma_f32 v133, -v147, v144, v133
    v_fma_f32 v134, -v148, v144, v134
    v_fma_f32 v135, -v149, v144, v135
    v_fma_f32 v132, v132, v145, v146
    v_fma_f32 v133, v133, v145, v147
    v_fma_f32 v134, v134, v145, v148
    v_fma_f32 v135, v135, v145, v149
    v_cvt_pk_bf16_f32 v132, v132, v133
    v_cvt_pk_bf16_f32 v133, v134, v135
    ds_write_b64 v130, v[132:133] offset:0
    v_cvt_pk_bf16_f32 v136, v136, v136
    v_lshlrev_b32 v136, 16, v136
    v_cvt_pk_bf16_f32 v137, v137, v137
    v_lshlrev_b32 v137, 16, v137
    v_cvt_pk_bf16_f32 v138, v138, v138
    v_lshlrev_b32 v138, 16, v138
    v_cvt_pk_bf16_f32 v139, v139, v139
    v_lshlrev_b32 v139, 16, v139
    v_mul_f32 v146, v136, v145
    v_mul_f32 v147, v137, v145
    v_mul_f32 v148, v138, v145
    v_mul_f32 v149, v139, v145
    v_fma_f32 v136, -v146, v144, v136
    v_fma_f32 v137, -v147, v144, v137
    v_fma_f32 v138, -v148, v144, v138
    v_fma_f32 v139, -v149, v144, v139
    v_fma_f32 v136, v136, v145, v146
    v_fma_f32 v137, v137, v145, v147
    v_fma_f32 v138, v138, v145, v148
    v_fma_f32 v139, v139, v145, v149
    v_cvt_pk_bf16_f32 v136, v136, v137
    v_cvt_pk_bf16_f32 v137, v138, v139
    s_and_saveexec_b64 s[30:31], s[34:35]
    ds_write_b64 v130, v[136:137] offset:32
    s_mov_b64 exec, s[30:31]
    s_nop 7
    s_lshl_b32 s36, s26, 2
    s_add_u32 s36, s36, 2
    s_mul_i32 s37, s36, 12288
    v_add_u32 v123, 0, v124
    buffer_load_dwordx4 v[16:19], v123, s[44:47], s37 offen
    buffer_load_dwordx4 v[20:23], v123, s[44:47], s37 offen offset:16
    v_add_u32 v123, 2048, v124
    buffer_load_dwordx4 v[24:27], v123, s[44:47], s37 offen
    buffer_load_dwordx4 v[28:31], v123, s[44:47], s37 offen offset:16
    v_add_u32 v123, 4096, v124
    buffer_load_dwordx4 v[32:35], v123, s[44:47], s37 offen
    buffer_load_dwordx4 v[36:39], v123, s[44:47], s37 offen offset:16
    v_add_u32 v123, 6144, v124
    buffer_load_dwordx4 v[40:43], v123, s[44:47], s37 offen
    buffer_load_dwordx4 v[44:47], v123, s[44:47], s37 offen offset:16
    v_add_u32 v123, 8192, v125
    buffer_load_dwordx4 v[48:51], v123, s[44:47], s37 offen
    buffer_load_dwordx4 v[52:55], v123, s[44:47], s37 offen offset:16
    v_add_u32 v123, 10240, v125
    buffer_load_dwordx4 v[56:59], v123, s[44:47], s37 offen
    buffer_load_dwordx4 v[60:63], v123, s[44:47], s37 offen offset:16
    s_add_u32 s38, s41, 0
    s_lshl_b32 s38, s38, 5
    s_add_u32 s38, s38, s36
    s_lshl_b32 s38, s38, 11
    buffer_load_dwordx4 a[0:3], v122, s[8:11], s38 offen offset:0
    buffer_load_dwordx4 a[4:7], v122, s[8:11], s38 offen offset:1024
    s_add_u32 s38, s41, 1
    s_lshl_b32 s38, s38, 5
    s_add_u32 s38, s38, s36
    s_lshl_b32 s38, s38, 11
    buffer_load_dwordx4 a[8:11], v122, s[8:11], s38 offen offset:0
    buffer_load_dwordx4 a[12:15], v122, s[8:11], s38 offen offset:1024
    s_add_u32 s38, s41, 2
    s_lshl_b32 s38, s38, 5
    s_add_u32 s38, s38, s36
    s_lshl_b32 s38, s38, 11
    buffer_load_dwordx4 a[16:19], v122, s[8:11], s38 offen offset:0
    buffer_load_dwordx4 a[20:23], v122, s[8:11], s38 offen offset:1024
    s_add_u32 s38, s41, 3
    s_lshl_b32 s38, s38, 5
    s_add_u32 s38, s38, s36
    s_lshl_b32 s38, s38, 11
    buffer_load_dwordx4 a[24:27], v122, s[8:11], s38 offen offset:0
    buffer_load_dwordx4 a[28:31], v122, s[8:11], s38 offen offset:1024
    s_waitcnt vmcnt(20)
    v_cvt_pk_bf16_f32 v64, v64, v65
    v_cvt_pk_bf16_f32 v65, v66, v67
    v_cvt_pk_bf16_f32 v66, v68, v69
    v_cvt_pk_bf16_f32 v67, v70, v71
    v_cvt_pk_bf16_f32 v72, v72, v73
    v_cvt_pk_bf16_f32 v73, v74, v75
    v_cvt_pk_bf16_f32 v74, v76, v77
    v_cvt_pk_bf16_f32 v75, v78, v79
    v_cvt_pk_bf16_f32 v80, v80, v81
    v_cvt_pk_bf16_f32 v81, v82, v83
    v_cvt_pk_bf16_f32 v82, v84, v85
    v_cvt_pk_bf16_f32 v83, v86, v87
    v_cvt_pk_bf16_f32 v88, v88, v89
    v_cvt_pk_bf16_f32 v89, v90, v91
    v_cvt_pk_bf16_f32 v90, v92, v93
    v_cvt_pk_bf16_f32 v91, v94, v95
    v_cvt_pk_bf16_f32 v96, v96, v97
    v_cvt_pk_bf16_f32 v97, v98, v99
    v_cvt_pk_bf16_f32 v98, v100, v101
    v_cvt_pk_bf16_f32 v99, v102, v103
    v_cvt_pk_bf16_f32 v104, v104, v105
    v_cvt_pk_bf16_f32 v105, v106, v107
    v_cvt_pk_bf16_f32 v106, v108, v109
    v_cvt_pk_bf16_f32 v107, v110, v111
    s_lshl_b32 s36, s26, 2
    s_add_u32 s36, s36, 1
    s_mul_i32 s39, s36, 40
    s_nop 0
    v_mfma_f32_16x16x32_bf16 v[132:135], v[64:67], a[32:35], 0
    v_mfma_f32_16x16x32_bf16 v[132:135], v[72:75], a[36:39], v[132:135]
    v_mfma_f32_16x16x32_bf16 v[136:139], v[80:83], a[32:35], 0
    v_mfma_f32_16x16x32_bf16 v[136:139], v[88:91], a[36:39], v[136:139]
    v_mfma_f32_16x16x32_bf16 v[140:143], v[96:99], a[32:35], 0
    v_mfma_f32_16x16x32_bf16 v[140:143], v[104:107], a[36:39], v[140:143]
    s_nop 7
    v_cvt_pk_bf16_f32 v144, v140, v140
    v_lshlrev_b32 v144, 16, v144
    v_add_f32 v144, 0x358637bd, v144
    v_cvt_pk_bf16_f32 v144, v144, v144
    v_lshlrev_b32 v144, 16, v144
    v_rcp_f32 v145, v144
    v_add_u32 v130, 0, v129
    v_add_u32 v130, s39, v130
    v_cvt_pk_bf16_f32 v132, v132, v132
    v_lshlrev_b32 v132, 16, v132
    v_cvt_pk_bf16_f32 v133, v133, v133
    v_lshlrev_b32 v133, 16, v133
    v_cvt_pk_bf16_f32 v134, v134, v134
    v_lshlrev_b32 v134, 16, v134
    v_cvt_pk_bf16_f32 v135, v135, v135
    v_lshlrev_b32 v135, 16, v135
    v_mul_f32 v146, v132, v145
    v_mul_f32 v147, v133, v145
    v_mul_f32 v148, v134, v145
    v_mul_f32 v149, v135, v145
    v_fma_f32 v132, -v146, v144, v132
    v_fma_f32 v133, -v147, v144, v133
    v_fma_f32 v134, -v148, v144, v134
    v_fma_f32 v135, -v149, v144, v135
    v_fma_f32 v132, v132, v145, v146
    v_fma_f32 v133, v133, v145, v147
    v_fma_f32 v134, v134, v145, v148
    v_fma_f32 v135, v135, v145, v149
    v_cvt_pk_bf16_f32 v132, v132, v133
    v_cvt_pk_bf16_f32 v133, v134, v135
    ds_write_b64 v130, v[132:133] offset:0
    v_cvt_pk_bf16_f32 v136, v136, v136
    v_lshlrev_b32 v136, 16, v136
    v_cvt_pk_bf16_f32 v137, v137, v137
    v_lshlrev_b32 v137, 16, v137
    v_cvt_pk_bf16_f32 v138, v138, v138
    v_lshlrev_b32 v138, 16, v138
    v_cvt_pk_bf16_f32 v139, v139, v139
    v_lshlrev_b32 v139, 16, v139
    v_mul_f32 v146, v136, v145
    v_mul_f32 v147, v137, v145
    v_mul_f32 v148, v138, v145
    v_mul_f32 v149, v139, v145
    v_fma_f32 v136, -v146, v144, v136
    v_fma_f32 v137, -v147, v144, v137
    v_fma_f32 v138, -v148, v144, v138
    v_fma_f32 v139, -v149, v144, v139
    v_fma_f32 v136, v136, v145, v146
    v_fma_f32 v137, v137, v145, v147
    v_fma_f32 v138, v138, v145, v148
    v_fma_f32 v139, v139, v145, v149
    v_cvt_pk_bf16_f32 v136, v136, v137
    v_cvt_pk_bf16_f32 v137, v138, v139
    s_and_saveexec_b64 s[30:31], s[34:35]
    ds_write_b64 v130, v[136:137] offset:32
    s_mov_b64 exec, s[30:31]
    v_mfma_f32_16x16x32_bf16 v[132:135], v[64:67], a[40:43], 0
    v_mfma_f32_16x16x32_bf16 v[132:135], v[72:75], a[44:47], v[132:135]
    v_mfma_f32_16x16x32_bf16 v[136:139], v[80:83], a[40:43], 0
    v_mfma_f32_16x16x32_bf16 v[136:139], v[88:91], a[44:47], v[136:139]
    v_mfma_f32_16x16x32_bf16 v[140:143], v[96:99], a[40:43], 0
    v_mfma_f32_16x16x32_bf16 v[140:143], v[104:107], a[44:47], v[140:143]
    s_nop 7
    v_cvt_pk_bf16_f32 v144, v140, v140
    v_lshlrev_b32 v144, 16, v144
    v_add_f32 v144, 0x358637bd, v144
    v_cvt_pk_bf16_f32 v144, v144, v144
    v_lshlrev_b32 v144, 16, v144
    v_rcp_f32 v145, v144
    v_add_u32 v130, 20736, v129
    v_add_u32 v130, s39, v130
    v_cvt_pk_bf16_f32 v132, v132, v132
    v_lshlrev_b32 v132, 16, v132
    v_cvt_pk_bf16_f32 v133, v133, v133
    v_lshlrev_b32 v133, 16, v133
    v_cvt_pk_bf16_f32 v134, v134, v134
    v_lshlrev_b32 v134, 16, v134
    v_cvt_pk_bf16_f32 v135, v135, v135
    v_lshlrev_b32 v135, 16, v135
    v_mul_f32 v146, v132, v145
    v_mul_f32 v147, v133, v145
    v_mul_f32 v148, v134, v145
    v_mul_f32 v149, v135, v145
    v_fma_f32 v132, -v146, v144, v132
    v_fma_f32 v133, -v147, v144, v133
    v_fma_f32 v134, -v148, v144, v134
    v_fma_f32 v135, -v149, v144, v135
    v_fma_f32 v132, v132, v145, v146
    v_fma_f32 v133, v133, v145, v147
    v_fma_f32 v134, v134, v145, v148
    v_fma_f32 v135, v135, v145, v149
    v_cvt_pk_bf16_f32 v132, v132, v133
    v_cvt_pk_bf16_f32 v133, v134, v135
    ds_write_b64 v130, v[132:133] offset:0
    v_cvt_pk_bf16_f32 v136, v136, v136
    v_lshlrev_b32 v136, 16, v136
    v_cvt_pk_bf16_f32 v137, v137, v137
    v_lshlrev_b32 v137, 16, v137
    v_cvt_pk_bf16_f32 v138, v138, v138
    v_lshlrev_b32 v138, 16, v138
    v_cvt_pk_bf16_f32 v139, v139, v139
    v_lshlrev_b32 v139, 16, v139
    v_mul_f32 v146, v136, v145
    v_mul_f32 v147, v137, v145
    v_mul_f32 v148, v138, v145
    v_mul_f32 v149, v139, v145
    v_fma_f32 v136, -v146, v144, v136
    v_fma_f32 v137, -v147, v144, v137
    v_fma_f32 v138, -v148, v144, v138
    v_fma_f32 v139, -v149, v144, v139
    v_fma_f32 v136, v136, v145, v146
    v_fma_f32 v137, v137, v145, v147
    v_fma_f32 v138, v138, v145, v148
    v_fma_f32 v139, v139, v145, v149
    v_cvt_pk_bf16_f32 v136, v136, v137
    v_cvt_pk_bf16_f32 v137, v138, v139
    s_and_saveexec_b64 s[30:31], s[34:35]
    ds_write_b64 v130, v[136:137] offset:32
    s_mov_b64 exec, s[30:31]
    v_mfma_f32_16x16x32_bf16 v[132:135], v[64:67], a[48:51], 0
    v_mfma_f32_16x16x32_bf16 v[132:135], v[72:75], a[52:55], v[132:135]
    v_mfma_f32_16x16x32_bf16 v[136:139], v[80:83], a[48:51], 0
    v_mfma_f32_16x16x32_bf16 v[136:139], v[88:91], a[52:55], v[136:139]
    v_mfma_f32_16x16x32_bf16 v[140:143], v[96:99], a[48:51], 0
    v_mfma_f32_16x16x32_bf16 v[140:143], v[104:107], a[52:55], v[140:143]
    s_nop 7
    v_cvt_pk_bf16_f32 v144, v140, v140
    v_lshlrev_b32 v144, 16, v144
    v_add_f32 v144, 0x358637bd, v144
    v_cvt_pk_bf16_f32 v144, v144, v144
    v_lshlrev_b32 v144, 16, v144
    v_rcp_f32 v145, v144
    v_add_u32 v130, 41472, v129
    v_add_u32 v130, s39, v130
    v_cvt_pk_bf16_f32 v132, v132, v132
    v_lshlrev_b32 v132, 16, v132
    v_cvt_pk_bf16_f32 v133, v133, v133
    v_lshlrev_b32 v133, 16, v133
    v_cvt_pk_bf16_f32 v134, v134, v134
    v_lshlrev_b32 v134, 16, v134
    v_cvt_pk_bf16_f32 v135, v135, v135
    v_lshlrev_b32 v135, 16, v135
    v_mul_f32 v146, v132, v145
    v_mul_f32 v147, v133, v145
    v_mul_f32 v148, v134, v145
    v_mul_f32 v149, v135, v145
    v_fma_f32 v132, -v146, v144, v132
    v_fma_f32 v133, -v147, v144, v133
    v_fma_f32 v134, -v148, v144, v134
    v_fma_f32 v135, -v149, v144, v135
    v_fma_f32 v132, v132, v145, v146
    v_fma_f32 v133, v133, v145, v147
    v_fma_f32 v134, v134, v145, v148
    v_fma_f32 v135, v135, v145, v149
    v_cvt_pk_bf16_f32 v132, v132, v133
    v_cvt_pk_bf16_f32 v133, v134, v135
    ds_write_b64 v130, v[132:133] offset:0
    v_cvt_pk_bf16_f32 v136, v136, v136
    v_lshlrev_b32 v136, 16, v136
    v_cvt_pk_bf16_f32 v137, v137, v137
    v_lshlrev_b32 v137, 16, v137
    v_cvt_pk_bf16_f32 v138, v138, v138
    v_lshlrev_b32 v138, 16, v138
    v_cvt_pk_bf16_f32 v139, v139, v139
    v_lshlrev_b32 v139, 16, v139
    v_mul_f32 v146, v136, v145
    v_mul_f32 v147, v137, v145
    v_mul_f32 v148, v138, v145
    v_mul_f32 v149, v139, v145
    v_fma_f32 v136, -v146, v144, v136
    v_fma_f32 v137, -v147, v144, v137
    v_fma_f32 v138, -v148, v144, v138
    v_fma_f32 v139, -v149, v144, v139
    v_fma_f32 v136, v136, v145, v146
    v_fma_f32 v137, v137, v145, v147
    v_fma_f32 v138, v138, v145, v148
    v_fma_f32 v139, v139, v145, v149
    v_cvt_pk_bf16_f32 v136, v136, v137
    v_cvt_pk_bf16_f32 v137, v138, v139
    s_and_saveexec_b64 s[30:31], s[34:35]
    ds_write_b64 v130, v[136:137] offset:32
    s_mov_b64 exec, s[30:31]
    v_mfma_f32_16x16x32_bf16 v[132:135], v[64:67], a[56:59], 0
    v_mfma_f32_16x16x32_bf16 v[132:135], v[72:75], a[60:63], v[132:135]
    v_mfma_f32_16x16x32_bf16 v[136:139], v[80:83], a[56:59], 0
    v_mfma_f32_16x16x32_bf16 v[136:139], v[88:91], a[60:63], v[136:139]
    v_mfma_f32_16x16x32_bf16 v[140:143], v[96:99], a[56:59], 0
    v_mfma_f32_16x16x32_bf16 v[140:143], v[104:107], a[60:63], v[140:143]
    s_nop 7
    v_cvt_pk_bf16_f32 v144, v140, v140
    v_lshlrev_b32 v144, 16, v144
    v_add_f32 v144, 0x358637bd, v144
    v_cvt_pk_bf16_f32 v144, v144, v144
    v_lshlrev_b32 v144, 16, v144
    v_rcp_f32 v145, v144
    v_add_u32 v130, 62208, v129
    v_add_u32 v130, s39, v130
    v_cvt_pk_bf16_f32 v132, v132, v132
    v_lshlrev_b32 v132, 16, v132
    v_cvt_pk_bf16_f32 v133, v133, v133
    v_lshlrev_b32 v133, 16, v133
    v_cvt_pk_bf16_f32 v134, v134, v134
    v_lshlrev_b32 v134, 16, v134
    v_cvt_pk_bf16_f32 v135, v135, v135
    v_lshlrev_b32 v135, 16, v135
    v_mul_f32 v146, v132, v145
    v_mul_f32 v147, v133, v145
    v_mul_f32 v148, v134, v145
    v_mul_f32 v149, v135, v145
    v_fma_f32 v132, -v146, v144, v132
    v_fma_f32 v133, -v147, v144, v133
    v_fma_f32 v134, -v148, v144, v134
    v_fma_f32 v135, -v149, v144, v135
    v_fma_f32 v132, v132, v145, v146
    v_fma_f32 v133, v133, v145, v147
    v_fma_f32 v134, v134, v145, v148
    v_fma_f32 v135, v135, v145, v149
    v_cvt_pk_bf16_f32 v132, v132, v133
    v_cvt_pk_bf16_f32 v133, v134, v135
    ds_write_b64 v130, v[132:133] offset:0
    v_cvt_pk_bf16_f32 v136, v136, v136
    v_lshlrev_b32 v136, 16, v136
    v_cvt_pk_bf16_f32 v137, v137, v137
    v_lshlrev_b32 v137, 16, v137
    v_cvt_pk_bf16_f32 v138, v138, v138
    v_lshlrev_b32 v138, 16, v138
    v_cvt_pk_bf16_f32 v139, v139, v139
    v_lshlrev_b32 v139, 16, v139
    v_mul_f32 v146, v136, v145
    v_mul_f32 v147, v137, v145
    v_mul_f32 v148, v138, v145
    v_mul_f32 v149, v139, v145
    v_fma_f32 v136, -v146, v144, v136
    v_fma_f32 v137, -v147, v144, v137
    v_fma_f32 v138, -v148, v144, v138
    v_fma_f32 v139, -v149, v144, v139
    v_fma_f32 v136, v136, v145, v146
    v_fma_f32 v137, v137, v145, v147
    v_fma_f32 v138, v138, v145, v148
    v_fma_f32 v139, v139, v145, v149
    v_cvt_pk_bf16_f32 v136, v136, v137
    v_cvt_pk_bf16_f32 v137, v138, v139
    s_and_saveexec_b64 s[30:31], s[34:35]
    ds_write_b64 v130, v[136:137] offset:32
    s_mov_b64 exec, s[30:31]
    s_nop 7
    s_lshl_b32 s36, s26, 2
    s_add_u32 s36, s36, 3
    s_mul_i32 s37, s36, 12288
    v_add_u32 v123, 0, v124
    buffer_load_dwordx4 v[64:67], v123, s[44:47], s37 offen
    buffer_load_dwordx4 v[68:71], v123, s[44:47], s37 offen offset:16
    v_add_u32 v123, 2048, v124
    buffer_load_dwordx4 v[72:75], v123, s[44:47], s37 offen
    buffer_load_dwordx4 v[76:79], v123, s[44:47], s37 offen offset:16
    v_add_u32 v123, 4096, v124
    buffer_load_dwordx4 v[80:83], v123, s[44:47], s37 offen
    buffer_load_dwordx4 v[84:87], v123, s[44:47], s37 offen offset:16
    v_add_u32 v123, 6144, v124
    buffer_load_dwordx4 v[88:91], v123, s[44:47], s37 offen
    buffer_load_dwordx4 v[92:95], v123, s[44:47], s37 offen offset:16
    v_add_u32 v123, 8192, v125
    buffer_load_dwordx4 v[96:99], v123, s[44:47], s37 offen
    buffer_load_dwordx4 v[100:103], v123, s[44:47], s37 offen offset:16
    v_add_u32 v123, 10240, v125
    buffer_load_dwordx4 v[104:107], v123, s[44:47], s37 offen
    buffer_load_dwordx4 v[108:111], v123, s[44:47], s37 offen offset:16
    s_add_u32 s38, s41, 0
    s_lshl_b32 s38, s38, 5
    s_add_u32 s38, s38, s36
    s_lshl_b32 s38, s38, 11
    buffer_load_dwordx4 a[32:35], v122, s[8:11], s38 offen offset:0
    buffer_load_dwordx4 a[36:39], v122, s[8:11], s38 offen offset:1024
    s_add_u32 s38, s41, 1
    s_lshl_b32 s38, s38, 5
    s_add_u32 s38, s38, s36
    s_lshl_b32 s38, s38, 11
    buffer_load_dwordx4 a[40:43], v122, s[8:11], s38 offen offset:0
    buffer_load_dwordx4 a[44:47], v122, s[8:11], s38 offen offset:1024
    s_add_u32 s38, s41, 2
    s_lshl_b32 s38, s38, 5
    s_add_u32 s38, s38, s36
    s_lshl_b32 s38, s38, 11
    buffer_load_dwordx4 a[48:51], v122, s[8:11], s38 offen offset:0
    buffer_load_dwordx4 a[52:55], v122, s[8:11], s38 offen offset:1024
    s_add_u32 s38, s41, 3
    s_lshl_b32 s38, s38, 5
    s_add_u32 s38, s38, s36
    s_lshl_b32 s38, s38, 11
    buffer_load_dwordx4 a[56:59], v122, s[8:11], s38 offen offset:0
    buffer_load_dwordx4 a[60:63], v122, s[8:11], s38 offen offset:1024
    s_waitcnt vmcnt(20)
    v_cvt_pk_bf16_f32 v16, v16, v17
    v_cvt_pk_bf16_f32 v17, v18, v19
    v_cvt_pk_bf16_f32 v18, v20, v21
    v_cvt_pk_bf16_f32 v19, v22, v23
    v_cvt_pk_bf16_f32 v24, v24, v25
    v_cvt_pk_bf16_f32 v25, v26, v27
    v_cvt_pk_bf16_f32 v26, v28, v29
    v_cvt_pk_bf16_f32 v27, v30, v31
    v_cvt_pk_bf16_f32 v32, v32, v33
    v_cvt_pk_bf16_f32 v33, v34, v35
    v_cvt_pk_bf16_f32 v34, v36, v37
    v_cvt_pk_bf16_f32 v35, v38, v39
    v_cvt_pk_bf16_f32 v40, v40, v41
    v_cvt_pk_bf16_f32 v41, v42, v43
    v_cvt_pk_bf16_f32 v42, v44, v45
    v_cvt_pk_bf16_f32 v43, v46, v47
    v_cvt_pk_bf16_f32 v48, v48, v49
    v_cvt_pk_bf16_f32 v49, v50, v51
    v_cvt_pk_bf16_f32 v50, v52, v53
    v_cvt_pk_bf16_f32 v51, v54, v55
    v_cvt_pk_bf16_f32 v56, v56, v57
    v_cvt_pk_bf16_f32 v57, v58, v59
    v_cvt_pk_bf16_f32 v58, v60, v61
    v_cvt_pk_bf16_f32 v59, v62, v63
    s_lshl_b32 s36, s26, 2
    s_add_u32 s36, s36, 2
    s_mul_i32 s39, s36, 40
    s_nop 0
    v_mfma_f32_16x16x32_bf16 v[132:135], v[16:19], a[0:3], 0
    v_mfma_f32_16x16x32_bf16 v[132:135], v[24:27], a[4:7], v[132:135]
    v_mfma_f32_16x16x32_bf16 v[136:139], v[32:35], a[0:3], 0
    v_mfma_f32_16x16x32_bf16 v[136:139], v[40:43], a[4:7], v[136:139]
    v_mfma_f32_16x16x32_bf16 v[140:143], v[48:51], a[0:3], 0
    v_mfma_f32_16x16x32_bf16 v[140:143], v[56:59], a[4:7], v[140:143]
    s_nop 7
    v_cvt_pk_bf16_f32 v144, v140, v140
    v_lshlrev_b32 v144, 16, v144
    v_add_f32 v144, 0x358637bd, v144
    v_cvt_pk_bf16_f32 v144, v144, v144
    v_lshlrev_b32 v144, 16, v144
    v_rcp_f32 v145, v144
    v_add_u32 v130, 0, v129
    v_add_u32 v130, s39, v130
    v_cvt_pk_bf16_f32 v132, v132, v132
    v_lshlrev_b32 v132, 16, v132
    v_cvt_pk_bf16_f32 v133, v133, v133
    v_lshlrev_b32 v133, 16, v133
    v_cvt_pk_bf16_f32 v134, v134, v134
    v_lshlrev_b32 v134, 16, v134
    v_cvt_pk_bf16_f32 v135, v135, v135
    v_lshlrev_b32 v135, 16, v135
    v_mul_f32 v146, v132, v145
    v_mul_f32 v147, v133, v145
    v_mul_f32 v148, v134, v145
    v_mul_f32 v149, v135, v145
    v_fma_f32 v132, -v146, v144, v132
    v_fma_f32 v133, -v147, v144, v133
    v_fma_f32 v134, -v148, v144, v134
    v_fma_f32 v135, -v149, v144, v135
    v_fma_f32 v132, v132, v145, v146
    v_fma_f32 v133, v133, v145, v147
    v_fma_f32 v134, v134, v145, v148
    v_fma_f32 v135, v135, v145, v149
    v_cvt_pk_bf16_f32 v132, v132, v133
    v_cvt_pk_bf16_f32 v133, v134, v135
    ds_write_b64 v130, v[132:133] offset:0
    v_cvt_pk_bf16_f32 v136, v136, v136
    v_lshlrev_b32 v136, 16, v136
    v_cvt_pk_bf16_f32 v137, v137, v137
    v_lshlrev_b32 v137, 16, v137
    v_cvt_pk_bf16_f32 v138, v138, v138
    v_lshlrev_b32 v138, 16, v138
    v_cvt_pk_bf16_f32 v139, v139, v139
    v_lshlrev_b32 v139, 16, v139
    v_mul_f32 v146, v136, v145
    v_mul_f32 v147, v137, v145
    v_mul_f32 v148, v138, v145
    v_mul_f32 v149, v139, v145
    v_fma_f32 v136, -v146, v144, v136
    v_fma_f32 v137, -v147, v144, v137
    v_fma_f32 v138, -v148, v144, v138
    v_fma_f32 v139, -v149, v144, v139
    v_fma_f32 v136, v136, v145, v146
    v_fma_f32 v137, v137, v145, v147
    v_fma_f32 v138, v138, v145, v148
    v_fma_f32 v139, v139, v145, v149
    v_cvt_pk_bf16_f32 v136, v136, v137
    v_cvt_pk_bf16_f32 v137, v138, v139
    s_and_saveexec_b64 s[30:31], s[34:35]
    ds_write_b64 v130, v[136:137] offset:32
    s_mov_b64 exec, s[30:31]
    v_mfma_f32_16x16x32_bf16 v[132:135], v[16:19], a[8:11], 0
    v_mfma_f32_16x16x32_bf16 v[132:135], v[24:27], a[12:15], v[132:135]
    v_mfma_f32_16x16x32_bf16 v[136:139], v[32:35], a[8:11], 0
    v_mfma_f32_16x16x32_bf16 v[136:139], v[40:43], a[12:15], v[136:139]
    v_mfma_f32_16x16x32_bf16 v[140:143], v[48:51], a[8:11], 0
    v_mfma_f32_16x16x32_bf16 v[140:143], v[56:59], a[12:15], v[140:143]
    s_nop 7
    v_cvt_pk_bf16_f32 v144, v140, v140
    v_lshlrev_b32 v144, 16, v144
    v_add_f32 v144, 0x358637bd, v144
    v_cvt_pk_bf16_f32 v144, v144, v144
    v_lshlrev_b32 v144, 16, v144
    v_rcp_f32 v145, v144
    v_add_u32 v130, 20736, v129
    v_add_u32 v130, s39, v130
    v_cvt_pk_bf16_f32 v132, v132, v132
    v_lshlrev_b32 v132, 16, v132
    v_cvt_pk_bf16_f32 v133, v133, v133
    v_lshlrev_b32 v133, 16, v133
    v_cvt_pk_bf16_f32 v134, v134, v134
    v_lshlrev_b32 v134, 16, v134
    v_cvt_pk_bf16_f32 v135, v135, v135
    v_lshlrev_b32 v135, 16, v135
    v_mul_f32 v146, v132, v145
    v_mul_f32 v147, v133, v145
    v_mul_f32 v148, v134, v145
    v_mul_f32 v149, v135, v145
    v_fma_f32 v132, -v146, v144, v132
    v_fma_f32 v133, -v147, v144, v133
    v_fma_f32 v134, -v148, v144, v134
    v_fma_f32 v135, -v149, v144, v135
    v_fma_f32 v132, v132, v145, v146
    v_fma_f32 v133, v133, v145, v147
    v_fma_f32 v134, v134, v145, v148
    v_fma_f32 v135, v135, v145, v149
    v_cvt_pk_bf16_f32 v132, v132, v133
    v_cvt_pk_bf16_f32 v133, v134, v135
    ds_write_b64 v130, v[132:133] offset:0
    v_cvt_pk_bf16_f32 v136, v136, v136
    v_lshlrev_b32 v136, 16, v136
    v_cvt_pk_bf16_f32 v137, v137, v137
    v_lshlrev_b32 v137, 16, v137
    v_cvt_pk_bf16_f32 v138, v138, v138
    v_lshlrev_b32 v138, 16, v138
    v_cvt_pk_bf16_f32 v139, v139, v139
    v_lshlrev_b32 v139, 16, v139
    v_mul_f32 v146, v136, v145
    v_mul_f32 v147, v137, v145
    v_mul_f32 v148, v138, v145
    v_mul_f32 v149, v139, v145
    v_fma_f32 v136, -v146, v144, v136
    v_fma_f32 v137, -v147, v144, v137
    v_fma_f32 v138, -v148, v144, v138
    v_fma_f32 v139, -v149, v144, v139
    v_fma_f32 v136, v136, v145, v146
    v_fma_f32 v137, v137, v145, v147
    v_fma_f32 v138, v138, v145, v148
    v_fma_f32 v139, v139, v145, v149
    v_cvt_pk_bf16_f32 v136, v136, v137
    v_cvt_pk_bf16_f32 v137, v138, v139
    s_and_saveexec_b64 s[30:31], s[34:35]
    ds_write_b64 v130, v[136:137] offset:32
    s_mov_b64 exec, s[30:31]
    v_mfma_f32_16x16x32_bf16 v[132:135], v[16:19], a[16:19], 0
    v_mfma_f32_16x16x32_bf16 v[132:135], v[24:27], a[20:23], v[132:135]
    v_mfma_f32_16x16x32_bf16 v[136:139], v[32:35], a[16:19], 0
    v_mfma_f32_16x16x32_bf16 v[136:139], v[40:43], a[20:23], v[136:139]
    v_mfma_f32_16x16x32_bf16 v[140:143], v[48:51], a[16:19], 0
    v_mfma_f32_16x16x32_bf16 v[140:143], v[56:59], a[20:23], v[140:143]
    s_nop 7
    v_cvt_pk_bf16_f32 v144, v140, v140
    v_lshlrev_b32 v144, 16, v144
    v_add_f32 v144, 0x358637bd, v144
    v_cvt_pk_bf16_f32 v144, v144, v144
    v_lshlrev_b32 v144, 16, v144
    v_rcp_f32 v145, v144
    v_add_u32 v130, 41472, v129
    v_add_u32 v130, s39, v130
    v_cvt_pk_bf16_f32 v132, v132, v132
    v_lshlrev_b32 v132, 16, v132
    v_cvt_pk_bf16_f32 v133, v133, v133
    v_lshlrev_b32 v133, 16, v133
    v_cvt_pk_bf16_f32 v134, v134, v134
    v_lshlrev_b32 v134, 16, v134
    v_cvt_pk_bf16_f32 v135, v135, v135
    v_lshlrev_b32 v135, 16, v135
    v_mul_f32 v146, v132, v145
    v_mul_f32 v147, v133, v145
    v_mul_f32 v148, v134, v145
    v_mul_f32 v149, v135, v145
    v_fma_f32 v132, -v146, v144, v132
    v_fma_f32 v133, -v147, v144, v133
    v_fma_f32 v134, -v148, v144, v134
    v_fma_f32 v135, -v149, v144, v135
    v_fma_f32 v132, v132, v145, v146
    v_fma_f32 v133, v133, v145, v147
    v_fma_f32 v134, v134, v145, v148
    v_fma_f32 v135, v135, v145, v149
    v_cvt_pk_bf16_f32 v132, v132, v133
    v_cvt_pk_bf16_f32 v133, v134, v135
    ds_write_b64 v130, v[132:133] offset:0
    v_cvt_pk_bf16_f32 v136, v136, v136
    v_lshlrev_b32 v136, 16, v136
    v_cvt_pk_bf16_f32 v137, v137, v137
    v_lshlrev_b32 v137, 16, v137
    v_cvt_pk_bf16_f32 v138, v138, v138
    v_lshlrev_b32 v138, 16, v138
    v_cvt_pk_bf16_f32 v139, v139, v139
    v_lshlrev_b32 v139, 16, v139
    v_mul_f32 v146, v136, v145
    v_mul_f32 v147, v137, v145
    v_mul_f32 v148, v138, v145
    v_mul_f32 v149, v139, v145
    v_fma_f32 v136, -v146, v144, v136
    v_fma_f32 v137, -v147, v144, v137
    v_fma_f32 v138, -v148, v144, v138
    v_fma_f32 v139, -v149, v144, v139
    v_fma_f32 v136, v136, v145, v146
    v_fma_f32 v137, v137, v145, v147
    v_fma_f32 v138, v138, v145, v148
    v_fma_f32 v139, v139, v145, v149
    v_cvt_pk_bf16_f32 v136, v136, v137
    v_cvt_pk_bf16_f32 v137, v138, v139
    s_and_saveexec_b64 s[30:31], s[34:35]
    ds_write_b64 v130, v[136:137] offset:32
    s_mov_b64 exec, s[30:31]
    v_mfma_f32_16x16x32_bf16 v[132:135], v[16:19], a[24:27], 0
    v_mfma_f32_16x16x32_bf16 v[132:135], v[24:27], a[28:31], v[132:135]
    v_mfma_f32_16x16x32_bf16 v[136:139], v[32:35], a[24:27], 0
    v_mfma_f32_16x16x32_bf16 v[136:139], v[40:43], a[28:31], v[136:139]
    v_mfma_f32_16x16x32_bf16 v[140:143], v[48:51], a[24:27], 0
    v_mfma_f32_16x16x32_bf16 v[140:143], v[56:59], a[28:31], v[140:143]
    s_nop 7
    v_cvt_pk_bf16_f32 v144, v140, v140
    v_lshlrev_b32 v144, 16, v144
    v_add_f32 v144, 0x358637bd, v144
    v_cvt_pk_bf16_f32 v144, v144, v144
    v_lshlrev_b32 v144, 16, v144
    v_rcp_f32 v145, v144
    v_add_u32 v130, 62208, v129
    v_add_u32 v130, s39, v130
    v_cvt_pk_bf16_f32 v132, v132, v132
    v_lshlrev_b32 v132, 16, v132
    v_cvt_pk_bf16_f32 v133, v133, v133
    v_lshlrev_b32 v133, 16, v133
    v_cvt_pk_bf16_f32 v134, v134, v134
    v_lshlrev_b32 v134, 16, v134
    v_cvt_pk_bf16_f32 v135, v135, v135
    v_lshlrev_b32 v135, 16, v135
    v_mul_f32 v146, v132, v145
    v_mul_f32 v147, v133, v145
    v_mul_f32 v148, v134, v145
    v_mul_f32 v149, v135, v145
    v_fma_f32 v132, -v146, v144, v132
    v_fma_f32 v133, -v147, v144, v133
    v_fma_f32 v134, -v148, v144, v134
    v_fma_f32 v135, -v149, v144, v135
    v_fma_f32 v132, v132, v145, v146
    v_fma_f32 v133, v133, v145, v147
    v_fma_f32 v134, v134, v145, v148
    v_fma_f32 v135, v135, v145, v149
    v_cvt_pk_bf16_f32 v132, v132, v133
    v_cvt_pk_bf16_f32 v133, v134, v135
    ds_write_b64 v130, v[132:133] offset:0
    v_cvt_pk_bf16_f32 v136, v136, v136
    v_lshlrev_b32 v136, 16, v136
    v_cvt_pk_bf16_f32 v137, v137, v137
    v_lshlrev_b32 v137, 16, v137
    v_cvt_pk_bf16_f32 v138, v138, v138
    v_lshlrev_b32 v138, 16, v138
    v_cvt_pk_bf16_f32 v139, v139, v139
    v_lshlrev_b32 v139, 16, v139
    v_mul_f32 v146, v136, v145
    v_mul_f32 v147, v137, v145
    v_mul_f32 v148, v138, v145
    v_mul_f32 v149, v139, v145
    v_fma_f32 v136, -v146, v144, v136
    v_fma_f32 v137, -v147, v144, v137
    v_fma_f32 v138, -v148, v144, v138
    v_fma_f32 v139, -v149, v144, v139
    v_fma_f32 v136, v136, v145, v146
    v_fma_f32 v137, v137, v145, v147
    v_fma_f32 v138, v138, v145, v148
    v_fma_f32 v139, v139, v145, v149
    v_cvt_pk_bf16_f32 v136, v136, v137
    v_cvt_pk_bf16_f32 v137, v138, v139
    s_and_saveexec_b64 s[30:31], s[34:35]
    ds_write_b64 v130, v[136:137] offset:32
    s_mov_b64 exec, s[30:31]
    s_waitcnt vmcnt(0)
    v_cvt_pk_bf16_f32 v64, v64, v65
    v_cvt_pk_bf16_f32 v65, v66, v67
    v_cvt_pk_bf16_f32 v66, v68, v69
    v_cvt_pk_bf16_f32 v67, v70, v71
    v_cvt_pk_bf16_f32 v72, v72, v73
    v_cvt_pk_bf16_f32 v73, v74, v75
    v_cvt_pk_bf16_f32 v74, v76, v77
    v_cvt_pk_bf16_f32 v75, v78, v79
    v_cvt_pk_bf16_f32 v80, v80, v81
    v_cvt_pk_bf16_f32 v81, v82, v83
    v_cvt_pk_bf16_f32 v82, v84, v85
    v_cvt_pk_bf16_f32 v83, v86, v87
    v_cvt_pk_bf16_f32 v88, v88, v89
    v_cvt_pk_bf16_f32 v89, v90, v91
    v_cvt_pk_bf16_f32 v90, v92, v93
    v_cvt_pk_bf16_f32 v91, v94, v95
    v_cvt_pk_bf16_f32 v96, v96, v97
    v_cvt_pk_bf16_f32 v97, v98, v99
    v_cvt_pk_bf16_f32 v98, v100, v101
    v_cvt_pk_bf16_f32 v99, v102, v103
    v_cvt_pk_bf16_f32 v104, v104, v105
    v_cvt_pk_bf16_f32 v105, v106, v107
    v_cvt_pk_bf16_f32 v106, v108, v109
    v_cvt_pk_bf16_f32 v107, v110, v111
    s_lshl_b32 s36, s26, 2
    s_add_u32 s36, s36, 3
    s_mul_i32 s39, s36, 40
    s_nop 0
    v_mfma_f32_16x16x32_bf16 v[132:135], v[64:67], a[32:35], 0
    v_mfma_f32_16x16x32_bf16 v[132:135], v[72:75], a[36:39], v[132:135]
    v_mfma_f32_16x16x32_bf16 v[136:139], v[80:83], a[32:35], 0
    v_mfma_f32_16x16x32_bf16 v[136:139], v[88:91], a[36:39], v[136:139]
    v_mfma_f32_16x16x32_bf16 v[140:143], v[96:99], a[32:35], 0
    v_mfma_f32_16x16x32_bf16 v[140:143], v[104:107], a[36:39], v[140:143]
    s_nop 7
    v_cvt_pk_bf16_f32 v144, v140, v140
    v_lshlrev_b32 v144, 16, v144
    v_add_f32 v144, 0x358637bd, v144
    v_cvt_pk_bf16_f32 v144, v144, v144
    v_lshlrev_b32 v144, 16, v144
    v_rcp_f32 v145, v144
    v_add_u32 v130, 0, v129
    v_add_u32 v130, s39, v130
    v_cvt_pk_bf16_f32 v132, v132, v132
    v_lshlrev_b32 v132, 16, v132
    v_cvt_pk_bf16_f32 v133, v133, v133
    v_lshlrev_b32 v133, 16, v133
    v_cvt_pk_bf16_f32 v134, v134, v134
    v_lshlrev_b32 v134, 16, v134
    v_cvt_pk_bf16_f32 v135, v135, v135
    v_lshlrev_b32 v135, 16, v135
    v_mul_f32 v146, v132, v145
    v_mul_f32 v147, v133, v145
    v_mul_f32 v148, v134, v145
    v_mul_f32 v149, v135, v145
    v_fma_f32 v132, -v146, v144, v132
    v_fma_f32 v133, -v147, v144, v133
    v_fma_f32 v134, -v148, v144, v134
    v_fma_f32 v135, -v149, v144, v135
    v_fma_f32 v132, v132, v145, v146
    v_fma_f32 v133, v133, v145, v147
    v_fma_f32 v134, v134, v145, v148
    v_fma_f32 v135, v135, v145, v149
    v_cvt_pk_bf16_f32 v132, v132, v133
    v_cvt_pk_bf16_f32 v133, v134, v135
    ds_write_b64 v130, v[132:133] offset:0
    v_cvt_pk_bf16_f32 v136, v136, v136
    v_lshlrev_b32 v136, 16, v136
    v_cvt_pk_bf16_f32 v137, v137, v137
    v_lshlrev_b32 v137, 16, v137
    v_cvt_pk_bf16_f32 v138, v138, v138
    v_lshlrev_b32 v138, 16, v138
    v_cvt_pk_bf16_f32 v139, v139, v139
    v_lshlrev_b32 v139, 16, v139
    v_mul_f32 v146, v136, v145
    v_mul_f32 v147, v137, v145
    v_mul_f32 v148, v138, v145
    v_mul_f32 v149, v139, v145
    v_fma_f32 v136, -v146, v144, v136
    v_fma_f32 v137, -v147, v144, v137
    v_fma_f32 v138, -v148, v144, v138
    v_fma_f32 v139, -v149, v144, v139
    v_fma_f32 v136, v136, v145, v146
    v_fma_f32 v137, v137, v145, v147
    v_fma_f32 v138, v138, v145, v148
    v_fma_f32 v139, v139, v145, v149
    v_cvt_pk_bf16_f32 v136, v136, v137
    v_cvt_pk_bf16_f32 v137, v138, v139
    s_and_saveexec_b64 s[30:31], s[34:35]
    ds_write_b64 v130, v[136:137] offset:32
    s_mov_b64 exec, s[30:31]
    v_mfma_f32_16x16x32_bf16 v[132:135], v[64:67], a[40:43], 0
    v_mfma_f32_16x16x32_bf16 v[132:135], v[72:75], a[44:47], v[132:135]
    v_mfma_f32_16x16x32_bf16 v[136:139], v[80:83], a[40:43], 0
    v_mfma_f32_16x16x32_bf16 v[136:139], v[88:91], a[44:47], v[136:139]
    v_mfma_f32_16x16x32_bf16 v[140:143], v[96:99], a[40:43], 0
    v_mfma_f32_16x16x32_bf16 v[140:143], v[104:107], a[44:47], v[140:143]
    s_nop 7
    v_cvt_pk_bf16_f32 v144, v140, v140
    v_lshlrev_b32 v144, 16, v144
    v_add_f32 v144, 0x358637bd, v144
    v_cvt_pk_bf16_f32 v144, v144, v144
    v_lshlrev_b32 v144, 16, v144
    v_rcp_f32 v145, v144
    v_add_u32 v130, 20736, v129
    v_add_u32 v130, s39, v130
    v_cvt_pk_bf16_f32 v132, v132, v132
    v_lshlrev_b32 v132, 16, v132
    v_cvt_pk_bf16_f32 v133, v133, v133
    v_lshlrev_b32 v133, 16, v133
    v_cvt_pk_bf16_f32 v134, v134, v134
    v_lshlrev_b32 v134, 16, v134
    v_cvt_pk_bf16_f32 v135, v135, v135
    v_lshlrev_b32 v135, 16, v135
    v_mul_f32 v146, v132, v145
    v_mul_f32 v147, v133, v145
    v_mul_f32 v148, v134, v145
    v_mul_f32 v149, v135, v145
    v_fma_f32 v132, -v146, v144, v132
    v_fma_f32 v133, -v147, v144, v133
    v_fma_f32 v134, -v148, v144, v134
    v_fma_f32 v135, -v149, v144, v135
    v_fma_f32 v132, v132, v145, v146
    v_fma_f32 v133, v133, v145, v147
    v_fma_f32 v134, v134, v145, v148
    v_fma_f32 v135, v135, v145, v149
    v_cvt_pk_bf16_f32 v132, v132, v133
    v_cvt_pk_bf16_f32 v133, v134, v135
    ds_write_b64 v130, v[132:133] offset:0
    v_cvt_pk_bf16_f32 v136, v136, v136
    v_lshlrev_b32 v136, 16, v136
    v_cvt_pk_bf16_f32 v137, v137, v137
    v_lshlrev_b32 v137, 16, v137
    v_cvt_pk_bf16_f32 v138, v138, v138
    v_lshlrev_b32 v138, 16, v138
    v_cvt_pk_bf16_f32 v139, v139, v139
    v_lshlrev_b32 v139, 16, v139
    v_mul_f32 v146, v136, v145
    v_mul_f32 v147, v137, v145
    v_mul_f32 v148, v138, v145
    v_mul_f32 v149, v139, v145
    v_fma_f32 v136, -v146, v144, v136
    v_fma_f32 v137, -v147, v144, v137
    v_fma_f32 v138, -v148, v144, v138
    v_fma_f32 v139, -v149, v144, v139
    v_fma_f32 v136, v136, v145, v146
    v_fma_f32 v137, v137, v145, v147
    v_fma_f32 v138, v138, v145, v148
    v_fma_f32 v139, v139, v145, v149
    v_cvt_pk_bf16_f32 v136, v136, v137
    v_cvt_pk_bf16_f32 v137, v138, v139
    s_and_saveexec_b64 s[30:31], s[34:35]
    ds_write_b64 v130, v[136:137] offset:32
    s_mov_b64 exec, s[30:31]
    v_mfma_f32_16x16x32_bf16 v[132:135], v[64:67], a[48:51], 0
    v_mfma_f32_16x16x32_bf16 v[132:135], v[72:75], a[52:55], v[132:135]
    v_mfma_f32_16x16x32_bf16 v[136:139], v[80:83], a[48:51], 0
    v_mfma_f32_16x16x32_bf16 v[136:139], v[88:91], a[52:55], v[136:139]
    v_mfma_f32_16x16x32_bf16 v[140:143], v[96:99], a[48:51], 0
    v_mfma_f32_16x16x32_bf16 v[140:143], v[104:107], a[52:55], v[140:143]
    s_nop 7
    v_cvt_pk_bf16_f32 v144, v140, v140
    v_lshlrev_b32 v144, 16, v144
    v_add_f32 v144, 0x358637bd, v144
    v_cvt_pk_bf16_f32 v144, v144, v144
    v_lshlrev_b32 v144, 16, v144
    v_rcp_f32 v145, v144
    v_add_u32 v130, 41472, v129
    v_add_u32 v130, s39, v130
    v_cvt_pk_bf16_f32 v132, v132, v132
    v_lshlrev_b32 v132, 16, v132
    v_cvt_pk_bf16_f32 v133, v133, v133
    v_lshlrev_b32 v133, 16, v133
    v_cvt_pk_bf16_f32 v134, v134, v134
    v_lshlrev_b32 v134, 16, v134
    v_cvt_pk_bf16_f32 v135, v135, v135
    v_lshlrev_b32 v135, 16, v135
    v_mul_f32 v146, v132, v145
    v_mul_f32 v147, v133, v145
    v_mul_f32 v148, v134, v145
    v_mul_f32 v149, v135, v145
    v_fma_f32 v132, -v146, v144, v132
    v_fma_f32 v133, -v147, v144, v133
    v_fma_f32 v134, -v148, v144, v134
    v_fma_f32 v135, -v149, v144, v135
    v_fma_f32 v132, v132, v145, v146
    v_fma_f32 v133, v133, v145, v147
    v_fma_f32 v134, v134, v145, v148
    v_fma_f32 v135, v135, v145, v149
    v_cvt_pk_bf16_f32 v132, v132, v133
    v_cvt_pk_bf16_f32 v133, v134, v135
    ds_write_b64 v130, v[132:133] offset:0
    v_cvt_pk_bf16_f32 v136, v136, v136
    v_lshlrev_b32 v136, 16, v136
    v_cvt_pk_bf16_f32 v137, v137, v137
    v_lshlrev_b32 v137, 16, v137
    v_cvt_pk_bf16_f32 v138, v138, v138
    v_lshlrev_b32 v138, 16, v138
    v_cvt_pk_bf16_f32 v139, v139, v139
    v_lshlrev_b32 v139, 16, v139
    v_mul_f32 v146, v136, v145
    v_mul_f32 v147, v137, v145
    v_mul_f32 v148, v138, v145
    v_mul_f32 v149, v139, v145
    v_fma_f32 v136, -v146, v144, v136
    v_fma_f32 v137, -v147, v144, v137
    v_fma_f32 v138, -v148, v144, v138
    v_fma_f32 v139, -v149, v144, v139
    v_fma_f32 v136, v136, v145, v146
    v_fma_f32 v137, v137, v145, v147
    v_fma_f32 v138, v138, v145, v148
    v_fma_f32 v139, v139, v145, v149
    v_cvt_pk_bf16_f32 v136, v136, v137
    v_cvt_pk_bf16_f32 v137, v138, v139
    s_and_saveexec_b64 s[30:31], s[34:35]
    ds_write_b64 v130, v[136:137] offset:32
    s_mov_b64 exec, s[30:31]
    v_mfma_f32_16x16x32_bf16 v[132:135], v[64:67], a[56:59], 0
    v_mfma_f32_16x16x32_bf16 v[132:135], v[72:75], a[60:63], v[132:135]
    v_mfma_f32_16x16x32_bf16 v[136:139], v[80:83], a[56:59], 0
    v_mfma_f32_16x16x32_bf16 v[136:139], v[88:91], a[60:63], v[136:139]
    v_mfma_f32_16x16x32_bf16 v[140:143], v[96:99], a[56:59], 0
    v_mfma_f32_16x16x32_bf16 v[140:143], v[104:107], a[60:63], v[140:143]
    s_nop 7
    v_cvt_pk_bf16_f32 v144, v140, v140
    v_lshlrev_b32 v144, 16, v144
    v_add_f32 v144, 0x358637bd, v144
    v_cvt_pk_bf16_f32 v144, v144, v144
    v_lshlrev_b32 v144, 16, v144
    v_rcp_f32 v145, v144
    v_add_u32 v130, 62208, v129
    v_add_u32 v130, s39, v130
    v_cvt_pk_bf16_f32 v132, v132, v132
    v_lshlrev_b32 v132, 16, v132
    v_cvt_pk_bf16_f32 v133, v133, v133
    v_lshlrev_b32 v133, 16, v133
    v_cvt_pk_bf16_f32 v134, v134, v134
    v_lshlrev_b32 v134, 16, v134
    v_cvt_pk_bf16_f32 v135, v135, v135
    v_lshlrev_b32 v135, 16, v135
    v_mul_f32 v146, v132, v145
    v_mul_f32 v147, v133, v145
    v_mul_f32 v148, v134, v145
    v_mul_f32 v149, v135, v145
    v_fma_f32 v132, -v146, v144, v132
    v_fma_f32 v133, -v147, v144, v133
    v_fma_f32 v134, -v148, v144, v134
    v_fma_f32 v135, -v149, v144, v135
    v_fma_f32 v132, v132, v145, v146
    v_fma_f32 v133, v133, v145, v147
    v_fma_f32 v134, v134, v145, v148
    v_fma_f32 v135, v135, v145, v149
    v_cvt_pk_bf16_f32 v132, v132, v133
    v_cvt_pk_bf16_f32 v133, v134, v135
    ds_write_b64 v130, v[132:133] offset:0
    v_cvt_pk_bf16_f32 v136, v136, v136
    v_lshlrev_b32 v136, 16, v136
    v_cvt_pk_bf16_f32 v137, v137, v137
    v_lshlrev_b32 v137, 16, v137
    v_cvt_pk_bf16_f32 v138, v138, v138
    v_lshlrev_b32 v138, 16, v138
    v_cvt_pk_bf16_f32 v139, v139, v139
    v_lshlrev_b32 v139, 16, v139
    v_mul_f32 v146, v136, v145
    v_mul_f32 v147, v137, v145
    v_mul_f32 v148, v138, v145
    v_mul_f32 v149, v139, v145
    v_fma_f32 v136, -v146, v144, v136
    v_fma_f32 v137, -v147, v144, v137
    v_fma_f32 v138, -v148, v144, v138
    v_fma_f32 v139, -v149, v144, v139
    v_fma_f32 v136, v136, v145, v146
    v_fma_f32 v137, v137, v145, v147
    v_fma_f32 v138, v138, v145, v148
    v_fma_f32 v139, v139, v145, v149
    v_cvt_pk_bf16_f32 v136, v136, v137
    v_cvt_pk_bf16_f32 v137, v138, v139
    s_and_saveexec_b64 s[30:31], s[34:35]
    ds_write_b64 v130, v[136:137] offset:32
    s_mov_b64 exec, s[30:31]
    s_waitcnt lgkmcnt(0)
    s_cmp_ge_u32 s26, 4
    s_cbranch_scc1 k2n_kernel_idle
    s_mul_i32 s27, s26, 16
    s_mov_b32 s28, 0
    v_and_b32 v8, 15, v1
    v_lshrrev_b32 v9, 4, v1
    v_add_u32 v11, s27, v8
    v_mul_u32_u24 v11, 1296, v11
    v_lshl_add_u32 v2, v9, 4, v11
    v_add_u32 v2, 0, v2
    v_lshrrev_b32 v10, 2, v8
    v_and_b32 v11, 3, v1
    v_and_b32 v12, 1, v9
    v_lshlrev_b32 v12, 2, v12
    v_add_u32 v12, v12, v10
    v_lshrrev_b32 v13, 1, v9
    v_lshl_add_u32 v12, v13, 4, v12
    v_mul_u32_u24 v12, 160, v12
    s_lshl_b32 s29, s28, 1
    v_lshl_add_u32 v13, v11, 3, v12
    v_add_u32 v4, s29, v13
    v_mov_b32 v64, 0
    v_mov_b32 v65, 0
    v_mov_b32 v66, 0
    v_mov_b32 v67, 0
    v_mov_b32 v68, 0
    v_mov_b32 v69, 0
    v_mov_b32 v70, 0
    v_mov_b32 v71, 0
    v_mov_b32 v72, 0
    v_mov_b32 v73, 0
    v_mov_b32 v74, 0
    v_mov_b32 v75, 0
    v_mov_b32 v76, 0
    v_mov_b32 v77, 0
    v_mov_b32 v78, 0
    v_mov_b32 v79, 0
    v_mov_b32 v80, 0
    v_mov_b32 v81, 0
    v_mov_b32 v82, 0
    v_mov_b32 v83, 0
    s_barrier
    v_add_u32 v9, 82944, v4
    ds_read_b128 v[16:19], v2 offset:0
    ds_read_b64_tr_b16 v[24:25], v9 offset:0
    ds_read_b64_tr_b16 v[26:27], v9 offset:1280
    ds_read_b64_tr_b16 v[28:29], v9 offset:32
    ds_read_b64_tr_b16 v[30:31], v9 offset:1312
    ds_read_b64_tr_b16 v[32:33], v9 offset:64
    ds_read_b64_tr_b16 v[34:35], v9 offset:1344
    ds_read_b64_tr_b16 v[36:37], v9 offset:96
    ds_read_b64_tr_b16 v[38:39], v9 offset:1376
    ds_read_b64_tr_b16 v[40:41], v9 offset:128
    ds_read_b64_tr_b16 v[42:43], v9 offset:1408
    v_add_u32 v9, 82944, v4
    ds_read_b128 v[20:23], v2 offset:64
    ds_read_b64_tr_b16 v[44:45], v9 offset:5120
    ds_read_b64_tr_b16 v[46:47], v9 offset:6400
    ds_read_b64_tr_b16 v[48:49], v9 offset:5152
    ds_read_b64_tr_b16 v[50:51], v9 offset:6432
    ds_read_b64_tr_b16 v[52:53], v9 offset:5184
    ds_read_b64_tr_b16 v[54:55], v9 offset:6464
    ds_read_b64_tr_b16 v[56:57], v9 offset:5216
    ds_read_b64_tr_b16 v[58:59], v9 offset:6496
    ds_read_b64_tr_b16 v[60:61], v9 offset:5248
    ds_read_b64_tr_b16 v[62:63], v9 offset:6528
    s_waitcnt lgkmcnt(11)
    v_mfma_f32_16x16x32_bf16 v[64:67], v[24:27], v[16:19], v[64:67]
    v_mfma_f32_16x16x32_bf16 v[68:71], v[28:31], v[16:19], v[68:71]
    v_mfma_f32_16x16x32_bf16 v[72:75], v[32:35], v[16:19], v[72:75]
    v_mfma_f32_16x16x32_bf16 v[76:79], v[36:39], v[16:19], v[76:79]
    v_mfma_f32_16x16x32_bf16 v[80:83], v[40:43], v[16:19], v[80:83]
    s_waitcnt lgkmcnt(0)
    s_barrier
    v_add_u32 v9, 93184, v4
    ds_read_b128 v[16:19], v2 offset:128
    ds_read_b64_tr_b16 v[24:25], v9 offset:0
    ds_read_b64_tr_b16 v[26:27], v9 offset:1280
    ds_read_b64_tr_b16 v[28:29], v9 offset:32
    ds_read_b64_tr_b16 v[30:31], v9 offset:1312
    ds_read_b64_tr_b16 v[32:33], v9 offset:64
    ds_read_b64_tr_b16 v[34:35], v9 offset:1344
    ds_read_b64_tr_b16 v[36:37], v9 offset:96
    ds_read_b64_tr_b16 v[38:39], v9 offset:1376
    ds_read_b64_tr_b16 v[40:41], v9 offset:128
    ds_read_b64_tr_b16 v[42:43], v9 offset:1408
    v_mfma_f32_16x16x32_bf16 v[64:67], v[44:47], v[20:23], v[64:67]
    v_mfma_f32_16x16x32_bf16 v[68:71], v[48:51], v[20:23], v[68:71]
    v_mfma_f32_16x16x32_bf16 v[72:75], v[52:55], v[20:23], v[72:75]
    v_mfma_f32_16x16x32_bf16 v[76:79], v[56:59], v[20:23], v[76:79]
    v_mfma_f32_16x16x32_bf16 v[80:83], v[60:63], v[20:23], v[80:83]
    v_add_u32 v9, 93184, v4
    ds_read_b128 v[20:23], v2 offset:192
    ds_read_b64_tr_b16 v[44:45], v9 offset:5120
    ds_read_b64_tr_b16 v[46:47], v9 offset:6400
    ds_read_b64_tr_b16 v[48:49], v9 offset:5152
    ds_read_b64_tr_b16 v[50:51], v9 offset:6432
    ds_read_b64_tr_b16 v[52:53], v9 offset:5184
    ds_read_b64_tr_b16 v[54:55], v9 offset:6464
    ds_read_b64_tr_b16 v[56:57], v9 offset:5216
    ds_read_b64_tr_b16 v[58:59], v9 offset:6496
    ds_read_b64_tr_b16 v[60:61], v9 offset:5248
    ds_read_b64_tr_b16 v[62:63], v9 offset:6528
    s_waitcnt lgkmcnt(11)
    v_mfma_f32_16x16x32_bf16 v[64:67], v[24:27], v[16:19], v[64:67]
    v_mfma_f32_16x16x32_bf16 v[68:71], v[28:31], v[16:19], v[68:71]
    v_mfma_f32_16x16x32_bf16 v[72:75], v[32:35], v[16:19], v[72:75]
    v_mfma_f32_16x16x32_bf16 v[76:79], v[36:39], v[16:19], v[76:79]
    v_mfma_f32_16x16x32_bf16 v[80:83], v[40:43], v[16:19], v[80:83]
    s_waitcnt lgkmcnt(0)
    s_barrier
    v_add_u32 v9, 103424, v4
    ds_read_b128 v[16:19], v2 offset:256
    ds_read_b64_tr_b16 v[24:25], v9 offset:0
    ds_read_b64_tr_b16 v[26:27], v9 offset:1280
    ds_read_b64_tr_b16 v[28:29], v9 offset:32
    ds_read_b64_tr_b16 v[30:31], v9 offset:1312
    ds_read_b64_tr_b16 v[32:33], v9 offset:64
    ds_read_b64_tr_b16 v[34:35], v9 offset:1344
    ds_read_b64_tr_b16 v[36:37], v9 offset:96
    ds_read_b64_tr_b16 v[38:39], v9 offset:1376
    ds_read_b64_tr_b16 v[40:41], v9 offset:128
    ds_read_b64_tr_b16 v[42:43], v9 offset:1408
    v_mfma_f32_16x16x32_bf16 v[64:67], v[44:47], v[20:23], v[64:67]
    v_mfma_f32_16x16x32_bf16 v[68:71], v[48:51], v[20:23], v[68:71]
    v_mfma_f32_16x16x32_bf16 v[72:75], v[52:55], v[20:23], v[72:75]
    v_mfma_f32_16x16x32_bf16 v[76:79], v[56:59], v[20:23], v[76:79]
    v_mfma_f32_16x16x32_bf16 v[80:83], v[60:63], v[20:23], v[80:83]
    v_add_u32 v9, 103424, v4
    ds_read_b128 v[20:23], v2 offset:320
    ds_read_b64_tr_b16 v[44:45], v9 offset:5120
    ds_read_b64_tr_b16 v[46:47], v9 offset:6400
    ds_read_b64_tr_b16 v[48:49], v9 offset:5152
    ds_read_b64_tr_b16 v[50:51], v9 offset:6432
    ds_read_b64_tr_b16 v[52:53], v9 offset:5184
    ds_read_b64_tr_b16 v[54:55], v9 offset:6464
    ds_read_b64_tr_b16 v[56:57], v9 offset:5216
    ds_read_b64_tr_b16 v[58:59], v9 offset:6496
    ds_read_b64_tr_b16 v[60:61], v9 offset:5248
    ds_read_b64_tr_b16 v[62:63], v9 offset:6528
    s_waitcnt lgkmcnt(11)
    v_mfma_f32_16x16x32_bf16 v[64:67], v[24:27], v[16:19], v[64:67]
    v_mfma_f32_16x16x32_bf16 v[68:71], v[28:31], v[16:19], v[68:71]
    v_mfma_f32_16x16x32_bf16 v[72:75], v[32:35], v[16:19], v[72:75]
    v_mfma_f32_16x16x32_bf16 v[76:79], v[36:39], v[16:19], v[76:79]
    v_mfma_f32_16x16x32_bf16 v[80:83], v[40:43], v[16:19], v[80:83]
    s_waitcnt lgkmcnt(0)
    s_barrier
    v_add_u32 v9, 113664, v4
    ds_read_b128 v[16:19], v2 offset:384
    ds_read_b64_tr_b16 v[24:25], v9 offset:0
    ds_read_b64_tr_b16 v[26:27], v9 offset:1280
    ds_read_b64_tr_b16 v[28:29], v9 offset:32
    ds_read_b64_tr_b16 v[30:31], v9 offset:1312
    ds_read_b64_tr_b16 v[32:33], v9 offset:64
    ds_read_b64_tr_b16 v[34:35], v9 offset:1344
    ds_read_b64_tr_b16 v[36:37], v9 offset:96
    ds_read_b64_tr_b16 v[38:39], v9 offset:1376
    ds_read_b64_tr_b16 v[40:41], v9 offset:128
    ds_read_b64_tr_b16 v[42:43], v9 offset:1408
    v_mfma_f32_16x16x32_bf16 v[64:67], v[44:47], v[20:23], v[64:67]
    v_mfma_f32_16x16x32_bf16 v[68:71], v[48:51], v[20:23], v[68:71]
    v_mfma_f32_16x16x32_bf16 v[72:75], v[52:55], v[20:23], v[72:75]
    v_mfma_f32_16x16x32_bf16 v[76:79], v[56:59], v[20:23], v[76:79]
    v_mfma_f32_16x16x32_bf16 v[80:83], v[60:63], v[20:23], v[80:83]
    v_add_u32 v9, 113664, v4
    ds_read_b128 v[20:23], v2 offset:448
    ds_read_b64_tr_b16 v[44:45], v9 offset:5120
    ds_read_b64_tr_b16 v[46:47], v9 offset:6400
    ds_read_b64_tr_b16 v[48:49], v9 offset:5152
    ds_read_b64_tr_b16 v[50:51], v9 offset:6432
    ds_read_b64_tr_b16 v[52:53], v9 offset:5184
    ds_read_b64_tr_b16 v[54:55], v9 offset:6464
    ds_read_b64_tr_b16 v[56:57], v9 offset:5216
    ds_read_b64_tr_b16 v[58:59], v9 offset:6496
    ds_read_b64_tr_b16 v[60:61], v9 offset:5248
    ds_read_b64_tr_b16 v[62:63], v9 offset:6528
    s_waitcnt lgkmcnt(11)
    v_mfma_f32_16x16x32_bf16 v[64:67], v[24:27], v[16:19], v[64:67]
    v_mfma_f32_16x16x32_bf16 v[68:71], v[28:31], v[16:19], v[68:71]
    v_mfma_f32_16x16x32_bf16 v[72:75], v[32:35], v[16:19], v[72:75]
    v_mfma_f32_16x16x32_bf16 v[76:79], v[36:39], v[16:19], v[76:79]
    v_mfma_f32_16x16x32_bf16 v[80:83], v[40:43], v[16:19], v[80:83]
    s_waitcnt lgkmcnt(0)
    s_barrier
    v_add_u32 v9, 123904, v4
    ds_read_b128 v[16:19], v2 offset:512
    ds_read_b64_tr_b16 v[24:25], v9 offset:0
    ds_read_b64_tr_b16 v[26:27], v9 offset:1280
    ds_read_b64_tr_b16 v[28:29], v9 offset:32
    ds_read_b64_tr_b16 v[30:31], v9 offset:1312
    ds_read_b64_tr_b16 v[32:33], v9 offset:64
    ds_read_b64_tr_b16 v[34:35], v9 offset:1344
    ds_read_b64_tr_b16 v[36:37], v9 offset:96
    ds_read_b64_tr_b16 v[38:39], v9 offset:1376
    ds_read_b64_tr_b16 v[40:41], v9 offset:128
    ds_read_b64_tr_b16 v[42:43], v9 offset:1408
    v_mfma_f32_16x16x32_bf16 v[64:67], v[44:47], v[20:23], v[64:67]
    v_mfma_f32_16x16x32_bf16 v[68:71], v[48:51], v[20:23], v[68:71]
    v_mfma_f32_16x16x32_bf16 v[72:75], v[52:55], v[20:23], v[72:75]
    v_mfma_f32_16x16x32_bf16 v[76:79], v[56:59], v[20:23], v[76:79]
    v_mfma_f32_16x16x32_bf16 v[80:83], v[60:63], v[20:23], v[80:83]
    v_add_u32 v9, 123904, v4
    ds_read_b128 v[20:23], v2 offset:576
    ds_read_b64_tr_b16 v[44:45], v9 offset:5120
    ds_read_b64_tr_b16 v[46:47], v9 offset:6400
    ds_read_b64_tr_b16 v[48:49], v9 offset:5152
    ds_read_b64_tr_b16 v[50:51], v9 offset:6432
    ds_read_b64_tr_b16 v[52:53], v9 offset:5184
    ds_read_b64_tr_b16 v[54:55], v9 offset:6464
    ds_read_b64_tr_b16 v[56:57], v9 offset:5216
    ds_read_b64_tr_b16 v[58:59], v9 offset:6496
    ds_read_b64_tr_b16 v[60:61], v9 offset:5248
    ds_read_b64_tr_b16 v[62:63], v9 offset:6528
    s_waitcnt lgkmcnt(11)
    v_mfma_f32_16x16x32_bf16 v[64:67], v[24:27], v[16:19], v[64:67]
    v_mfma_f32_16x16x32_bf16 v[68:71], v[28:31], v[16:19], v[68:71]
    v_mfma_f32_16x16x32_bf16 v[72:75], v[32:35], v[16:19], v[72:75]
    v_mfma_f32_16x16x32_bf16 v[76:79], v[36:39], v[16:19], v[76:79]
    v_mfma_f32_16x16x32_bf16 v[80:83], v[40:43], v[16:19], v[80:83]
    s_waitcnt lgkmcnt(0)
    s_barrier
    v_add_u32 v9, 134144, v4
    ds_read_b128 v[16:19], v2 offset:640
    ds_read_b64_tr_b16 v[24:25], v9 offset:0
    ds_read_b64_tr_b16 v[26:27], v9 offset:1280
    ds_read_b64_tr_b16 v[28:29], v9 offset:32
    ds_read_b64_tr_b16 v[30:31], v9 offset:1312
    ds_read_b64_tr_b16 v[32:33], v9 offset:64
    ds_read_b64_tr_b16 v[34:35], v9 offset:1344
    ds_read_b64_tr_b16 v[36:37], v9 offset:96
    ds_read_b64_tr_b16 v[38:39], v9 offset:1376
    ds_read_b64_tr_b16 v[40:41], v9 offset:128
    ds_read_b64_tr_b16 v[42:43], v9 offset:1408
    v_mfma_f32_16x16x32_bf16 v[64:67], v[44:47], v[20:23], v[64:67]
    v_mfma_f32_16x16x32_bf16 v[68:71], v[48:51], v[20:23], v[68:71]
    v_mfma_f32_16x16x32_bf16 v[72:75], v[52:55], v[20:23], v[72:75]
    v_mfma_f32_16x16x32_bf16 v[76:79], v[56:59], v[20:23], v[76:79]
    v_mfma_f32_16x16x32_bf16 v[80:83], v[60:63], v[20:23], v[80:83]
    v_add_u32 v9, 134144, v4
    ds_read_b128 v[20:23], v2 offset:704
    ds_read_b64_tr_b16 v[44:45], v9 offset:5120
    ds_read_b64_tr_b16 v[46:47], v9 offset:6400
    ds_read_b64_tr_b16 v[48:49], v9 offset:5152
    ds_read_b64_tr_b16 v[50:51], v9 offset:6432
    ds_read_b64_tr_b16 v[52:53], v9 offset:5184
    ds_read_b64_tr_b16 v[54:55], v9 offset:6464
    ds_read_b64_tr_b16 v[56:57], v9 offset:5216
    ds_read_b64_tr_b16 v[58:59], v9 offset:6496
    ds_read_b64_tr_b16 v[60:61], v9 offset:5248
    ds_read_b64_tr_b16 v[62:63], v9 offset:6528
    s_waitcnt lgkmcnt(11)
    v_mfma_f32_16x16x32_bf16 v[64:67], v[24:27], v[16:19], v[64:67]
    v_mfma_f32_16x16x32_bf16 v[68:71], v[28:31], v[16:19], v[68:71]
    v_mfma_f32_16x16x32_bf16 v[72:75], v[32:35], v[16:19], v[72:75]
    v_mfma_f32_16x16x32_bf16 v[76:79], v[36:39], v[16:19], v[76:79]
    v_mfma_f32_16x16x32_bf16 v[80:83], v[40:43], v[16:19], v[80:83]
    s_waitcnt lgkmcnt(0)
    s_barrier
    v_add_u32 v9, 82944, v4
    ds_read_b128 v[16:19], v2 offset:768
    ds_read_b64_tr_b16 v[24:25], v9 offset:0
    ds_read_b64_tr_b16 v[26:27], v9 offset:1280
    ds_read_b64_tr_b16 v[28:29], v9 offset:32
    ds_read_b64_tr_b16 v[30:31], v9 offset:1312
    ds_read_b64_tr_b16 v[32:33], v9 offset:64
    ds_read_b64_tr_b16 v[34:35], v9 offset:1344
    ds_read_b64_tr_b16 v[36:37], v9 offset:96
    ds_read_b64_tr_b16 v[38:39], v9 offset:1376
    ds_read_b64_tr_b16 v[40:41], v9 offset:128
    ds_read_b64_tr_b16 v[42:43], v9 offset:1408
    v_mfma_f32_16x16x32_bf16 v[64:67], v[44:47], v[20:23], v[64:67]
    v_mfma_f32_16x16x32_bf16 v[68:71], v[48:51], v[20:23], v[68:71]
    v_mfma_f32_16x16x32_bf16 v[72:75], v[52:55], v[20:23], v[72:75]
    v_mfma_f32_16x16x32_bf16 v[76:79], v[56:59], v[20:23], v[76:79]
    v_mfma_f32_16x16x32_bf16 v[80:83], v[60:63], v[20:23], v[80:83]
    v_add_u32 v9, 82944, v4
    ds_read_b128 v[20:23], v2 offset:832
    ds_read_b64_tr_b16 v[44:45], v9 offset:5120
    ds_read_b64_tr_b16 v[46:47], v9 offset:6400
    ds_read_b64_tr_b16 v[48:49], v9 offset:5152
    ds_read_b64_tr_b16 v[50:51], v9 offset:6432
    ds_read_b64_tr_b16 v[52:53], v9 offset:5184
    ds_read_b64_tr_b16 v[54:55], v9 offset:6464
    ds_read_b64_tr_b16 v[56:57], v9 offset:5216
    ds_read_b64_tr_b16 v[58:59], v9 offset:6496
    ds_read_b64_tr_b16 v[60:61], v9 offset:5248
    ds_read_b64_tr_b16 v[62:63], v9 offset:6528
    s_waitcnt lgkmcnt(11)
    v_mfma_f32_16x16x32_bf16 v[64:67], v[24:27], v[16:19], v[64:67]
    v_mfma_f32_16x16x32_bf16 v[68:71], v[28:31], v[16:19], v[68:71]
    v_mfma_f32_16x16x32_bf16 v[72:75], v[32:35], v[16:19], v[72:75]
    v_mfma_f32_16x16x32_bf16 v[76:79], v[36:39], v[16:19], v[76:79]
    v_mfma_f32_16x16x32_bf16 v[80:83], v[40:43], v[16:19], v[80:83]
    s_waitcnt lgkmcnt(0)
    s_barrier
    v_add_u32 v9, 93184, v4
    ds_read_b128 v[16:19], v2 offset:896
    ds_read_b64_tr_b16 v[24:25], v9 offset:0
    ds_read_b64_tr_b16 v[26:27], v9 offset:1280
    ds_read_b64_tr_b16 v[28:29], v9 offset:32
    ds_read_b64_tr_b16 v[30:31], v9 offset:1312
    ds_read_b64_tr_b16 v[32:33], v9 offset:64
    ds_read_b64_tr_b16 v[34:35], v9 offset:1344
    ds_read_b64_tr_b16 v[36:37], v9 offset:96
    ds_read_b64_tr_b16 v[38:39], v9 offset:1376
    ds_read_b64_tr_b16 v[40:41], v9 offset:128
    ds_read_b64_tr_b16 v[42:43], v9 offset:1408
    v_mfma_f32_16x16x32_bf16 v[64:67], v[44:47], v[20:23], v[64:67]
    v_mfma_f32_16x16x32_bf16 v[68:71], v[48:51], v[20:23], v[68:71]
    v_mfma_f32_16x16x32_bf16 v[72:75], v[52:55], v[20:23], v[72:75]
    v_mfma_f32_16x16x32_bf16 v[76:79], v[56:59], v[20:23], v[76:79]
    v_mfma_f32_16x16x32_bf16 v[80:83], v[60:63], v[20:23], v[80:83]
    v_add_u32 v9, 93184, v4
    ds_read_b128 v[20:23], v2 offset:960
    ds_read_b64_tr_b16 v[44:45], v9 offset:5120
    ds_read_b64_tr_b16 v[46:47], v9 offset:6400
    ds_read_b64_tr_b16 v[48:49], v9 offset:5152
    ds_read_b64_tr_b16 v[50:51], v9 offset:6432
    ds_read_b64_tr_b16 v[52:53], v9 offset:5184
    ds_read_b64_tr_b16 v[54:55], v9 offset:6464
    ds_read_b64_tr_b16 v[56:57], v9 offset:5216
    ds_read_b64_tr_b16 v[58:59], v9 offset:6496
    ds_read_b64_tr_b16 v[60:61], v9 offset:5248
    ds_read_b64_tr_b16 v[62:63], v9 offset:6528
    s_waitcnt lgkmcnt(11)
    v_mfma_f32_16x16x32_bf16 v[64:67], v[24:27], v[16:19], v[64:67]
    v_mfma_f32_16x16x32_bf16 v[68:71], v[28:31], v[16:19], v[68:71]
    v_mfma_f32_16x16x32_bf16 v[72:75], v[32:35], v[16:19], v[72:75]
    v_mfma_f32_16x16x32_bf16 v[76:79], v[36:39], v[16:19], v[76:79]
    v_mfma_f32_16x16x32_bf16 v[80:83], v[40:43], v[16:19], v[80:83]
    s_waitcnt lgkmcnt(0)
    s_barrier
    v_add_u32 v9, 103424, v4
    ds_read_b128 v[16:19], v2 offset:1024
    ds_read_b64_tr_b16 v[24:25], v9 offset:0
    ds_read_b64_tr_b16 v[26:27], v9 offset:1280
    ds_read_b64_tr_b16 v[28:29], v9 offset:32
    ds_read_b64_tr_b16 v[30:31], v9 offset:1312
    ds_read_b64_tr_b16 v[32:33], v9 offset:64
    ds_read_b64_tr_b16 v[34:35], v9 offset:1344
    ds_read_b64_tr_b16 v[36:37], v9 offset:96
    ds_read_b64_tr_b16 v[38:39], v9 offset:1376
    ds_read_b64_tr_b16 v[40:41], v9 offset:128
    ds_read_b64_tr_b16 v[42:43], v9 offset:1408
    v_mfma_f32_16x16x32_bf16 v[64:67], v[44:47], v[20:23], v[64:67]
    v_mfma_f32_16x16x32_bf16 v[68:71], v[48:51], v[20:23], v[68:71]
    v_mfma_f32_16x16x32_bf16 v[72:75], v[52:55], v[20:23], v[72:75]
    v_mfma_f32_16x16x32_bf16 v[76:79], v[56:59], v[20:23], v[76:79]
    v_mfma_f32_16x16x32_bf16 v[80:83], v[60:63], v[20:23], v[80:83]
    v_add_u32 v9, 103424, v4
    ds_read_b128 v[20:23], v2 offset:1088
    ds_read_b64_tr_b16 v[44:45], v9 offset:5120
    ds_read_b64_tr_b16 v[46:47], v9 offset:6400
    ds_read_b64_tr_b16 v[48:49], v9 offset:5152
    ds_read_b64_tr_b16 v[50:51], v9 offset:6432
    ds_read_b64_tr_b16 v[52:53], v9 offset:5184
    ds_read_b64_tr_b16 v[54:55], v9 offset:6464
    ds_read_b64_tr_b16 v[56:57], v9 offset:5216
    ds_read_b64_tr_b16 v[58:59], v9 offset:6496
    ds_read_b64_tr_b16 v[60:61], v9 offset:5248
    ds_read_b64_tr_b16 v[62:63], v9 offset:6528
    s_waitcnt lgkmcnt(11)
    v_mfma_f32_16x16x32_bf16 v[64:67], v[24:27], v[16:19], v[64:67]
    v_mfma_f32_16x16x32_bf16 v[68:71], v[28:31], v[16:19], v[68:71]
    v_mfma_f32_16x16x32_bf16 v[72:75], v[32:35], v[16:19], v[72:75]
    v_mfma_f32_16x16x32_bf16 v[76:79], v[36:39], v[16:19], v[76:79]
    v_mfma_f32_16x16x32_bf16 v[80:83], v[40:43], v[16:19], v[80:83]
    s_waitcnt lgkmcnt(0)
    s_barrier
    v_add_u32 v9, 113664, v4
    ds_read_b128 v[16:19], v2 offset:1152
    ds_read_b64_tr_b16 v[24:25], v9 offset:0
    ds_read_b64_tr_b16 v[26:27], v9 offset:1280
    ds_read_b64_tr_b16 v[28:29], v9 offset:32
    ds_read_b64_tr_b16 v[30:31], v9 offset:1312
    ds_read_b64_tr_b16 v[32:33], v9 offset:64
    ds_read_b64_tr_b16 v[34:35], v9 offset:1344
    ds_read_b64_tr_b16 v[36:37], v9 offset:96
    ds_read_b64_tr_b16 v[38:39], v9 offset:1376
    ds_read_b64_tr_b16 v[40:41], v9 offset:128
    ds_read_b64_tr_b16 v[42:43], v9 offset:1408
    v_mfma_f32_16x16x32_bf16 v[64:67], v[44:47], v[20:23], v[64:67]
    v_mfma_f32_16x16x32_bf16 v[68:71], v[48:51], v[20:23], v[68:71]
    v_mfma_f32_16x16x32_bf16 v[72:75], v[52:55], v[20:23], v[72:75]
    v_mfma_f32_16x16x32_bf16 v[76:79], v[56:59], v[20:23], v[76:79]
    v_mfma_f32_16x16x32_bf16 v[80:83], v[60:63], v[20:23], v[80:83]
    v_add_u32 v9, 113664, v4
    ds_read_b128 v[20:23], v2 offset:1216
    ds_read_b64_tr_b16 v[44:45], v9 offset:5120
    ds_read_b64_tr_b16 v[46:47], v9 offset:6400
    ds_read_b64_tr_b16 v[48:49], v9 offset:5152
    ds_read_b64_tr_b16 v[50:51], v9 offset:6432
    ds_read_b64_tr_b16 v[52:53], v9 offset:5184
    ds_read_b64_tr_b16 v[54:55], v9 offset:6464
    ds_read_b64_tr_b16 v[56:57], v9 offset:5216
    ds_read_b64_tr_b16 v[58:59], v9 offset:6496
    ds_read_b64_tr_b16 v[60:61], v9 offset:5248
    ds_read_b64_tr_b16 v[62:63], v9 offset:6528
    s_waitcnt lgkmcnt(11)
    v_mfma_f32_16x16x32_bf16 v[64:67], v[24:27], v[16:19], v[64:67]
    v_mfma_f32_16x16x32_bf16 v[68:71], v[28:31], v[16:19], v[68:71]
    v_mfma_f32_16x16x32_bf16 v[72:75], v[32:35], v[16:19], v[72:75]
    v_mfma_f32_16x16x32_bf16 v[76:79], v[36:39], v[16:19], v[76:79]
    v_mfma_f32_16x16x32_bf16 v[80:83], v[40:43], v[16:19], v[80:83]
    s_waitcnt lgkmcnt(0)
    v_mfma_f32_16x16x32_bf16 v[64:67], v[44:47], v[20:23], v[64:67]
    v_mfma_f32_16x16x32_bf16 v[68:71], v[48:51], v[20:23], v[68:71]
    v_mfma_f32_16x16x32_bf16 v[72:75], v[52:55], v[20:23], v[72:75]
    v_mfma_f32_16x16x32_bf16 v[76:79], v[56:59], v[20:23], v[76:79]
    v_mfma_f32_16x16x32_bf16 v[80:83], v[60:63], v[20:23], v[80:83]
    s_nop 15
    s_branch k2n_kernel_epi
k2n_kernel_idle:
    s_waitcnt vmcnt(12)
    s_barrier
    s_add_u32 s29, s40, 0
    s_lshl_b32 m0, s29, 10
    s_add_u32 m0, m0, 134144
    s_nop 0
    buffer_load_dwordx4 v2, s[12:15], 0 offen lds
    v_add_u32 v2, 81920, v2
    s_add_u32 s29, s40, 4
    s_lshl_b32 m0, s29, 10
    s_add_u32 m0, m0, 134144
    s_nop 0
    buffer_load_dwordx4 v3, s[12:15], 0 offen lds
    v_add_u32 v3, 81920, v3
    s_add_u32 s29, s40, 8
    s_cmp_ge_u32 s29, 10
    s_cselect_b32 s29, s40, s29
    s_lshl_b32 m0, s29, 10
    s_add_u32 m0, m0, 134144
    s_nop 0
    buffer_load_dwordx4 v4, s[12:15], 0 offen lds
    v_add_u32 v4, 81920, v4
    s_waitcnt vmcnt(12)
    s_barrier
    s_add_u32 s29, s40, 0
    s_lshl_b32 m0, s29, 10
    s_add_u32 m0, m0, 82944
    s_nop 0
    buffer_load_dwordx4 v2, s[12:15], 0 offen lds
    v_add_u32 v2, 81920, v2
    s_add_u32 s29, s40, 4
    s_lshl_b32 m0, s29, 10
    s_add_u32 m0, m0, 82944
    s_nop 0
    buffer_load_dwordx4 v3, s[12:15], 0 offen lds
    v_add_u32 v3, 81920, v3
    s_add_u32 s29, s40, 8
    s_cmp_ge_u32 s29, 10
    s_cselect_b32 s29, s40, s29
    s_lshl_b32 m0, s29, 10
    s_add_u32 m0, m0, 82944
    s_nop 0
    buffer_load_dwordx4 v4, s[12:15], 0 offen lds
    v_add_u32 v4, 81920, v4
    s_waitcnt vmcnt(12)
    s_barrier
    s_add_u32 s29, s40, 0
    s_lshl_b32 m0, s29, 10
    s_add_u32 m0, m0, 93184
    s_nop 0
    buffer_load_dwordx4 v2, s[12:15], 0 offen lds
    v_add_u32 v2, 81920, v2
    s_add_u32 s29, s40, 4
    s_lshl_b32 m0, s29, 10
    s_add_u32 m0, m0, 93184
    s_nop 0
    buffer_load_dwordx4 v3, s[12:15], 0 offen lds
    v_add_u32 v3, 81920, v3
    s_add_u32 s29, s40, 8
    s_cmp_ge_u32 s29, 10
    s_cselect_b32 s29, s40, s29
    s_lshl_b32 m0, s29, 10
    s_add_u32 m0, m0, 93184
    s_nop 0
    buffer_load_dwordx4 v4, s[12:15], 0 offen lds
    v_add_u32 v4, 81920, v4
    s_waitcnt vmcnt(12)
    s_barrier
    s_add_u32 s29, s40, 0
    s_lshl_b32 m0, s29, 10
    s_add_u32 m0, m0, 103424
    s_nop 0
    buffer_load_dwordx4 v2, s[12:15], 0 offen lds
    v_add_u32 v2, 81920, v2
    s_add_u32 s29, s40, 4
    s_lshl_b32 m0, s29, 10
    s_add_u32 m0, m0, 103424
    s_nop 0
    buffer_load_dwordx4 v3, s[12:15], 0 offen lds
    v_add_u32 v3, 81920, v3
    s_add_u32 s29, s40, 8
    s_cmp_ge_u32 s29, 10
    s_cselect_b32 s29, s40, s29
    s_lshl_b32 m0, s29, 10
    s_add_u32 m0, m0, 103424
    s_nop 0
    buffer_load_dwordx4 v4, s[12:15], 0 offen lds
    v_add_u32 v4, 81920, v4
    s_waitcnt vmcnt(12)
    s_barrier
    s_add_u32 s29, s40, 0
    s_lshl_b32 m0, s29, 10
    s_add_u32 m0, m0, 113664
    s_nop 0
    buffer_load_dwordx4 v2, s[12:15], 0 offen lds
    v_add_u32 v2, 81920, v2
    s_add_u32 s29, s40, 4
    s_lshl_b32 m0, s29, 10
    s_add_u32 m0, m0, 113664
    s_nop 0
    buffer_load_dwordx4 v3, s[12:15], 0 offen lds
    v_add_u32 v3, 81920, v3
    s_add_u32 s29, s40, 8
    s_cmp_ge_u32 s29, 10
    s_cselect_b32 s29, s40, s29
    s_lshl_b32 m0, s29, 10
    s_add_u32 m0, m0, 113664
    s_nop 0
    buffer_load_dwordx4 v4, s[12:15], 0 offen lds
    v_add_u32 v4, 81920, v4
    s_waitcnt vmcnt(12)
    s_barrier
    s_waitcnt vmcnt(9)
    s_barrier
    s_waitcnt vmcnt(6)
    s_barrier
    s_waitcnt vmcnt(3)
    s_barrier
    s_waitcnt vmcnt(0)
    s_barrier
k2n_kernel_epi:
    s_barrier
    s_cmp_ge_u32 s26, 4
    s_cbranch_scc1 k2n_kernel_e2
    v_and_b32 v8, 15, v1
    v_lshrrev_b32 v9, 4, v1
    v_add_u32 v8, s27, v8
    v_mul_u32_u24 v8, 176, v8
    v_lshlrev_b32 v9, 3, v9
    s_lshl_b32 s29, s28, 1
    v_add3_u32 v8, v8, v9, s29
    v_cvt_pk_bf16_f32 v64, v64, v65
    v_cvt_pk_bf16_f32 v65, v66, v67
    ds_write_b64 v8, v[64:65] offset:0
    v_cvt_pk_bf16_f32 v68, v68, v69
    v_cvt_pk_bf16_f32 v69, v70, v71
    ds_write_b64 v8, v[68:69] offset:32
    v_cvt_pk_bf16_f32 v72, v72, v73
    v_cvt_pk_bf16_f32 v73, v74, v75
    ds_write_b64 v8, v[72:73] offset:64
    v_cvt_pk_bf16_f32 v76, v76, v77
    v_cvt_pk_bf16_f32 v77, v78, v79
    ds_write_b64 v8, v[76:77] offset:96
    v_cvt_pk_bf16_f32 v80, v80, v81
    v_cvt_pk_bf16_f32 v81, v82, v83
    ds_write_b64 v8, v[80:81] offset:128
    s_waitcnt lgkmcnt(0)
k2n_kernel_e2:
    v_lshlrev_b32 v8, 2, v0
    v_mov_b32 v9, 0
    ds_write_b32 v8, v9 offset:16384
    s_waitcnt lgkmcnt(0)
    s_barrier
    s_add_u32 s48, s82, 18939904
    s_addc_u32 s49, s83, 0
    s_and_b32 s49, s49, 0xffff
    s_mov_b32 s50, 16384
    s_mov_b32 s51, 0x00020000
    s_mul_i32 s29, s24, 1280
    s_lshl_b32 s30, s25, 1
    s_add_u32 s29, s29, s30
    v_add_u32 v8, 0, v0
    v_mul_u32_u24 v9, 1639, v8
    v_lshrrev_b32 v9, 14, v9
    v_mul_u32_u24 v10, 10, v9
    v_sub_u32 v10, v8, v10
    v_mul_u32_u24 v11, 176, v9
    v_lshl_add_u32 v11, v10, 4, v11
    ds_read_b128 v[16:19], v11 offset:0
    v_mul_u32_u24 v11, 1280, v9
    v_lshl_add_u32 v24, v10, 4, v11
    v_lshlrev_b32 v12, 3, v10
    v_add_u32 v12, s25, v12
    v_cmp_gt_u32 vcc, 640, v8
    s_mov_b64 s[34:35], vcc
    v_cmp_gt_u32 vcc, 640, v12
    s_and_b64 s[34:35], s[34:35], vcc
    v_cndmask_b32 v24, -1, v24, s[34:35]
    buffer_load_dwordx4 v[20:23], v24, s[20:23], s29 offen
    v_add_u32 v8, 512, v0
    v_mul_u32_u24 v9, 1639, v8
    v_lshrrev_b32 v9, 14, v9
    v_mul_u32_u24 v10, 10, v9
    v_sub_u32 v10, v8, v10
    v_mul_u32_u24 v11, 176, v9
    v_lshl_add_u32 v11, v10, 4, v11
    ds_read_b128 v[28:31], v11 offset:0
    v_mul_u32_u24 v11, 1280, v9
    v_lshl_add_u32 v36, v10, 4, v11
    v_lshlrev_b32 v12, 3, v10
    v_add_u32 v12, s25, v12
    v_cmp_gt_u32 vcc, 640, v8
    s_mov_b64 s[34:35], vcc
    v_cmp_gt_u32 vcc, 640, v12
    s_and_b64 s[34:35], s[34:35], vcc
    v_cndmask_b32 v36, -1, v36, s[34:35]
    buffer_load_dwordx4 v[32:35], v36, s[20:23], s29 offen
    s_waitcnt vmcnt(0) lgkmcnt(0)
    v_lshlrev_b32 v8, 16, v16
    v_and_b32 v9, 0xffff0000, v16
    v_lshlrev_b32 v10, 16, v20
    v_and_b32 v11, 0xffff0000, v20
    v_add_f32 v8, v8, v10
    v_add_f32 v9, v9, v11
    v_cvt_pk_bf16_f32 v16, v8, v9
    v_lshlrev_b32 v8, 16, v17
    v_and_b32 v9, 0xffff0000, v17
    v_lshlrev_b32 v10, 16, v21
    v_and_b32 v11, 0xffff0000, v21
    v_add_f32 v8, v8, v10
    v_add_f32 v9, v9, v11
    v_cvt_pk_bf16_f32 v17, v8, v9
    v_lshlrev_b32 v8, 16, v18
    v_and_b32 v9, 0xffff0000, v18
    v_lshlrev_b32 v10, 16, v22
    v_and_b32 v11, 0xffff0000, v22
    v_add_f32 v8, v8, v10
    v_add_f32 v9, v9, v11
    v_cvt_pk_bf16_f32 v18, v8, v9
    v_lshlrev_b32 v8, 16, v19
    v_and_b32 v9, 0xffff0000, v19
    v_lshlrev_b32 v10, 16, v23
    v_and_b32 v11, 0xffff0000, v23
    v_add_f32 v8, v8, v10
    v_add_f32 v9, v9, v11
    v_cvt_pk_bf16_f32 v19, v8, v9
    buffer_store_dwordx4 v[16:19], v24, s[16:19], s29 offen
    v_lshlrev_b32 v8, 16, v28
    v_and_b32 v9, 0xffff0000, v28
    v_lshlrev_b32 v10, 16, v32
    v_and_b32 v11, 0xffff0000, v32
    v_add_f32 v8, v8, v10
    v_add_f32 v9, v9, v11
    v_cvt_pk_bf16_f32 v28, v8, v9
    v_lshlrev_b32 v8, 16, v29
    v_and_b32 v9, 0xffff0000, v29
    v_lshlrev_b32 v10, 16, v33
    v_and_b32 v11, 0xffff0000, v33
    v_add_f32 v8, v8, v10
    v_add_f32 v9, v9, v11
    v_cvt_pk_bf16_f32 v29, v8, v9
    v_lshlrev_b32 v8, 16, v30
    v_and_b32 v9, 0xffff0000, v30
    v_lshlrev_b32 v10, 16, v34
    v_and_b32 v11, 0xffff0000, v34
    v_add_f32 v8, v8, v10
    v_add_f32 v9, v9, v11
    v_cvt_pk_bf16_f32 v30, v8, v9
    v_lshlrev_b32 v8, 16, v31
    v_and_b32 v9, 0xffff0000, v31
    v_lshlrev_b32 v10, 16, v35
    v_and_b32 v11, 0xffff0000, v35
    v_add_f32 v8, v8, v10
    v_add_f32 v9, v9, v11
    v_cvt_pk_bf16_f32 v31, v8, v9
    buffer_store_dwordx4 v[28:31], v36, s[16:19], s29 offen
    s_waitcnt vmcnt(0)
k2n_kernel_end:
    s_endpgm

.globl k4_kernel
.p2align 8
.type k4_kernel,@function
k4_kernel:
    s_cmp_ge_u32 s2, 224
    s_cbranch_scc1 k4_kernel_end
    s_load_dwordx16 s[64:79], s[0:1], 0
    s_load_dwordx4 s[80:83], s[0:1], 64
    v_and_b32 v1, 63, v0
    v_lshrrev_b32 v2, 6, v0
    s_nop 0
    v_readfirstlane_b32 s26, v2
    s_nop 1
    s_waitcnt lgkmcnt(0)
    s_add_u32 s8, s82, 20971520
    s_addc_u32 s9, s83, 0
    s_and_b32 s9, s9, 0xffff
    s_mov_b32 s10, 2621440
    s_mov_b32 s11, 0x00020000
    s_mov_b32 s12, s74
    s_and_b32 s13, s75, 0xffff
    s_mov_b32 s14, 2211840
    s_mov_b32 s15, 0x00020000
    s_add_u32 s16, s82, 27262976
    s_addc_u32 s17, s83, 0
    s_and_b32 s17, s17, 0xffff
    s_mov_b32 s18, 7077888
    s_mov_b32 s19, 0x00020000
    s_and_b32 s29, s2, 7
    s_lshr_b32 s30, s2, 3
    s_mul_i32 s31, s29, 257
    s_lshr_b32 s31, s31, 8
    s_mul_i32 s32, s31, 1
    s_sub_u32 s32, s29, s32
    s_mul_i32 s33, s30, 37
    s_lshr_b32 s33, s33, 9
    s_mul_i32 s34, s33, 14
    s_sub_u32 s34, s30, s34
    s_mul_i32 s24, s31, 2
    s_add_u32 s24, s24, s33
    s_mul_i32 s25, s32, 14
    s_add_u32 s25, s25, s34
    s_mul_i32 s24, s24, 128
    s_mul_i32 s25, s25, 128
    s_add_u32 s48, s82, 18939904
    s_addc_u32 s49, s83, 0
    s_and_b32 s49, s49, 0xffff
    s_mov_b32 s50, 16384
    s_mov_b32 s51, 0x00020000
    s_cmp_ge_u32 s26, 8
    s_cbranch_scc1 k4_kernel_bl
    v_lshrrev_b32 v2, 2, v1
    v_and_b32 v3, 3, v1
    s_lshl_b32 s29, s26, 4
    v_add_u32 v4, s29, v2
    v_add_u32 v5, s24, v4
    s_mov_b32 s30, 1280
    v_mul_lo_u32 v5, v5, s30
    v_mul_u32_u24 v6, 320, v3
    v_add_u32 v5, v5, v6
    buffer_load_dwordx4 v[16:19], v5, s[8:11], 0 offen offset:0
    buffer_load_dwordx4 v[20:23], v5, s[8:11], 0 offen offset:16
    buffer_load_dwordx4 v[24:27], v5, s[8:11], 0 offen offset:32
    buffer_load_dwordx4 v[28:31], v5, s[8:11], 0 offen offset:48
    buffer_load_dwordx4 v[32:35], v5, s[8:11], 0 offen offset:64
    buffer_load_dwordx4 v[36:39], v5, s[8:11], 0 offen offset:80
    buffer_load_dwordx4 v[40:43], v5, s[8:11], 0 offen offset:96
    buffer_load_dwordx4 v[44:47], v5, s[8:11], 0 offen offset:112
    buffer_load_dwordx4 v[48:51], v5, s[8:11], 0 offen offset:128
    buffer_load_dwordx4 v[52:55], v5, s[8:11], 0 offen offset:144
    buffer_load_dwordx4 v[56:59], v5, s[8:11], 0 offen offset:160
    buffer_load_dwordx4 v[60:63], v5, s[8:11], 0 offen offset:176
    buffer_load_dwordx4 v[64:67], v5, s[8:11], 0 offen offset:192
    buffer_load_dwordx4 v[68:71], v5, s[8:11], 0 offen offset:208
    buffer_load_dwordx4 v[72:75], v5, s[8:11], 0 offen offset:224
    buffer_load_dwordx4 v[76:79], v5, s[8:11], 0 offen offset:240
    buffer_load_dwordx4 v[80:83], v5, s[8:11], 0 offen offset:256
    buffer_load_dwordx4 v[84:87], v5, s[8:11], 0 offen offset:272
    buffer_load_dwordx4 v[88:91], v5, s[8:11], 0 offen offset:288
    buffer_load_dwordx4 v[92:95], v5, s[8:11], 0 offen offset:304
    s_waitcnt vmcnt(0)
    v_mov_b32 v100, 0
    v_mov_b32 v101, 0
    v_mov_b32 v102, 0
    v_mov_b32 v103, 0
    v_lshlrev_b32 v104, 16, v16
    v_and_b32 v105, 0xffff0000, v16
    v_add_f32 v100, v100, v104
    v_add_f32 v101, v101, v105
    v_lshlrev_b32 v106, 16, v17
    v_and_b32 v107, 0xffff0000, v17
    v_add_f32 v102, v102, v106
    v_add_f32 v103, v103, v107
    v_lshlrev_b32 v104, 16, v18
    v_and_b32 v105, 0xffff0000, v18
    v_add_f32 v100, v100, v104
    v_add_f32 v101, v101, v105
    v_lshlrev_b32 v106, 16, v19
    v_and_b32 v107, 0xffff0000, v19
    v_add_f32 v102, v102, v106
    v_add_f32 v103, v103, v107
    v_lshlrev_b32 v104, 16, v20
    v_and_b32 v105, 0xffff0000, v20
    v_add_f32 v100, v100, v104
    v_add_f32 v101, v101, v105
    v_lshlrev_b32 v106, 16, v21
    v_and_b32 v107, 0xffff0000, v21
    v_add_f32 v102, v102, v106
    v_add_f32 v103, v103, v107
    v_lshlrev_b32 v104, 16, v22
    v_and_b32 v105, 0xffff0000, v22
    v_add_f32 v100, v100, v104
    v_add_f32 v101, v101, v105
    v_lshlrev_b32 v106, 16, v23
    v_and_b32 v107, 0xffff0000, v23
    v_add_f32 v102, v102, v106
    v_add_f32 v103, v103, v107
    v_lshlrev_b32 v104, 16, v24
    v_and_b32 v105, 0xffff0000, v24
    v_add_f32 v100, v100, v104
    v_add_f32 v101, v101, v105
    v_lshlrev_b32 v106, 16, v25
    v_and_b32 v107, 0xffff0000, v25
    v_add_f32 v102, v102, v106
    v_add_f32 v103, v103, v107
    v_lshlrev_b32 v104, 16, v26
    v_and_b32 v105, 0xffff0000, v26
    v_add_f32 v100, v100, v104
    v_add_f32 v101, v101, v105
    v_lshlrev_b32 v106, 16, v27
    v_and_b32 v107, 0xffff0000, v27
    v_add_f32 v102, v102, v106
    v_add_f32 v103, v103, v107
    v_lshlrev_b32 v104, 16, v28
    v_and_b32 v105, 0xffff0000, v28
    v_add_f32 v100, v100, v104
    v_add_f32 v101, v101, v105
    v_lshlrev_b32 v106, 16, v29
    v_and_b32 v107, 0xffff0000, v29
    v_add_f32 v102, v102, v106
    v_add_f32 v103, v103, v107
    v_lshlrev_b32 v104, 16, v30
    v_and_b32 v105, 0xffff0000, v30
    v_add_f32 v100, v100, v104
    v_add_f32 v101, v101, v105
    v_lshlrev_b32 v106, 16, v31
    v_and_b32 v107, 0xffff0000, v31
    v_add_f32 v102, v102, v106
    v_add_f32 v103, v103, v107
    v_lshlrev_b32 v104, 16, v32
    v_and_b32 v105, 0xffff0000, v32
    v_add_f32 v100, v100, v104
    v_add_f32 v101, v101, v105
    v_lshlrev_b32 v106, 16, v33
    v_and_b32 v107, 0xffff0000, v33
    v_add_f32 v102, v102, v106
    v_add_f32 v103, v103, v107
    v_lshlrev_b32 v104, 16, v34
    v_and_b32 v105, 0xffff0000, v34
    v_add_f32 v100, v100, v104
    v_add_f32 v101, v101, v105
    v_lshlrev_b32 v106, 16, v35
    v_and_b32 v107, 0xffff0000, v35
    v_add_f32 v102, v102, v106
    v_add_f32 v103, v103, v107
    v_lshlrev_b32 v104, 16, v36
    v_and_b32 v105, 0xffff0000, v36
    v_add_f32 v100, v100, v104
    v_add_f32 v101, v101, v105
    v_lshlrev_b32 v106, 16, v37
    v_and_b32 v107, 0xffff0000, v37
    v_add_f32 v102, v102, v106
    v_add_f32 v103, v103, v107
    v_lshlrev_b32 v104, 16, v38
    v_and_b32 v105, 0xffff0000, v38
    v_add_f32 v100, v100, v104
    v_add_f32 v101, v101, v105
    v_lshlrev_b32 v106, 16, v39
    v_and_b32 v107, 0xffff0000, v39
    v_add_f32 v102, v102, v106
    v_add_f32 v103, v103, v107
    v_lshlrev_b32 v104, 16, v40
    v_and_b32 v105, 0xffff0000, v40
    v_add_f32 v100, v100, v104
    v_add_f32 v101, v101, v105
    v_lshlrev_b32 v106, 16, v41
    v_and_b32 v107, 0xffff0000, v41
    v_add_f32 v102, v102, v106
    v_add_f32 v103, v103, v107
    v_lshlrev_b32 v104, 16, v42
    v_and_b32 v105, 0xffff0000, v42
    v_add_f32 v100, v100, v104
    v_add_f32 v101, v101, v105
    v_lshlrev_b32 v106, 16, v43
    v_and_b32 v107, 0xffff0000, v43
    v_add_f32 v102, v102, v106
    v_add_f32 v103, v103, v107
    v_lshlrev_b32 v104, 16, v44
    v_and_b32 v105, 0xffff0000, v44
    v_add_f32 v100, v100, v104
    v_add_f32 v101, v101, v105
    v_lshlrev_b32 v106, 16, v45
    v_and_b32 v107, 0xffff0000, v45
    v_add_f32 v102, v102, v106
    v_add_f32 v103, v103, v107
    v_lshlrev_b32 v104, 16, v46
    v_and_b32 v105, 0xffff0000, v46
    v_add_f32 v100, v100, v104
    v_add_f32 v101, v101, v105
    v_lshlrev_b32 v106, 16, v47
    v_and_b32 v107, 0xffff0000, v47
    v_add_f32 v102, v102, v106
    v_add_f32 v103, v103, v107
    v_lshlrev_b32 v104, 16, v48
    v_and_b32 v105, 0xffff0000, v48
    v_add_f32 v100, v100, v104
    v_add_f32 v101, v101, v105
    v_lshlrev_b32 v106, 16, v49
    v_and_b32 v107, 0xffff0000, v49
    v_add_f32 v102, v102, v106
    v_add_f32 v103, v103, v107
    v_lshlrev_b32 v104, 16, v50
    v_and_b32 v105, 0xffff0000, v50
    v_add_f32 v100, v100, v104
    v_add_f32 v101, v101, v105
    v_lshlrev_b32 v106, 16, v51
    v_and_b32 v107, 0xffff0000, v51
    v_add_f32 v102, v102, v106
    v_add_f32 v103, v103, v107
    v_lshlrev_b32 v104, 16, v52
    v_and_b32 v105, 0xffff0000, v52
    v_add_f32 v100, v100, v104
    v_add_f32 v101, v101, v105
    v_lshlrev_b32 v106, 16, v53
    v_and_b32 v107, 0xffff0000, v53
    v_add_f32 v102, v102, v106
    v_add_f32 v103, v103, v107
    v_lshlrev_b32 v104, 16, v54
    v_and_b32 v105, 0xffff0000, v54
    v_add_f32 v100, v100, v104
    v_add_f32 v101, v101, v105
    v_lshlrev_b32 v106, 16, v55
    v_and_b32 v107, 0xffff0000, v55
    v_add_f32 v102, v102, v106
    v_add_f32 v103, v103, v107
    v_lshlrev_b32 v104, 16, v56
    v_and_b32 v105, 0xffff0000, v56
    v_add_f32 v100, v100, v104
    v_add_f32 v101, v101, v105
    v_lshlrev_b32 v106, 16, v57
    v_and_b32 v107, 0xffff0000, v57
    v_add_f32 v102, v102, v106
    v_add_f32 v103, v103, v107
    v_lshlrev_b32 v104, 16, v58
    v_and_b32 v105, 0xffff0000, v58
    v_add_f32 v100, v100, v104
    v_add_f32 v101, v101, v105
    v_lshlrev_b32 v106, 16, v59
    v_and_b32 v107, 0xffff0000, v59
    v_add_f32 v102, v102, v106
    v_add_f32 v103, v103, v107
    v_lshlrev_b32 v104, 16, v60
    v_and_b32 v105, 0xffff0000, v60
    v_add_f32 v100, v100, v104
    v_add_f32 v101, v101, v105
    v_lshlrev_b32 v106, 16, v61
    v_and_b32 v107, 0xffff0000, v61
    v_add_f32 v102, v102, v106
    v_add_f32 v103, v103, v107
    v_lshlrev_b32 v104, 16, v62
    v_and_b32 v105, 0xffff0000, v62
    v_add_f32 v100, v100, v104
    v_add_f32 v101, v101, v105
    v_lshlrev_b32 v106, 16, v63
    v_and_b32 v107, 0xffff0000, v63
    v_add_f32 v102, v102, v106
    v_add_f32 v103, v103, v107
    v_lshlrev_b32 v104, 16, v64
    v_and_b32 v105, 0xffff0000, v64
    v_add_f32 v100, v100, v104
    v_add_f32 v101, v101, v105
    v_lshlrev_b32 v106, 16, v65
    v_and_b32 v107, 0xffff0000, v65
    v_add_f32 v102, v102, v106
    v_add_f32 v103, v103, v107
    v_lshlrev_b32 v104, 16, v66
    v_and_b32 v105, 0xffff0000, v66
    v_add_f32 v100, v100, v104
    v_add_f32 v101, v101, v105
    v_lshlrev_b32 v106, 16, v67
    v_and_b32 v107, 0xffff0000, v67
    v_add_f32 v102, v102, v106
    v_add_f32 v103, v103, v107
    v_lshlrev_b32 v104, 16, v68
    v_and_b32 v105, 0xffff0000, v68
    v_add_f32 v100, v100, v104
    v_add_f32 v101, v101, v105
    v_lshlrev_b32 v106, 16, v69
    v_and_b32 v107, 0xffff0000, v69
    v_add_f32 v102, v102, v106
    v_add_f32 v103, v103, v107
    v_lshlrev_b32 v104, 16, v70
    v_and_b32 v105, 0xffff0000, v70
    v_add_f32 v100, v100, v104
    v_add_f32 v101, v101, v105
    v_lshlrev_b32 v106, 16, v71
    v_and_b32 v107, 0xffff0000, v71
    v_add_f32 v102, v102, v106
    v_add_f32 v103, v103, v107
    v_lshlrev_b32 v104, 16, v72
    v_and_b32 v105, 0xffff0000, v72
    v_add_f32 v100, v100, v104
    v_add_f32 v101, v101, v105
    v_lshlrev_b32 v106, 16, v73
    v_and_b32 v107, 0xffff0000, v73
    v_add_f32 v102, v102, v106
    v_add_f32 v103, v103, v107
    v_lshlrev_b32 v104, 16, v74
    v_and_b32 v105, 0xffff0000, v74
    v_add_f32 v100, v100, v104
    v_add_f32 v101, v101, v105
    v_lshlrev_b32 v106, 16, v75
    v_and_b32 v107, 0xffff0000, v75
    v_add_f32 v102, v102, v106
    v_add_f32 v103, v103, v107
    v_lshlrev_b32 v104, 16, v76
    v_and_b32 v105, 0xffff0000, v76
    v_add_f32 v100, v100, v104
    v_add_f32 v101, v101, v105
    v_lshlrev_b32 v106, 16, v77
    v_and_b32 v107, 0xffff0000, v77
    v_add_f32 v102, v102, v106
    v_add_f32 v103, v103, v107
    v_lshlrev_b32 v104, 16, v78
    v_and_b32 v105, 0xffff0000, v78
    v_add_f32 v100, v100, v104
    v_add_f32 v101, v101, v105
    v_lshlrev_b32 v106, 16, v79
    v_and_b32 v107, 0xffff0000, v79
    v_add_f32 v102, v102, v106
    v_add_f32 v103, v103, v107
    v_lshlrev_b32 v104, 16, v80
    v_and_b32 v105, 0xffff0000, v80
    v_add_f32 v100, v100, v104
    v_add_f32 v101, v101, v105
    v_lshlrev_b32 v106, 16, v81
    v_and_b32 v107, 0xffff0000, v81
    v_add_f32 v102, v102, v106
    v_add_f32 v103, v103, v107
    v_lshlrev_b32 v104, 16, v82
    v_and_b32 v105, 0xffff0000, v82
    v_add_f32 v100, v100, v104
    v_add_f32 v101, v101, v105
    v_lshlrev_b32 v106, 16, v83
    v_and_b32 v107, 0xffff0000, v83
    v_add_f32 v102, v102, v106
    v_add_f32 v103, v103, v107
    v_lshlrev_b32 v104, 16, v84
    v_and_b32 v105, 0xffff0000, v84
    v_add_f32 v100, v100, v104
    v_add_f32 v101, v101, v105
    v_lshlrev_b32 v106, 16, v85
    v_and_b32 v107, 0xffff0000, v85
    v_add_f32 v102, v102, v106
    v_add_f32 v103, v103, v107
    v_lshlrev_b32 v104, 16, v86
    v_and_b32 v105, 0xffff0000, v86
    v_add_f32 v100, v100, v104
    v_add_f32 v101, v101, v105
    v_lshlrev_b32 v106, 16, v87
    v_and_b32 v107, 0xffff0000, v87
    v_add_f32 v102, v102, v106
    v_add_f32 v103, v103, v107
    v_lshlrev_b32 v104, 16, v88
    v_and_b32 v105, 0xffff0000, v88
    v_add_f32 v100, v100, v104
    v_add_f32 v101, v101, v105
    v_lshlrev_b32 v106, 16, v89
    v_and_b32 v107, 0xffff0000, v89
    v_add_f32 v102, v102, v106
    v_add_f32 v103, v103, v107
    v_lshlrev_b32 v104, 16, v90
    v_and_b32 v105, 0xffff0000, v90
    v_add_f32 v100, v100, v104
    v_add_f32 v101, v101, v105
    v_lshlrev_b32 v106, 16, v91
    v_and_b32 v107, 0xffff0000, v91
    v_add_f32 v102, v102, v106
    v_add_f32 v103, v103, v107
    v_lshlrev_b32 v104, 16, v92
    v_and_b32 v105, 0xffff0000, v92
    v_add_f32 v100, v100, v104
    v_add_f32 v101, v101, v105
    v_lshlrev_b32 v106, 16, v93
    v_and_b32 v107, 0xffff0000, v93
    v_add_f32 v102, v102, v106
    v_add_f32 v103, v103, v107
    v_lshlrev_b32 v104, 16, v94
    v_and_b32 v105, 0xffff0000, v94
    v_add_f32 v100, v100, v104
    v_add_f32 v101, v101, v105
    v_lshlrev_b32 v106, 16, v95
    v_and_b32 v107, 0xffff0000, v95
    v_add_f32 v102, v102, v106
    v_add_f32 v103, v103, v107
    v_add_f32 v100, v100, v101
    v_add_f32 v102, v102, v103
    v_add_f32 v7, v100, v102
    s_nop 1
    v_add_f32_dpp v7, v7, v7 quad_perm:[1,0,3,2] row_mask:0xf bank_mask:0xf
    s_nop 1
    v_add_f32_dpp v7, v7, v7 quad_perm:[2,3,0,1] row_mask:0xf bank_mask:0xf
    v_mul_f32 v7, 0x3acccccd, v7
    v_mov_b32 v100, 0
    v_mov_b32 v101, 0
    v_mov_b32 v102, 0
    v_mov_b32 v103, 0
    v_lshlrev_b32 v104, 16, v16
    v_and_b32 v105, 0xffff0000, v16
    v_sub_f32 v104, v104, v7
    v_sub_f32 v105, v105, v7
    v_fmac_f32 v100, v104, v104
    v_fmac_f32 v101, v105, v105
    v_lshlrev_b32 v106, 16, v17
    v_and_b32 v107, 0xffff0000, v17
    v_sub_f32 v106, v106, v7
    v_sub_f32 v107, v107, v7
    v_fmac_f32 v102, v106, v106
    v_fmac_f32 v103, v107, v107
    v_lshlrev_b32 v104, 16, v18
    v_and_b32 v105, 0xffff0000, v18
    v_sub_f32 v104, v104, v7
    v_sub_f32 v105, v105, v7
    v_fmac_f32 v100, v104, v104
    v_fmac_f32 v101, v105, v105
    v_lshlrev_b32 v106, 16, v19
    v_and_b32 v107, 0xffff0000, v19
    v_sub_f32 v106, v106, v7
    v_sub_f32 v107, v107, v7
    v_fmac_f32 v102, v106, v106
    v_fmac_f32 v103, v107, v107
    v_lshlrev_b32 v104, 16, v20
    v_and_b32 v105, 0xffff0000, v20
    v_sub_f32 v104, v104, v7
    v_sub_f32 v105, v105, v7
    v_fmac_f32 v100, v104, v104
    v_fmac_f32 v101, v105, v105
    v_lshlrev_b32 v106, 16, v21
    v_and_b32 v107, 0xffff0000, v21
    v_sub_f32 v106, v106, v7
    v_sub_f32 v107, v107, v7
    v_fmac_f32 v102, v106, v106
    v_fmac_f32 v103, v107, v107
    v_lshlrev_b32 v104, 16, v22
    v_and_b32 v105, 0xffff0000, v22
    v_sub_f32 v104, v104, v7
    v_sub_f32 v105, v105, v7
    v_fmac_f32 v100, v104, v104
    v_fmac_f32 v101, v105, v105
    v_lshlrev_b32 v106, 16, v23
    v_and_b32 v107, 0xffff0000, v23
    v_sub_f32 v106, v106, v7
    v_sub_f32 v107, v107, v7
    v_fmac_f32 v102, v106, v106
    v_fmac_f32 v103, v107, v107
    v_lshlrev_b32 v104, 16, v24
    v_and_b32 v105, 0xffff0000, v24
    v_sub_f32 v104, v104, v7
    v_sub_f32 v105, v105, v7
    v_fmac_f32 v100, v104, v104
    v_fmac_f32 v101, v105, v105
    v_lshlrev_b32 v106, 16, v25
    v_and_b32 v107, 0xffff0000, v25
    v_sub_f32 v106, v106, v7
    v_sub_f32 v107, v107, v7
    v_fmac_f32 v102, v106, v106
    v_fmac_f32 v103, v107, v107
    v_lshlrev_b32 v104, 16, v26
    v_and_b32 v105, 0xffff0000, v26
    v_sub_f32 v104, v104, v7
    v_sub_f32 v105, v105, v7
    v_fmac_f32 v100, v104, v104
    v_fmac_f32 v101, v105, v105
    v_lshlrev_b32 v106, 16, v27
    v_and_b32 v107, 0xffff0000, v27
    v_sub_f32 v106, v106, v7
    v_sub_f32 v107, v107, v7
    v_fmac_f32 v102, v106, v106
    v_fmac_f32 v103, v107, v107
    v_lshlrev_b32 v104, 16, v28
    v_and_b32 v105, 0xffff0000, v28
    v_sub_f32 v104, v104, v7
    v_sub_f32 v105, v105, v7
    v_fmac_f32 v100, v104, v104
    v_fmac_f32 v101, v105, v105
    v_lshlrev_b32 v106, 16, v29
    v_and_b32 v107, 0xffff0000, v29
    v_sub_f32 v106, v106, v7
    v_sub_f32 v107, v107, v7
    v_fmac_f32 v102, v106, v106
    v_fmac_f32 v103, v107, v107
    v_lshlrev_b32 v104, 16, v30
    v_and_b32 v105, 0xffff0000, v30
    v_sub_f32 v104, v104, v7
    v_sub_f32 v105, v105, v7
    v_fmac_f32 v100, v104, v104
    v_fmac_f32 v101, v105, v105
    v_lshlrev_b32 v106, 16, v31
    v_and_b32 v107, 0xffff0000, v31
    v_sub_f32 v106, v106, v7
    v_sub_f32 v107, v107, v7
    v_fmac_f32 v102, v106, v106
    v_fmac_f32 v103, v107, v107
    v_lshlrev_b32 v104, 16, v32
    v_and_b32 v105, 0xffff0000, v32
    v_sub_f32 v104, v104, v7
    v_sub_f32 v105, v105, v7
    v_fmac_f32 v100, v104, v104
    v_fmac_f32 v101, v105, v105
    v_lshlrev_b32 v106, 16, v33
    v_and_b32 v107, 0xffff0000, v33
    v_sub_f32 v106, v106, v7
    v_sub_f32 v107, v107, v7
    v_fmac_f32 v102, v106, v106
    v_fmac_f32 v103, v107, v107
    v_lshlrev_b32 v104, 16, v34
    v_and_b32 v105, 0xffff0000, v34
    v_sub_f32 v104, v104, v7
    v_sub_f32 v105, v105, v7
    v_fmac_f32 v100, v104, v104
    v_fmac_f32 v101, v105, v105
    v_lshlrev_b32 v106, 16, v35
    v_and_b32 v107, 0xffff0000, v35
    v_sub_f32 v106, v106, v7
    v_sub_f32 v107, v107, v7
    v_fmac_f32 v102, v106, v106
    v_fmac_f32 v103, v107, v107
    v_lshlrev_b32 v104, 16, v36
    v_and_b32 v105, 0xffff0000, v36
    v_sub_f32 v104, v104, v7
    v_sub_f32 v105, v105, v7
    v_fmac_f32 v100, v104, v104
    v_fmac_f32 v101, v105, v105
    v_lshlrev_b32 v106, 16, v37
    v_and_b32 v107, 0xffff0000, v37
    v_sub_f32 v106, v106, v7
    v_sub_f32 v107, v107, v7
    v_fmac_f32 v102, v106, v106
    v_fmac_f32 v103, v107, v107
    v_lshlrev_b32 v104, 16, v38
    v_and_b32 v105, 0xffff0000, v38
    v_sub_f32 v104, v104, v7
    v_sub_f32 v105, v105, v7
    v_fmac_f32 v100, v104, v104
    v_fmac_f32 v101, v105, v105
    v_lshlrev_b32 v106, 16, v39
    v_and_b32 v107, 0xffff0000, v39
    v_sub_f32 v106, v106, v7
    v_sub_f32 v107, v107, v7
    v_fmac_f32 v102, v106, v106
    v_fmac_f32 v103, v107, v107
    v_lshlrev_b32 v104, 16, v40
    v_and_b32 v105, 0xffff0000, v40
    v_sub_f32 v104, v104, v7
    v_sub_f32 v105, v105, v7
    v_fmac_f32 v100, v104, v104
    v_fmac_f32 v101, v105, v105
    v_lshlrev_b32 v106, 16, v41
    v_and_b32 v107, 0xffff0000, v41
    v_sub_f32 v106, v106, v7
    v_sub_f32 v107, v107, v7
    v_fmac_f32 v102, v106, v106
    v_fmac_f32 v103, v107, v107
    v_lshlrev_b32 v104, 16, v42
    v_and_b32 v105, 0xffff0000, v42
    v_sub_f32 v104, v104, v7
    v_sub_f32 v105, v105, v7
    v_fmac_f32 v100, v104, v104
    v_fmac_f32 v101, v105, v105
    v_lshlrev_b32 v106, 16, v43
    v_and_b32 v107, 0xffff0000, v43
    v_sub_f32 v106, v106, v7
    v_sub_f32 v107, v107, v7
    v_fmac_f32 v102, v106, v106
    v_fmac_f32 v103, v107, v107
    v_lshlrev_b32 v104, 16, v44
    v_and_b32 v105, 0xffff0000, v44
    v_sub_f32 v104, v104, v7
    v_sub_f32 v105, v105, v7
    v_fmac_f32 v100, v104, v104
    v_fmac_f32 v101, v105, v105
    v_lshlrev_b32 v106, 16, v45
    v_and_b32 v107, 0xffff0000, v45
    v_sub_f32 v106, v106, v7
    v_sub_f32 v107, v107, v7
    v_fmac_f32 v102, v106, v106
    v_fmac_f32 v103, v107, v107
    v_lshlrev_b32 v104, 16, v46
    v_and_b32 v105, 0xffff0000, v46
    v_sub_f32 v104, v104, v7
    v_sub_f32 v105, v105, v7
    v_fmac_f32 v100, v104, v104
    v_fmac_f32 v101, v105, v105
    v_lshlrev_b32 v106, 16, v47
    v_and_b32 v107, 0xffff0000, v47
    v_sub_f32 v106, v106, v7
    v_sub_f32 v107, v107, v7
    v_fmac_f32 v102, v106, v106
    v_fmac_f32 v103, v107, v107
    v_lshlrev_b32 v104, 16, v48
    v_and_b32 v105, 0xffff0000, v48
    v_sub_f32 v104, v104, v7
    v_sub_f32 v105, v105, v7
    v_fmac_f32 v100, v104, v104
    v_fmac_f32 v101, v105, v105
    v_lshlrev_b32 v106, 16, v49
    v_and_b32 v107, 0xffff0000, v49
    v_sub_f32 v106, v106, v7
    v_sub_f32 v107, v107, v7
    v_fmac_f32 v102, v106, v106
    v_fmac_f32 v103, v107, v107
    v_lshlrev_b32 v104, 16, v50
    v_and_b32 v105, 0xffff0000, v50
    v_sub_f32 v104, v104, v7
    v_sub_f32 v105, v105, v7
    v_fmac_f32 v100, v104, v104
    v_fmac_f32 v101, v105, v105
    v_lshlrev_b32 v106, 16, v51
    v_and_b32 v107, 0xffff0000, v51
    v_sub_f32 v106, v106, v7
    v_sub_f32 v107, v107, v7
    v_fmac_f32 v102, v106, v106
    v_fmac_f32 v103, v107, v107
    v_lshlrev_b32 v104, 16, v52
    v_and_b32 v105, 0xffff0000, v52
    v_sub_f32 v104, v104, v7
    v_sub_f32 v105, v105, v7
    v_fmac_f32 v100, v104, v104
    v_fmac_f32 v101, v105, v105
    v_lshlrev_b32 v106, 16, v53
    v_and_b32 v107, 0xffff0000, v53
    v_sub_f32 v106, v106, v7
    v_sub_f32 v107, v107, v7
    v_fmac_f32 v102, v106, v106
    v_fmac_f32 v103, v107, v107
    v_lshlrev_b32 v104, 16, v54
    v_and_b32 v105, 0xffff0000, v54
    v_sub_f32 v104, v104, v7
    v_sub_f32 v105, v105, v7
    v_fmac_f32 v100, v104, v104
    v_fmac_f32 v101, v105, v105
    v_lshlrev_b32 v106, 16, v55
    v_and_b32 v107, 0xffff0000, v55
    v_sub_f32 v106, v106, v7
    v_sub_f32 v107, v107, v7
    v_fmac_f32 v102, v106, v106
    v_fmac_f32 v103, v107, v107
    v_lshlrev_b32 v104, 16, v56
    v_and_b32 v105, 0xffff0000, v56
    v_sub_f32 v104, v104, v7
    v_sub_f32 v105, v105, v7
    v_fmac_f32 v100, v104, v104
    v_fmac_f32 v101, v105, v105
    v_lshlrev_b32 v106, 16, v57
    v_and_b32 v107, 0xffff0000, v57
    v_sub_f32 v106, v106, v7
    v_sub_f32 v107, v107, v7
    v_fmac_f32 v102, v106, v106
    v_fmac_f32 v103, v107, v107
    v_lshlrev_b32 v104, 16, v58
    v_and_b32 v105, 0xffff0000, v58
    v_sub_f32 v104, v104, v7
    v_sub_f32 v105, v105, v7
    v_fmac_f32 v100, v104, v104
    v_fmac_f32 v101, v105, v105
    v_lshlrev_b32 v106, 16, v59
    v_and_b32 v107, 0xffff0000, v59
    v_sub_f32 v106, v106, v7
    v_sub_f32 v107, v107, v7
    v_fmac_f32 v102, v106, v106
    v_fmac_f32 v103, v107, v107
    v_lshlrev_b32 v104, 16, v60
    v_and_b32 v105, 0xffff0000, v60
    v_sub_f32 v104, v104, v7
    v_sub_f32 v105, v105, v7
    v_fmac_f32 v100, v104, v104
    v_fmac_f32 v101, v105, v105
    v_lshlrev_b32 v106, 16, v61
    v_and_b32 v107, 0xffff0000, v61
    v_sub_f32 v106, v106, v7
    v_sub_f32 v107, v107, v7
    v_fmac_f32 v102, v106, v106
    v_fmac_f32 v103, v107, v107
    v_lshlrev_b32 v104, 16, v62
    v_and_b32 v105, 0xffff0000, v62
    v_sub_f32 v104, v104, v7
    v_sub_f32 v105, v105, v7
    v_fmac_f32 v100, v104, v104
    v_fmac_f32 v101, v105, v105
    v_lshlrev_b32 v106, 16, v63
    v_and_b32 v107, 0xffff0000, v63
    v_sub_f32 v106, v106, v7
    v_sub_f32 v107, v107, v7
    v_fmac_f32 v102, v106, v106
    v_fmac_f32 v103, v107, v107
    v_lshlrev_b32 v104, 16, v64
    v_and_b32 v105, 0xffff0000, v64
    v_sub_f32 v104, v104, v7
    v_sub_f32 v105, v105, v7
    v_fmac_f32 v100, v104, v104
    v_fmac_f32 v101, v105, v105
    v_lshlrev_b32 v106, 16, v65
    v_and_b32 v107, 0xffff0000, v65
    v_sub_f32 v106, v106, v7
    v_sub_f32 v107, v107, v7
    v_fmac_f32 v102, v106, v106
    v_fmac_f32 v103, v107, v107
    v_lshlrev_b32 v104, 16, v66
    v_and_b32 v105, 0xffff0000, v66
    v_sub_f32 v104, v104, v7
    v_sub_f32 v105, v105, v7
    v_fmac_f32 v100, v104, v104
    v_fmac_f32 v101, v105, v105
    v_lshlrev_b32 v106, 16, v67
    v_and_b32 v107, 0xffff0000, v67
    v_sub_f32 v106, v106, v7
    v_sub_f32 v107, v107, v7
    v_fmac_f32 v102, v106, v106
    v_fmac_f32 v103, v107, v107
    v_lshlrev_b32 v104, 16, v68
    v_and_b32 v105, 0xffff0000, v68
    v_sub_f32 v104, v104, v7
    v_sub_f32 v105, v105, v7
    v_fmac_f32 v100, v104, v104
    v_fmac_f32 v101, v105, v105
    v_lshlrev_b32 v106, 16, v69
    v_and_b32 v107, 0xffff0000, v69
    v_sub_f32 v106, v106, v7
    v_sub_f32 v107, v107, v7
    v_fmac_f32 v102, v106, v106
    v_fmac_f32 v103, v107, v107
    v_lshlrev_b32 v104, 16, v70
    v_and_b32 v105, 0xffff0000, v70
    v_sub_f32 v104, v104, v7
    v_sub_f32 v105, v105, v7
    v_fmac_f32 v100, v104, v104
    v_fmac_f32 v101, v105, v105
    v_lshlrev_b32 v106, 16, v71
    v_and_b32 v107, 0xffff0000, v71
    v_sub_f32 v106, v106, v7
    v_sub_f32 v107, v107, v7
    v_fmac_f32 v102, v106, v106
    v_fmac_f32 v103, v107, v107
    v_lshlrev_b32 v104, 16, v72
    v_and_b32 v105, 0xffff0000, v72
    v_sub_f32 v104, v104, v7
    v_sub_f32 v105, v105, v7
    v_fmac_f32 v100, v104, v104
    v_fmac_f32 v101, v105, v105
    v_lshlrev_b32 v106, 16, v73
    v_and_b32 v107, 0xffff0000, v73
    v_sub_f32 v106, v106, v7
    v_sub_f32 v107, v107, v7
    v_fmac_f32 v102, v106, v106
    v_fmac_f32 v103, v107, v107
    v_lshlrev_b32 v104, 16, v74
    v_and_b32 v105, 0xffff0000, v74
    v_sub_f32 v104, v104, v7
    v_sub_f32 v105, v105, v7
    v_fmac_f32 v100, v104, v104
    v_fmac_f32 v101, v105, v105
    v_lshlrev_b32 v106, 16, v75
    v_and_b32 v107, 0xffff0000, v75
    v_sub_f32 v106, v106, v7
    v_sub_f32 v107, v107, v7
    v_fmac_f32 v102, v106, v106
    v_fmac_f32 v103, v107, v107
    v_lshlrev_b32 v104, 16, v76
    v_and_b32 v105, 0xffff0000, v76
    v_sub_f32 v104, v104, v7
    v_sub_f32 v105, v105, v7
    v_fmac_f32 v100, v104, v104
    v_fmac_f32 v101, v105, v105
    v_lshlrev_b32 v106, 16, v77
    v_and_b32 v107, 0xffff0000, v77
    v_sub_f32 v106, v106, v7
    v_sub_f32 v107, v107, v7
    v_fmac_f32 v102, v106, v106
    v_fmac_f32 v103, v107, v107
    v_lshlrev_b32 v104, 16, v78
    v_and_b32 v105, 0xffff0000, v78
    v_sub_f32 v104, v104, v7
    v_sub_f32 v105, v105, v7
    v_fmac_f32 v100, v104, v104
    v_fmac_f32 v101, v105, v105
    v_lshlrev_b32 v106, 16, v79
    v_and_b32 v107, 0xffff0000, v79
    v_sub_f32 v106, v106, v7
    v_sub_f32 v107, v107, v7
    v_fmac_f32 v102, v106, v106
    v_fmac_f32 v103, v107, v107
    v_lshlrev_b32 v104, 16, v80
    v_and_b32 v105, 0xffff0000, v80
    v_sub_f32 v104, v104, v7
    v_sub_f32 v105, v105, v7
    v_fmac_f32 v100, v104, v104
    v_fmac_f32 v101, v105, v105
    v_lshlrev_b32 v106, 16, v81
    v_and_b32 v107, 0xffff0000, v81
    v_sub_f32 v106, v106, v7
    v_sub_f32 v107, v107, v7
    v_fmac_f32 v102, v106, v106
    v_fmac_f32 v103, v107, v107
    v_lshlrev_b32 v104, 16, v82
    v_and_b32 v105, 0xffff0000, v82
    v_sub_f32 v104, v104, v7
    v_sub_f32 v105, v105, v7
    v_fmac_f32 v100, v104, v104
    v_fmac_f32 v101, v105, v105
    v_lshlrev_b32 v106, 16, v83
    v_and_b32 v107, 0xffff0000, v83
    v_sub_f32 v106, v106, v7
    v_sub_f32 v107, v107, v7
    v_fmac_f32 v102, v106, v106
    v_fmac_f32 v103, v107, v107
    v_lshlrev_b32 v104, 16, v84
    v_and_b32 v105, 0xffff0000, v84
    v_sub_f32 v104, v104, v7
    v_sub_f32 v105, v105, v7
    v_fmac_f32 v100, v104, v104
    v_fmac_f32 v101, v105, v105
    v_lshlrev_b32 v106, 16, v85
    v_and_b32 v107, 0xffff0000, v85
    v_sub_f32 v106, v106, v7
    v_sub_f32 v107, v107, v7
    v_fmac_f32 v102, v106, v106
    v_fmac_f32 v103, v107, v107
    v_lshlrev_b32 v104, 16, v86
    v_and_b32 v105, 0xffff0000, v86
    v_sub_f32 v104, v104, v7
    v_sub_f32 v105, v105, v7
    v_fmac_f32 v100, v104, v104
    v_fmac_f32 v101, v105, v105
    v_lshlrev_b32 v106, 16, v87
    v_and_b32 v107, 0xffff0000, v87
    v_sub_f32 v106, v106, v7
    v_sub_f32 v107, v107, v7
    v_fmac_f32 v102, v106, v106
    v_fmac_f32 v103, v107, v107
    v_lshlrev_b32 v104, 16, v88
    v_and_b32 v105, 0xffff0000, v88
    v_sub_f32 v104, v104, v7
    v_sub_f32 v105, v105, v7
    v_fmac_f32 v100, v104, v104
    v_fmac_f32 v101, v105, v105
    v_lshlrev_b32 v106, 16, v89
    v_and_b32 v107, 0xffff0000, v89
    v_sub_f32 v106, v106, v7
    v_sub_f32 v107, v107, v7
    v_fmac_f32 v102, v106, v106
    v_fmac_f32 v103, v107, v107
    v_lshlrev_b32 v104, 16, v90
    v_and_b32 v105, 0xffff0000, v90
    v_sub_f32 v104, v104, v7
    v_sub_f32 v105, v105, v7
    v_fmac_f32 v100, v104, v104
    v_fmac_f32 v101, v105, v105
    v_lshlrev_b32 v106, 16, v91
    v_and_b32 v107, 0xffff0000, v91
    v_sub_f32 v106, v106, v7
    v_sub_f32 v107, v107, v7
    v_fmac_f32 v102, v106, v106
    v_fmac_f32 v103, v107, v107
    v_lshlrev_b32 v104, 16, v92
    v_and_b32 v105, 0xffff0000, v92
    v_sub_f32 v104, v104, v7
    v_sub_f32 v105, v105, v7
    v_fmac_f32 v100, v104, v104
    v_fmac_f32 v101, v105, v105
    v_lshlrev_b32 v106, 16, v93
    v_and_b32 v107, 0xffff0000, v93
    v_sub_f32 v106, v106, v7
    v_sub_f32 v107, v107, v7
    v_fmac_f32 v102, v106, v106
    v_fmac_f32 v103, v107, v107
    v_lshlrev_b32 v104, 16, v94
    v_and_b32 v105, 0xffff0000, v94
    v_sub_f32 v104, v104, v7
    v_sub_f32 v105, v105, v7
    v_fmac_f32 v100, v104, v104
    v_fmac_f32 v101, v105, v105
    v_lshlrev_b32 v106, 16, v95
    v_and_b32 v107, 0xffff0000, v95
    v_sub_f32 v106, v106, v7
    v_sub_f32 v107, v107, v7
    v_fmac_f32 v102, v106, v106
    v_fmac_f32 v103, v107, v107
    v_add_f32 v100, v100, v101
    v_add_f32 v102, v102, v103
    v_add_f32 v10, v100, v102
    s_nop 1
    v_add_f32_dpp v10, v10, v10 quad_perm:[1,0,3,2] row_mask:0xf bank_mask:0xf
    s_nop 1
    v_add_f32_dpp v10, v10, v10 quad_perm:[2,3,0,1] row_mask:0xf bank_mask:0xf
    v_mul_f32 v10, 0x3acccccd, v10
    v_cvt_pk_bf16_f32 v7, v7, v7
    v_lshlrev_b32 v7, 16, v7
    v_cvt_pk_bf16_f32 v10, v10, v10
    v_lshlrev_b32 v10, 16, v10
    v_add_f32 v10, 0x3727c5ac, v10
    v_cvt_pk_bf16_f32 v10, v10, v10
    v_lshlrev_b32 v10, 16, v10
    v_sqrt_f32 v10, v10
    s_nop 0
    v_cvt_pk_bf16_f32 v10, v10, v10
    v_lshlrev_b32 v10, 16, v10
    v_rcp_f32 v11, v10
    v_lshlrev_b32 v4, 3, v4
    s_nop 0
    v_mov_b32 v10, v7
    v_add_u32 v4, 131072, v4
    ds_write_b64 v4, v[10:11]
    s_waitcnt lgkmcnt(0)
    s_barrier
    s_cmp_ge_u32 s26, 4
    s_cbranch_scc1 k4_kernel_nm
    s_lshr_b32 s27, s26, 1
    s_and_b32 s28, s26, 1
    s_mul_i32 s27, s27, 64
    s_mul_i32 s28, s28, 64
    v_and_b32 v8, 15, v1
    v_lshrrev_b32 v9, 4, v1
    v_lshrrev_b32 v10, 1, v1
    v_and_b32 v10, 7, v10
    v_xor_b32 v10, v10, v9
    v_lshlrev_b32 v10, 4, v10
    v_add_u32 v11, s27, v8
    v_lshlrev_b32 v11, 7, v11
    v_add_u32 v2, v11, v10
    v_xor_b32 v3, 64, v2
    v_lshrrev_b32 v10, 2, v8
    v_and_b32 v11, 3, v1
    v_lshl_add_u32 v12, v9, 3, v10
    v_lshlrev_b32 v12, 8, v12
    v_and_b32 v13, 1, v11
    v_lshl_add_u32 v12, v13, 3, v12
    v_lshrrev_b32 v13, 1, v11
    v_lshl_add_u32 v12, v13, 4, v12
    v_and_b32 v13, 1, v9
    s_lshr_b32 s29, s28, 6
    v_xor_b32 v13, s29, v13
    v_lshl_add_u32 v12, v13, 7, v12
    v_xor_b32 v13, 0, v10
    v_lshl_add_u32 v4, v13, 5, v12
    v_xor_b32 v13, 1, v10
    v_lshl_add_u32 v5, v13, 5, v12
    v_xor_b32 v13, 2, v10
    v_lshl_add_u32 v6, v13, 5, v12
    v_xor_b32 v13, 3, v10
    v_lshl_add_u32 v7, v13, 5, v12
    v_mov_b32 v80, 0
    v_mov_b32 v81, 0
    v_mov_b32 v82, 0
    v_mov_b32 v83, 0
    v_mov_b32 v84, 0
    v_mov_b32 v85, 0
    v_mov_b32 v86, 0
    v_mov_b32 v87, 0
    v_mov_b32 v88, 0
    v_mov_b32 v89, 0
    v_mov_b32 v90, 0
    v_mov_b32 v91, 0
    v_mov_b32 v92, 0
    v_mov_b32 v93, 0
    v_mov_b32 v94, 0
    v_mov_b32 v95, 0
    v_mov_b32 v96, 0
    v_mov_b32 v97, 0
    v_mov_b32 v98, 0
    v_mov_b32 v99, 0
    v_mov_b32 v100, 0
    v_mov_b32 v101, 0
    v_mov_b32 v102, 0
    v_mov_b32 v103, 0
    v_mov_b32 v104, 0
    v_mov_b32 v105, 0
    v_mov_b32 v106, 0
    v_mov_b32 v107, 0
    v_mov_b32 v108, 0
    v_mov_b32 v109, 0
    v_mov_b32 v110, 0
    v_mov_b32 v111, 0
    v_mov_b32 v112, 0
    v_mov_b32 v113, 0
    v_mov_b32 v114, 0
    v_mov_b32 v115, 0
    v_mov_b32 v116, 0
    v_mov_b32 v117, 0
    v_mov_b32 v118, 0
    v_mov_b32 v119, 0
    v_mov_b32 v120, 0
    v_mov_b32 v121, 0
    v_mov_b32 v122, 0
    v_mov_b32 v123, 0
    v_mov_b32 v124, 0
    v_mov_b32 v125, 0
    v_mov_b32 v126, 0
    v_mov_b32 v127, 0
    v_mov_b32 v128, 0
    v_mov_b32 v129, 0
    v_mov_b32 v130, 0
    v_mov_b32 v131, 0
    v_mov_b32 v132, 0
    v_mov_b32 v133, 0
    v_mov_b32 v134, 0
    v_mov_b32 v135, 0
    v_mov_b32 v136, 0
    v_mov_b32 v137, 0
    v_mov_b32 v138, 0
    v_mov_b32 v139, 0
    v_mov_b32 v140, 0
    v_mov_b32 v141, 0
    v_mov_b32 v142, 0
    v_mov_b32 v143, 0
    s_barrier
    v_add_u32 v8, 0, v2
    v_add_u32 v9, 16384, v4
    v_add_u32 v10, 16384, v5
    v_add_u32 v11, 16384, v6
    v_add_u32 v12, 16384, v7
    ds_read_b128 v[16:19], v8 offset:0
    ds_read_b128 v[20:23], v8 offset:2048
    ds_read_b128 v[24:27], v8 offset:4096
    ds_read_b128 v[28:31], v8 offset:6144
    ds_read_b64_tr_b16 v[48:49], v9 offset:0
    ds_read_b64_tr_b16 v[50:51], v9 offset:1024
    ds_read_b64_tr_b16 v[52:53], v10 offset:0
    ds_read_b64_tr_b16 v[54:55], v10 offset:1024
    ds_read_b64_tr_b16 v[56:57], v11 offset:0
    ds_read_b64_tr_b16 v[58:59], v11 offset:1024
    ds_read_b64_tr_b16 v[60:61], v12 offset:0
    ds_read_b64_tr_b16 v[62:63], v12 offset:1024
    v_add_u32 v8, 0, v3
    v_add_u32 v9, 16384, v4
    v_add_u32 v10, 16384, v5
    v_add_u32 v11, 16384, v6
    v_add_u32 v12, 16384, v7
    ds_read_b128 v[32:35], v8 offset:0
    ds_read_b128 v[36:39], v8 offset:2048
    ds_read_b128 v[40:43], v8 offset:4096
    ds_read_b128 v[44:47], v8 offset:6144
    ds_read_b64_tr_b16 v[64:65], v9 offset:8192
    ds_read_b64_tr_b16 v[66:67], v9 offset:9216
    ds_read_b64_tr_b16 v[68:69], v10 offset:8192
    ds_read_b64_tr_b16 v[70:71], v10 offset:9216
    ds_read_b64_tr_b16 v[72:73], v11 offset:8192
    ds_read_b64_tr_b16 v[74:75], v11 offset:9216
    ds_read_b64_tr_b16 v[76:77], v12 offset:8192
    ds_read_b64_tr_b16 v[78:79], v12 offset:9216
    s_waitcnt lgkmcnt(12)
    v_mfma_f32_16x16x32_bf16 v[80:83], v[48:51], v[16:19], v[80:83]
    v_mfma_f32_16x16x32_bf16 v[84:87], v[52:55], v[16:19], v[84:87]
    v_mfma_f32_16x16x32_bf16 v[88:91], v[56:59], v[16:19], v[88:91]
    v_mfma_f32_16x16x32_bf16 v[92:95], v[60:63], v[16:19], v[92:95]
    v_mfma_f32_16x16x32_bf16 v[96:99], v[48:51], v[20:23], v[96:99]
    v_mfma_f32_16x16x32_bf16 v[100:103], v[52:55], v[20:23], v[100:103]
    v_mfma_f32_16x16x32_bf16 v[104:107], v[56:59], v[20:23], v[104:107]
    v_mfma_f32_16x16x32_bf16 v[108:111], v[60:63], v[20:23], v[108:111]
    v_mfma_f32_16x16x32_bf16 v[112:115], v[48:51], v[24:27], v[112:115]
    v_mfma_f32_16x16x32_bf16 v[116:119], v[52:55], v[24:27], v[116:119]
    v_mfma_f32_16x16x32_bf16 v[120:123], v[56:59], v[24:27], v[120:123]
    v_mfma_f32_16x16x32_bf16 v[124:127], v[60:63], v[24:27], v[124:127]
    v_mfma_f32_16x16x32_bf16 v[128:131], v[48:51], v[28:31], v[128:131]
    v_mfma_f32_16x16x32_bf16 v[132:135], v[52:55], v[28:31], v[132:135]
    v_mfma_f32_16x16x32_bf16 v[136:139], v[56:59], v[28:31], v[136:139]
    v_mfma_f32_16x16x32_bf16 v[140:143], v[60:63], v[28:31], v[140:143]
    s_waitcnt lgkmcnt(0)
    s_barrier
    v_add_u32 v8, 32768, v2
    v_add_u32 v9, 49152, v4
    v_add_u32 v10, 49152, v5
    v_add_u32 v11, 49152, v6
    v_add_u32 v12, 49152, v7
    ds_read_b128 v[16:19], v8 offset:0
    ds_read_b128 v[20:23], v8 offset:2048
    ds_read_b128 v[24:27], v8 offset:4096
    ds_read_b128 v[28:31], v8 offset:6144
    ds_read_b64_tr_b16 v[48:49], v9 offset:0
    ds_read_b64_tr_b16 v[50:51], v9 offset:1024
    ds_read_b64_tr_b16 v[52:53], v10 offset:0
    ds_read_b64_tr_b16 v[54:55], v10 offset:1024
    ds_read_b64_tr_b16 v[56:57], v11 offset:0
    ds_read_b64_tr_b16 v[58:59], v11 offset:1024
    ds_read_b64_tr_b16 v[60:61], v12 offset:0
    ds_read_b64_tr_b16 v[62:63], v12 offset:1024
    v_mfma_f32_16x16x32_bf16 v[80:83], v[64:67], v[32:35], v[80:83]
    v_mfma_f32_16x16x32_bf16 v[84:87], v[68:71], v[32:35], v[84:87]
    v_mfma_f32_16x16x32_bf16 v[88:91], v[72:75], v[32:35], v[88:91]
    v_mfma_f32_16x16x32_bf16 v[92:95], v[76:79], v[32:35], v[92:95]
    v_mfma_f32_16x16x32_bf16 v[96:99], v[64:67], v[36:39], v[96:99]
    v_mfma_f32_16x16x32_bf16 v[100:103], v[68:71], v[36:39], v[100:103]
    v_mfma_f32_16x16x32_bf16 v[104:107], v[72:75], v[36:39], v[104:107]
    v_mfma_f32_16x16x32_bf16 v[108:111], v[76:79], v[36:39], v[108:111]
    v_mfma_f32_16x16x32_bf16 v[112:115], v[64:67], v[40:43], v[112:115]
    v_mfma_f32_16x16x32_bf16 v[116:119], v[68:71], v[40:43], v[116:119]
    v_mfma_f32_16x16x32_bf16 v[120:123], v[72:75], v[40:43], v[120:123]
    v_mfma_f32_16x16x32_bf16 v[124:127], v[76:79], v[40:43], v[124:127]
    v_mfma_f32_16x16x32_bf16 v[128:131], v[64:67], v[44:47], v[128:131]
    v_mfma_f32_16x16x32_bf16 v[132:135], v[68:71], v[44:47], v[132:135]
    v_mfma_f32_16x16x32_bf16 v[136:139], v[72:75], v[44:47], v[136:139]
    v_mfma_f32_16x16x32_bf16 v[140:143], v[76:79], v[44:47], v[140:143]
    v_add_u32 v8, 32768, v3
    v_add_u32 v9, 49152, v4
    v_add_u32 v10, 49152, v5
    v_add_u32 v11, 49152, v6
    v_add_u32 v12, 49152, v7
    ds_read_b128 v[32:35], v8 offset:0
    ds_read_b128 v[36:39], v8 offset:2048
    ds_read_b128 v[40:43], v8 offset:4096
    ds_read_b128 v[44:47], v8 offset:6144
    ds_read_b64_tr_b16 v[64:65], v9 offset:8192
    ds_read_b64_tr_b16 v[66:67], v9 offset:9216
    ds_read_b64_tr_b16 v[68:69], v10 offset:8192
    ds_read_b64_tr_b16 v[70:71], v10 offset:9216
    ds_read_b64_tr_b16 v[72:73], v11 offset:8192
    ds_read_b64_tr_b16 v[74:75], v11 offset:9216
    ds_read_b64_tr_b16 v[76:77], v12 offset:8192
    ds_read_b64_tr_b16 v[78:79], v12 offset:9216
    s_waitcnt lgkmcnt(12)
    v_mfma_f32_16x16x32_bf16 v[80:83], v[48:51], v[16:19], v[80:83]
    v_mfma_f32_16x16x32_bf16 v[84:87], v[52:55], v[16:19], v[84:87]
    v_mfma_f32_16x16x32_bf16 v[88:91], v[56:59], v[16:19], v[88:91]
    v_mfma_f32_16x16x32_bf16 v[92:95], v[60:63], v[16:19], v[92:95]
    v_mfma_f32_16x16x32_bf16 v[96:99], v[48:51], v[20:23], v[96:99]
    v_mfma_f32_16x16x32_bf16 v[100:103], v[52:55], v[20:23], v[100:103]
    v_mfma_f32_16x16x32_bf16 v[104:107], v[56:59], v[20:23], v[104:107]
    v_mfma_f32_16x16x32_bf16 v[108:111], v[60:63], v[20:23], v[108:111]
    v_mfma_f32_16x16x32_bf16 v[112:115], v[48:51], v[24:27], v[112:115]
    v_mfma_f32_16x16x32_bf16 v[116:119], v[52:55], v[24:27], v[116:119]
    v_mfma_f32_16x16x32_bf16 v[120:123], v[56:59], v[24:27], v[120:123]
    v_mfma_f32_16x16x32_bf16 v[124:127], v[60:63], v[24:27], v[124:127]
    v_mfma_f32_16x16x32_bf16 v[128:131], v[48:51], v[28:31], v[128:131]
    v_mfma_f32_16x16x32_bf16 v[132:135], v[52:55], v[28:31], v[132:135]
    v_mfma_f32_16x16x32_bf16 v[136:139], v[56:59], v[28:31], v[136:139]
    v_mfma_f32_16x16x32_bf16 v[140:143], v[60:63], v[28:31], v[140:143]
    s_waitcnt lgkmcnt(0)
    s_barrier
    v_add_u32 v8, 65536, v2
    v_add_u32 v9, 81920, v4
    v_add_u32 v10, 81920, v5
    v_add_u32 v11, 81920, v6
    v_add_u32 v12, 81920, v7
    ds_read_b128 v[16:19], v8 offset:0
    ds_read_b128 v[20:23], v8 offset:2048
    ds_read_b128 v[24:27], v8 offset:4096
    ds_read_b128 v[28:31], v8 offset:6144
    ds_read_b64_tr_b16 v[48:49], v9 offset:0
    ds_read_b64_tr_b16 v[50:51], v9 offset:1024
    ds_read_b64_tr_b16 v[52:53], v10 offset:0
    ds_read_b64_tr_b16 v[54:55], v10 offset:1024
    ds_read_b64_tr_b16 v[56:57], v11 offset:0
    ds_read_b64_tr_b16 v[58:59], v11 offset:1024
    ds_read_b64_tr_b16 v[60:61], v12 offset:0
    ds_read_b64_tr_b16 v[62:63], v12 offset:1024
    v_mfma_f32_16x16x32_bf16 v[80:83], v[64:67], v[32:35], v[80:83]
    v_mfma_f32_16x16x32_bf16 v[84:87], v[68:71], v[32:35], v[84:87]
    v_mfma_f32_16x16x32_bf16 v[88:91], v[72:75], v[32:35], v[88:91]
    v_mfma_f32_16x16x32_bf16 v[92:95], v[76:79], v[32:35], v[92:95]
    v_mfma_f32_16x16x32_bf16 v[96:99], v[64:67], v[36:39], v[96:99]
    v_mfma_f32_16x16x32_bf16 v[100:103], v[68:71], v[36:39], v[100:103]
    v_mfma_f32_16x16x32_bf16 v[104:107], v[72:75], v[36:39], v[104:107]
    v_mfma_f32_16x16x32_bf16 v[108:111], v[76:79], v[36:39], v[108:111]
    v_mfma_f32_16x16x32_bf16 v[112:115], v[64:67], v[40:43], v[112:115]
    v_mfma_f32_16x16x32_bf16 v[116:119], v[68:71], v[40:43], v[116:119]
    v_mfma_f32_16x16x32_bf16 v[120:123], v[72:75], v[40:43], v[120:123]
    v_mfma_f32_16x16x32_bf16 v[124:127], v[76:79], v[40:43], v[124:127]
    v_mfma_f32_16x16x32_bf16 v[128:131], v[64:67], v[44:47], v[128:131]
    v_mfma_f32_16x16x32_bf16 v[132:135], v[68:71], v[44:47], v[132:135]
    v_mfma_f32_16x16x32_bf16 v[136:139], v[72:75], v[44:47], v[136:139]
    v_mfma_f32_16x16x32_bf16 v[140:143], v[76:79], v[44:47], v[140:143]
    v_add_u32 v8, 65536, v3
    v_add_u32 v9, 81920, v4
    v_add_u32 v10, 81920, v5
    v_add_u32 v11, 81920, v6
    v_add_u32 v12, 81920, v7
    ds_read_b128 v[32:35], v8 offset:0
    ds_read_b128 v[36:39], v8 offset:2048
    ds_read_b128 v[40:43], v8 offset:4096
    ds_read_b128 v[44:47], v8 offset:6144
    ds_read_b64_tr_b16 v[64:65], v9 offset:8192
    ds_read_b64_tr_b16 v[66:67], v9 offset:9216
    ds_read_b64_tr_b16 v[68:69], v10 offset:8192
    ds_read_b64_tr_b16 v[70:71], v10 offset:9216
    ds_read_b64_tr_b16 v[72:73], v11 offset:8192
    ds_read_b64_tr_b16 v[74:75], v11 offset:9216
    ds_read_b64_tr_b16 v[76:77], v12 offset:8192
    ds_read_b64_tr_b16 v[78:79], v12 offset:9216
    s_waitcnt lgkmcnt(12)
    v_mfma_f32_16x16x32_bf16 v[80:83], v[48:51], v[16:19], v[80:83]
    v_mfma_f32_16x16x32_bf16 v[84:87], v[52:55], v[16:19], v[84:87]
    v_mfma_f32_16x16x32_bf16 v[88:91], v[56:59], v[16:19], v[88:91]
    v_mfma_f32_16x16x32_bf16 v[92:95], v[60:63], v[16:19], v[92:95]
    v_mfma_f32_16x16x32_bf16 v[96:99], v[48:51], v[20:23], v[96:99]
    v_mfma_f32_16x16x32_bf16 v[100:103], v[52:55], v[20:23], v[100:103]
    v_mfma_f32_16x16x32_bf16 v[104:107], v[56:59], v[20:23], v[104:107]
    v_mfma_f32_16x16x32_bf16 v[108:111], v[60:63], v[20:23], v[108:111]
    v_mfma_f32_16x16x32_bf16 v[112:115], v[48:51], v[24:27], v[112:115]
    v_mfma_f32_16x16x32_bf16 v[116:119], v[52:55], v[24:27], v[116:119]
    v_mfma_f32_16x16x32_bf16 v[120:123], v[56:59], v[24:27], v[120:123]
    v_mfma_f32_16x16x32_bf16 v[124:127], v[60:63], v[24:27], v[124:127]
    v_mfma_f32_16x16x32_bf16 v[128:131], v[48:51], v[28:31], v[128:131]
    v_mfma_f32_16x16x32_bf16 v[132:135], v[52:55], v[28:31], v[132:135]
    v_mfma_f32_16x16x32_bf16 v[136:139], v[56:59], v[28:31], v[136:139]
    v_mfma_f32_16x16x32_bf16 v[140:143], v[60:63], v[28:31], v[140:143]
    s_waitcnt lgkmcnt(0)
    s_barrier
    v_add_u32 v8, 98304, v2
    v_add_u32 v9, 114688, v4
    v_add_u32 v10, 114688, v5
    v_add_u32 v11, 114688, v6
    v_add_u32 v12, 114688, v7
    ds_read_b128 v[16:19], v8 offset:0
    ds_read_b128 v[20:23], v8 offset:2048
    ds_read_b128 v[24:27], v8 offset:4096
    ds_read_b128 v[28:31], v8 offset:6144
    ds_read_b64_tr_b16 v[48:49], v9 offset:0
    ds_read_b64_tr_b16 v[50:51], v9 offset:1024
    ds_read_b64_tr_b16 v[52:53], v10 offset:0
    ds_read_b64_tr_b16 v[54:55], v10 offset:1024
    ds_read_b64_tr_b16 v[56:57], v11 offset:0
    ds_read_b64_tr_b16 v[58:59], v11 offset:1024
    ds_read_b64_tr_b16 v[60:61], v12 offset:0
    ds_read_b64_tr_b16 v[62:63], v12 offset:1024
    v_mfma_f32_16x16x32_bf16 v[80:83], v[64:67], v[32:35], v[80:83]
    v_mfma_f32_16x16x32_bf16 v[84:87], v[68:71], v[32:35], v[84:87]
    v_mfma_f32_16x16x32_bf16 v[88:91], v[72:75], v[32:35], v[88:91]
    v_mfma_f32_16x16x32_bf16 v[92:95], v[76:79], v[32:35], v[92:95]
    v_mfma_f32_16x16x32_bf16 v[96:99], v[64:67], v[36:39], v[96:99]
    v_mfma_f32_16x16x32_bf16 v[100:103], v[68:71], v[36:39], v[100:103]
    v_mfma_f32_16x16x32_bf16 v[104:107], v[72:75], v[36:39], v[104:107]
    v_mfma_f32_16x16x32_bf16 v[108:111], v[76:79], v[36:39], v[108:111]
    v_mfma_f32_16x16x32_bf16 v[112:115], v[64:67], v[40:43], v[112:115]
    v_mfma_f32_16x16x32_bf16 v[116:119], v[68:71], v[40:43], v[116:119]
    v_mfma_f32_16x16x32_bf16 v[120:123], v[72:75], v[40:43], v[120:123]
    v_mfma_f32_16x16x32_bf16 v[124:127], v[76:79], v[40:43], v[124:127]
    v_mfma_f32_16x16x32_bf16 v[128:131], v[64:67], v[44:47], v[128:131]
    v_mfma_f32_16x16x32_bf16 v[132:135], v[68:71], v[44:47], v[132:135]
    v_mfma_f32_16x16x32_bf16 v[136:139], v[72:75], v[44:47], v[136:139]
    v_mfma_f32_16x16x32_bf16 v[140:143], v[76:79], v[44:47], v[140:143]
    v_add_u32 v8, 98304, v3
    v_add_u32 v9, 114688, v4
    v_add_u32 v10, 114688, v5
    v_add_u32 v11, 114688, v6
    v_add_u32 v12, 114688, v7
    ds_read_b128 v[32:35], v8 offset:0
    ds_read_b128 v[36:39], v8 offset:2048
    ds_read_b128 v[40:43], v8 offset:4096
    ds_read_b128 v[44:47], v8 offset:6144
    ds_read_b64_tr_b16 v[64:65], v9 offset:8192
    ds_read_b64_tr_b16 v[66:67], v9 offset:9216
    ds_read_b64_tr_b16 v[68:69], v10 offset:8192
    ds_read_b64_tr_b16 v[70:71], v10 offset:9216
    ds_read_b64_tr_b16 v[72:73], v11 offset:8192
    ds_read_b64_tr_b16 v[74:75], v11 offset:9216
    ds_read_b64_tr_b16 v[76:77], v12 offset:8192
    ds_read_b64_tr_b16 v[78:79], v12 offset:9216
    s_waitcnt lgkmcnt(12)
    v_mfma_f32_16x16x32_bf16 v[80:83], v[48:51], v[16:19], v[80:83]
    v_mfma_f32_16x16x32_bf16 v[84:87], v[52:55], v[16:19], v[84:87]
    v_mfma_f32_16x16x32_bf16 v[88:91], v[56:59], v[16:19], v[88:91]
    v_mfma_f32_16x16x32_bf16 v[92:95], v[60:63], v[16:19], v[92:95]
    v_mfma_f32_16x16x32_bf16 v[96:99], v[48:51], v[20:23], v[96:99]
    v_mfma_f32_16x16x32_bf16 v[100:103], v[52:55], v[20:23], v[100:103]
    v_mfma_f32_16x16x32_bf16 v[104:107], v[56:59], v[20:23], v[104:107]
    v_mfma_f32_16x16x32_bf16 v[108:111], v[60:63], v[20:23], v[108:111]
    v_mfma_f32_16x16x32_bf16 v[112:115], v[48:51], v[24:27], v[112:115]
    v_mfma_f32_16x16x32_bf16 v[116:119], v[52:55], v[24:27], v[116:119]
    v_mfma_f32_16x16x32_bf16 v[120:123], v[56:59], v[24:27], v[120:123]
    v_mfma_f32_16x16x32_bf16 v[124:127], v[60:63], v[24:27], v[124:127]
    v_mfma_f32_16x16x32_bf16 v[128:131], v[48:51], v[28:31], v[128:131]
    v_mfma_f32_16x16x32_bf16 v[132:135], v[52:55], v[28:31], v[132:135]
    v_mfma_f32_16x16x32_bf16 v[136:139], v[56:59], v[28:31], v[136:139]
    v_mfma_f32_16x16x32_bf16 v[140:143], v[60:63], v[28:31], v[140:143]
    s_waitcnt lgkmcnt(0)
    s_barrier
    v_add_u32 v8, 0, v2
    v_add_u32 v9, 16384, v4
    v_add_u32 v10, 16384, v5
    v_add_u32 v11, 16384, v6
    v_add_u32 v12, 16384, v7
    ds_read_b128 v[16:19], v8 offset:0
    ds_read_b128 v[20:23], v8 offset:2048
    ds_read_b128 v[24:27], v8 offset:4096
    ds_read_b128 v[28:31], v8 offset:6144
    ds_read_b64_tr_b16 v[48:49], v9 offset:0
    ds_read_b64_tr_b16 v[50:51], v9 offset:1024
    ds_read_b64_tr_b16 v[52:53], v10 offset:0
    ds_read_b64_tr_b16 v[54:55], v10 offset:1024
    ds_read_b64_tr_b16 v[56:57], v11 offset:0
    ds_read_b64_tr_b16 v[58:59], v11 offset:1024
    ds_read_b64_tr_b16 v[60:61], v12 offset:0
    ds_read_b64_tr_b16 v[62:63], v12 offset:1024
    v_mfma_f32_16x16x32_bf16 v[80:83], v[64:67], v[32:35], v[80:83]
    v_mfma_f32_16x16x32_bf16 v[84:87], v[68:71], v[32:35], v[84:87]
    v_mfma_f32_16x16x32_bf16 v[88:91], v[72:75], v[32:35], v[88:91]
    v_mfma_f32_16x16x32_bf16 v[92:95], v[76:79], v[32:35], v[92:95]
    v_mfma_f32_16x16x32_bf16 v[96:99], v[64:67], v[36:39], v[96:99]
    v_mfma_f32_16x16x32_bf16 v[100:103], v[68:71], v[36:39], v[100:103]
    v_mfma_f32_16x16x32_bf16 v[104:107], v[72:75], v[36:39], v[104:107]
    v_mfma_f32_16x16x32_bf16 v[108:111], v[76:79], v[36:39], v[108:111]
    v_mfma_f32_16x16x32_bf16 v[112:115], v[64:67], v[40:43], v[112:115]
    v_mfma_f32_16x16x32_bf16 v[116:119], v[68:71], v[40:43], v[116:119]
    v_mfma_f32_16x16x32_bf16 v[120:123], v[72:75], v[40:43], v[120:123]
    v_mfma_f32_16x16x32_bf16 v[124:127], v[76:79], v[40:43], v[124:127]
    v_mfma_f32_16x16x32_bf16 v[128:131], v[64:67], v[44:47], v[128:131]
    v_mfma_f32_16x16x32_bf16 v[132:135], v[68:71], v[44:47], v[132:135]
    v_mfma_f32_16x16x32_bf16 v[136:139], v[72:75], v[44:47], v[136:139]
    v_mfma_f32_16x16x32_bf16 v[140:143], v[76:79], v[44:47], v[140:143]
    v_add_u32 v8, 0, v3
    v_add_u32 v9, 16384, v4
    v_add_u32 v10, 16384, v5
    v_add_u32 v11, 16384, v6
    v_add_u32 v12, 16384, v7
    ds_read_b128 v[32:35], v8 offset:0
    ds_read_b128 v[36:39], v8 offset:2048
    ds_read_b128 v[40:43], v8 offset:4096
    ds_read_b128 v[44:47], v8 offset:6144
    ds_read_b64_tr_b16 v[64:65], v9 offset:8192
    ds_read_b64_tr_b16 v[66:67], v9 offset:9216
    ds_read_b64_tr_b16 v[68:69], v10 offset:8192
    ds_read_b64_tr_b16 v[70:71], v10 offset:9216
    ds_read_b64_tr_b16 v[72:73], v11 offset:8192
    ds_read_b64_tr_b16 v[74:75], v11 offset:9216
    ds_read_b64_tr_b16 v[76:77], v12 offset:8192
    ds_read_b64_tr_b16 v[78:79], v12 offset:9216
    s_waitcnt lgkmcnt(12)
    v_mfma_f32_16x16x32_bf16 v[80:83], v[48:51], v[16:19], v[80:83]
    v_mfma_f32_16x16x32_bf16 v[84:87], v[52:55], v[16:19], v[84:87]
    v_mfma_f32_16x16x32_bf16 v[88:91], v[56:59], v[16:19], v[88:91]
    v_mfma_f32_16x16x32_bf16 v[92:95], v[60:63], v[16:19], v[92:95]
    v_mfma_f32_16x16x32_bf16 v[96:99], v[48:51], v[20:23], v[96:99]
    v_mfma_f32_16x16x32_bf16 v[100:103], v[52:55], v[20:23], v[100:103]
    v_mfma_f32_16x16x32_bf16 v[104:107], v[56:59], v[20:23], v[104:107]
    v_mfma_f32_16x16x32_bf16 v[108:111], v[60:63], v[20:23], v[108:111]
    v_mfma_f32_16x16x32_bf16 v[112:115], v[48:51], v[24:27], v[112:115]
    v_mfma_f32_16x16x32_bf16 v[116:119], v[52:55], v[24:27], v[116:119]
    v_mfma_f32_16x16x32_bf16 v[120:123], v[56:59], v[24:27], v[120:123]
    v_mfma_f32_16x16x32_bf16 v[124:127], v[60:63], v[24:27], v[124:127]
    v_mfma_f32_16x16x32_bf16 v[128:131], v[48:51], v[28:31], v[128:131]
    v_mfma_f32_16x16x32_bf16 v[132:135], v[52:55], v[28:31], v[132:135]
    v_mfma_f32_16x16x32_bf16 v[136:139], v[56:59], v[28:31], v[136:139]
    v_mfma_f32_16x16x32_bf16 v[140:143], v[60:63], v[28:31], v[140:143]
    s_waitcnt lgkmcnt(0)
    s_barrier
    v_add_u32 v8, 32768, v2
    v_add_u32 v9, 49152, v4
    v_add_u32 v10, 49152, v5
    v_add_u32 v11, 49152, v6
    v_add_u32 v12, 49152, v7
    ds_read_b128 v[16:19], v8 offset:0
    ds_read_b128 v[20:23], v8 offset:2048
    ds_read_b128 v[24:27], v8 offset:4096
    ds_read_b128 v[28:31], v8 offset:6144
    ds_read_b64_tr_b16 v[48:49], v9 offset:0
    ds_read_b64_tr_b16 v[50:51], v9 offset:1024
    ds_read_b64_tr_b16 v[52:53], v10 offset:0
    ds_read_b64_tr_b16 v[54:55], v10 offset:1024
    ds_read_b64_tr_b16 v[56:57], v11 offset:0
    ds_read_b64_tr_b16 v[58:59], v11 offset:1024
    ds_read_b64_tr_b16 v[60:61], v12 offset:0
    ds_read_b64_tr_b16 v[62:63], v12 offset:1024
    v_mfma_f32_16x16x32_bf16 v[80:83], v[64:67], v[32:35], v[80:83]
    v_mfma_f32_16x16x32_bf16 v[84:87], v[68:71], v[32:35], v[84:87]
    v_mfma_f32_16x16x32_bf16 v[88:91], v[72:75], v[32:35], v[88:91]
    v_mfma_f32_16x16x32_bf16 v[92:95], v[76:79], v[32:35], v[92:95]
    v_mfma_f32_16x16x32_bf16 v[96:99], v[64:67], v[36:39], v[96:99]
    v_mfma_f32_16x16x32_bf16 v[100:103], v[68:71], v[36:39], v[100:103]
    v_mfma_f32_16x16x32_bf16 v[104:107], v[72:75], v[36:39], v[104:107]
    v_mfma_f32_16x16x32_bf16 v[108:111], v[76:79], v[36:39], v[108:111]
    v_mfma_f32_16x16x32_bf16 v[112:115], v[64:67], v[40:43], v[112:115]
    v_mfma_f32_16x16x32_bf16 v[116:119], v[68:71], v[40:43], v[116:119]
    v_mfma_f32_16x16x32_bf16 v[120:123], v[72:75], v[40:43], v[120:123]
    v_mfma_f32_16x16x32_bf16 v[124:127], v[76:79], v[40:43], v[124:127]
    v_mfma_f32_16x16x32_bf16 v[128:131], v[64:67], v[44:47], v[128:131]
    v_mfma_f32_16x16x32_bf16 v[132:135], v[68:71], v[44:47], v[132:135]
    v_mfma_f32_16x16x32_bf16 v[136:139], v[72:75], v[44:47], v[136:139]
    v_mfma_f32_16x16x32_bf16 v[140:143], v[76:79], v[44:47], v[140:143]
    v_add_u32 v8, 32768, v3
    v_add_u32 v9, 49152, v4
    v_add_u32 v10, 49152, v5
    v_add_u32 v11, 49152, v6
    v_add_u32 v12, 49152, v7
    ds_read_b128 v[32:35], v8 offset:0
    ds_read_b128 v[36:39], v8 offset:2048
    ds_read_b128 v[40:43], v8 offset:4096
    ds_read_b128 v[44:47], v8 offset:6144
    ds_read_b64_tr_b16 v[64:65], v9 offset:8192
    ds_read_b64_tr_b16 v[66:67], v9 offset:9216
    ds_read_b64_tr_b16 v[68:69], v10 offset:8192
    ds_read_b64_tr_b16 v[70:71], v10 offset:9216
    ds_read_b64_tr_b16 v[72:73], v11 offset:8192
    ds_read_b64_tr_b16 v[74:75], v11 offset:9216
    ds_read_b64_tr_b16 v[76:77], v12 offset:8192
    ds_read_b64_tr_b16 v[78:79], v12 offset:9216
    s_waitcnt lgkmcnt(12)
    v_mfma_f32_16x16x32_bf16 v[80:83], v[48:51], v[16:19], v[80:83]
    v_mfma_f32_16x16x32_bf16 v[84:87], v[52:55], v[16:19], v[84:87]
    v_mfma_f32_16x16x32_bf16 v[88:91], v[56:59], v[16:19], v[88:91]
    v_mfma_f32_16x16x32_bf16 v[92:95], v[60:63], v[16:19], v[92:95]
    v_mfma_f32_16x16x32_bf16 v[96:99], v[48:51], v[20:23], v[96:99]
    v_mfma_f32_16x16x32_bf16 v[100:103], v[52:55], v[20:23], v[100:103]
    v_mfma_f32_16x16x32_bf16 v[104:107], v[56:59], v[20:23], v[104:107]
    v_mfma_f32_16x16x32_bf16 v[108:111], v[60:63], v[20:23], v[108:111]
    v_mfma_f32_16x16x32_bf16 v[112:115], v[48:51], v[24:27], v[112:115]
    v_mfma_f32_16x16x32_bf16 v[116:119], v[52:55], v[24:27], v[116:119]
    v_mfma_f32_16x16x32_bf16 v[120:123], v[56:59], v[24:27], v[120:123]
    v_mfma_f32_16x16x32_bf16 v[124:127], v[60:63], v[24:27], v[124:127]
    v_mfma_f32_16x16x32_bf16 v[128:131], v[48:51], v[28:31], v[128:131]
    v_mfma_f32_16x16x32_bf16 v[132:135], v[52:55], v[28:31], v[132:135]
    v_mfma_f32_16x16x32_bf16 v[136:139], v[56:59], v[28:31], v[136:139]
    v_mfma_f32_16x16x32_bf16 v[140:143], v[60:63], v[28:31], v[140:143]
    s_waitcnt lgkmcnt(0)
    s_barrier
    v_add_u32 v8, 65536, v2
    v_add_u32 v9, 81920, v4
    v_add_u32 v10, 81920, v5
    v_add_u32 v11, 81920, v6
    v_add_u32 v12, 81920, v7
    ds_read_b128 v[16:19], v8 offset:0
    ds_read_b128 v[20:23], v8 offset:2048
    ds_read_b128 v[24:27], v8 offset:4096
    ds_read_b128 v[28:31], v8 offset:6144
    ds_read_b64_tr_b16 v[48:49], v9 offset:0
    ds_read_b64_tr_b16 v[50:51], v9 offset:1024
    ds_read_b64_tr_b16 v[52:53], v10 offset:0
    ds_read_b64_tr_b16 v[54:55], v10 offset:1024
    ds_read_b64_tr_b16 v[56:57], v11 offset:0
    ds_read_b64_tr_b16 v[58:59], v11 offset:1024
    ds_read_b64_tr_b16 v[60:61], v12 offset:0
    ds_read_b64_tr_b16 v[62:63], v12 offset:1024
    v_mfma_f32_16x16x32_bf16 v[80:83], v[64:67], v[32:35], v[80:83]
    v_mfma_f32_16x16x32_bf16 v[84:87], v[68:71], v[32:35], v[84:87]
    v_mfma_f32_16x16x32_bf16 v[88:91], v[72:75], v[32:35], v[88:91]
    v_mfma_f32_16x16x32_bf16 v[92:95], v[76:79], v[32:35], v[92:95]
    v_mfma_f32_16x16x32_bf16 v[96:99], v[64:67], v[36:39], v[96:99]
    v_mfma_f32_16x16x32_bf16 v[100:103], v[68:71], v[36:39], v[100:103]
    v_mfma_f32_16x16x32_bf16 v[104:107], v[72:75], v[36:39], v[104:107]
    v_mfma_f32_16x16x32_bf16 v[108:111], v[76:79], v[36:39], v[108:111]
    v_mfma_f32_16x16x32_bf16 v[112:115], v[64:67], v[40:43], v[112:115]
    v_mfma_f32_16x16x32_bf16 v[116:119], v[68:71], v[40:43], v[116:119]
    v_mfma_f32_16x16x32_bf16 v[120:123], v[72:75], v[40:43], v[120:123]
    v_mfma_f32_16x16x32_bf16 v[124:127], v[76:79], v[40:43], v[124:127]
    v_mfma_f32_16x16x32_bf16 v[128:131], v[64:67], v[44:47], v[128:131]
    v_mfma_f32_16x16x32_bf16 v[132:135], v[68:71], v[44:47], v[132:135]
    v_mfma_f32_16x16x32_bf16 v[136:139], v[72:75], v[44:47], v[136:139]
    v_mfma_f32_16x16x32_bf16 v[140:143], v[76:79], v[44:47], v[140:143]
    v_add_u32 v8, 65536, v3
    v_add_u32 v9, 81920, v4
    v_add_u32 v10, 81920, v5
    v_add_u32 v11, 81920, v6
    v_add_u32 v12, 81920, v7
    ds_read_b128 v[32:35], v8 offset:0
    ds_read_b128 v[36:39], v8 offset:2048
    ds_read_b128 v[40:43], v8 offset:4096
    ds_read_b128 v[44:47], v8 offset:6144
    ds_read_b64_tr_b16 v[64:65], v9 offset:8192
    ds_read_b64_tr_b16 v[66:67], v9 offset:9216
    ds_read_b64_tr_b16 v[68:69], v10 offset:8192
    ds_read_b64_tr_b16 v[70:71], v10 offset:9216
    ds_read_b64_tr_b16 v[72:73], v11 offset:8192
    ds_read_b64_tr_b16 v[74:75], v11 offset:9216
    ds_read_b64_tr_b16 v[76:77], v12 offset:8192
    ds_read_b64_tr_b16 v[78:79], v12 offset:9216
    s_waitcnt lgkmcnt(12)
    v_mfma_f32_16x16x32_bf16 v[80:83], v[48:51], v[16:19], v[80:83]
    v_mfma_f32_16x16x32_bf16 v[84:87], v[52:55], v[16:19], v[84:87]
    v_mfma_f32_16x16x32_bf16 v[88:91], v[56:59], v[16:19], v[88:91]
    v_mfma_f32_16x16x32_bf16 v[92:95], v[60:63], v[16:19], v[92:95]
    v_mfma_f32_16x16x32_bf16 v[96:99], v[48:51], v[20:23], v[96:99]
    v_mfma_f32_16x16x32_bf16 v[100:103], v[52:55], v[20:23], v[100:103]
    v_mfma_f32_16x16x32_bf16 v[104:107], v[56:59], v[20:23], v[104:107]
    v_mfma_f32_16x16x32_bf16 v[108:111], v[60:63], v[20:23], v[108:111]
    v_mfma_f32_16x16x32_bf16 v[112:115], v[48:51], v[24:27], v[112:115]
    v_mfma_f32_16x16x32_bf16 v[116:119], v[52:55], v[24:27], v[116:119]
    v_mfma_f32_16x16x32_bf16 v[120:123], v[56:59], v[24:27], v[120:123]
    v_mfma_f32_16x16x32_bf16 v[124:127], v[60:63], v[24:27], v[124:127]
    v_mfma_f32_16x16x32_bf16 v[128:131], v[48:51], v[28:31], v[128:131]
    v_mfma_f32_16x16x32_bf16 v[132:135], v[52:55], v[28:31], v[132:135]
    v_mfma_f32_16x16x32_bf16 v[136:139], v[56:59], v[28:31], v[136:139]
    v_mfma_f32_16x16x32_bf16 v[140:143], v[60:63], v[28:31], v[140:143]
    s_waitcnt lgkmcnt(0)
    s_barrier
    v_add_u32 v8, 98304, v2
    v_add_u32 v9, 114688, v4
    v_add_u32 v10, 114688, v5
    v_add_u32 v11, 114688, v6
    v_add_u32 v12, 114688, v7
    ds_read_b128 v[16:19], v8 offset:0
    ds_read_b128 v[20:23], v8 offset:2048
    ds_read_b128 v[24:27], v8 offset:4096
    ds_read_b128 v[28:31], v8 offset:6144
    ds_read_b64_tr_b16 v[48:49], v9 offset:0
    ds_read_b64_tr_b16 v[50:51], v9 offset:1024
    ds_read_b64_tr_b16 v[52:53], v10 offset:0
    ds_read_b64_tr_b16 v[54:55], v10 offset:1024
    ds_read_b64_tr_b16 v[56:57], v11 offset:0
    ds_read_b64_tr_b16 v[58:59], v11 offset:1024
    ds_read_b64_tr_b16 v[60:61], v12 offset:0
    ds_read_b64_tr_b16 v[62:63], v12 offset:1024
    v_mfma_f32_16x16x32_bf16 v[80:83], v[64:67], v[32:35], v[80:83]
    v_mfma_f32_16x16x32_bf16 v[84:87], v[68:71], v[32:35], v[84:87]
    v_mfma_f32_16x16x32_bf16 v[88:91], v[72:75], v[32:35], v[88:91]
    v_mfma_f32_16x16x32_bf16 v[92:95], v[76:79], v[32:35], v[92:95]
    v_mfma_f32_16x16x32_bf16 v[96:99], v[64:67], v[36:39], v[96:99]
    v_mfma_f32_16x16x32_bf16 v[100:103], v[68:71], v[36:39], v[100:103]
    v_mfma_f32_16x16x32_bf16 v[104:107], v[72:75], v[36:39], v[104:107]
    v_mfma_f32_16x16x32_bf16 v[108:111], v[76:79], v[36:39], v[108:111]
    v_mfma_f32_16x16x32_bf16 v[112:115], v[64:67], v[40:43], v[112:115]
    v_mfma_f32_16x16x32_bf16 v[116:119], v[68:71], v[40:43], v[116:119]
    v_mfma_f32_16x16x32_bf16 v[120:123], v[72:75], v[40:43], v[120:123]
    v_mfma_f32_16x16x32_bf16 v[124:127], v[76:79], v[40:43], v[124:127]
    v_mfma_f32_16x16x32_bf16 v[128:131], v[64:67], v[44:47], v[128:131]
    v_mfma_f32_16x16x32_bf16 v[132:135], v[68:71], v[44:47], v[132:135]
    v_mfma_f32_16x16x32_bf16 v[136:139], v[72:75], v[44:47], v[136:139]
    v_mfma_f32_16x16x32_bf16 v[140:143], v[76:79], v[44:47], v[140:143]
    v_add_u32 v8, 98304, v3
    v_add_u32 v9, 114688, v4
    v_add_u32 v10, 114688, v5
    v_add_u32 v11, 114688, v6
    v_add_u32 v12, 114688, v7
    ds_read_b128 v[32:35], v8 offset:0
    ds_read_b128 v[36:39], v8 offset:2048
    ds_read_b128 v[40:43], v8 offset:4096
    ds_read_b128 v[44:47], v8 offset:6144
    ds_read_b64_tr_b16 v[64:65], v9 offset:8192
    ds_read_b64_tr_b16 v[66:67], v9 offset:9216
    ds_read_b64_tr_b16 v[68:69], v10 offset:8192
    ds_read_b64_tr_b16 v[70:71], v10 offset:9216
    ds_read_b64_tr_b16 v[72:73], v11 offset:8192
    ds_read_b64_tr_b16 v[74:75], v11 offset:9216
    ds_read_b64_tr_b16 v[76:77], v12 offset:8192
    ds_read_b64_tr_b16 v[78:79], v12 offset:9216
    s_waitcnt lgkmcnt(12)
    v_mfma_f32_16x16x32_bf16 v[80:83], v[48:51], v[16:19], v[80:83]
    v_mfma_f32_16x16x32_bf16 v[84:87], v[52:55], v[16:19], v[84:87]
    v_mfma_f32_16x16x32_bf16 v[88:91], v[56:59], v[16:19], v[88:91]
    v_mfma_f32_16x16x32_bf16 v[92:95], v[60:63], v[16:19], v[92:95]
    v_mfma_f32_16x16x32_bf16 v[96:99], v[48:51], v[20:23], v[96:99]
    v_mfma_f32_16x16x32_bf16 v[100:103], v[52:55], v[20:23], v[100:103]
    v_mfma_f32_16x16x32_bf16 v[104:107], v[56:59], v[20:23], v[104:107]
    v_mfma_f32_16x16x32_bf16 v[108:111], v[60:63], v[20:23], v[108:111]
    v_mfma_f32_16x16x32_bf16 v[112:115], v[48:51], v[24:27], v[112:115]
    v_mfma_f32_16x16x32_bf16 v[116:119], v[52:55], v[24:27], v[116:119]
    v_mfma_f32_16x16x32_bf16 v[120:123], v[56:59], v[24:27], v[120:123]
    v_mfma_f32_16x16x32_bf16 v[124:127], v[60:63], v[24:27], v[124:127]
    v_mfma_f32_16x16x32_bf16 v[128:131], v[48:51], v[28:31], v[128:131]
    v_mfma_f32_16x16x32_bf16 v[132:135], v[52:55], v[28:31], v[132:135]
    v_mfma_f32_16x16x32_bf16 v[136:139], v[56:59], v[28:31], v[136:139]
    v_mfma_f32_16x16x32_bf16 v[140:143], v[60:63], v[28:31], v[140:143]
    s_waitcnt lgkmcnt(0)
    s_barrier
    v_add_u32 v8, 0, v2
    v_add_u32 v9, 16384, v4
    v_add_u32 v10, 16384, v5
    v_add_u32 v11, 16384, v6
    v_add_u32 v12, 16384, v7
    ds_read_b128 v[16:19], v8 offset:0
    ds_read_b128 v[20:23], v8 offset:2048
    ds_read_b128 v[24:27], v8 offset:4096
    ds_read_b128 v[28:31], v8 offset:6144
    ds_read_b64_tr_b16 v[48:49], v9 offset:0
    ds_read_b64_tr_b16 v[50:51], v9 offset:1024
    ds_read_b64_tr_b16 v[52:53], v10 offset:0
    ds_read_b64_tr_b16 v[54:55], v10 offset:1024
    ds_read_b64_tr_b16 v[56:57], v11 offset:0
    ds_read_b64_tr_b16 v[58:59], v11 offset:1024
    ds_read_b64_tr_b16 v[60:61], v12 offset:0
    ds_read_b64_tr_b16 v[62:63], v12 offset:1024
    v_mfma_f32_16x16x32_bf16 v[80:83], v[64:67], v[32:35], v[80:83]
    v_mfma_f32_16x16x32_bf16 v[84:87], v[68:71], v[32:35], v[84:87]
    v_mfma_f32_16x16x32_bf16 v[88:91], v[72:75], v[32:35], v[88:91]
    v_mfma_f32_16x16x32_bf16 v[92:95], v[76:79], v[32:35], v[92:95]
    v_mfma_f32_16x16x32_bf16 v[96:99], v[64:67], v[36:39], v[96:99]
    v_mfma_f32_16x16x32_bf16 v[100:103], v[68:71], v[36:39], v[100:103]
    v_mfma_f32_16x16x32_bf16 v[104:107], v[72:75], v[36:39], v[104:107]
    v_mfma_f32_16x16x32_bf16 v[108:111], v[76:79], v[36:39], v[108:111]
    v_mfma_f32_16x16x32_bf16 v[112:115], v[64:67], v[40:43], v[112:115]
    v_mfma_f32_16x16x32_bf16 v[116:119], v[68:71], v[40:43], v[116:119]
    v_mfma_f32_16x16x32_bf16 v[120:123], v[72:75], v[40:43], v[120:123]
    v_mfma_f32_16x16x32_bf16 v[124:127], v[76:79], v[40:43], v[124:127]
    v_mfma_f32_16x16x32_bf16 v[128:131], v[64:67], v[44:47], v[128:131]
    v_mfma_f32_16x16x32_bf16 v[132:135], v[68:71], v[44:47], v[132:135]
    v_mfma_f32_16x16x32_bf16 v[136:139], v[72:75], v[44:47], v[136:139]
    v_mfma_f32_16x16x32_bf16 v[140:143], v[76:79], v[44:47], v[140:143]
    v_add_u32 v8, 0, v3
    v_add_u32 v9, 16384, v4
    v_add_u32 v10, 16384, v5
    v_add_u32 v11, 16384, v6
    v_add_u32 v12, 16384, v7
    ds_read_b128 v[32:35], v8 offset:0
    ds_read_b128 v[36:39], v8 offset:2048
    ds_read_b128 v[40:43], v8 offset:4096
    ds_read_b128 v[44:47], v8 offset:6144
    ds_read_b64_tr_b16 v[64:65], v9 offset:8192
    ds_read_b64_tr_b16 v[66:67], v9 offset:9216
    ds_read_b64_tr_b16 v[68:69], v10 offset:8192
    ds_read_b64_tr_b16 v[70:71], v10 offset:9216
    ds_read_b64_tr_b16 v[72:73], v11 offset:8192
    ds_read_b64_tr_b16 v[74:75], v11 offset:9216
    ds_read_b64_tr_b16 v[76:77], v12 offset:8192
    ds_read_b64_tr_b16 v[78:79], v12 offset:9216
    s_waitcnt lgkmcnt(12)
    v_mfma_f32_16x16x32_bf16 v[80:83], v[48:51], v[16:19], v[80:83]
    v_mfma_f32_16x16x32_bf16 v[84:87], v[52:55], v[16:19], v[84:87]
    v_mfma_f32_16x16x32_bf16 v[88:91], v[56:59], v[16:19], v[88:91]
    v_mfma_f32_16x16x32_bf16 v[92:95], v[60:63], v[16:19], v[92:95]
    v_mfma_f32_16x16x32_bf16 v[96:99], v[48:51], v[20:23], v[96:99]
    v_mfma_f32_16x16x32_bf16 v[100:103], v[52:55], v[20:23], v[100:103]
    v_mfma_f32_16x16x32_bf16 v[104:107], v[56:59], v[20:23], v[104:107]
    v_mfma_f32_16x16x32_bf16 v[108:111], v[60:63], v[20:23], v[108:111]
    v_mfma_f32_16x16x32_bf16 v[112:115], v[48:51], v[24:27], v[112:115]
    v_mfma_f32_16x16x32_bf16 v[116:119], v[52:55], v[24:27], v[116:119]
    v_mfma_f32_16x16x32_bf16 v[120:123], v[56:59], v[24:27], v[120:123]
    v_mfma_f32_16x16x32_bf16 v[124:127], v[60:63], v[24:27], v[124:127]
    v_mfma_f32_16x16x32_bf16 v[128:131], v[48:51], v[28:31], v[128:131]
    v_mfma_f32_16x16x32_bf16 v[132:135], v[52:55], v[28:31], v[132:135]
    v_mfma_f32_16x16x32_bf16 v[136:139], v[56:59], v[28:31], v[136:139]
    v_mfma_f32_16x16x32_bf16 v[140:143], v[60:63], v[28:31], v[140:143]
    s_waitcnt lgkmcnt(0)
    s_barrier
    v_add_u32 v8, 32768, v2
    v_add_u32 v9, 49152, v4
    v_add_u32 v10, 49152, v5
    v_add_u32 v11, 49152, v6
    v_add_u32 v12, 49152, v7
    ds_read_b128 v[16:19], v8 offset:0
    ds_read_b128 v[20:23], v8 offset:2048
    ds_read_b128 v[24:27], v8 offset:4096
    ds_read_b128 v[28:31], v8 offset:6144
    ds_read_b64_tr_b16 v[48:49], v9 offset:0
    ds_read_b64_tr_b16 v[50:51], v9 offset:1024
    ds_read_b64_tr_b16 v[52:53], v10 offset:0
    ds_read_b64_tr_b16 v[54:55], v10 offset:1024
    ds_read_b64_tr_b16 v[56:57], v11 offset:0
    ds_read_b64_tr_b16 v[58:59], v11 offset:1024
    ds_read_b64_tr_b16 v[60:61], v12 offset:0
    ds_read_b64_tr_b16 v[62:63], v12 offset:1024
    v_mfma_f32_16x16x32_bf16 v[80:83], v[64:67], v[32:35], v[80:83]
    v_mfma_f32_16x16x32_bf16 v[84:87], v[68:71], v[32:35], v[84:87]
    v_mfma_f32_16x16x32_bf16 v[88:91], v[72:75], v[32:35], v[88:91]
    v_mfma_f32_16x16x32_bf16 v[92:95], v[76:79], v[32:35], v[92:95]
    v_mfma_f32_16x16x32_bf16 v[96:99], v[64:67], v[36:39], v[96:99]
    v_mfma_f32_16x16x32_bf16 v[100:103], v[68:71], v[36:39], v[100:103]
    v_mfma_f32_16x16x32_bf16 v[104:107], v[72:75], v[36:39], v[104:107]
    v_mfma_f32_16x16x32_bf16 v[108:111], v[76:79], v[36:39], v[108:111]
    v_mfma_f32_16x16x32_bf16 v[112:115], v[64:67], v[40:43], v[112:115]
    v_mfma_f32_16x16x32_bf16 v[116:119], v[68:71], v[40:43], v[116:119]
    v_mfma_f32_16x16x32_bf16 v[120:123], v[72:75], v[40:43], v[120:123]
    v_mfma_f32_16x16x32_bf16 v[124:127], v[76:79], v[40:43], v[124:127]
    v_mfma_f32_16x16x32_bf16 v[128:131], v[64:67], v[44:47], v[128:131]
    v_mfma_f32_16x16x32_bf16 v[132:135], v[68:71], v[44:47], v[132:135]
    v_mfma_f32_16x16x32_bf16 v[136:139], v[72:75], v[44:47], v[136:139]
    v_mfma_f32_16x16x32_bf16 v[140:143], v[76:79], v[44:47], v[140:143]
    v_add_u32 v8, 32768, v3
    v_add_u32 v9, 49152, v4
    v_add_u32 v10, 49152, v5
    v_add_u32 v11, 49152, v6
    v_add_u32 v12, 49152, v7
    ds_read_b128 v[32:35], v8 offset:0
    ds_read_b128 v[36:39], v8 offset:2048
    ds_read_b128 v[40:43], v8 offset:4096
    ds_read_b128 v[44:47], v8 offset:6144
    ds_read_b64_tr_b16 v[64:65], v9 offset:8192
    ds_read_b64_tr_b16 v[66:67], v9 offset:9216
    ds_read_b64_tr_b16 v[68:69], v10 offset:8192
    ds_read_b64_tr_b16 v[70:71], v10 offset:9216
    ds_read_b64_tr_b16 v[72:73], v11 offset:8192
    ds_read_b64_tr_b16 v[74:75], v11 offset:9216
    ds_read_b64_tr_b16 v[76:77], v12 offset:8192
    ds_read_b64_tr_b16 v[78:79], v12 offset:9216
    s_waitcnt lgkmcnt(12)
    v_mfma_f32_16x16x32_bf16 v[80:83], v[48:51], v[16:19], v[80:83]
    v_mfma_f32_16x16x32_bf16 v[84:87], v[52:55], v[16:19], v[84:87]
    v_mfma_f32_16x16x32_bf16 v[88:91], v[56:59], v[16:19], v[88:91]
    v_mfma_f32_16x16x32_bf16 v[92:95], v[60:63], v[16:19], v[92:95]
    v_mfma_f32_16x16x32_bf16 v[96:99], v[48:51], v[20:23], v[96:99]
    v_mfma_f32_16x16x32_bf16 v[100:103], v[52:55], v[20:23], v[100:103]
    v_mfma_f32_16x16x32_bf16 v[104:107], v[56:59], v[20:23], v[104:107]
    v_mfma_f32_16x16x32_bf16 v[108:111], v[60:63], v[20:23], v[108:111]
    v_mfma_f32_16x16x32_bf16 v[112:115], v[48:51], v[24:27], v[112:115]
    v_mfma_f32_16x16x32_bf16 v[116:119], v[52:55], v[24:27], v[116:119]
    v_mfma_f32_16x16x32_bf16 v[120:123], v[56:59], v[24:27], v[120:123]
    v_mfma_f32_16x16x32_bf16 v[124:127], v[60:63], v[24:27], v[124:127]
    v_mfma_f32_16x16x32_bf16 v[128:131], v[48:51], v[28:31], v[128:131]
    v_mfma_f32_16x16x32_bf16 v[132:135], v[52:55], v[28:31], v[132:135]
    v_mfma_f32_16x16x32_bf16 v[136:139], v[56:59], v[28:31], v[136:139]
    v_mfma_f32_16x16x32_bf16 v[140:143], v[60:63], v[28:31], v[140:143]
    s_waitcnt lgkmcnt(0)
    v_mfma_f32_16x16x32_bf16 v[80:83], v[64:67], v[32:35], v[80:83]
    v_mfma_f32_16x16x32_bf16 v[84:87], v[68:71], v[32:35], v[84:87]
    v_mfma_f32_16x16x32_bf16 v[88:91], v[72:75], v[32:35], v[88:91]
    v_mfma_f32_16x16x32_bf16 v[92:95], v[76:79], v[32:35], v[92:95]
    v_mfma_f32_16x16x32_bf16 v[96:99], v[64:67], v[36:39], v[96:99]
    v_mfma_f32_16x16x32_bf16 v[100:103], v[68:71], v[36:39], v[100:103]
    v_mfma_f32_16x16x32_bf16 v[104:107], v[72:75], v[36:39], v[104:107]
    v_mfma_f32_16x16x32_bf16 v[108:111], v[76:79], v[36:39], v[108:111]
    v_mfma_f32_16x16x32_bf16 v[112:115], v[64:67], v[40:43], v[112:115]
    v_mfma_f32_16x16x32_bf16 v[116:119], v[68:71], v[40:43], v[116:119]
    v_mfma_f32_16x16x32_bf16 v[120:123], v[72:75], v[40:43], v[120:123]
    v_mfma_f32_16x16x32_bf16 v[124:127], v[76:79], v[40:43], v[124:127]
    v_mfma_f32_16x16x32_bf16 v[128:131], v[64:67], v[44:47], v[128:131]
    v_mfma_f32_16x16x32_bf16 v[132:135], v[68:71], v[44:47], v[132:135]
    v_mfma_f32_16x16x32_bf16 v[136:139], v[72:75], v[44:47], v[136:139]
    v_mfma_f32_16x16x32_bf16 v[140:143], v[76:79], v[44:47], v[140:143]
    s_nop 15
    s_branch k4_kernel_epi
k4_kernel_nm:
    v_subrev_u32 v2, 256, v0
    v_lshrrev_b32 v3, 3, v2
    v_and_b32 v4, 7, v2
    v_add_u32 v5, s24, v3
    s_mov_b32 s30, 1280
    v_mul_lo_u32 v5, v5, s30
    v_lshl_add_u32 v5, v4, 4, v5
    v_add_u32 v6, 40960, v5
    v_add_u32 v7, 81920, v5
    v_add_u32 v8, 122880, v5
    v_lshrrev_b32 v9, 1, v3
    v_and_b32 v9, 7, v9
    v_xor_b32 v9, v9, v4
    v_lshlrev_b32 v9, 4, v9
    v_lshl_add_u32 v9, v3, 7, v9
    v_lshlrev_b32 v10, 3, v3
    v_add_u32 v10, 131072, v10
    ds_read_b64 v[16:17], v10 offset:0
    ds_read_b64 v[18:19], v10 offset:256
    ds_read_b64 v[20:21], v10 offset:512
    ds_read_b64 v[22:23], v10 offset:768
    buffer_load_dwordx4 v[32:35], v5, s[8:11], 0 offen offset:0
    buffer_load_dwordx4 v[36:39], v6, s[8:11], 0 offen offset:0
    buffer_load_dwordx4 v[40:43], v7, s[8:11], 0 offen offset:0
    buffer_load_dwordx4 v[44:47], v8, s[8:11], 0 offen offset:0
    buffer_load_dwordx4 v[48:51], v5, s[8:11], 0 offen offset:128
    buffer_load_dwordx4 v[52:55], v6, s[8:11], 0 offen offset:128
    buffer_load_dwordx4 v[56:59], v7, s[8:11], 0 offen offset:128
    buffer_load_dwordx4 v[60:63], v8, s[8:11], 0 offen offset:128
    s_waitcnt lgkmcnt(0)
    s_waitcnt vmcnt(4)
    v_lshlrev_b32 v11, 16, v32
    v_and_b32 v12, 0xffff0000, v32
    v_sub_f32 v11, v11, v16
    v_sub_f32 v12, v12, v16
    v_cvt_pk_bf16_f32 v13, v11, v12
    v_lshlrev_b32 v11, 16, v13
    v_and_b32 v12, 0xffff0000, v13
    v_mul_f32 v11, v11, v17
    v_mul_f32 v12, v12, v17
    v_cvt_pk_bf16_f32 v32, v11, v12
    v_lshlrev_b32 v11, 16, v33
    v_and_b32 v12, 0xffff0000, v33
    v_sub_f32 v11, v11, v16
    v_sub_f32 v12, v12, v16
    v_cvt_pk_bf16_f32 v13, v11, v12
    v_lshlrev_b32 v11, 16, v13
    v_and_b32 v12, 0xffff0000, v13
    v_mul_f32 v11, v11, v17
    v_mul_f32 v12, v12, v17
    v_cvt_pk_bf16_f32 v33, v11, v12
    v_lshlrev_b32 v11, 16, v34
    v_and_b32 v12, 0xffff0000, v34
    v_sub_f32 v11, v11, v16
    v_sub_f32 v12, v12, v16
    v_cvt_pk_bf16_f32 v13, v11, v12
    v_lshlrev_b32 v11, 16, v13
    v_and_b32 v12, 0xffff0000, v13
    v_mul_f32 v11, v11, v17
    v_mul_f32 v12, v12, v17
    v_cvt_pk_bf16_f32 v34, v11, v12
    v_lshlrev_b32 v11, 16, v35
    v_and_b32 v12, 0xffff0000, v35
    v_sub_f32 v11, v11, v16
    v_sub_f32 v12, v12, v16
    v_cvt_pk_bf16_f32 v13, v11, v12
    v_lshlrev_b32 v11, 16, v13
    v_and_b32 v12, 0xffff0000, v13
    v_mul_f32 v11, v11, v17
    v_mul_f32 v12, v12, v17
    v_cvt_pk_bf16_f32 v35, v11, v12
    v_add_u32 v14, 0, v9
    ds_write_b128 v14, v[32:35]
    v_lshlrev_b32 v11, 16, v36
    v_and_b32 v12, 0xffff0000, v36
    v_sub_f32 v11, v11, v18
    v_sub_f32 v12, v12, v18
    v_cvt_pk_bf16_f32 v13, v11, v12
    v_lshlrev_b32 v11, 16, v13
    v_and_b32 v12, 0xffff0000, v13
    v_mul_f32 v11, v11, v19
    v_mul_f32 v12, v12, v19
    v_cvt_pk_bf16_f32 v36, v11, v12
    v_lshlrev_b32 v11, 16, v37
    v_and_b32 v12, 0xffff0000, v37
    v_sub_f32 v11, v11, v18
    v_sub_f32 v12, v12, v18
    v_cvt_pk_bf16_f32 v13, v11, v12
    v_lshlrev_b32 v11, 16, v13
    v_and_b32 v12, 0xffff0000, v13
    v_mul_f32 v11, v11, v19
    v_mul_f32 v12, v12, v19
    v_cvt_pk_bf16_f32 v37, v11, v12
    v_lshlrev_b32 v11, 16, v38
    v_and_b32 v12, 0xffff0000, v38
    v_sub_f32 v11, v11, v18
    v_sub_f32 v12, v12, v18
    v_cvt_pk_bf16_f32 v13, v11, v12
    v_lshlrev_b32 v11, 16, v13
    v_and_b32 v12, 0xffff0000, v13
    v_mul_f32 v11, v11, v19
    v_mul_f32 v12, v12, v19
    v_cvt_pk_bf16_f32 v38, v11, v12
    v_lshlrev_b32 v11, 16, v39
    v_and_b32 v12, 0xffff0000, v39
    v_sub_f32 v11, v11, v18
    v_sub_f32 v12, v12, v18
    v_cvt_pk_bf16_f32 v13, v11, v12
    v_lshlrev_b32 v11, 16, v13
    v_and_b32 v12, 0xffff0000, v13
    v_mul_f32 v11, v11, v19
    v_mul_f32 v12, v12, v19
    v_cvt_pk_bf16_f32 v39, v11, v12
    v_add_u32 v14, 4096, v9
    ds_write_b128 v14, v[36:39]
    v_lshlrev_b32 v11, 16, v40
    v_and_b32 v12, 0xffff0000, v40
    v_sub_f32 v11, v11, v20
    v_sub_f32 v12, v12, v20
    v_cvt_pk_bf16_f32 v13, v11, v12
    v_lshlrev_b32 v11, 16, v13
    v_and_b32 v12, 0xffff0000, v13
    v_mul_f32 v11, v11, v21
    v_mul_f32 v12, v12, v21
    v_cvt_pk_bf16_f32 v40, v11, v12
    v_lshlrev_b32 v11, 16, v41
    v_and_b32 v12, 0xffff0000, v41
    v_sub_f32 v11, v11, v20
    v_sub_f32 v12, v12, v20
    v_cvt_pk_bf16_f32 v13, v11, v12
    v_lshlrev_b32 v11, 16, v13
    v_and_b32 v12, 0xffff0000, v13
    v_mul_f32 v11, v11, v21
    v_mul_f32 v12, v12, v21
    v_cvt_pk_bf16_f32 v41, v11, v12
    v_lshlrev_b32 v11, 16, v42
    v_and_b32 v12, 0xffff0000, v42
    v_sub_f32 v11, v11, v20
    v_sub_f32 v12, v12, v20
    v_cvt_pk_bf16_f32 v13, v11, v12
    v_lshlrev_b32 v11, 16, v13
    v_and_b32 v12, 0xffff0000, v13
    v_mul_f32 v11, v11, v21
    v_mul_f32 v12, v12, v21
    v_cvt_pk_bf16_f32 v42, v11, v12
    v_lshlrev_b32 v11, 16, v43
    v_and_b32 v12, 0xffff0000, v43
    v_sub_f32 v11, v11, v20
    v_sub_f32 v12, v12, v20
    v_cvt_pk_bf16_f32 v13, v11, v12
    v_lshlrev_b32 v11, 16, v13
    v_and_b32 v12, 0xffff0000, v13
    v_mul_f32 v11, v11, v21
    v_mul_f32 v12, v12, v21
    v_cvt_pk_bf16_f32 v43, v11, v12
    v_add_u32 v14, 8192, v9
    ds_write_b128 v14, v[40:43]
    v_lshlrev_b32 v11, 16, v44
    v_and_b32 v12, 0xffff0000, v44
    v_sub_f32 v11, v11, v22
    v_sub_f32 v12, v12, v22
    v_cvt_pk_bf16_f32 v13, v11, v12
    v_lshlrev_b32 v11, 16, v13
    v_and_b32 v12, 0xffff0000, v13
    v_mul_f32 v11, v11, v23
    v_mul_f32 v12, v12, v23
    v_cvt_pk_bf16_f32 v44, v11, v12
    v_lshlrev_b32 v11, 16, v45
    v_and_b32 v12, 0xffff0000, v45
    v_sub_f32 v11, v11, v22
    v_sub_f32 v12, v12, v22
    v_cvt_pk_bf16_f32 v13, v11, v12
    v_lshlrev_b32 v11, 16, v13
    v_and_b32 v12, 0xffff0000, v13
    v_mul_f32 v11, v11, v23
    v_mul_f32 v12, v12, v23
    v_cvt_pk_bf16_f32 v45, v11, v12
    v_lshlrev_b32 v11, 16, v46
    v_and_b32 v12, 0xffff0000, v46
    v_sub_f32 v11, v11, v22
    v_sub_f32 v12, v12, v22
    v_cvt_pk_bf16_f32 v13, v11, v12
    v_lshlrev_b32 v11, 16, v13
    v_and_b32 v12, 0xffff0000, v13
    v_mul_f32 v11, v11, v23
    v_mul_f32 v12, v12, v23
    v_cvt_pk_bf16_f32 v46, v11, v12
    v_lshlrev_b32 v11, 16, v47
    v_and_b32 v12, 0xffff0000, v47
    v_sub_f32 v11, v11, v22
    v_sub_f32 v12, v12, v22
    v_cvt_pk_bf16_f32 v13, v11, v12
    v_lshlrev_b32 v11, 16, v13
    v_and_b32 v12, 0xffff0000, v13
    v_mul_f32 v11, v11, v23
    v_mul_f32 v12, v12, v23
    v_cvt_pk_bf16_f32 v47, v11, v12
    v_add_u32 v14, 12288, v9
    ds_write_b128 v14, v[44:47]
    s_waitcnt lgkmcnt(0)
    buffer_load_dwordx4 v[32:35], v5, s[8:11], 0 offen offset:256
    buffer_load_dwordx4 v[36:39], v6, s[8:11], 0 offen offset:256
    buffer_load_dwordx4 v[40:43], v7, s[8:11], 0 offen offset:256
    buffer_load_dwordx4 v[44:47], v8, s[8:11], 0 offen offset:256
    s_waitcnt vmcnt(4)
    v_lshlrev_b32 v11, 16, v48
    v_and_b32 v12, 0xffff0000, v48
    v_sub_f32 v11, v11, v16
    v_sub_f32 v12, v12, v16
    v_cvt_pk_bf16_f32 v13, v11, v12
    v_lshlrev_b32 v11, 16, v13
    v_and_b32 v12, 0xffff0000, v13
    v_mul_f32 v11, v11, v17
    v_mul_f32 v12, v12, v17
    v_cvt_pk_bf16_f32 v48, v11, v12
    v_lshlrev_b32 v11, 16, v49
    v_and_b32 v12, 0xffff0000, v49
    v_sub_f32 v11, v11, v16
    v_sub_f32 v12, v12, v16
    v_cvt_pk_bf16_f32 v13, v11, v12
    v_lshlrev_b32 v11, 16, v13
    v_and_b32 v12, 0xffff0000, v13
    v_mul_f32 v11, v11, v17
    v_mul_f32 v12, v12, v17
    v_cvt_pk_bf16_f32 v49, v11, v12
    v_lshlrev_b32 v11, 16, v50
    v_and_b32 v12, 0xffff0000, v50
    v_sub_f32 v11, v11, v16
    v_sub_f32 v12, v12, v16
    v_cvt_pk_bf16_f32 v13, v11, v12
    v_lshlrev_b32 v11, 16, v13
    v_and_b32 v12, 0xffff0000, v13
    v_mul_f32 v11, v11, v17
    v_mul_f32 v12, v12, v17
    v_cvt_pk_bf16_f32 v50, v11, v12
    v_lshlrev_b32 v11, 16, v51
    v_and_b32 v12, 0xffff0000, v51
    v_sub_f32 v11, v11, v16
    v_sub_f32 v12, v12, v16
    v_cvt_pk_bf16_f32 v13, v11, v12
    v_lshlrev_b32 v11, 16, v13
    v_and_b32 v12, 0xffff0000, v13
    v_mul_f32 v11, v11, v17
    v_mul_f32 v12, v12, v17
    v_cvt_pk_bf16_f32 v51, v11, v12
    v_add_u32 v14, 32768, v9
    ds_write_b128 v14, v[48:51]
    v_lshlrev_b32 v11, 16, v52
    v_and_b32 v12, 0xffff0000, v52
    v_sub_f32 v11, v11, v18
    v_sub_f32 v12, v12, v18
    v_cvt_pk_bf16_f32 v13, v11, v12
    v_lshlrev_b32 v11, 16, v13
    v_and_b32 v12, 0xffff0000, v13
    v_mul_f32 v11, v11, v19
    v_mul_f32 v12, v12, v19
    v_cvt_pk_bf16_f32 v52, v11, v12
    v_lshlrev_b32 v11, 16, v53
    v_and_b32 v12, 0xffff0000, v53
    v_sub_f32 v11, v11, v18
    v_sub_f32 v12, v12, v18
    v_cvt_pk_bf16_f32 v13, v11, v12
    v_lshlrev_b32 v11, 16, v13
    v_and_b32 v12, 0xffff0000, v13
    v_mul_f32 v11, v11, v19
    v_mul_f32 v12, v12, v19
    v_cvt_pk_bf16_f32 v53, v11, v12
    v_lshlrev_b32 v11, 16, v54
    v_and_b32 v12, 0xffff0000, v54
    v_sub_f32 v11, v11, v18
    v_sub_f32 v12, v12, v18
    v_cvt_pk_bf16_f32 v13, v11, v12
    v_lshlrev_b32 v11, 16, v13
    v_and_b32 v12, 0xffff0000, v13
    v_mul_f32 v11, v11, v19
    v_mul_f32 v12, v12, v19
    v_cvt_pk_bf16_f32 v54, v11, v12
    v_lshlrev_b32 v11, 16, v55
    v_and_b32 v12, 0xffff0000, v55
    v_sub_f32 v11, v11, v18
    v_sub_f32 v12, v12, v18
    v_cvt_pk_bf16_f32 v13, v11, v12
    v_lshlrev_b32 v11, 16, v13
    v_and_b32 v12, 0xffff0000, v13
    v_mul_f32 v11, v11, v19
    v_mul_f32 v12, v12, v19
    v_cvt_pk_bf16_f32 v55, v11, v12
    v_add_u32 v14, 36864, v9
    ds_write_b128 v14, v[52:55]
    v_lshlrev_b32 v11, 16, v56
    v_and_b32 v12, 0xffff0000, v56
    v_sub_f32 v11, v11, v20
    v_sub_f32 v12, v12, v20
    v_cvt_pk_bf16_f32 v13, v11, v12
    v_lshlrev_b32 v11, 16, v13
    v_and_b32 v12, 0xffff0000, v13
    v_mul_f32 v11, v11, v21
    v_mul_f32 v12, v12, v21
    v_cvt_pk_bf16_f32 v56, v11, v12
    v_lshlrev_b32 v11, 16, v57
    v_and_b32 v12, 0xffff0000, v57
    v_sub_f32 v11, v11, v20
    v_sub_f32 v12, v12, v20
    v_cvt_pk_bf16_f32 v13, v11, v12
    v_lshlrev_b32 v11, 16, v13
    v_and_b32 v12, 0xffff0000, v13
    v_mul_f32 v11, v11, v21
    v_mul_f32 v12, v12, v21
    v_cvt_pk_bf16_f32 v57, v11, v12
    v_lshlrev_b32 v11, 16, v58
    v_and_b32 v12, 0xffff0000, v58
    v_sub_f32 v11, v11, v20
    v_sub_f32 v12, v12, v20
    v_cvt_pk_bf16_f32 v13, v11, v12
    v_lshlrev_b32 v11, 16, v13
    v_and_b32 v12, 0xffff0000, v13
    v_mul_f32 v11, v11, v21
    v_mul_f32 v12, v12, v21
    v_cvt_pk_bf16_f32 v58, v11, v12
    v_lshlrev_b32 v11, 16, v59
    v_and_b32 v12, 0xffff0000, v59
    v_sub_f32 v11, v11, v20
    v_sub_f32 v12, v12, v20
    v_cvt_pk_bf16_f32 v13, v11, v12
    v_lshlrev_b32 v11, 16, v13
    v_and_b32 v12, 0xffff0000, v13
    v_mul_f32 v11, v11, v21
    v_mul_f32 v12, v12, v21
    v_cvt_pk_bf16_f32 v59, v11, v12
    v_add_u32 v14, 40960, v9
    ds_write_b128 v14, v[56:59]
    v_lshlrev_b32 v11, 16, v60
    v_and_b32 v12, 0xffff0000, v60
    v_sub_f32 v11, v11, v22
    v_sub_f32 v12, v12, v22
    v_cvt_pk_bf16_f32 v13, v11, v12
    v_lshlrev_b32 v11, 16, v13
    v_and_b32 v12, 0xffff0000, v13
    v_mul_f32 v11, v11, v23
    v_mul_f32 v12, v12, v23
    v_cvt_pk_bf16_f32 v60, v11, v12
    v_lshlrev_b32 v11, 16, v61
    v_and_b32 v12, 0xffff0000, v61
    v_sub_f32 v11, v11, v22
    v_sub_f32 v12, v12, v22
    v_cvt_pk_bf16_f32 v13, v11, v12
    v_lshlrev_b32 v11, 16, v13
    v_and_b32 v12, 0xffff0000, v13
    v_mul_f32 v11, v11, v23
    v_mul_f32 v12, v12, v23
    v_cvt_pk_bf16_f32 v61, v11, v12
    v_lshlrev_b32 v11, 16, v62
    v_and_b32 v12, 0xffff0000, v62
    v_sub_f32 v11, v11, v22
    v_sub_f32 v12, v12, v22
    v_cvt_pk_bf16_f32 v13, v11, v12
    v_lshlrev_b32 v11, 16, v13
    v_and_b32 v12, 0xffff0000, v13
    v_mul_f32 v11, v11, v23
    v_mul_f32 v12, v12, v23
    v_cvt_pk_bf16_f32 v62, v11, v12
    v_lshlrev_b32 v11, 16, v63
    v_and_b32 v12, 0xffff0000, v63
    v_sub_f32 v11, v11, v22
    v_sub_f32 v12, v12, v22
    v_cvt_pk_bf16_f32 v13, v11, v12
    v_lshlrev_b32 v11, 16, v13
    v_and_b32 v12, 0xffff0000, v13
    v_mul_f32 v11, v11, v23
    v_mul_f32 v12, v12, v23
    v_cvt_pk_bf16_f32 v63, v11, v12
    v_add_u32 v14, 45056, v9
    ds_write_b128 v14, v[60:63]
    s_waitcnt lgkmcnt(0)
    buffer_load_dwordx4 v[48:51], v5, s[8:11], 0 offen offset:384
    buffer_load_dwordx4 v[52:55], v6, s[8:11], 0 offen offset:384
    buffer_load_dwordx4 v[56:59], v7, s[8:11], 0 offen offset:384
    buffer_load_dwordx4 v[60:63], v8, s[8:11], 0 offen offset:384
    s_waitcnt vmcnt(4)
    v_lshlrev_b32 v11, 16, v32
    v_and_b32 v12, 0xffff0000, v32
    v_sub_f32 v11, v11, v16
    v_sub_f32 v12, v12, v16
    v_cvt_pk_bf16_f32 v13, v11, v12
    v_lshlrev_b32 v11, 16, v13
    v_and_b32 v12, 0xffff0000, v13
    v_mul_f32 v11, v11, v17
    v_mul_f32 v12, v12, v17
    v_cvt_pk_bf16_f32 v32, v11, v12
    v_lshlrev_b32 v11, 16, v33
    v_and_b32 v12, 0xffff0000, v33
    v_sub_f32 v11, v11, v16
    v_sub_f32 v12, v12, v16
    v_cvt_pk_bf16_f32 v13, v11, v12
    v_lshlrev_b32 v11, 16, v13
    v_and_b32 v12, 0xffff0000, v13
    v_mul_f32 v11, v11, v17
    v_mul_f32 v12, v12, v17
    v_cvt_pk_bf16_f32 v33, v11, v12
    v_lshlrev_b32 v11, 16, v34
    v_and_b32 v12, 0xffff0000, v34
    v_sub_f32 v11, v11, v16
    v_sub_f32 v12, v12, v16
    v_cvt_pk_bf16_f32 v13, v11, v12
    v_lshlrev_b32 v11, 16, v13
    v_and_b32 v12, 0xffff0000, v13
    v_mul_f32 v11, v11, v17
    v_mul_f32 v12, v12, v17
    v_cvt_pk_bf16_f32 v34, v11, v12
    v_lshlrev_b32 v11, 16, v35
    v_and_b32 v12, 0xffff0000, v35
    v_sub_f32 v11, v11, v16
    v_sub_f32 v12, v12, v16
    v_cvt_pk_bf16_f32 v13, v11, v12
    v_lshlrev_b32 v11, 16, v13
    v_and_b32 v12, 0xffff0000, v13
    v_mul_f32 v11, v11, v17
    v_mul_f32 v12, v12, v17
    v_cvt_pk_bf16_f32 v35, v11, v12
    v_add_u32 v14, 65536, v9
    ds_write_b128 v14, v[32:35]
    v_lshlrev_b32 v11, 16, v36
    v_and_b32 v12, 0xffff0000, v36
    v_sub_f32 v11, v11, v18
    v_sub_f32 v12, v12, v18
    v_cvt_pk_bf16_f32 v13, v11, v12
    v_lshlrev_b32 v11, 16, v13
    v_and_b32 v12, 0xffff0000, v13
    v_mul_f32 v11, v11, v19
    v_mul_f32 v12, v12, v19
    v_cvt_pk_bf16_f32 v36, v11, v12
    v_lshlrev_b32 v11, 16, v37
    v_and_b32 v12, 0xffff0000, v37
    v_sub_f32 v11, v11, v18
    v_sub_f32 v12, v12, v18
    v_cvt_pk_bf16_f32 v13, v11, v12
    v_lshlrev_b32 v11, 16, v13
    v_and_b32 v12, 0xffff0000, v13
    v_mul_f32 v11, v11, v19
    v_mul_f32 v12, v12, v19
    v_cvt_pk_bf16_f32 v37, v11, v12
    v_lshlrev_b32 v11, 16, v38
    v_and_b32 v12, 0xffff0000, v38
    v_sub_f32 v11, v11, v18
    v_sub_f32 v12, v12, v18
    v_cvt_pk_bf16_f32 v13, v11, v12
    v_lshlrev_b32 v11, 16, v13
    v_and_b32 v12, 0xffff0000, v13
    v_mul_f32 v11, v11, v19
    v_mul_f32 v12, v12, v19
    v_cvt_pk_bf16_f32 v38, v11, v12
    v_lshlrev_b32 v11, 16, v39
    v_and_b32 v12, 0xffff0000, v39
    v_sub_f32 v11, v11, v18
    v_sub_f32 v12, v12, v18
    v_cvt_pk_bf16_f32 v13, v11, v12
    v_lshlrev_b32 v11, 16, v13
    v_and_b32 v12, 0xffff0000, v13
    v_mul_f32 v11, v11, v19
    v_mul_f32 v12, v12, v19
    v_cvt_pk_bf16_f32 v39, v11, v12
    v_add_u32 v14, 69632, v9
    ds_write_b128 v14, v[36:39]
    v_lshlrev_b32 v11, 16, v40
    v_and_b32 v12, 0xffff0000, v40
    v_sub_f32 v11, v11, v20
    v_sub_f32 v12, v12, v20
    v_cvt_pk_bf16_f32 v13, v11, v12
    v_lshlrev_b32 v11, 16, v13
    v_and_b32 v12, 0xffff0000, v13
    v_mul_f32 v11, v11, v21
    v_mul_f32 v12, v12, v21
    v_cvt_pk_bf16_f32 v40, v11, v12
    v_lshlrev_b32 v11, 16, v41
    v_and_b32 v12, 0xffff0000, v41
    v_sub_f32 v11, v11, v20
    v_sub_f32 v12, v12, v20
    v_cvt_pk_bf16_f32 v13, v11, v12
    v_lshlrev_b32 v11, 16, v13
    v_and_b32 v12, 0xffff0000, v13
    v_mul_f32 v11, v11, v21
    v_mul_f32 v12, v12, v21
    v_cvt_pk_bf16_f32 v41, v11, v12
    v_lshlrev_b32 v11, 16, v42
    v_and_b32 v12, 0xffff0000, v42
    v_sub_f32 v11, v11, v20
    v_sub_f32 v12, v12, v20
    v_cvt_pk_bf16_f32 v13, v11, v12
    v_lshlrev_b32 v11, 16, v13
    v_and_b32 v12, 0xffff0000, v13
    v_mul_f32 v11, v11, v21
    v_mul_f32 v12, v12, v21
    v_cvt_pk_bf16_f32 v42, v11, v12
    v_lshlrev_b32 v11, 16, v43
    v_and_b32 v12, 0xffff0000, v43
    v_sub_f32 v11, v11, v20
    v_sub_f32 v12, v12, v20
    v_cvt_pk_bf16_f32 v13, v11, v12
    v_lshlrev_b32 v11, 16, v13
    v_and_b32 v12, 0xffff0000, v13
    v_mul_f32 v11, v11, v21
    v_mul_f32 v12, v12, v21
    v_cvt_pk_bf16_f32 v43, v11, v12
    v_add_u32 v14, 73728, v9
    ds_write_b128 v14, v[40:43]
    v_lshlrev_b32 v11, 16, v44
    v_and_b32 v12, 0xffff0000, v44
    v_sub_f32 v11, v11, v22
    v_sub_f32 v12, v12, v22
    v_cvt_pk_bf16_f32 v13, v11, v12
    v_lshlrev_b32 v11, 16, v13
    v_and_b32 v12, 0xffff0000, v13
    v_mul_f32 v11, v11, v23
    v_mul_f32 v12, v12, v23
    v_cvt_pk_bf16_f32 v44, v11, v12
    v_lshlrev_b32 v11, 16, v45
    v_and_b32 v12, 0xffff0000, v45
    v_sub_f32 v11, v11, v22
    v_sub_f32 v12, v12, v22
    v_cvt_pk_bf16_f32 v13, v11, v12
    v_lshlrev_b32 v11, 16, v13
    v_and_b32 v12, 0xffff0000, v13
    v_mul_f32 v11, v11, v23
    v_mul_f32 v12, v12, v23
    v_cvt_pk_bf16_f32 v45, v11, v12
    v_lshlrev_b32 v11, 16, v46
    v_and_b32 v12, 0xffff0000, v46
    v_sub_f32 v11, v11, v22
    v_sub_f32 v12, v12, v22
    v_cvt_pk_bf16_f32 v13, v11, v12
    v_lshlrev_b32 v11, 16, v13
    v_and_b32 v12, 0xffff0000, v13
    v_mul_f32 v11, v11, v23
    v_mul_f32 v12, v12, v23
    v_cvt_pk_bf16_f32 v46, v11, v12
    v_lshlrev_b32 v11, 16, v47
    v_and_b32 v12, 0xffff0000, v47
    v_sub_f32 v11, v11, v22
    v_sub_f32 v12, v12, v22
    v_cvt_pk_bf16_f32 v13, v11, v12
    v_lshlrev_b32 v11, 16, v13
    v_and_b32 v12, 0xffff0000, v13
    v_mul_f32 v11, v11, v23
    v_mul_f32 v12, v12, v23
    v_cvt_pk_bf16_f32 v47, v11, v12
    v_add_u32 v14, 77824, v9
    ds_write_b128 v14, v[44:47]
    s_waitcnt lgkmcnt(0)
    buffer_load_dwordx4 v[32:35], v5, s[8:11], 0 offen offset:512
    buffer_load_dwordx4 v[36:39], v6, s[8:11], 0 offen offset:512
    buffer_load_dwordx4 v[40:43], v7, s[8:11], 0 offen offset:512
    buffer_load_dwordx4 v[44:47], v8, s[8:11], 0 offen offset:512
    s_waitcnt lgkmcnt(0)
    s_barrier
    s_waitcnt vmcnt(4)
    v_lshlrev_b32 v11, 16, v48
    v_and_b32 v12, 0xffff0000, v48
    v_sub_f32 v11, v11, v16
    v_sub_f32 v12, v12, v16
    v_cvt_pk_bf16_f32 v13, v11, v12
    v_lshlrev_b32 v11, 16, v13
    v_and_b32 v12, 0xffff0000, v13
    v_mul_f32 v11, v11, v17
    v_mul_f32 v12, v12, v17
    v_cvt_pk_bf16_f32 v48, v11, v12
    v_lshlrev_b32 v11, 16, v49
    v_and_b32 v12, 0xffff0000, v49
    v_sub_f32 v11, v11, v16
    v_sub_f32 v12, v12, v16
    v_cvt_pk_bf16_f32 v13, v11, v12
    v_lshlrev_b32 v11, 16, v13
    v_and_b32 v12, 0xffff0000, v13
    v_mul_f32 v11, v11, v17
    v_mul_f32 v12, v12, v17
    v_cvt_pk_bf16_f32 v49, v11, v12
    v_lshlrev_b32 v11, 16, v50
    v_and_b32 v12, 0xffff0000, v50
    v_sub_f32 v11, v11, v16
    v_sub_f32 v12, v12, v16
    v_cvt_pk_bf16_f32 v13, v11, v12
    v_lshlrev_b32 v11, 16, v13
    v_and_b32 v12, 0xffff0000, v13
    v_mul_f32 v11, v11, v17
    v_mul_f32 v12, v12, v17
    v_cvt_pk_bf16_f32 v50, v11, v12
    v_lshlrev_b32 v11, 16, v51
    v_and_b32 v12, 0xffff0000, v51
    v_sub_f32 v11, v11, v16
    v_sub_f32 v12, v12, v16
    v_cvt_pk_bf16_f32 v13, v11, v12
    v_lshlrev_b32 v11, 16, v13
    v_and_b32 v12, 0xffff0000, v13
    v_mul_f32 v11, v11, v17
    v_mul_f32 v12, v12, v17
    v_cvt_pk_bf16_f32 v51, v11, v12
    v_add_u32 v14, 98304, v9
    ds_write_b128 v14, v[48:51]
    v_lshlrev_b32 v11, 16, v52
    v_and_b32 v12, 0xffff0000, v52
    v_sub_f32 v11, v11, v18
    v_sub_f32 v12, v12, v18
    v_cvt_pk_bf16_f32 v13, v11, v12
    v_lshlrev_b32 v11, 16, v13
    v_and_b32 v12, 0xffff0000, v13
    v_mul_f32 v11, v11, v19
    v_mul_f32 v12, v12, v19
    v_cvt_pk_bf16_f32 v52, v11, v12
    v_lshlrev_b32 v11, 16, v53
    v_and_b32 v12, 0xffff0000, v53
    v_sub_f32 v11, v11, v18
    v_sub_f32 v12, v12, v18
    v_cvt_pk_bf16_f32 v13, v11, v12
    v_lshlrev_b32 v11, 16, v13
    v_and_b32 v12, 0xffff0000, v13
    v_mul_f32 v11, v11, v19
    v_mul_f32 v12, v12, v19
    v_cvt_pk_bf16_f32 v53, v11, v12
    v_lshlrev_b32 v11, 16, v54
    v_and_b32 v12, 0xffff0000, v54
    v_sub_f32 v11, v11, v18
    v_sub_f32 v12, v12, v18
    v_cvt_pk_bf16_f32 v13, v11, v12
    v_lshlrev_b32 v11, 16, v13
    v_and_b32 v12, 0xffff0000, v13
    v_mul_f32 v11, v11, v19
    v_mul_f32 v12, v12, v19
    v_cvt_pk_bf16_f32 v54, v11, v12
    v_lshlrev_b32 v11, 16, v55
    v_and_b32 v12, 0xffff0000, v55
    v_sub_f32 v11, v11, v18
    v_sub_f32 v12, v12, v18
    v_cvt_pk_bf16_f32 v13, v11, v12
    v_lshlrev_b32 v11, 16, v13
    v_and_b32 v12, 0xffff0000, v13
    v_mul_f32 v11, v11, v19
    v_mul_f32 v12, v12, v19
    v_cvt_pk_bf16_f32 v55, v11, v12
    v_add_u32 v14, 102400, v9
    ds_write_b128 v14, v[52:55]
    v_lshlrev_b32 v11, 16, v56
    v_and_b32 v12, 0xffff0000, v56
    v_sub_f32 v11, v11, v20
    v_sub_f32 v12, v12, v20
    v_cvt_pk_bf16_f32 v13, v11, v12
    v_lshlrev_b32 v11, 16, v13
    v_and_b32 v12, 0xffff0000, v13
    v_mul_f32 v11, v11, v21
    v_mul_f32 v12, v12, v21
    v_cvt_pk_bf16_f32 v56, v11, v12
    v_lshlrev_b32 v11, 16, v57
    v_and_b32 v12, 0xffff0000, v57
    v_sub_f32 v11, v11, v20
    v_sub_f32 v12, v12, v20
    v_cvt_pk_bf16_f32 v13, v11, v12
    v_lshlrev_b32 v11, 16, v13
    v_and_b32 v12, 0xffff0000, v13
    v_mul_f32 v11, v11, v21
    v_mul_f32 v12, v12, v21
    v_cvt_pk_bf16_f32 v57, v11, v12
    v_lshlrev_b32 v11, 16, v58
    v_and_b32 v12, 0xffff0000, v58
    v_sub_f32 v11, v11, v20
    v_sub_f32 v12, v12, v20
    v_cvt_pk_bf16_f32 v13, v11, v12
    v_lshlrev_b32 v11, 16, v13
    v_and_b32 v12, 0xffff0000, v13
    v_mul_f32 v11, v11, v21
    v_mul_f32 v12, v12, v21
    v_cvt_pk_bf16_f32 v58, v11, v12
    v_lshlrev_b32 v11, 16, v59
    v_and_b32 v12, 0xffff0000, v59
    v_sub_f32 v11, v11, v20
    v_sub_f32 v12, v12, v20
    v_cvt_pk_bf16_f32 v13, v11, v12
    v_lshlrev_b32 v11, 16, v13
    v_and_b32 v12, 0xffff0000, v13
    v_mul_f32 v11, v11, v21
    v_mul_f32 v12, v12, v21
    v_cvt_pk_bf16_f32 v59, v11, v12
    v_add_u32 v14, 106496, v9
    ds_write_b128 v14, v[56:59]
    v_lshlrev_b32 v11, 16, v60
    v_and_b32 v12, 0xffff0000, v60
    v_sub_f32 v11, v11, v22
    v_sub_f32 v12, v12, v22
    v_cvt_pk_bf16_f32 v13, v11, v12
    v_lshlrev_b32 v11, 16, v13
    v_and_b32 v12, 0xffff0000, v13
    v_mul_f32 v11, v11, v23
    v_mul_f32 v12, v12, v23
    v_cvt_pk_bf16_f32 v60, v11, v12
    v_lshlrev_b32 v11, 16, v61
    v_and_b32 v12, 0xffff0000, v61
    v_sub_f32 v11, v11, v22
    v_sub_f32 v12, v12, v22
    v_cvt_pk_bf16_f32 v13, v11, v12
    v_lshlrev_b32 v11, 16, v13
    v_and_b32 v12, 0xffff0000, v13
    v_mul_f32 v11, v11, v23
    v_mul_f32 v12, v12, v23
    v_cvt_pk_bf16_f32 v61, v11, v12
    v_lshlrev_b32 v11, 16, v62
    v_and_b32 v12, 0xffff0000, v62
    v_sub_f32 v11, v11, v22
    v_sub_f32 v12, v12, v22
    v_cvt_pk_bf16_f32 v13, v11, v12
    v_lshlrev_b32 v11, 16, v13
    v_and_b32 v12, 0xffff0000, v13
    v_mul_f32 v11, v11, v23
    v_mul_f32 v12, v12, v23
    v_cvt_pk_bf16_f32 v62, v11, v12
    v_lshlrev_b32 v11, 16, v63
    v_and_b32 v12, 0xffff0000, v63
    v_sub_f32 v11, v11, v22
    v_sub_f32 v12, v12, v22
    v_cvt_pk_bf16_f32 v13, v11, v12
    v_lshlrev_b32 v11, 16, v13
    v_and_b32 v12, 0xffff0000, v13
    v_mul_f32 v11, v11, v23
    v_mul_f32 v12, v12, v23
    v_cvt_pk_bf16_f32 v63, v11, v12
    v_add_u32 v14, 110592, v9
    ds_write_b128 v14, v[60:63]
    s_waitcnt lgkmcnt(0)
    buffer_load_dwordx4 v[48:51], v5, s[8:11], 0 offen offset:640
    buffer_load_dwordx4 v[52:55], v6, s[8:11], 0 offen offset:640
    buffer_load_dwordx4 v[56:59], v7, s[8:11], 0 offen offset:640
    buffer_load_dwordx4 v[60:63], v8, s[8:11], 0 offen offset:640
    s_waitcnt lgkmcnt(0)
    s_barrier
    s_waitcnt vmcnt(4)
    v_lshlrev_b32 v11, 16, v32
    v_and_b32 v12, 0xffff0000, v32
    v_sub_f32 v11, v11, v16
    v_sub_f32 v12, v12, v16
    v_cvt_pk_bf16_f32 v13, v11, v12
    v_lshlrev_b32 v11, 16, v13
    v_and_b32 v12, 0xffff0000, v13
    v_mul_f32 v11, v11, v17
    v_mul_f32 v12, v12, v17
    v_cvt_pk_bf16_f32 v32, v11, v12
    v_lshlrev_b32 v11, 16, v33
    v_and_b32 v12, 0xffff0000, v33
    v_sub_f32 v11, v11, v16
    v_sub_f32 v12, v12, v16
    v_cvt_pk_bf16_f32 v13, v11, v12
    v_lshlrev_b32 v11, 16, v13
    v_and_b32 v12, 0xffff0000, v13
    v_mul_f32 v11, v11, v17
    v_mul_f32 v12, v12, v17
    v_cvt_pk_bf16_f32 v33, v11, v12
    v_lshlrev_b32 v11, 16, v34
    v_and_b32 v12, 0xffff0000, v34
    v_sub_f32 v11, v11, v16
    v_sub_f32 v12, v12, v16
    v_cvt_pk_bf16_f32 v13, v11, v12
    v_lshlrev_b32 v11, 16, v13
    v_and_b32 v12, 0xffff0000, v13
    v_mul_f32 v11, v11, v17
    v_mul_f32 v12, v12, v17
    v_cvt_pk_bf16_f32 v34, v11, v12
    v_lshlrev_b32 v11, 16, v35
    v_and_b32 v12, 0xffff0000, v35
    v_sub_f32 v11, v11, v16
    v_sub_f32 v12, v12, v16
    v_cvt_pk_bf16_f32 v13, v11, v12
    v_lshlrev_b32 v11, 16, v13
    v_and_b32 v12, 0xffff0000, v13
    v_mul_f32 v11, v11, v17
    v_mul_f32 v12, v12, v17
    v_cvt_pk_bf16_f32 v35, v11, v12
    v_add_u32 v14, 0, v9
    ds_write_b128 v14, v[32:35]
    v_lshlrev_b32 v11, 16, v36
    v_and_b32 v12, 0xffff0000, v36
    v_sub_f32 v11, v11, v18
    v_sub_f32 v12, v12, v18
    v_cvt_pk_bf16_f32 v13, v11, v12
    v_lshlrev_b32 v11, 16, v13
    v_and_b32 v12, 0xffff0000, v13
    v_mul_f32 v11, v11, v19
    v_mul_f32 v12, v12, v19
    v_cvt_pk_bf16_f32 v36, v11, v12
    v_lshlrev_b32 v11, 16, v37
    v_and_b32 v12, 0xffff0000, v37
    v_sub_f32 v11, v11, v18
    v_sub_f32 v12, v12, v18
    v_cvt_pk_bf16_f32 v13, v11, v12
    v_lshlrev_b32 v11, 16, v13
    v_and_b32 v12, 0xffff0000, v13
    v_mul_f32 v11, v11, v19
    v_mul_f32 v12, v12, v19
    v_cvt_pk_bf16_f32 v37, v11, v12
    v_lshlrev_b32 v11, 16, v38
    v_and_b32 v12, 0xffff0000, v38
    v_sub_f32 v11, v11, v18
    v_sub_f32 v12, v12, v18
    v_cvt_pk_bf16_f32 v13, v11, v12
    v_lshlrev_b32 v11, 16, v13
    v_and_b32 v12, 0xffff0000, v13
    v_mul_f32 v11, v11, v19
    v_mul_f32 v12, v12, v19
    v_cvt_pk_bf16_f32 v38, v11, v12
    v_lshlrev_b32 v11, 16, v39
    v_and_b32 v12, 0xffff0000, v39
    v_sub_f32 v11, v11, v18
    v_sub_f32 v12, v12, v18
    v_cvt_pk_bf16_f32 v13, v11, v12
    v_lshlrev_b32 v11, 16, v13
    v_and_b32 v12, 0xffff0000, v13
    v_mul_f32 v11, v11, v19
    v_mul_f32 v12, v12, v19
    v_cvt_pk_bf16_f32 v39, v11, v12
    v_add_u32 v14, 4096, v9
    ds_write_b128 v14, v[36:39]
    v_lshlrev_b32 v11, 16, v40
    v_and_b32 v12, 0xffff0000, v40
    v_sub_f32 v11, v11, v20
    v_sub_f32 v12, v12, v20
    v_cvt_pk_bf16_f32 v13, v11, v12
    v_lshlrev_b32 v11, 16, v13
    v_and_b32 v12, 0xffff0000, v13
    v_mul_f32 v11, v11, v21
    v_mul_f32 v12, v12, v21
    v_cvt_pk_bf16_f32 v40, v11, v12
    v_lshlrev_b32 v11, 16, v41
    v_and_b32 v12, 0xffff0000, v41
    v_sub_f32 v11, v11, v20
    v_sub_f32 v12, v12, v20
    v_cvt_pk_bf16_f32 v13, v11, v12
    v_lshlrev_b32 v11, 16, v13
    v_and_b32 v12, 0xffff0000, v13
    v_mul_f32 v11, v11, v21
    v_mul_f32 v12, v12, v21
    v_cvt_pk_bf16_f32 v41, v11, v12
    v_lshlrev_b32 v11, 16, v42
    v_and_b32 v12, 0xffff0000, v42
    v_sub_f32 v11, v11, v20
    v_sub_f32 v12, v12, v20
    v_cvt_pk_bf16_f32 v13, v11, v12
    v_lshlrev_b32 v11, 16, v13
    v_and_b32 v12, 0xffff0000, v13
    v_mul_f32 v11, v11, v21
    v_mul_f32 v12, v12, v21
    v_cvt_pk_bf16_f32 v42, v11, v12
    v_lshlrev_b32 v11, 16, v43
    v_and_b32 v12, 0xffff0000, v43
    v_sub_f32 v11, v11, v20
    v_sub_f32 v12, v12, v20
    v_cvt_pk_bf16_f32 v13, v11, v12
    v_lshlrev_b32 v11, 16, v13
    v_and_b32 v12, 0xffff0000, v13
    v_mul_f32 v11, v11, v21
    v_mul_f32 v12, v12, v21
    v_cvt_pk_bf16_f32 v43, v11, v12
    v_add_u32 v14, 8192, v9
    ds_write_b128 v14, v[40:43]
    v_lshlrev_b32 v11, 16, v44
    v_and_b32 v12, 0xffff0000, v44
    v_sub_f32 v11, v11, v22
    v_sub_f32 v12, v12, v22
    v_cvt_pk_bf16_f32 v13, v11, v12
    v_lshlrev_b32 v11, 16, v13
    v_and_b32 v12, 0xffff0000, v13
    v_mul_f32 v11, v11, v23
    v_mul_f32 v12, v12, v23
    v_cvt_pk_bf16_f32 v44, v11, v12
    v_lshlrev_b32 v11, 16, v45
    v_and_b32 v12, 0xffff0000, v45
    v_sub_f32 v11, v11, v22
    v_sub_f32 v12, v12, v22
    v_cvt_pk_bf16_f32 v13, v11, v12
    v_lshlrev_b32 v11, 16, v13
    v_and_b32 v12, 0xffff0000, v13
    v_mul_f32 v11, v11, v23
    v_mul_f32 v12, v12, v23
    v_cvt_pk_bf16_f32 v45, v11, v12
    v_lshlrev_b32 v11, 16, v46
    v_and_b32 v12, 0xffff0000, v46
    v_sub_f32 v11, v11, v22
    v_sub_f32 v12, v12, v22
    v_cvt_pk_bf16_f32 v13, v11, v12
    v_lshlrev_b32 v11, 16, v13
    v_and_b32 v12, 0xffff0000, v13
    v_mul_f32 v11, v11, v23
    v_mul_f32 v12, v12, v23
    v_cvt_pk_bf16_f32 v46, v11, v12
    v_lshlrev_b32 v11, 16, v47
    v_and_b32 v12, 0xffff0000, v47
    v_sub_f32 v11, v11, v22
    v_sub_f32 v12, v12, v22
    v_cvt_pk_bf16_f32 v13, v11, v12
    v_lshlrev_b32 v11, 16, v13
    v_and_b32 v12, 0xffff0000, v13
    v_mul_f32 v11, v11, v23
    v_mul_f32 v12, v12, v23
    v_cvt_pk_bf16_f32 v47, v11, v12
    v_add_u32 v14, 12288, v9
    ds_write_b128 v14, v[44:47]
    s_waitcnt lgkmcnt(0)
    buffer_load_dwordx4 v[32:35], v5, s[8:11], 0 offen offset:768
    buffer_load_dwordx4 v[36:39], v6, s[8:11], 0 offen offset:768
    buffer_load_dwordx4 v[40:43], v7, s[8:11], 0 offen offset:768
    buffer_load_dwordx4 v[44:47], v8, s[8:11], 0 offen offset:768
    s_waitcnt lgkmcnt(0)
    s_barrier
    s_waitcnt vmcnt(4)
    v_lshlrev_b32 v11, 16, v48
    v_and_b32 v12, 0xffff0000, v48
    v_sub_f32 v11, v11, v16
    v_sub_f32 v12, v12, v16
    v_cvt_pk_bf16_f32 v13, v11, v12
    v_lshlrev_b32 v11, 16, v13
    v_and_b32 v12, 0xffff0000, v13
    v_mul_f32 v11, v11, v17
    v_mul_f32 v12, v12, v17
    v_cvt_pk_bf16_f32 v48, v11, v12
    v_lshlrev_b32 v11, 16, v49
    v_and_b32 v12, 0xffff0000, v49
    v_sub_f32 v11, v11, v16
    v_sub_f32 v12, v12, v16
    v_cvt_pk_bf16_f32 v13, v11, v12
    v_lshlrev_b32 v11, 16, v13
    v_and_b32 v12, 0xffff0000, v13
    v_mul_f32 v11, v11, v17
    v_mul_f32 v12, v12, v17
    v_cvt_pk_bf16_f32 v49, v11, v12
    v_lshlrev_b32 v11, 16, v50
    v_and_b32 v12, 0xffff0000, v50
    v_sub_f32 v11, v11, v16
    v_sub_f32 v12, v12, v16
    v_cvt_pk_bf16_f32 v13, v11, v12
    v_lshlrev_b32 v11, 16, v13
    v_and_b32 v12, 0xffff0000, v13
    v_mul_f32 v11, v11, v17
    v_mul_f32 v12, v12, v17
    v_cvt_pk_bf16_f32 v50, v11, v12
    v_lshlrev_b32 v11, 16, v51
    v_and_b32 v12, 0xffff0000, v51
    v_sub_f32 v11, v11, v16
    v_sub_f32 v12, v12, v16
    v_cvt_pk_bf16_f32 v13, v11, v12
    v_lshlrev_b32 v11, 16, v13
    v_and_b32 v12, 0xffff0000, v13
    v_mul_f32 v11, v11, v17
    v_mul_f32 v12, v12, v17
    v_cvt_pk_bf16_f32 v51, v11, v12
    v_add_u32 v14, 32768, v9
    ds_write_b128 v14, v[48:51]
    v_lshlrev_b32 v11, 16, v52
    v_and_b32 v12, 0xffff0000, v52
    v_sub_f32 v11, v11, v18
    v_sub_f32 v12, v12, v18
    v_cvt_pk_bf16_f32 v13, v11, v12
    v_lshlrev_b32 v11, 16, v13
    v_and_b32 v12, 0xffff0000, v13
    v_mul_f32 v11, v11, v19
    v_mul_f32 v12, v12, v19
    v_cvt_pk_bf16_f32 v52, v11, v12
    v_lshlrev_b32 v11, 16, v53
    v_and_b32 v12, 0xffff0000, v53
    v_sub_f32 v11, v11, v18
    v_sub_f32 v12, v12, v18
    v_cvt_pk_bf16_f32 v13, v11, v12
    v_lshlrev_b32 v11, 16, v13
    v_and_b32 v12, 0xffff0000, v13
    v_mul_f32 v11, v11, v19
    v_mul_f32 v12, v12, v19
    v_cvt_pk_bf16_f32 v53, v11, v12
    v_lshlrev_b32 v11, 16, v54
    v_and_b32 v12, 0xffff0000, v54
    v_sub_f32 v11, v11, v18
    v_sub_f32 v12, v12, v18
    v_cvt_pk_bf16_f32 v13, v11, v12
    v_lshlrev_b32 v11, 16, v13
    v_and_b32 v12, 0xffff0000, v13
    v_mul_f32 v11, v11, v19
    v_mul_f32 v12, v12, v19
    v_cvt_pk_bf16_f32 v54, v11, v12
    v_lshlrev_b32 v11, 16, v55
    v_and_b32 v12, 0xffff0000, v55
    v_sub_f32 v11, v11, v18
    v_sub_f32 v12, v12, v18
    v_cvt_pk_bf16_f32 v13, v11, v12
    v_lshlrev_b32 v11, 16, v13
    v_and_b32 v12, 0xffff0000, v13
    v_mul_f32 v11, v11, v19
    v_mul_f32 v12, v12, v19
    v_cvt_pk_bf16_f32 v55, v11, v12
    v_add_u32 v14, 36864, v9
    ds_write_b128 v14, v[52:55]
    v_lshlrev_b32 v11, 16, v56
    v_and_b32 v12, 0xffff0000, v56
    v_sub_f32 v11, v11, v20
    v_sub_f32 v12, v12, v20
    v_cvt_pk_bf16_f32 v13, v11, v12
    v_lshlrev_b32 v11, 16, v13
    v_and_b32 v12, 0xffff0000, v13
    v_mul_f32 v11, v11, v21
    v_mul_f32 v12, v12, v21
    v_cvt_pk_bf16_f32 v56, v11, v12
    v_lshlrev_b32 v11, 16, v57
    v_and_b32 v12, 0xffff0000, v57
    v_sub_f32 v11, v11, v20
    v_sub_f32 v12, v12, v20
    v_cvt_pk_bf16_f32 v13, v11, v12
    v_lshlrev_b32 v11, 16, v13
    v_and_b32 v12, 0xffff0000, v13
    v_mul_f32 v11, v11, v21
    v_mul_f32 v12, v12, v21
    v_cvt_pk_bf16_f32 v57, v11, v12
    v_lshlrev_b32 v11, 16, v58
    v_and_b32 v12, 0xffff0000, v58
    v_sub_f32 v11, v11, v20
    v_sub_f32 v12, v12, v20
    v_cvt_pk_bf16_f32 v13, v11, v12
    v_lshlrev_b32 v11, 16, v13
    v_and_b32 v12, 0xffff0000, v13
    v_mul_f32 v11, v11, v21
    v_mul_f32 v12, v12, v21
    v_cvt_pk_bf16_f32 v58, v11, v12
    v_lshlrev_b32 v11, 16, v59
    v_and_b32 v12, 0xffff0000, v59
    v_sub_f32 v11, v11, v20
    v_sub_f32 v12, v12, v20
    v_cvt_pk_bf16_f32 v13, v11, v12
    v_lshlrev_b32 v11, 16, v13
    v_and_b32 v12, 0xffff0000, v13
    v_mul_f32 v11, v11, v21
    v_mul_f32 v12, v12, v21
    v_cvt_pk_bf16_f32 v59, v11, v12
    v_add_u32 v14, 40960, v9
    ds_write_b128 v14, v[56:59]
    v_lshlrev_b32 v11, 16, v60
    v_and_b32 v12, 0xffff0000, v60
    v_sub_f32 v11, v11, v22
    v_sub_f32 v12, v12, v22
    v_cvt_pk_bf16_f32 v13, v11, v12
    v_lshlrev_b32 v11, 16, v13
    v_and_b32 v12, 0xffff0000, v13
    v_mul_f32 v11, v11, v23
    v_mul_f32 v12, v12, v23
    v_cvt_pk_bf16_f32 v60, v11, v12
    v_lshlrev_b32 v11, 16, v61
    v_and_b32 v12, 0xffff0000, v61
    v_sub_f32 v11, v11, v22
    v_sub_f32 v12, v12, v22
    v_cvt_pk_bf16_f32 v13, v11, v12
    v_lshlrev_b32 v11, 16, v13
    v_and_b32 v12, 0xffff0000, v13
    v_mul_f32 v11, v11, v23
    v_mul_f32 v12, v12, v23
    v_cvt_pk_bf16_f32 v61, v11, v12
    v_lshlrev_b32 v11, 16, v62
    v_and_b32 v12, 0xffff0000, v62
    v_sub_f32 v11, v11, v22
    v_sub_f32 v12, v12, v22
    v_cvt_pk_bf16_f32 v13, v11, v12
    v_lshlrev_b32 v11, 16, v13
    v_and_b32 v12, 0xffff0000, v13
    v_mul_f32 v11, v11, v23
    v_mul_f32 v12, v12, v23
    v_cvt_pk_bf16_f32 v62, v11, v12
    v_lshlrev_b32 v11, 16, v63
    v_and_b32 v12, 0xffff0000, v63
    v_sub_f32 v11, v11, v22
    v_sub_f32 v12, v12, v22
    v_cvt_pk_bf16_f32 v13, v11, v12
    v_lshlrev_b32 v11, 16, v13
    v_and_b32 v12, 0xffff0000, v13
    v_mul_f32 v11, v11, v23
    v_mul_f32 v12, v12, v23
    v_cvt_pk_bf16_f32 v63, v11, v12
    v_add_u32 v14, 45056, v9
    ds_write_b128 v14, v[60:63]
    s_waitcnt lgkmcnt(0)
    buffer_load_dwordx4 v[48:51], v5, s[8:11], 0 offen offset:896
    buffer_load_dwordx4 v[52:55], v6, s[8:11], 0 offen offset:896
    buffer_load_dwordx4 v[56:59], v7, s[8:11], 0 offen offset:896
    buffer_load_dwordx4 v[60:63], v8, s[8:11], 0 offen offset:896
    s_waitcnt lgkmcnt(0)
    s_barrier
    s_waitcnt vmcnt(4)
    v_lshlrev_b32 v11, 16, v32
    v_and_b32 v12, 0xffff0000, v32
    v_sub_f32 v11, v11, v16
    v_sub_f32 v12, v12, v16
    v_cvt_pk_bf16_f32 v13, v11, v12
    v_lshlrev_b32 v11, 16, v13
    v_and_b32 v12, 0xffff0000, v13
    v_mul_f32 v11, v11, v17
    v_mul_f32 v12, v12, v17
    v_cvt_pk_bf16_f32 v32, v11, v12
    v_lshlrev_b32 v11, 16, v33
    v_and_b32 v12, 0xffff0000, v33
    v_sub_f32 v11, v11, v16
    v_sub_f32 v12, v12, v16
    v_cvt_pk_bf16_f32 v13, v11, v12
    v_lshlrev_b32 v11, 16, v13
    v_and_b32 v12, 0xffff0000, v13
    v_mul_f32 v11, v11, v17
    v_mul_f32 v12, v12, v17
    v_cvt_pk_bf16_f32 v33, v11, v12
    v_lshlrev_b32 v11, 16, v34
    v_and_b32 v12, 0xffff0000, v34
    v_sub_f32 v11, v11, v16
    v_sub_f32 v12, v12, v16
    v_cvt_pk_bf16_f32 v13, v11, v12
    v_lshlrev_b32 v11, 16, v13
    v_and_b32 v12, 0xffff0000, v13
    v_mul_f32 v11, v11, v17
    v_mul_f32 v12, v12, v17
    v_cvt_pk_bf16_f32 v34, v11, v12
    v_lshlrev_b32 v11, 16, v35
    v_and_b32 v12, 0xffff0000, v35
    v_sub_f32 v11, v11, v16
    v_sub_f32 v12, v12, v16
    v_cvt_pk_bf16_f32 v13, v11, v12
    v_lshlrev_b32 v11, 16, v13
    v_and_b32 v12, 0xffff0000, v13
    v_mul_f32 v11, v11, v17
    v_mul_f32 v12, v12, v17
    v_cvt_pk_bf16_f32 v35, v11, v12
    v_add_u32 v14, 65536, v9
    ds_write_b128 v14, v[32:35]
    v_lshlrev_b32 v11, 16, v36
    v_and_b32 v12, 0xffff0000, v36
    v_sub_f32 v11, v11, v18
    v_sub_f32 v12, v12, v18
    v_cvt_pk_bf16_f32 v13, v11, v12
    v_lshlrev_b32 v11, 16, v13
    v_and_b32 v12, 0xffff0000, v13
    v_mul_f32 v11, v11, v19
    v_mul_f32 v12, v12, v19
    v_cvt_pk_bf16_f32 v36, v11, v12
    v_lshlrev_b32 v11, 16, v37
    v_and_b32 v12, 0xffff0000, v37
    v_sub_f32 v11, v11, v18
    v_sub_f32 v12, v12, v18
    v_cvt_pk_bf16_f32 v13, v11, v12
    v_lshlrev_b32 v11, 16, v13
    v_and_b32 v12, 0xffff0000, v13
    v_mul_f32 v11, v11, v19
    v_mul_f32 v12, v12, v19
    v_cvt_pk_bf16_f32 v37, v11, v12
    v_lshlrev_b32 v11, 16, v38
    v_and_b32 v12, 0xffff0000, v38
    v_sub_f32 v11, v11, v18
    v_sub_f32 v12, v12, v18
    v_cvt_pk_bf16_f32 v13, v11, v12
    v_lshlrev_b32 v11, 16, v13
    v_and_b32 v12, 0xffff0000, v13
    v_mul_f32 v11, v11, v19
    v_mul_f32 v12, v12, v19
    v_cvt_pk_bf16_f32 v38, v11, v12
    v_lshlrev_b32 v11, 16, v39
    v_and_b32 v12, 0xffff0000, v39
    v_sub_f32 v11, v11, v18
    v_sub_f32 v12, v12, v18
    v_cvt_pk_bf16_f32 v13, v11, v12
    v_lshlrev_b32 v11, 16, v13
    v_and_b32 v12, 0xffff0000, v13
    v_mul_f32 v11, v11, v19
    v_mul_f32 v12, v12, v19
    v_cvt_pk_bf16_f32 v39, v11, v12
    v_add_u32 v14, 69632, v9
    ds_write_b128 v14, v[36:39]
    v_lshlrev_b32 v11, 16, v40
    v_and_b32 v12, 0xffff0000, v40
    v_sub_f32 v11, v11, v20
    v_sub_f32 v12, v12, v20
    v_cvt_pk_bf16_f32 v13, v11, v12
    v_lshlrev_b32 v11, 16, v13
    v_and_b32 v12, 0xffff0000, v13
    v_mul_f32 v11, v11, v21
    v_mul_f32 v12, v12, v21
    v_cvt_pk_bf16_f32 v40, v11, v12
    v_lshlrev_b32 v11, 16, v41
    v_and_b32 v12, 0xffff0000, v41
    v_sub_f32 v11, v11, v20
    v_sub_f32 v12, v12, v20
    v_cvt_pk_bf16_f32 v13, v11, v12
    v_lshlrev_b32 v11, 16, v13
    v_and_b32 v12, 0xffff0000, v13
    v_mul_f32 v11, v11, v21
    v_mul_f32 v12, v12, v21
    v_cvt_pk_bf16_f32 v41, v11, v12
    v_lshlrev_b32 v11, 16, v42
    v_and_b32 v12, 0xffff0000, v42
    v_sub_f32 v11, v11, v20
    v_sub_f32 v12, v12, v20
    v_cvt_pk_bf16_f32 v13, v11, v12
    v_lshlrev_b32 v11, 16, v13
    v_and_b32 v12, 0xffff0000, v13
    v_mul_f32 v11, v11, v21
    v_mul_f32 v12, v12, v21
    v_cvt_pk_bf16_f32 v42, v11, v12
    v_lshlrev_b32 v11, 16, v43
    v_and_b32 v12, 0xffff0000, v43
    v_sub_f32 v11, v11, v20
    v_sub_f32 v12, v12, v20
    v_cvt_pk_bf16_f32 v13, v11, v12
    v_lshlrev_b32 v11, 16, v13
    v_and_b32 v12, 0xffff0000, v13
    v_mul_f32 v11, v11, v21
    v_mul_f32 v12, v12, v21
    v_cvt_pk_bf16_f32 v43, v11, v12
    v_add_u32 v14, 73728, v9
    ds_write_b128 v14, v[40:43]
    v_lshlrev_b32 v11, 16, v44
    v_and_b32 v12, 0xffff0000, v44
    v_sub_f32 v11, v11, v22
    v_sub_f32 v12, v12, v22
    v_cvt_pk_bf16_f32 v13, v11, v12
    v_lshlrev_b32 v11, 16, v13
    v_and_b32 v12, 0xffff0000, v13
    v_mul_f32 v11, v11, v23
    v_mul_f32 v12, v12, v23
    v_cvt_pk_bf16_f32 v44, v11, v12
    v_lshlrev_b32 v11, 16, v45
    v_and_b32 v12, 0xffff0000, v45
    v_sub_f32 v11, v11, v22
    v_sub_f32 v12, v12, v22
    v_cvt_pk_bf16_f32 v13, v11, v12
    v_lshlrev_b32 v11, 16, v13
    v_and_b32 v12, 0xffff0000, v13
    v_mul_f32 v11, v11, v23
    v_mul_f32 v12, v12, v23
    v_cvt_pk_bf16_f32 v45, v11, v12
    v_lshlrev_b32 v11, 16, v46
    v_and_b32 v12, 0xffff0000, v46
    v_sub_f32 v11, v11, v22
    v_sub_f32 v12, v12, v22
    v_cvt_pk_bf16_f32 v13, v11, v12
    v_lshlrev_b32 v11, 16, v13
    v_and_b32 v12, 0xffff0000, v13
    v_mul_f32 v11, v11, v23
    v_mul_f32 v12, v12, v23
    v_cvt_pk_bf16_f32 v46, v11, v12
    v_lshlrev_b32 v11, 16, v47
    v_and_b32 v12, 0xffff0000, v47
    v_sub_f32 v11, v11, v22
    v_sub_f32 v12, v12, v22
    v_cvt_pk_bf16_f32 v13, v11, v12
    v_lshlrev_b32 v11, 16, v13
    v_and_b32 v12, 0xffff0000, v13
    v_mul_f32 v11, v11, v23
    v_mul_f32 v12, v12, v23
    v_cvt_pk_bf16_f32 v47, v11, v12
    v_add_u32 v14, 77824, v9
    ds_write_b128 v14, v[44:47]
    s_waitcnt lgkmcnt(0)
    buffer_load_dwordx4 v[32:35], v5, s[8:11], 0 offen offset:1024
    buffer_load_dwordx4 v[36:39], v6, s[8:11], 0 offen offset:1024
    buffer_load_dwordx4 v[40:43], v7, s[8:11], 0 offen offset:1024
    buffer_load_dwordx4 v[44:47], v8, s[8:11], 0 offen offset:1024
    s_waitcnt lgkmcnt(0)
    s_barrier
    s_waitcnt vmcnt(4)
    v_lshlrev_b32 v11, 16, v48
    v_and_b32 v12, 0xffff0000, v48
    v_sub_f32 v11, v11, v16
    v_sub_f32 v12, v12, v16
    v_cvt_pk_bf16_f32 v13, v11, v12
    v_lshlrev_b32 v11, 16, v13
    v_and_b32 v12, 0xffff0000, v13
    v_mul_f32 v11, v11, v17
    v_mul_f32 v12, v12, v17
    v_cvt_pk_bf16_f32 v48, v11, v12
    v_lshlrev_b32 v11, 16, v49
    v_and_b32 v12, 0xffff0000, v49
    v_sub_f32 v11, v11, v16
    v_sub_f32 v12, v12, v16
    v_cvt_pk_bf16_f32 v13, v11, v12
    v_lshlrev_b32 v11, 16, v13
    v_and_b32 v12, 0xffff0000, v13
    v_mul_f32 v11, v11, v17
    v_mul_f32 v12, v12, v17
    v_cvt_pk_bf16_f32 v49, v11, v12
    v_lshlrev_b32 v11, 16, v50
    v_and_b32 v12, 0xffff0000, v50
    v_sub_f32 v11, v11, v16
    v_sub_f32 v12, v12, v16
    v_cvt_pk_bf16_f32 v13, v11, v12
    v_lshlrev_b32 v11, 16, v13
    v_and_b32 v12, 0xffff0000, v13
    v_mul_f32 v11, v11, v17
    v_mul_f32 v12, v12, v17
    v_cvt_pk_bf16_f32 v50, v11, v12
    v_lshlrev_b32 v11, 16, v51
    v_and_b32 v12, 0xffff0000, v51
    v_sub_f32 v11, v11, v16
    v_sub_f32 v12, v12, v16
    v_cvt_pk_bf16_f32 v13, v11, v12
    v_lshlrev_b32 v11, 16, v13
    v_and_b32 v12, 0xffff0000, v13
    v_mul_f32 v11, v11, v17
    v_mul_f32 v12, v12, v17
    v_cvt_pk_bf16_f32 v51, v11, v12
    v_add_u32 v14, 98304, v9
    ds_write_b128 v14, v[48:51]
    v_lshlrev_b32 v11, 16, v52
    v_and_b32 v12, 0xffff0000, v52
    v_sub_f32 v11, v11, v18
    v_sub_f32 v12, v12, v18
    v_cvt_pk_bf16_f32 v13, v11, v12
    v_lshlrev_b32 v11, 16, v13
    v_and_b32 v12, 0xffff0000, v13
    v_mul_f32 v11, v11, v19
    v_mul_f32 v12, v12, v19
    v_cvt_pk_bf16_f32 v52, v11, v12
    v_lshlrev_b32 v11, 16, v53
    v_and_b32 v12, 0xffff0000, v53
    v_sub_f32 v11, v11, v18
    v_sub_f32 v12, v12, v18
    v_cvt_pk_bf16_f32 v13, v11, v12
    v_lshlrev_b32 v11, 16, v13
    v_and_b32 v12, 0xffff0000, v13
    v_mul_f32 v11, v11, v19
    v_mul_f32 v12, v12, v19
    v_cvt_pk_bf16_f32 v53, v11, v12
    v_lshlrev_b32 v11, 16, v54
    v_and_b32 v12, 0xffff0000, v54
    v_sub_f32 v11, v11, v18
    v_sub_f32 v12, v12, v18
    v_cvt_pk_bf16_f32 v13, v11, v12
    v_lshlrev_b32 v11, 16, v13
    v_and_b32 v12, 0xffff0000, v13
    v_mul_f32 v11, v11, v19
    v_mul_f32 v12, v12, v19
    v_cvt_pk_bf16_f32 v54, v11, v12
    v_lshlrev_b32 v11, 16, v55
    v_and_b32 v12, 0xffff0000, v55
    v_sub_f32 v11, v11, v18
    v_sub_f32 v12, v12, v18
    v_cvt_pk_bf16_f32 v13, v11, v12
    v_lshlrev_b32 v11, 16, v13
    v_and_b32 v12, 0xffff0000, v13
    v_mul_f32 v11, v11, v19
    v_mul_f32 v12, v12, v19
    v_cvt_pk_bf16_f32 v55, v11, v12
    v_add_u32 v14, 102400, v9
    ds_write_b128 v14, v[52:55]
    v_lshlrev_b32 v11, 16, v56
    v_and_b32 v12, 0xffff0000, v56
    v_sub_f32 v11, v11, v20
    v_sub_f32 v12, v12, v20
    v_cvt_pk_bf16_f32 v13, v11, v12
    v_lshlrev_b32 v11, 16, v13
    v_and_b32 v12, 0xffff0000, v13
    v_mul_f32 v11, v11, v21
    v_mul_f32 v12, v12, v21
    v_cvt_pk_bf16_f32 v56, v11, v12
    v_lshlrev_b32 v11, 16, v57
    v_and_b32 v12, 0xffff0000, v57
    v_sub_f32 v11, v11, v20
    v_sub_f32 v12, v12, v20
    v_cvt_pk_bf16_f32 v13, v11, v12
    v_lshlrev_b32 v11, 16, v13
    v_and_b32 v12, 0xffff0000, v13
    v_mul_f32 v11, v11, v21
    v_mul_f32 v12, v12, v21
    v_cvt_pk_bf16_f32 v57, v11, v12
    v_lshlrev_b32 v11, 16, v58
    v_and_b32 v12, 0xffff0000, v58
    v_sub_f32 v11, v11, v20
    v_sub_f32 v12, v12, v20
    v_cvt_pk_bf16_f32 v13, v11, v12
    v_lshlrev_b32 v11, 16, v13
    v_and_b32 v12, 0xffff0000, v13
    v_mul_f32 v11, v11, v21
    v_mul_f32 v12, v12, v21
    v_cvt_pk_bf16_f32 v58, v11, v12
    v_lshlrev_b32 v11, 16, v59
    v_and_b32 v12, 0xffff0000, v59
    v_sub_f32 v11, v11, v20
    v_sub_f32 v12, v12, v20
    v_cvt_pk_bf16_f32 v13, v11, v12
    v_lshlrev_b32 v11, 16, v13
    v_and_b32 v12, 0xffff0000, v13
    v_mul_f32 v11, v11, v21
    v_mul_f32 v12, v12, v21
    v_cvt_pk_bf16_f32 v59, v11, v12
    v_add_u32 v14, 106496, v9
    ds_write_b128 v14, v[56:59]
    v_lshlrev_b32 v11, 16, v60
    v_and_b32 v12, 0xffff0000, v60
    v_sub_f32 v11, v11, v22
    v_sub_f32 v12, v12, v22
    v_cvt_pk_bf16_f32 v13, v11, v12
    v_lshlrev_b32 v11, 16, v13
    v_and_b32 v12, 0xffff0000, v13
    v_mul_f32 v11, v11, v23
    v_mul_f32 v12, v12, v23
    v_cvt_pk_bf16_f32 v60, v11, v12
    v_lshlrev_b32 v11, 16, v61
    v_and_b32 v12, 0xffff0000, v61
    v_sub_f32 v11, v11, v22
    v_sub_f32 v12, v12, v22
    v_cvt_pk_bf16_f32 v13, v11, v12
    v_lshlrev_b32 v11, 16, v13
    v_and_b32 v12, 0xffff0000, v13
    v_mul_f32 v11, v11, v23
    v_mul_f32 v12, v12, v23
    v_cvt_pk_bf16_f32 v61, v11, v12
    v_lshlrev_b32 v11, 16, v62
    v_and_b32 v12, 0xffff0000, v62
    v_sub_f32 v11, v11, v22
    v_sub_f32 v12, v12, v22
    v_cvt_pk_bf16_f32 v13, v11, v12
    v_lshlrev_b32 v11, 16, v13
    v_and_b32 v12, 0xffff0000, v13
    v_mul_f32 v11, v11, v23
    v_mul_f32 v12, v12, v23
    v_cvt_pk_bf16_f32 v62, v11, v12
    v_lshlrev_b32 v11, 16, v63
    v_and_b32 v12, 0xffff0000, v63
    v_sub_f32 v11, v11, v22
    v_sub_f32 v12, v12, v22
    v_cvt_pk_bf16_f32 v13, v11, v12
    v_lshlrev_b32 v11, 16, v13
    v_and_b32 v12, 0xffff0000, v13
    v_mul_f32 v11, v11, v23
    v_mul_f32 v12, v12, v23
    v_cvt_pk_bf16_f32 v63, v11, v12
    v_add_u32 v14, 110592, v9
    ds_write_b128 v14, v[60:63]
    s_waitcnt lgkmcnt(0)
    buffer_load_dwordx4 v[48:51], v5, s[8:11], 0 offen offset:1152
    buffer_load_dwordx4 v[52:55], v6, s[8:11], 0 offen offset:1152
    buffer_load_dwordx4 v[56:59], v7, s[8:11], 0 offen offset:1152
    buffer_load_dwordx4 v[60:63], v8, s[8:11], 0 offen offset:1152
    s_waitcnt lgkmcnt(0)
    s_barrier
    s_waitcnt vmcnt(4)
    v_lshlrev_b32 v11, 16, v32
    v_and_b32 v12, 0xffff0000, v32
    v_sub_f32 v11, v11, v16
    v_sub_f32 v12, v12, v16
    v_cvt_pk_bf16_f32 v13, v11, v12
    v_lshlrev_b32 v11, 16, v13
    v_and_b32 v12, 0xffff0000, v13
    v_mul_f32 v11, v11, v17
    v_mul_f32 v12, v12, v17
    v_cvt_pk_bf16_f32 v32, v11, v12
    v_lshlrev_b32 v11, 16, v33
    v_and_b32 v12, 0xffff0000, v33
    v_sub_f32 v11, v11, v16
    v_sub_f32 v12, v12, v16
    v_cvt_pk_bf16_f32 v13, v11, v12
    v_lshlrev_b32 v11, 16, v13
    v_and_b32 v12, 0xffff0000, v13
    v_mul_f32 v11, v11, v17
    v_mul_f32 v12, v12, v17
    v_cvt_pk_bf16_f32 v33, v11, v12
    v_lshlrev_b32 v11, 16, v34
    v_and_b32 v12, 0xffff0000, v34
    v_sub_f32 v11, v11, v16
    v_sub_f32 v12, v12, v16
    v_cvt_pk_bf16_f32 v13, v11, v12
    v_lshlrev_b32 v11, 16, v13
    v_and_b32 v12, 0xffff0000, v13
    v_mul_f32 v11, v11, v17
    v_mul_f32 v12, v12, v17
    v_cvt_pk_bf16_f32 v34, v11, v12
    v_lshlrev_b32 v11, 16, v35
    v_and_b32 v12, 0xffff0000, v35
    v_sub_f32 v11, v11, v16
    v_sub_f32 v12, v12, v16
    v_cvt_pk_bf16_f32 v13, v11, v12
    v_lshlrev_b32 v11, 16, v13
    v_and_b32 v12, 0xffff0000, v13
    v_mul_f32 v11, v11, v17
    v_mul_f32 v12, v12, v17
    v_cvt_pk_bf16_f32 v35, v11, v12
    v_add_u32 v14, 0, v9
    ds_write_b128 v14, v[32:35]
    v_lshlrev_b32 v11, 16, v36
    v_and_b32 v12, 0xffff0000, v36
    v_sub_f32 v11, v11, v18
    v_sub_f32 v12, v12, v18
    v_cvt_pk_bf16_f32 v13, v11, v12
    v_lshlrev_b32 v11, 16, v13
    v_and_b32 v12, 0xffff0000, v13
    v_mul_f32 v11, v11, v19
    v_mul_f32 v12, v12, v19
    v_cvt_pk_bf16_f32 v36, v11, v12
    v_lshlrev_b32 v11, 16, v37
    v_and_b32 v12, 0xffff0000, v37
    v_sub_f32 v11, v11, v18
    v_sub_f32 v12, v12, v18
    v_cvt_pk_bf16_f32 v13, v11, v12
    v_lshlrev_b32 v11, 16, v13
    v_and_b32 v12, 0xffff0000, v13
    v_mul_f32 v11, v11, v19
    v_mul_f32 v12, v12, v19
    v_cvt_pk_bf16_f32 v37, v11, v12
    v_lshlrev_b32 v11, 16, v38
    v_and_b32 v12, 0xffff0000, v38
    v_sub_f32 v11, v11, v18
    v_sub_f32 v12, v12, v18
    v_cvt_pk_bf16_f32 v13, v11, v12
    v_lshlrev_b32 v11, 16, v13
    v_and_b32 v12, 0xffff0000, v13
    v_mul_f32 v11, v11, v19
    v_mul_f32 v12, v12, v19
    v_cvt_pk_bf16_f32 v38, v11, v12
    v_lshlrev_b32 v11, 16, v39
    v_and_b32 v12, 0xffff0000, v39
    v_sub_f32 v11, v11, v18
    v_sub_f32 v12, v12, v18
    v_cvt_pk_bf16_f32 v13, v11, v12
    v_lshlrev_b32 v11, 16, v13
    v_and_b32 v12, 0xffff0000, v13
    v_mul_f32 v11, v11, v19
    v_mul_f32 v12, v12, v19
    v_cvt_pk_bf16_f32 v39, v11, v12
    v_add_u32 v14, 4096, v9
    ds_write_b128 v14, v[36:39]
    v_lshlrev_b32 v11, 16, v40
    v_and_b32 v12, 0xffff0000, v40
    v_sub_f32 v11, v11, v20
    v_sub_f32 v12, v12, v20
    v_cvt_pk_bf16_f32 v13, v11, v12
    v_lshlrev_b32 v11, 16, v13
    v_and_b32 v12, 0xffff0000, v13
    v_mul_f32 v11, v11, v21
    v_mul_f32 v12, v12, v21
    v_cvt_pk_bf16_f32 v40, v11, v12
    v_lshlrev_b32 v11, 16, v41
    v_and_b32 v12, 0xffff0000, v41
    v_sub_f32 v11, v11, v20
    v_sub_f32 v12, v12, v20
    v_cvt_pk_bf16_f32 v13, v11, v12
    v_lshlrev_b32 v11, 16, v13
    v_and_b32 v12, 0xffff0000, v13
    v_mul_f32 v11, v11, v21
    v_mul_f32 v12, v12, v21
    v_cvt_pk_bf16_f32 v41, v11, v12
    v_lshlrev_b32 v11, 16, v42
    v_and_b32 v12, 0xffff0000, v42
    v_sub_f32 v11, v11, v20
    v_sub_f32 v12, v12, v20
    v_cvt_pk_bf16_f32 v13, v11, v12
    v_lshlrev_b32 v11, 16, v13
    v_and_b32 v12, 0xffff0000, v13
    v_mul_f32 v11, v11, v21
    v_mul_f32 v12, v12, v21
    v_cvt_pk_bf16_f32 v42, v11, v12
    v_lshlrev_b32 v11, 16, v43
    v_and_b32 v12, 0xffff0000, v43
    v_sub_f32 v11, v11, v20
    v_sub_f32 v12, v12, v20
    v_cvt_pk_bf16_f32 v13, v11, v12
    v_lshlrev_b32 v11, 16, v13
    v_and_b32 v12, 0xffff0000, v13
    v_mul_f32 v11, v11, v21
    v_mul_f32 v12, v12, v21
    v_cvt_pk_bf16_f32 v43, v11, v12
    v_add_u32 v14, 8192, v9
    ds_write_b128 v14, v[40:43]
    v_lshlrev_b32 v11, 16, v44
    v_and_b32 v12, 0xffff0000, v44
    v_sub_f32 v11, v11, v22
    v_sub_f32 v12, v12, v22
    v_cvt_pk_bf16_f32 v13, v11, v12
    v_lshlrev_b32 v11, 16, v13
    v_and_b32 v12, 0xffff0000, v13
    v_mul_f32 v11, v11, v23
    v_mul_f32 v12, v12, v23
    v_cvt_pk_bf16_f32 v44, v11, v12
    v_lshlrev_b32 v11, 16, v45
    v_and_b32 v12, 0xffff0000, v45
    v_sub_f32 v11, v11, v22
    v_sub_f32 v12, v12, v22
    v_cvt_pk_bf16_f32 v13, v11, v12
    v_lshlrev_b32 v11, 16, v13
    v_and_b32 v12, 0xffff0000, v13
    v_mul_f32 v11, v11, v23
    v_mul_f32 v12, v12, v23
    v_cvt_pk_bf16_f32 v45, v11, v12
    v_lshlrev_b32 v11, 16, v46
    v_and_b32 v12, 0xffff0000, v46
    v_sub_f32 v11, v11, v22
    v_sub_f32 v12, v12, v22
    v_cvt_pk_bf16_f32 v13, v11, v12
    v_lshlrev_b32 v11, 16, v13
    v_and_b32 v12, 0xffff0000, v13
    v_mul_f32 v11, v11, v23
    v_mul_f32 v12, v12, v23
    v_cvt_pk_bf16_f32 v46, v11, v12
    v_lshlrev_b32 v11, 16, v47
    v_and_b32 v12, 0xffff0000, v47
    v_sub_f32 v11, v11, v22
    v_sub_f32 v12, v12, v22
    v_cvt_pk_bf16_f32 v13, v11, v12
    v_lshlrev_b32 v11, 16, v13
    v_and_b32 v12, 0xffff0000, v13
    v_mul_f32 v11, v11, v23
    v_mul_f32 v12, v12, v23
    v_cvt_pk_bf16_f32 v47, v11, v12
    v_add_u32 v14, 12288, v9
    ds_write_b128 v14, v[44:47]
    s_waitcnt lgkmcnt(0)
    s_barrier
    s_waitcnt vmcnt(0)
    v_lshlrev_b32 v11, 16, v48
    v_and_b32 v12, 0xffff0000, v48
    v_sub_f32 v11, v11, v16
    v_sub_f32 v12, v12, v16
    v_cvt_pk_bf16_f32 v13, v11, v12
    v_lshlrev_b32 v11, 16, v13
    v_and_b32 v12, 0xffff0000, v13
    v_mul_f32 v11, v11, v17
    v_mul_f32 v12, v12, v17
    v_cvt_pk_bf16_f32 v48, v11, v12
    v_lshlrev_b32 v11, 16, v49
    v_and_b32 v12, 0xffff0000, v49
    v_sub_f32 v11, v11, v16
    v_sub_f32 v12, v12, v16
    v_cvt_pk_bf16_f32 v13, v11, v12
    v_lshlrev_b32 v11, 16, v13
    v_and_b32 v12, 0xffff0000, v13
    v_mul_f32 v11, v11, v17
    v_mul_f32 v12, v12, v17
    v_cvt_pk_bf16_f32 v49, v11, v12
    v_lshlrev_b32 v11, 16, v50
    v_and_b32 v12, 0xffff0000, v50
    v_sub_f32 v11, v11, v16
    v_sub_f32 v12, v12, v16
    v_cvt_pk_bf16_f32 v13, v11, v12
    v_lshlrev_b32 v11, 16, v13
    v_and_b32 v12, 0xffff0000, v13
    v_mul_f32 v11, v11, v17
    v_mul_f32 v12, v12, v17
    v_cvt_pk_bf16_f32 v50, v11, v12
    v_lshlrev_b32 v11, 16, v51
    v_and_b32 v12, 0xffff0000, v51
    v_sub_f32 v11, v11, v16
    v_sub_f32 v12, v12, v16
    v_cvt_pk_bf16_f32 v13, v11, v12
    v_lshlrev_b32 v11, 16, v13
    v_and_b32 v12, 0xffff0000, v13
    v_mul_f32 v11, v11, v17
    v_mul_f32 v12, v12, v17
    v_cvt_pk_bf16_f32 v51, v11, v12
    v_add_u32 v14, 32768, v9
    ds_write_b128 v14, v[48:51]
    v_lshlrev_b32 v11, 16, v52
    v_and_b32 v12, 0xffff0000, v52
    v_sub_f32 v11, v11, v18
    v_sub_f32 v12, v12, v18
    v_cvt_pk_bf16_f32 v13, v11, v12
    v_lshlrev_b32 v11, 16, v13
    v_and_b32 v12, 0xffff0000, v13
    v_mul_f32 v11, v11, v19
    v_mul_f32 v12, v12, v19
    v_cvt_pk_bf16_f32 v52, v11, v12
    v_lshlrev_b32 v11, 16, v53
    v_and_b32 v12, 0xffff0000, v53
    v_sub_f32 v11, v11, v18
    v_sub_f32 v12, v12, v18
    v_cvt_pk_bf16_f32 v13, v11, v12
    v_lshlrev_b32 v11, 16, v13
    v_and_b32 v12, 0xffff0000, v13
    v_mul_f32 v11, v11, v19
    v_mul_f32 v12, v12, v19
    v_cvt_pk_bf16_f32 v53, v11, v12
    v_lshlrev_b32 v11, 16, v54
    v_and_b32 v12, 0xffff0000, v54
    v_sub_f32 v11, v11, v18
    v_sub_f32 v12, v12, v18
    v_cvt_pk_bf16_f32 v13, v11, v12
    v_lshlrev_b32 v11, 16, v13
    v_and_b32 v12, 0xffff0000, v13
    v_mul_f32 v11, v11, v19
    v_mul_f32 v12, v12, v19
    v_cvt_pk_bf16_f32 v54, v11, v12
    v_lshlrev_b32 v11, 16, v55
    v_and_b32 v12, 0xffff0000, v55
    v_sub_f32 v11, v11, v18
    v_sub_f32 v12, v12, v18
    v_cvt_pk_bf16_f32 v13, v11, v12
    v_lshlrev_b32 v11, 16, v13
    v_and_b32 v12, 0xffff0000, v13
    v_mul_f32 v11, v11, v19
    v_mul_f32 v12, v12, v19
    v_cvt_pk_bf16_f32 v55, v11, v12
    v_add_u32 v14, 36864, v9
    ds_write_b128 v14, v[52:55]
    v_lshlrev_b32 v11, 16, v56
    v_and_b32 v12, 0xffff0000, v56
    v_sub_f32 v11, v11, v20
    v_sub_f32 v12, v12, v20
    v_cvt_pk_bf16_f32 v13, v11, v12
    v_lshlrev_b32 v11, 16, v13
    v_and_b32 v12, 0xffff0000, v13
    v_mul_f32 v11, v11, v21
    v_mul_f32 v12, v12, v21
    v_cvt_pk_bf16_f32 v56, v11, v12
    v_lshlrev_b32 v11, 16, v57
    v_and_b32 v12, 0xffff0000, v57
    v_sub_f32 v11, v11, v20
    v_sub_f32 v12, v12, v20
    v_cvt_pk_bf16_f32 v13, v11, v12
    v_lshlrev_b32 v11, 16, v13
    v_and_b32 v12, 0xffff0000, v13
    v_mul_f32 v11, v11, v21
    v_mul_f32 v12, v12, v21
    v_cvt_pk_bf16_f32 v57, v11, v12
    v_lshlrev_b32 v11, 16, v58
    v_and_b32 v12, 0xffff0000, v58
    v_sub_f32 v11, v11, v20
    v_sub_f32 v12, v12, v20
    v_cvt_pk_bf16_f32 v13, v11, v12
    v_lshlrev_b32 v11, 16, v13
    v_and_b32 v12, 0xffff0000, v13
    v_mul_f32 v11, v11, v21
    v_mul_f32 v12, v12, v21
    v_cvt_pk_bf16_f32 v58, v11, v12
    v_lshlrev_b32 v11, 16, v59
    v_and_b32 v12, 0xffff0000, v59
    v_sub_f32 v11, v11, v20
    v_sub_f32 v12, v12, v20
    v_cvt_pk_bf16_f32 v13, v11, v12
    v_lshlrev_b32 v11, 16, v13
    v_and_b32 v12, 0xffff0000, v13
    v_mul_f32 v11, v11, v21
    v_mul_f32 v12, v12, v21
    v_cvt_pk_bf16_f32 v59, v11, v12
    v_add_u32 v14, 40960, v9
    ds_write_b128 v14, v[56:59]
    v_lshlrev_b32 v11, 16, v60
    v_and_b32 v12, 0xffff0000, v60
    v_sub_f32 v11, v11, v22
    v_sub_f32 v12, v12, v22
    v_cvt_pk_bf16_f32 v13, v11, v12
    v_lshlrev_b32 v11, 16, v13
    v_and_b32 v12, 0xffff0000, v13
    v_mul_f32 v11, v11, v23
    v_mul_f32 v12, v12, v23
    v_cvt_pk_bf16_f32 v60, v11, v12
    v_lshlrev_b32 v11, 16, v61
    v_and_b32 v12, 0xffff0000, v61
    v_sub_f32 v11, v11, v22
    v_sub_f32 v12, v12, v22
    v_cvt_pk_bf16_f32 v13, v11, v12
    v_lshlrev_b32 v11, 16, v13
    v_and_b32 v12, 0xffff0000, v13
    v_mul_f32 v11, v11, v23
    v_mul_f32 v12, v12, v23
    v_cvt_pk_bf16_f32 v61, v11, v12
    v_lshlrev_b32 v11, 16, v62
    v_and_b32 v12, 0xffff0000, v62
    v_sub_f32 v11, v11, v22
    v_sub_f32 v12, v12, v22
    v_cvt_pk_bf16_f32 v13, v11, v12
    v_lshlrev_b32 v11, 16, v13
    v_and_b32 v12, 0xffff0000, v13
    v_mul_f32 v11, v11, v23
    v_mul_f32 v12, v12, v23
    v_cvt_pk_bf16_f32 v62, v11, v12
    v_lshlrev_b32 v11, 16, v63
    v_and_b32 v12, 0xffff0000, v63
    v_sub_f32 v11, v11, v22
    v_sub_f32 v12, v12, v22
    v_cvt_pk_bf16_f32 v13, v11, v12
    v_lshlrev_b32 v11, 16, v13
    v_and_b32 v12, 0xffff0000, v13
    v_mul_f32 v11, v11, v23
    v_mul_f32 v12, v12, v23
    v_cvt_pk_bf16_f32 v63, v11, v12
    v_add_u32 v14, 45056, v9
    ds_write_b128 v14, v[60:63]
    s_waitcnt lgkmcnt(0)
    s_barrier
    s_waitcnt lgkmcnt(0)
    s_barrier
    s_waitcnt lgkmcnt(0)
    s_barrier
    s_branch k4_kernel_epi
k4_kernel_bl:
    s_sub_u32 s37, s26, 8
    s_lshl_b32 s30, s25, 1
    s_mov_b32 s31, 3456
    s_mul_i32 s29, s37, 1
    s_add_u32 s29, s29, 0
    s_lshr_b32 s32, s29, 1
    s_and_b32 s32, s32, 1
    s_lshl_b32 s32, s32, 2
    v_lshrrev_b32 v16, 4, v1
    v_add_u32 v17, s32, v16
    v_lshlrev_b32 v17, 1, v17
    v_and_b32 v18, 15, v1
    v_xor_b32 v17, v17, v18
    v_lshlrev_b32 v17, 4, v17
    v_add_u32 v17, s30, v17
    s_lshl_b32 s29, s29, 2
    v_add_u32 v16, s29, v16
    v_mul_lo_u32 v16, v16, s31
    v_add_u32 v2, v16, v17
    s_mul_i32 s29, s37, 1
    s_add_u32 s29, s29, 2
    s_lshr_b32 s32, s29, 1
    s_and_b32 s32, s32, 1
    s_lshl_b32 s32, s32, 2
    v_lshrrev_b32 v16, 4, v1
    v_add_u32 v17, s32, v16
    v_lshlrev_b32 v17, 1, v17
    v_and_b32 v18, 15, v1
    v_xor_b32 v17, v17, v18
    v_lshlrev_b32 v17, 4, v17
    v_add_u32 v17, s30, v17
    s_lshl_b32 s29, s29, 2
    v_add_u32 v16, s29, v16
    v_mul_lo_u32 v16, v16, s31
    v_add_u32 v3, v16, v17
    s_mul_i32 s29, s37, 1
    s_add_u32 s29, s29, 4
    s_lshr_b32 s32, s29, 1
    s_and_b32 s32, s32, 1
    s_lshl_b32 s32, s32, 2
    v_lshrrev_b32 v16, 4, v1
    v_add_u32 v17, s32, v16
    v_lshlrev_b32 v17, 1, v17
    v_and_b32 v18, 15, v1
    v_xor_b32 v17, v17, v18
    v_lshlrev_b32 v17, 4, v17
    v_add_u32 v17, s30, v17
    s_lshl_b32 s29, s29, 2
    v_add_u32 v16, s29, v16
    v_mul_lo_u32 v16, v16, s31
    v_add_u32 v4, v16, v17
    s_mul_i32 s29, s37, 1
    s_add_u32 s29, s29, 6
    s_lshr_b32 s32, s29, 1
    s_and_b32 s32, s32, 1
    s_lshl_b32 s32, s32, 2
    v_lshrrev_b32 v16, 4, v1
    v_add_u32 v17, s32, v16
    v_lshlrev_b32 v17, 1, v17
    v_and_b32 v18, 15, v1
    v_xor_b32 v17, v17, v18
    v_lshlrev_b32 v17, 4, v17
    v_add_u32 v17, s30, v17
    s_lshl_b32 s29, s29, 2
    v_add_u32 v16, s29, v16
    v_mul_lo_u32 v16, v16, s31
    v_add_u32 v5, v16, v17
    s_mul_i32 s29, s37, 1
    s_add_u32 s29, s29, 8
    s_lshr_b32 s32, s29, 1
    s_and_b32 s32, s32, 1
    s_lshl_b32 s32, s32, 2
    v_lshrrev_b32 v16, 4, v1
    v_add_u32 v17, s32, v16
    v_lshlrev_b32 v17, 1, v17
    v_and_b32 v18, 15, v1
    v_xor_b32 v17, v17, v18
    v_lshlrev_b32 v17, 4, v17
    v_add_u32 v17, s30, v17
    s_lshl_b32 s29, s29, 2
    v_add_u32 v16, s29, v16
    v_mul_lo_u32 v16, v16, s31
    v_add_u32 v6, v16, v17
    s_mul_i32 s29, s37, 1
    s_add_u32 s29, s29, 10
    s_lshr_b32 s32, s29, 1
    s_and_b32 s32, s32, 1
    s_lshl_b32 s32, s32, 2
    v_lshrrev_b32 v16, 4, v1
    v_add_u32 v17, s32, v16
    v_lshlrev_b32 v17, 1, v17
    v_and_b32 v18, 15, v1
    v_xor_b32 v17, v17, v18
    v_lshlrev_b32 v17, 4, v17
    v_add_u32 v17, s30, v17
    s_lshl_b32 s29, s29, 2
    v_add_u32 v16, s29, v16
    v_mul_lo_u32 v16, v16, s31
    v_add_u32 v7, v16, v17
    s_mul_i32 s29, s37, 1
    s_add_u32 s29, s29, 12
    s_lshr_b32 s32, s29, 1
    s_and_b32 s32, s32, 1
    s_lshl_b32 s32, s32, 2
    v_lshrrev_b32 v16, 4, v1
    v_add_u32 v17, s32, v16
    v_lshlrev_b32 v17, 1, v17
    v_and_b32 v18, 15, v1
    v_xor_b32 v17, v17, v18
    v_lshlrev_b32 v17, 4, v17
    v_add_u32 v17, s30, v17
    s_lshl_b32 s29, s29, 2
    v_add_u32 v16, s29, v16
    v_mul_lo_u32 v16, v16, s31
    v_add_u32 v8, v16, v17
    s_mul_i32 s29, s37, 1
    s_add_u32 s29, s29, 14
    s_lshr_b32 s32, s29, 1
    s_and_b32 s32, s32, 1
    s_lshl_b32 s32, s32, 2
    v_lshrrev_b32 v16, 4, v1
    v_add_u32 v17, s32, v16
    v_lshlrev_b32 v17, 1, v17
    v_and_b32 v18, 15, v1
    v_xor_b32 v17, v17, v18
    v_lshlrev_b32 v17, 4, v17
    v_add_u32 v17, s30, v17
    s_lshl_b32 s29, s29, 2
    v_add_u32 v16, s29, v16
    v_mul_lo_u32 v16, v16, s31
    v_add_u32 v9, v16, v17
    s_add_u32 s29, s37, 0
    s_lshl_b32 m0, s29, 10
    s_add_u32 m0, m0, 16384
    s_nop 0
    buffer_load_dwordx4 v2, s[12:15], 0 offen lds
    v_add_u32 v2, 221184, v2
    s_add_u32 s29, s37, 2
    s_lshl_b32 m0, s29, 10
    s_add_u32 m0, m0, 16384
    s_nop 0
    buffer_load_dwordx4 v3, s[12:15], 0 offen lds
    v_add_u32 v3, 221184, v3
    s_add_u32 s29, s37, 4
    s_lshl_b32 m0, s29, 10
    s_add_u32 m0, m0, 16384
    s_nop 0
    buffer_load_dwordx4 v4, s[12:15], 0 offen lds
    v_add_u32 v4, 221184, v4
    s_add_u32 s29, s37, 6
    s_lshl_b32 m0, s29, 10
    s_add_u32 m0, m0, 16384
    s_nop 0
    buffer_load_dwordx4 v5, s[12:15], 0 offen lds
    v_add_u32 v5, 221184, v5
    s_add_u32 s29, s37, 8
    s_lshl_b32 m0, s29, 10
    s_add_u32 m0, m0, 16384
    s_nop 0
    buffer_load_dwordx4 v6, s[12:15], 0 offen lds
    v_add_u32 v6, 221184, v6
    s_add_u32 s29, s37, 10
    s_lshl_b32 m0, s29, 10
    s_add_u32 m0, m0, 16384
    s_nop 0
    buffer_load_dwordx4 v7, s[12:15], 0 offen lds
    v_add_u32 v7, 221184, v7
    s_add_u32 s29, s37, 12
    s_lshl_b32 m0, s29, 10
    s_add_u32 m0, m0, 16384
    s_nop 0
    buffer_load_dwordx4 v8, s[12:15], 0 offen lds
    v_add_u32 v8, 221184, v8
    s_add_u32 s29, s37, 14
    s_lshl_b32 m0, s29, 10
    s_add_u32 m0, m0, 16384
    s_nop 0
    buffer_load_dwordx4 v9, s[12:15], 0 offen lds
    v_add_u32 v9, 221184, v9
    s_add_u32 s29, s37, 0
    s_lshl_b32 m0, s29, 10
    s_add_u32 m0, m0, 49152
    s_nop 0
    buffer_load_dwordx4 v2, s[12:15], 0 offen lds
    v_add_u32 v2, 221184, v2
    s_add_u32 s29, s37, 2
    s_lshl_b32 m0, s29, 10
    s_add_u32 m0, m0, 49152
    s_nop 0
    buffer_load_dwordx4 v3, s[12:15], 0 offen lds
    v_add_u32 v3, 221184, v3
    s_add_u32 s29, s37, 4
    s_lshl_b32 m0, s29, 10
    s_add_u32 m0, m0, 49152
    s_nop 0
    buffer_load_dwordx4 v4, s[12:15], 0 offen lds
    v_add_u32 v4, 221184, v4
    s_add_u32 s29, s37, 6
    s_lshl_b32 m0, s29, 10
    s_add_u32 m0, m0, 49152
    s_nop 0
    buffer_load_dwordx4 v5, s[12:15], 0 offen lds
    v_add_u32 v5, 221184, v5
    s_add_u32 s29, s37, 8
    s_lshl_b32 m0, s29, 10
    s_add_u32 m0, m0, 49152
    s_nop 0
    buffer_load_dwordx4 v6, s[12:15], 0 offen lds
    v_add_u32 v6, 221184, v6
    s_add_u32 s29, s37, 10
    s_lshl_b32 m0, s29, 10
    s_add_u32 m0, m0, 49152
    s_nop 0
    buffer_load_dwordx4 v7, s[12:15], 0 offen lds
    v_add_u32 v7, 221184, v7
    s_add_u32 s29, s37, 12
    s_lshl_b32 m0, s29, 10
    s_add_u32 m0, m0, 49152
    s_nop 0
    buffer_load_dwordx4 v8, s[12:15], 0 offen lds
    v_add_u32 v8, 221184, v8
    s_add_u32 s29, s37, 14
    s_lshl_b32 m0, s29, 10
    s_add_u32 m0, m0, 49152
    s_nop 0
    buffer_load_dwordx4 v9, s[12:15], 0 offen lds
    v_add_u32 v9, 221184, v9
    s_add_u32 s29, s37, 0
    s_lshl_b32 m0, s29, 10
    s_add_u32 m0, m0, 81920
    s_nop 0
    buffer_load_dwordx4 v2, s[12:15], 0 offen lds
    v_add_u32 v2, 221184, v2
    s_add_u32 s29, s37, 2
    s_lshl_b32 m0, s29, 10
    s_add_u32 m0, m0, 81920
    s_nop 0
    buffer_load_dwordx4 v3, s[12:15], 0 offen lds
    v_add_u32 v3, 221184, v3
    s_add_u32 s29, s37, 4
    s_lshl_b32 m0, s29, 10
    s_add_u32 m0, m0, 81920
    s_nop 0
    buffer_load_dwordx4 v4, s[12:15], 0 offen lds
    v_add_u32 v4, 221184, v4
    s_add_u32 s29, s37, 6
    s_lshl_b32 m0, s29, 10
    s_add_u32 m0, m0, 81920
    s_nop 0
    buffer_load_dwordx4 v5, s[12:15], 0 offen lds
    v_add_u32 v5, 221184, v5
    s_add_u32 s29, s37, 8
    s_lshl_b32 m0, s29, 10
    s_add_u32 m0, m0, 81920
    s_nop 0
    buffer_load_dwordx4 v6, s[12:15], 0 offen lds
    v_add_u32 v6, 221184, v6
    s_add_u32 s29, s37, 10
    s_lshl_b32 m0, s29, 10
    s_add_u32 m0, m0, 81920
    s_nop 0
    buffer_load_dwordx4 v7, s[12:15], 0 offen lds
    v_add_u32 v7, 221184, v7
    s_add_u32 s29, s37, 12
    s_lshl_b32 m0, s29, 10
    s_add_u32 m0, m0, 81920
    s_nop 0
    buffer_load_dwordx4 v8, s[12:15], 0 offen lds
    v_add_u32 v8, 221184, v8
    s_add_u32 s29, s37, 14
    s_lshl_b32 m0, s29, 10
    s_add_u32 m0, m0, 81920
    s_nop 0
    buffer_load_dwordx4 v9, s[12:15], 0 offen lds
    v_add_u32 v9, 221184, v9
    s_barrier
    s_waitcnt vmcnt(16)
    s_barrier
    s_add_u32 s29, s37, 0
    s_lshl_b32 m0, s29, 10
    s_add_u32 m0, m0, 114688
    s_nop 0
    buffer_load_dwordx4 v2, s[12:15], 0 offen lds
    v_add_u32 v2, 221184, v2
    s_add_u32 s29, s37, 2
    s_lshl_b32 m0, s29, 10
    s_add_u32 m0, m0, 114688
    s_nop 0
    buffer_load_dwordx4 v3, s[12:15], 0 offen lds
    v_add_u32 v3, 221184, v3
    s_add_u32 s29, s37, 4
    s_lshl_b32 m0, s29, 10
    s_add_u32 m0, m0, 114688
    s_nop 0
    buffer_load_dwordx4 v4, s[12:15], 0 offen lds
    v_add_u32 v4, 221184, v4
    s_add_u32 s29, s37, 6
    s_lshl_b32 m0, s29, 10
    s_add_u32 m0, m0, 114688
    s_nop 0
    buffer_load_dwordx4 v5, s[12:15], 0 offen lds
    v_add_u32 v5, 221184, v5
    s_add_u32 s29, s37, 8
    s_lshl_b32 m0, s29, 10
    s_add_u32 m0, m0, 114688
    s_nop 0
    buffer_load_dwordx4 v6, s[12:15], 0 offen lds
    v_add_u32 v6, 221184, v6
    s_add_u32 s29, s37, 10
    s_lshl_b32 m0, s29, 10
    s_add_u32 m0, m0, 114688
    s_nop 0
    buffer_load_dwordx4 v7, s[12:15], 0 offen lds
    v_add_u32 v7, 221184, v7
    s_add_u32 s29, s37, 12
    s_lshl_b32 m0, s29, 10
    s_add_u32 m0, m0, 114688
    s_nop 0
    buffer_load_dwordx4 v8, s[12:15], 0 offen lds
    v_add_u32 v8, 221184, v8
    s_add_u32 s29, s37, 14
    s_lshl_b32 m0, s29, 10
    s_add_u32 m0, m0, 114688
    s_nop 0
    buffer_load_dwordx4 v9, s[12:15], 0 offen lds
    v_add_u32 v9, 221184, v9
    s_waitcnt vmcnt(16)
    s_barrier
    s_add_u32 s29, s37, 0
    s_lshl_b32 m0, s29, 10
    s_add_u32 m0, m0, 16384
    s_nop 0
    buffer_load_dwordx4 v2, s[12:15], 0 offen lds
    v_add_u32 v2, 221184, v2
    s_add_u32 s29, s37, 2
    s_lshl_b32 m0, s29, 10
    s_add_u32 m0, m0, 16384
    s_nop 0
    buffer_load_dwordx4 v3, s[12:15], 0 offen lds
    v_add_u32 v3, 221184, v3
    s_add_u32 s29, s37, 4
    s_lshl_b32 m0, s29, 10
    s_add_u32 m0, m0, 16384
    s_nop 0
    buffer_load_dwordx4 v4, s[12:15], 0 offen lds
    v_add_u32 v4, 221184, v4
    s_add_u32 s29, s37, 6
    s_lshl_b32 m0, s29, 10
    s_add_u32 m0, m0, 16384
    s_nop 0
    buffer_load_dwordx4 v5, s[12:15], 0 offen lds
    v_add_u32 v5, 221184, v5
    s_add_u32 s29, s37, 8
    s_lshl_b32 m0, s29, 10
    s_add_u32 m0, m0, 16384
    s_nop 0
    buffer_load_dwordx4 v6, s[12:15], 0 offen lds
    v_add_u32 v6, 221184, v6
    s_add_u32 s29, s37, 10
    s_lshl_b32 m0, s29, 10
    s_add_u32 m0, m0, 16384
    s_nop 0
    buffer_load_dwordx4 v7, s[12:15], 0 offen lds
    v_add_u32 v7, 221184, v7
    s_add_u32 s29, s37, 12
    s_lshl_b32 m0, s29, 10
    s_add_u32 m0, m0, 16384
    s_nop 0
    buffer_load_dwordx4 v8, s[12:15], 0 offen lds
    v_add_u32 v8, 221184, v8
    s_add_u32 s29, s37, 14
    s_lshl_b32 m0, s29, 10
    s_add_u32 m0, m0, 16384
    s_nop 0
    buffer_load_dwordx4 v9, s[12:15], 0 offen lds
    v_add_u32 v9, 221184, v9
    s_waitcnt vmcnt(16)
    s_barrier
    s_add_u32 s29, s37, 0
    s_lshl_b32 m0, s29, 10
    s_add_u32 m0, m0, 49152
    s_nop 0
    buffer_load_dwordx4 v2, s[12:15], 0 offen lds
    v_add_u32 v2, 221184, v2
    s_add_u32 s29, s37, 2
    s_lshl_b32 m0, s29, 10
    s_add_u32 m0, m0, 49152
    s_nop 0
    buffer_load_dwordx4 v3, s[12:15], 0 offen lds
    v_add_u32 v3, 221184, v3
    s_add_u32 s29, s37, 4
    s_lshl_b32 m0, s29, 10
    s_add_u32 m0, m0, 49152
    s_nop 0
    buffer_load_dwordx4 v4, s[12:15], 0 offen lds
    v_add_u32 v4, 221184, v4
    s_add_u32 s29, s37, 6
    s_lshl_b32 m0, s29, 10
    s_add_u32 m0, m0, 49152
    s_nop 0
    buffer_load_dwordx4 v5, s[12:15], 0 offen lds
    v_add_u32 v5, 221184, v5
    s_add_u32 s29, s37, 8
    s_lshl_b32 m0, s29, 10
    s_add_u32 m0, m0, 49152
    s_nop 0
    buffer_load_dwordx4 v6, s[12:15], 0 offen lds
    v_add_u32 v6, 221184, v6
    s_add_u32 s29, s37, 10
    s_lshl_b32 m0, s29, 10
    s_add_u32 m0, m0, 49152
    s_nop 0
    buffer_load_dwordx4 v7, s[12:15], 0 offen lds
    v_add_u32 v7, 221184, v7
    s_add_u32 s29, s37, 12
    s_lshl_b32 m0, s29, 10
    s_add_u32 m0, m0, 49152
    s_nop 0
    buffer_load_dwordx4 v8, s[12:15], 0 offen lds
    v_add_u32 v8, 221184, v8
    s_add_u32 s29, s37, 14
    s_lshl_b32 m0, s29, 10
    s_add_u32 m0, m0, 49152
    s_nop 0
    buffer_load_dwordx4 v9, s[12:15], 0 offen lds
    v_add_u32 v9, 221184, v9
    s_waitcnt vmcnt(16)
    s_barrier
    s_add_u32 s29, s37, 0
    s_lshl_b32 m0, s29, 10
    s_add_u32 m0, m0, 81920
    s_nop 0
    buffer_load_dwordx4 v2, s[12:15], 0 offen lds
    v_add_u32 v2, 221184, v2
    s_add_u32 s29, s37, 2
    s_lshl_b32 m0, s29, 10
    s_add_u32 m0, m0, 81920
    s_nop 0
    buffer_load_dwordx4 v3, s[12:15], 0 offen lds
    v_add_u32 v3, 221184, v3
    s_add_u32 s29, s37, 4
    s_lshl_b32 m0, s29, 10
    s_add_u32 m0, m0, 81920
    s_nop 0
    buffer_load_dwordx4 v4, s[12:15], 0 offen lds
    v_add_u32 v4, 221184, v4
    s_add_u32 s29, s37, 6
    s_lshl_b32 m0, s29, 10
    s_add_u32 m0, m0, 81920
    s_nop 0
    buffer_load_dwordx4 v5, s[12:15], 0 offen lds
    v_add_u32 v5, 221184, v5
    s_add_u32 s29, s37, 8
    s_lshl_b32 m0, s29, 10
    s_add_u32 m0, m0, 81920
    s_nop 0
    buffer_load_dwordx4 v6, s[12:15], 0 offen lds
    v_add_u32 v6, 221184, v6
    s_add_u32 s29, s37, 10
    s_lshl_b32 m0, s29, 10
    s_add_u32 m0, m0, 81920
    s_nop 0
    buffer_load_dwordx4 v7, s[12:15], 0 offen lds
    v_add_u32 v7, 221184, v7
    s_add_u32 s29, s37, 12
    s_lshl_b32 m0, s29, 10
    s_add_u32 m0, m0, 81920
    s_nop 0
    buffer_load_dwordx4 v8, s[12:15], 0 offen lds
    v_add_u32 v8, 221184, v8
    s_add_u32 s29, s37, 14
    s_lshl_b32 m0, s29, 10
    s_add_u32 m0, m0, 81920
    s_nop 0
    buffer_load_dwordx4 v9, s[12:15], 0 offen lds
    v_add_u32 v9, 221184, v9
    s_waitcnt vmcnt(16)
    s_barrier
    s_add_u32 s29, s37, 0
    s_lshl_b32 m0, s29, 10
    s_add_u32 m0, m0, 114688
    s_nop 0
    buffer_load_dwordx4 v2, s[12:15], 0 offen lds
    v_add_u32 v2, 221184, v2
    s_add_u32 s29, s37, 2
    s_lshl_b32 m0, s29, 10
    s_add_u32 m0, m0, 114688
    s_nop 0
    buffer_load_dwordx4 v3, s[12:15], 0 offen lds
    v_add_u32 v3, 221184, v3
    s_add_u32 s29, s37, 4
    s_lshl_b32 m0, s29, 10
    s_add_u32 m0, m0, 114688
    s_nop 0
    buffer_load_dwordx4 v4, s[12:15], 0 offen lds
    v_add_u32 v4, 221184, v4
    s_add_u32 s29, s37, 6
    s_lshl_b32 m0, s29, 10
    s_add_u32 m0, m0, 114688
    s_nop 0
    buffer_load_dwordx4 v5, s[12:15], 0 offen lds
    v_add_u32 v5, 221184, v5
    s_add_u32 s29, s37, 8
    s_lshl_b32 m0, s29, 10
    s_add_u32 m0, m0, 114688
    s_nop 0
    buffer_load_dwordx4 v6, s[12:15], 0 offen lds
    v_add_u32 v6, 221184, v6
    s_add_u32 s29, s37, 10
    s_lshl_b32 m0, s29, 10
    s_add_u32 m0, m0, 114688
    s_nop 0
    buffer_load_dwordx4 v7, s[12:15], 0 offen lds
    v_add_u32 v7, 221184, v7
    s_add_u32 s29, s37, 12
    s_lshl_b32 m0, s29, 10
    s_add_u32 m0, m0, 114688
    s_nop 0
    buffer_load_dwordx4 v8, s[12:15], 0 offen lds
    v_add_u32 v8, 221184, v8
    s_add_u32 s29, s37, 14
    s_lshl_b32 m0, s29, 10
    s_add_u32 m0, m0, 114688
    s_nop 0
    buffer_load_dwordx4 v9, s[12:15], 0 offen lds
    v_add_u32 v9, 221184, v9
    s_waitcnt vmcnt(16)
    s_barrier
    s_add_u32 s29, s37, 0
    s_lshl_b32 m0, s29, 10
    s_add_u32 m0, m0, 16384
    s_nop 0
    buffer_load_dwordx4 v2, s[12:15], 0 offen lds
    v_add_u32 v2, 221184, v2
    s_add_u32 s29, s37, 2
    s_lshl_b32 m0, s29, 10
    s_add_u32 m0, m0, 16384
    s_nop 0
    buffer_load_dwordx4 v3, s[12:15], 0 offen lds
    v_add_u32 v3, 221184, v3
    s_add_u32 s29, s37, 4
    s_lshl_b32 m0, s29, 10
    s_add_u32 m0, m0, 16384
    s_nop 0
    buffer_load_dwordx4 v4, s[12:15], 0 offen lds
    v_add_u32 v4, 221184, v4
    s_add_u32 s29, s37, 6
    s_lshl_b32 m0, s29, 10
    s_add_u32 m0, m0, 16384
    s_nop 0
    buffer_load_dwordx4 v5, s[12:15], 0 offen lds
    v_add_u32 v5, 221184, v5
    s_add_u32 s29, s37, 8
    s_lshl_b32 m0, s29, 10
    s_add_u32 m0, m0, 16384
    s_nop 0
    buffer_load_dwordx4 v6, s[12:15], 0 offen lds
    v_add_u32 v6, 221184, v6
    s_add_u32 s29, s37, 10
    s_lshl_b32 m0, s29, 10
    s_add_u32 m0, m0, 16384
    s_nop 0
    buffer_load_dwordx4 v7, s[12:15], 0 offen lds
    v_add_u32 v7, 221184, v7
    s_add_u32 s29, s37, 12
    s_lshl_b32 m0, s29, 10
    s_add_u32 m0, m0, 16384
    s_nop 0
    buffer_load_dwordx4 v8, s[12:15], 0 offen lds
    v_add_u32 v8, 221184, v8
    s_add_u32 s29, s37, 14
    s_lshl_b32 m0, s29, 10
    s_add_u32 m0, m0, 16384
    s_nop 0
    buffer_load_dwordx4 v9, s[12:15], 0 offen lds
    v_add_u32 v9, 221184, v9
    s_waitcnt vmcnt(16)
    s_barrier
    s_add_u32 s29, s37, 0
    s_lshl_b32 m0, s29, 10
    s_add_u32 m0, m0, 49152
    s_nop 0
    buffer_load_dwordx4 v2, s[12:15], 0 offen lds
    v_add_u32 v2, 221184, v2
    s_add_u32 s29, s37, 2
    s_lshl_b32 m0, s29, 10
    s_add_u32 m0, m0, 49152
    s_nop 0
    buffer_load_dwordx4 v3, s[12:15], 0 offen lds
    v_add_u32 v3, 221184, v3
    s_add_u32 s29, s37, 4
    s_lshl_b32 m0, s29, 10
    s_add_u32 m0, m0, 49152
    s_nop 0
    buffer_load_dwordx4 v4, s[12:15], 0 offen lds
    v_add_u32 v4, 221184, v4
    s_add_u32 s29, s37, 6
    s_lshl_b32 m0, s29, 10
    s_add_u32 m0, m0, 49152
    s_nop 0
    buffer_load_dwordx4 v5, s[12:15], 0 offen lds
    v_add_u32 v5, 221184, v5
    s_add_u32 s29, s37, 8
    s_lshl_b32 m0, s29, 10
    s_add_u32 m0, m0, 49152
    s_nop 0
    buffer_load_dwordx4 v6, s[12:15], 0 offen lds
    v_add_u32 v6, 221184, v6
    s_add_u32 s29, s37, 10
    s_lshl_b32 m0, s29, 10
    s_add_u32 m0, m0, 49152
    s_nop 0
    buffer_load_dwordx4 v7, s[12:15], 0 offen lds
    v_add_u32 v7, 221184, v7
    s_add_u32 s29, s37, 12
    s_lshl_b32 m0, s29, 10
    s_add_u32 m0, m0, 49152
    s_nop 0
    buffer_load_dwordx4 v8, s[12:15], 0 offen lds
    v_add_u32 v8, 221184, v8
    s_add_u32 s29, s37, 14
    s_lshl_b32 m0, s29, 10
    s_add_u32 m0, m0, 49152
    s_nop 0
    buffer_load_dwordx4 v9, s[12:15], 0 offen lds
    v_add_u32 v9, 221184, v9
    s_waitcnt vmcnt(16)
    s_barrier
    s_waitcnt vmcnt(8)
    s_barrier
    s_waitcnt vmcnt(0)
    s_barrier
k4_kernel_epi:
    s_barrier
    s_cmp_ge_u32 s26, 4
    s_cbranch_scc1 k4_kernel_e2
    v_and_b32 v8, 15, v1
    v_lshrrev_b32 v9, 4, v1
    v_add_u32 v8, s27, v8
    v_mul_u32_u24 v8, 272, v8
    v_lshlrev_b32 v9, 3, v9
    s_lshl_b32 s29, s28, 1
    v_add3_u32 v8, v8, v9, s29
    v_cvt_pk_bf16_f32 v80, v80, v80
    v_lshlrev_b32 v80, 16, v80
    v_mul_f32 v9, 0xbfb8aa3b, v80
    v_cvt_pk_bf16_f32 v81, v81, v81
    v_lshlrev_b32 v81, 16, v81
    v_mul_f32 v10, 0xbfb8aa3b, v81
    v_cvt_pk_bf16_f32 v82, v82, v82
    v_lshlrev_b32 v82, 16, v82
    v_mul_f32 v11, 0xbfb8aa3b, v82
    v_cvt_pk_bf16_f32 v83, v83, v83
    v_lshlrev_b32 v83, 16, v83
    v_mul_f32 v12, 0xbfb8aa3b, v83
    v_exp_f32 v9, v9
    v_exp_f32 v10, v10
    v_exp_f32 v11, v11
    v_exp_f32 v12, v12
    s_nop 0
    v_add_f32 v9, 1.0, v9
    v_add_f32 v10, 1.0, v10
    v_add_f32 v11, 1.0, v11
    v_add_f32 v12, 1.0, v12
    v_rcp_f32 v9, v9
    v_rcp_f32 v10, v10
    v_rcp_f32 v11, v11
    v_rcp_f32 v12, v12
    s_nop 0
    v_mul_f32 v80, v80, v9
    v_mul_f32 v81, v81, v10
    v_mul_f32 v82, v82, v11
    v_mul_f32 v83, v83, v12
    v_cvt_pk_bf16_f32 v80, v80, v81
    v_cvt_pk_bf16_f32 v81, v82, v83
    ds_write_b64 v8, v[80:81] offset:0
    v_cvt_pk_bf16_f32 v84, v84, v84
    v_lshlrev_b32 v84, 16, v84
    v_mul_f32 v9, 0xbfb8aa3b, v84
    v_cvt_pk_bf16_f32 v85, v85, v85
    v_lshlrev_b32 v85, 16, v85
    v_mul_f32 v10, 0xbfb8aa3b, v85
    v_cvt_pk_bf16_f32 v86, v86, v86
    v_lshlrev_b32 v86, 16, v86
    v_mul_f32 v11, 0xbfb8aa3b, v86
    v_cvt_pk_bf16_f32 v87, v87, v87
    v_lshlrev_b32 v87, 16, v87
    v_mul_f32 v12, 0xbfb8aa3b, v87
    v_exp_f32 v9, v9
    v_exp_f32 v10, v10
    v_exp_f32 v11, v11
    v_exp_f32 v12, v12
    s_nop 0
    v_add_f32 v9, 1.0, v9
    v_add_f32 v10, 1.0, v10
    v_add_f32 v11, 1.0, v11
    v_add_f32 v12, 1.0, v12
    v_rcp_f32 v9, v9
    v_rcp_f32 v10, v10
    v_rcp_f32 v11, v11
    v_rcp_f32 v12, v12
    s_nop 0
    v_mul_f32 v84, v84, v9
    v_mul_f32 v85, v85, v10
    v_mul_f32 v86, v86, v11
    v_mul_f32 v87, v87, v12
    v_cvt_pk_bf16_f32 v84, v84, v85
    v_cvt_pk_bf16_f32 v85, v86, v87
    ds_write_b64 v8, v[84:85] offset:32
    v_cvt_pk_bf16_f32 v88, v88, v88
    v_lshlrev_b32 v88, 16, v88
    v_mul_f32 v9, 0xbfb8aa3b, v88
    v_cvt_pk_bf16_f32 v89, v89, v89
    v_lshlrev_b32 v89, 16, v89
    v_mul_f32 v10, 0xbfb8aa3b, v89
    v_cvt_pk_bf16_f32 v90, v90, v90
    v_lshlrev_b32 v90, 16, v90
    v_mul_f32 v11, 0xbfb8aa3b, v90
    v_cvt_pk_bf16_f32 v91, v91, v91
    v_lshlrev_b32 v91, 16, v91
    v_mul_f32 v12, 0xbfb8aa3b, v91
    v_exp_f32 v9, v9
    v_exp_f32 v10, v10
    v_exp_f32 v11, v11
    v_exp_f32 v12, v12
    s_nop 0
    v_add_f32 v9, 1.0, v9
    v_add_f32 v10, 1.0, v10
    v_add_f32 v11, 1.0, v11
    v_add_f32 v12, 1.0, v12
    v_rcp_f32 v9, v9
    v_rcp_f32 v10, v10
    v_rcp_f32 v11, v11
    v_rcp_f32 v12, v12
    s_nop 0
    v_mul_f32 v88, v88, v9
    v_mul_f32 v89, v89, v10
    v_mul_f32 v90, v90, v11
    v_mul_f32 v91, v91, v12
    v_cvt_pk_bf16_f32 v88, v88, v89
    v_cvt_pk_bf16_f32 v89, v90, v91
    ds_write_b64 v8, v[88:89] offset:64
    v_cvt_pk_bf16_f32 v92, v92, v92
    v_lshlrev_b32 v92, 16, v92
    v_mul_f32 v9, 0xbfb8aa3b, v92
    v_cvt_pk_bf16_f32 v93, v93, v93
    v_lshlrev_b32 v93, 16, v93
    v_mul_f32 v10, 0xbfb8aa3b, v93
    v_cvt_pk_bf16_f32 v94, v94, v94
    v_lshlrev_b32 v94, 16, v94
    v_mul_f32 v11, 0xbfb8aa3b, v94
    v_cvt_pk_bf16_f32 v95, v95, v95
    v_lshlrev_b32 v95, 16, v95
    v_mul_f32 v12, 0xbfb8aa3b, v95
    v_exp_f32 v9, v9
    v_exp_f32 v10, v10
    v_exp_f32 v11, v11
    v_exp_f32 v12, v12
    s_nop 0
    v_add_f32 v9, 1.0, v9
    v_add_f32 v10, 1.0, v10
    v_add_f32 v11, 1.0, v11
    v_add_f32 v12, 1.0, v12
    v_rcp_f32 v9, v9
    v_rcp_f32 v10, v10
    v_rcp_f32 v11, v11
    v_rcp_f32 v12, v12
    s_nop 0
    v_mul_f32 v92, v92, v9
    v_mul_f32 v93, v93, v10
    v_mul_f32 v94, v94, v11
    v_mul_f32 v95, v95, v12
    v_cvt_pk_bf16_f32 v92, v92, v93
    v_cvt_pk_bf16_f32 v93, v94, v95
    ds_write_b64 v8, v[92:93] offset:96
    v_cvt_pk_bf16_f32 v96, v96, v96
    v_lshlrev_b32 v96, 16, v96
    v_mul_f32 v9, 0xbfb8aa3b, v96
    v_cvt_pk_bf16_f32 v97, v97, v97
    v_lshlrev_b32 v97, 16, v97
    v_mul_f32 v10, 0xbfb8aa3b, v97
    v_cvt_pk_bf16_f32 v98, v98, v98
    v_lshlrev_b32 v98, 16, v98
    v_mul_f32 v11, 0xbfb8aa3b, v98
    v_cvt_pk_bf16_f32 v99, v99, v99
    v_lshlrev_b32 v99, 16, v99
    v_mul_f32 v12, 0xbfb8aa3b, v99
    v_exp_f32 v9, v9
    v_exp_f32 v10, v10
    v_exp_f32 v11, v11
    v_exp_f32 v12, v12
    s_nop 0
    v_add_f32 v9, 1.0, v9
    v_add_f32 v10, 1.0, v10
    v_add_f32 v11, 1.0, v11
    v_add_f32 v12, 1.0, v12
    v_rcp_f32 v9, v9
    v_rcp_f32 v10, v10
    v_rcp_f32 v11, v11
    v_rcp_f32 v12, v12
    s_nop 0
    v_mul_f32 v96, v96, v9
    v_mul_f32 v97, v97, v10
    v_mul_f32 v98, v98, v11
    v_mul_f32 v99, v99, v12
    v_cvt_pk_bf16_f32 v96, v96, v97
    v_cvt_pk_bf16_f32 v97, v98, v99
    ds_write_b64 v8, v[96:97] offset:4352
    v_cvt_pk_bf16_f32 v100, v100, v100
    v_lshlrev_b32 v100, 16, v100
    v_mul_f32 v9, 0xbfb8aa3b, v100
    v_cvt_pk_bf16_f32 v101, v101, v101
    v_lshlrev_b32 v101, 16, v101
    v_mul_f32 v10, 0xbfb8aa3b, v101
    v_cvt_pk_bf16_f32 v102, v102, v102
    v_lshlrev_b32 v102, 16, v102
    v_mul_f32 v11, 0xbfb8aa3b, v102
    v_cvt_pk_bf16_f32 v103, v103, v103
    v_lshlrev_b32 v103, 16, v103
    v_mul_f32 v12, 0xbfb8aa3b, v103
    v_exp_f32 v9, v9
    v_exp_f32 v10, v10
    v_exp_f32 v11, v11
    v_exp_f32 v12, v12
    s_nop 0
    v_add_f32 v9, 1.0, v9
    v_add_f32 v10, 1.0, v10
    v_add_f32 v11, 1.0, v11
    v_add_f32 v12, 1.0, v12
    v_rcp_f32 v9, v9
    v_rcp_f32 v10, v10
    v_rcp_f32 v11, v11
    v_rcp_f32 v12, v12
    s_nop 0
    v_mul_f32 v100, v100, v9
    v_mul_f32 v101, v101, v10
    v_mul_f32 v102, v102, v11
    v_mul_f32 v103, v103, v12
    v_cvt_pk_bf16_f32 v100, v100, v101
    v_cvt_pk_bf16_f32 v101, v102, v103
    ds_write_b64 v8, v[100:101] offset:4384
    v_cvt_pk_bf16_f32 v104, v104, v104
    v_lshlrev_b32 v104, 16, v104
    v_mul_f32 v9, 0xbfb8aa3b, v104
    v_cvt_pk_bf16_f32 v105, v105, v105
    v_lshlrev_b32 v105, 16, v105
    v_mul_f32 v10, 0xbfb8aa3b, v105
    v_cvt_pk_bf16_f32 v106, v106, v106
    v_lshlrev_b32 v106, 16, v106
    v_mul_f32 v11, 0xbfb8aa3b, v106
    v_cvt_pk_bf16_f32 v107, v107, v107
    v_lshlrev_b32 v107, 16, v107
    v_mul_f32 v12, 0xbfb8aa3b, v107
    v_exp_f32 v9, v9
    v_exp_f32 v10, v10
    v_exp_f32 v11, v11
    v_exp_f32 v12, v12
    s_nop 0
    v_add_f32 v9, 1.0, v9
    v_add_f32 v10, 1.0, v10
    v_add_f32 v11, 1.0, v11
    v_add_f32 v12, 1.0, v12
    v_rcp_f32 v9, v9
    v_rcp_f32 v10, v10
    v_rcp_f32 v11, v11
    v_rcp_f32 v12, v12
    s_nop 0
    v_mul_f32 v104, v104, v9
    v_mul_f32 v105, v105, v10
    v_mul_f32 v106, v106, v11
    v_mul_f32 v107, v107, v12
    v_cvt_pk_bf16_f32 v104, v104, v105
    v_cvt_pk_bf16_f32 v105, v106, v107
    ds_write_b64 v8, v[104:105] offset:4416
    v_cvt_pk_bf16_f32 v108, v108, v108
    v_lshlrev_b32 v108, 16, v108
    v_mul_f32 v9, 0xbfb8aa3b, v108
    v_cvt_pk_bf16_f32 v109, v109, v109
    v_lshlrev_b32 v109, 16, v109
    v_mul_f32 v10, 0xbfb8aa3b, v109
    v_cvt_pk_bf16_f32 v110, v110, v110
    v_lshlrev_b32 v110, 16, v110
    v_mul_f32 v11, 0xbfb8aa3b, v110
    v_cvt_pk_bf16_f32 v111, v111, v111
    v_lshlrev_b32 v111, 16, v111
    v_mul_f32 v12, 0xbfb8aa3b, v111
    v_exp_f32 v9, v9
    v_exp_f32 v10, v10
    v_exp_f32 v11, v11
    v_exp_f32 v12, v12
    s_nop 0
    v_add_f32 v9, 1.0, v9
    v_add_f32 v10, 1.0, v10
    v_add_f32 v11, 1.0, v11
    v_add_f32 v12, 1.0, v12
    v_rcp_f32 v9, v9
    v_rcp_f32 v10, v10
    v_rcp_f32 v11, v11
    v_rcp_f32 v12, v12
    s_nop 0
    v_mul_f32 v108, v108, v9
    v_mul_f32 v109, v109, v10
    v_mul_f32 v110, v110, v11
    v_mul_f32 v111, v111, v12
    v_cvt_pk_bf16_f32 v108, v108, v109
    v_cvt_pk_bf16_f32 v109, v110, v111
    ds_write_b64 v8, v[108:109] offset:4448
    v_cvt_pk_bf16_f32 v112, v112, v112
    v_lshlrev_b32 v112, 16, v112
    v_mul_f32 v9, 0xbfb8aa3b, v112
    v_cvt_pk_bf16_f32 v113, v113, v113
    v_lshlrev_b32 v113, 16, v113
    v_mul_f32 v10, 0xbfb8aa3b, v113
    v_cvt_pk_bf16_f32 v114, v114, v114
    v_lshlrev_b32 v114, 16, v114
    v_mul_f32 v11, 0xbfb8aa3b, v114
    v_cvt_pk_bf16_f32 v115, v115, v115
    v_lshlrev_b32 v115, 16, v115
    v_mul_f32 v12, 0xbfb8aa3b, v115
    v_exp_f32 v9, v9
    v_exp_f32 v10, v10
    v_exp_f32 v11, v11
    v_exp_f32 v12, v12
    s_nop 0
    v_add_f32 v9, 1.0, v9
    v_add_f32 v10, 1.0, v10
    v_add_f32 v11, 1.0, v11
    v_add_f32 v12, 1.0, v12
    v_rcp_f32 v9, v9
    v_rcp_f32 v10, v10
    v_rcp_f32 v11, v11
    v_rcp_f32 v12, v12
    s_nop 0
    v_mul_f32 v112, v112, v9
    v_mul_f32 v113, v113, v10
    v_mul_f32 v114, v114, v11
    v_mul_f32 v115, v115, v12
    v_cvt_pk_bf16_f32 v112, v112, v113
    v_cvt_pk_bf16_f32 v113, v114, v115
    ds_write_b64 v8, v[112:113] offset:8704
    v_cvt_pk_bf16_f32 v116, v116, v116
    v_lshlrev_b32 v116, 16, v116
    v_mul_f32 v9, 0xbfb8aa3b, v116
    v_cvt_pk_bf16_f32 v117, v117, v117
    v_lshlrev_b32 v117, 16, v117
    v_mul_f32 v10, 0xbfb8aa3b, v117
    v_cvt_pk_bf16_f32 v118, v118, v118
    v_lshlrev_b32 v118, 16, v118
    v_mul_f32 v11, 0xbfb8aa3b, v118
    v_cvt_pk_bf16_f32 v119, v119, v119
    v_lshlrev_b32 v119, 16, v119
    v_mul_f32 v12, 0xbfb8aa3b, v119
    v_exp_f32 v9, v9
    v_exp_f32 v10, v10
    v_exp_f32 v11, v11
    v_exp_f32 v12, v12
    s_nop 0
    v_add_f32 v9, 1.0, v9
    v_add_f32 v10, 1.0, v10
    v_add_f32 v11, 1.0, v11
    v_add_f32 v12, 1.0, v12
    v_rcp_f32 v9, v9
    v_rcp_f32 v10, v10
    v_rcp_f32 v11, v11
    v_rcp_f32 v12, v12
    s_nop 0
    v_mul_f32 v116, v116, v9
    v_mul_f32 v117, v117, v10
    v_mul_f32 v118, v118, v11
    v_mul_f32 v119, v119, v12
    v_cvt_pk_bf16_f32 v116, v116, v117
    v_cvt_pk_bf16_f32 v117, v118, v119
    ds_write_b64 v8, v[116:117] offset:8736
    v_cvt_pk_bf16_f32 v120, v120, v120
    v_lshlrev_b32 v120, 16, v120
    v_mul_f32 v9, 0xbfb8aa3b, v120
    v_cvt_pk_bf16_f32 v121, v121, v121
    v_lshlrev_b32 v121, 16, v121
    v_mul_f32 v10, 0xbfb8aa3b, v121
    v_cvt_pk_bf16_f32 v122, v122, v122
    v_lshlrev_b32 v122, 16, v122
    v_mul_f32 v11, 0xbfb8aa3b, v122
    v_cvt_pk_bf16_f32 v123, v123, v123
    v_lshlrev_b32 v123, 16, v123
    v_mul_f32 v12, 0xbfb8aa3b, v123
    v_exp_f32 v9, v9
    v_exp_f32 v10, v10
    v_exp_f32 v11, v11
    v_exp_f32 v12, v12
    s_nop 0
    v_add_f32 v9, 1.0, v9
    v_add_f32 v10, 1.0, v10
    v_add_f32 v11, 1.0, v11
    v_add_f32 v12, 1.0, v12
    v_rcp_f32 v9, v9
    v_rcp_f32 v10, v10
    v_rcp_f32 v11, v11
    v_rcp_f32 v12, v12
    s_nop 0
    v_mul_f32 v120, v120, v9
    v_mul_f32 v121, v121, v10
    v_mul_f32 v122, v122, v11
    v_mul_f32 v123, v123, v12
    v_cvt_pk_bf16_f32 v120, v120, v121
    v_cvt_pk_bf16_f32 v121, v122, v123
    ds_write_b64 v8, v[120:121] offset:8768
    v_cvt_pk_bf16_f32 v124, v124, v124
    v_lshlrev_b32 v124, 16, v124
    v_mul_f32 v9, 0xbfb8aa3b, v124
    v_cvt_pk_bf16_f32 v125, v125, v125
    v_lshlrev_b32 v125, 16, v125
    v_mul_f32 v10, 0xbfb8aa3b, v125
    v_cvt_pk_bf16_f32 v126, v126, v126
    v_lshlrev_b32 v126, 16, v126
    v_mul_f32 v11, 0xbfb8aa3b, v126
    v_cvt_pk_bf16_f32 v127, v127, v127
    v_lshlrev_b32 v127, 16, v127
    v_mul_f32 v12, 0xbfb8aa3b, v127
    v_exp_f32 v9, v9
    v_exp_f32 v10, v10
    v_exp_f32 v11, v11
    v_exp_f32 v12, v12
    s_nop 0
    v_add_f32 v9, 1.0, v9
    v_add_f32 v10, 1.0, v10
    v_add_f32 v11, 1.0, v11
    v_add_f32 v12, 1.0, v12
    v_rcp_f32 v9, v9
    v_rcp_f32 v10, v10
    v_rcp_f32 v11, v11
    v_rcp_f32 v12, v12
    s_nop 0
    v_mul_f32 v124, v124, v9
    v_mul_f32 v125, v125, v10
    v_mul_f32 v126, v126, v11
    v_mul_f32 v127, v127, v12
    v_cvt_pk_bf16_f32 v124, v124, v125
    v_cvt_pk_bf16_f32 v125, v126, v127
    ds_write_b64 v8, v[124:125] offset:8800
    v_cvt_pk_bf16_f32 v128, v128, v128
    v_lshlrev_b32 v128, 16, v128
    v_mul_f32 v9, 0xbfb8aa3b, v128
    v_cvt_pk_bf16_f32 v129, v129, v129
    v_lshlrev_b32 v129, 16, v129
    v_mul_f32 v10, 0xbfb8aa3b, v129
    v_cvt_pk_bf16_f32 v130, v130, v130
    v_lshlrev_b32 v130, 16, v130
    v_mul_f32 v11, 0xbfb8aa3b, v130
    v_cvt_pk_bf16_f32 v131, v131, v131
    v_lshlrev_b32 v131, 16, v131
    v_mul_f32 v12, 0xbfb8aa3b, v131
    v_exp_f32 v9, v9
    v_exp_f32 v10, v10
    v_exp_f32 v11, v11
    v_exp_f32 v12, v12
    s_nop 0
    v_add_f32 v9, 1.0, v9
    v_add_f32 v10, 1.0, v10
    v_add_f32 v11, 1.0, v11
    v_add_f32 v12, 1.0, v12
    v_rcp_f32 v9, v9
    v_rcp_f32 v10, v10
    v_rcp_f32 v11, v11
    v_rcp_f32 v12, v12
    s_nop 0
    v_mul_f32 v128, v128, v9
    v_mul_f32 v129, v129, v10
    v_mul_f32 v130, v130, v11
    v_mul_f32 v131, v131, v12
    v_cvt_pk_bf16_f32 v128, v128, v129
    v_cvt_pk_bf16_f32 v129, v130, v131
    ds_write_b64 v8, v[128:129] offset:13056
    v_cvt_pk_bf16_f32 v132, v132, v132
    v_lshlrev_b32 v132, 16, v132
    v_mul_f32 v9, 0xbfb8aa3b, v132
    v_cvt_pk_bf16_f32 v133, v133, v133
    v_lshlrev_b32 v133, 16, v133
    v_mul_f32 v10, 0xbfb8aa3b, v133
    v_cvt_pk_bf16_f32 v134, v134, v134
    v_lshlrev_b32 v134, 16, v134
    v_mul_f32 v11, 0xbfb8aa3b, v134
    v_cvt_pk_bf16_f32 v135, v135, v135
    v_lshlrev_b32 v135, 16, v135
    v_mul_f32 v12, 0xbfb8aa3b, v135
    v_exp_f32 v9, v9
    v_exp_f32 v10, v10
    v_exp_f32 v11, v11
    v_exp_f32 v12, v12
    s_nop 0
    v_add_f32 v9, 1.0, v9
    v_add_f32 v10, 1.0, v10
    v_add_f32 v11, 1.0, v11
    v_add_f32 v12, 1.0, v12
    v_rcp_f32 v9, v9
    v_rcp_f32 v10, v10
    v_rcp_f32 v11, v11
    v_rcp_f32 v12, v12
    s_nop 0
    v_mul_f32 v132, v132, v9
    v_mul_f32 v133, v133, v10
    v_mul_f32 v134, v134, v11
    v_mul_f32 v135, v135, v12
    v_cvt_pk_bf16_f32 v132, v132, v133
    v_cvt_pk_bf16_f32 v133, v134, v135
    ds_write_b64 v8, v[132:133] offset:13088
    v_cvt_pk_bf16_f32 v136, v136, v136
    v_lshlrev_b32 v136, 16, v136
    v_mul_f32 v9, 0xbfb8aa3b, v136
    v_cvt_pk_bf16_f32 v137, v137, v137
    v_lshlrev_b32 v137, 16, v137
    v_mul_f32 v10, 0xbfb8aa3b, v137
    v_cvt_pk_bf16_f32 v138, v138, v138
    v_lshlrev_b32 v138, 16, v138
    v_mul_f32 v11, 0xbfb8aa3b, v138
    v_cvt_pk_bf16_f32 v139, v139, v139
    v_lshlrev_b32 v139, 16, v139
    v_mul_f32 v12, 0xbfb8aa3b, v139
    v_exp_f32 v9, v9
    v_exp_f32 v10, v10
    v_exp_f32 v11, v11
    v_exp_f32 v12, v12
    s_nop 0
    v_add_f32 v9, 1.0, v9
    v_add_f32 v10, 1.0, v10
    v_add_f32 v11, 1.0, v11
    v_add_f32 v12, 1.0, v12
    v_rcp_f32 v9, v9
    v_rcp_f32 v10, v10
    v_rcp_f32 v11, v11
    v_rcp_f32 v12, v12
    s_nop 0
    v_mul_f32 v136, v136, v9
    v_mul_f32 v137, v137, v10
    v_mul_f32 v138, v138, v11
    v_mul_f32 v139, v139, v12
    v_cvt_pk_bf16_f32 v136, v136, v137
    v_cvt_pk_bf16_f32 v137, v138, v139
    ds_write_b64 v8, v[136:137] offset:13120
    v_cvt_pk_bf16_f32 v140, v140, v140
    v_lshlrev_b32 v140, 16, v140
    v_mul_f32 v9, 0xbfb8aa3b, v140
    v_cvt_pk_bf16_f32 v141, v141, v141
    v_lshlrev_b32 v141, 16, v141
    v_mul_f32 v10, 0xbfb8aa3b, v141
    v_cvt_pk_bf16_f32 v142, v142, v142
    v_lshlrev_b32 v142, 16, v142
    v_mul_f32 v11, 0xbfb8aa3b, v142
    v_cvt_pk_bf16_f32 v143, v143, v143
    v_lshlrev_b32 v143, 16, v143
    v_mul_f32 v12, 0xbfb8aa3b, v143
    v_exp_f32 v9, v9
    v_exp_f32 v10, v10
    v_exp_f32 v11, v11
    v_exp_f32 v12, v12
    s_nop 0
    v_add_f32 v9, 1.0, v9
    v_add_f32 v10, 1.0, v10
    v_add_f32 v11, 1.0, v11
    v_add_f32 v12, 1.0, v12
    v_rcp_f32 v9, v9
    v_rcp_f32 v10, v10
    v_rcp_f32 v11, v11
    v_rcp_f32 v12, v12
    s_nop 0
    v_mul_f32 v140, v140, v9
    v_mul_f32 v141, v141, v10
    v_mul_f32 v142, v142, v11
    v_mul_f32 v143, v143, v12
    v_cvt_pk_bf16_f32 v140, v140, v141
    v_cvt_pk_bf16_f32 v141, v142, v143
    ds_write_b64 v8, v[140:141] offset:13152
    s_waitcnt lgkmcnt(0)
k4_kernel_e2:
    s_barrier
    s_mul_i32 s29, s24, 3456
    s_lshl_b32 s30, s25, 1
    s_add_u32 s29, s29, s30
    v_add_u32 v8, 0, v0
    v_mul_u32_u24 v9, 4097, v8
    v_lshrrev_b32 v9, 16, v9
    v_mul_u32_u24 v10, 16, v9
    v_sub_u32 v10, v8, v10
    v_mul_u32_u24 v11, 272, v9
    v_lshl_add_u32 v11, v10, 4, v11
    ds_read_b128 v[16:19], v11 offset:0
    v_mul_u32_u24 v11, 3456, v9
    v_lshl_add_u32 v24, v10, 4, v11
    v_lshlrev_b32 v12, 3, v10
    v_add_u32 v12, s25, v12
    v_cmp_gt_u32 vcc, 2048, v8
    s_mov_b64 s[34:35], vcc
    v_cmp_gt_u32 vcc, 1728, v12
    s_and_b64 s[34:35], s[34:35], vcc
    v_cndmask_b32 v24, -1, v24, s[34:35]
    v_add_u32 v8, 640, v0
    v_mul_u32_u24 v9, 4097, v8
    v_lshrrev_b32 v9, 16, v9
    v_mul_u32_u24 v10, 16, v9
    v_sub_u32 v10, v8, v10
    v_mul_u32_u24 v11, 272, v9
    v_lshl_add_u32 v11, v10, 4, v11
    ds_read_b128 v[28:31], v11 offset:0
    v_mul_u32_u24 v11, 3456, v9
    v_lshl_add_u32 v36, v10, 4, v11
    v_lshlrev_b32 v12, 3, v10
    v_add_u32 v12, s25, v12
    v_cmp_gt_u32 vcc, 2048, v8
    s_mov_b64 s[34:35], vcc
    v_cmp_gt_u32 vcc, 1728, v12
    s_and_b64 s[34:35], s[34:35], vcc
    v_cndmask_b32 v36, -1, v36, s[34:35]
    v_add_u32 v8, 1280, v0
    v_mul_u32_u24 v9, 4097, v8
    v_lshrrev_b32 v9, 16, v9
    v_mul_u32_u24 v10, 16, v9
    v_sub_u32 v10, v8, v10
    v_mul_u32_u24 v11, 272, v9
    v_lshl_add_u32 v11, v10, 4, v11
    ds_read_b128 v[40:43], v11 offset:0
    v_mul_u32_u24 v11, 3456, v9
    v_lshl_add_u32 v48, v10, 4, v11
    v_lshlrev_b32 v12, 3, v10
    v_add_u32 v12, s25, v12
    v_cmp_gt_u32 vcc, 2048, v8
    s_mov_b64 s[34:35], vcc
    v_cmp_gt_u32 vcc, 1728, v12
    s_and_b64 s[34:35], s[34:35], vcc
    v_cndmask_b32 v48, -1, v48, s[34:35]
    v_add_u32 v8, 1920, v0
    v_mul_u32_u24 v9, 4097, v8
    v_lshrrev_b32 v9, 16, v9
    v_mul_u32_u24 v10, 16, v9
    v_sub_u32 v10, v8, v10
    v_mul_u32_u24 v11, 272, v9
    v_lshl_add_u32 v11, v10, 4, v11
    ds_read_b128 v[52:55], v11 offset:0
    v_mul_u32_u24 v11, 3456, v9
    v_lshl_add_u32 v60, v10, 4, v11
    v_lshlrev_b32 v12, 3, v10
    v_add_u32 v12, s25, v12
    v_cmp_gt_u32 vcc, 2048, v8
    s_mov_b64 s[34:35], vcc
    v_cmp_gt_u32 vcc, 1728, v12
    s_and_b64 s[34:35], s[34:35], vcc
    v_cndmask_b32 v60, -1, v60, s[34:35]
    s_waitcnt vmcnt(0) lgkmcnt(0)
    buffer_store_dwordx4 v[16:19], v24, s[16:19], s29 offen
    buffer_store_dwordx4 v[28:31], v36, s[16:19], s29 offen
    buffer_store_dwordx4 v[40:43], v48, s[16:19], s29 offen
    buffer_store_dwordx4 v[52:55], v60, s[16:19], s29 offen
    s_waitcnt vmcnt(0)
k4_kernel_end:
    s_endpgm

.globl k5_kernel
.p2align 8
.type k5_kernel,@function
k5_kernel:
    s_cmp_ge_u32 s2, 256
    s_cbranch_scc1 k5_kernel_end
    s_load_dwordx16 s[64:79], s[0:1], 0
    s_load_dwordx4 s[80:83], s[0:1], 64
    v_and_b32 v1, 63, v0
    v_lshrrev_b32 v2, 6, v0
    s_nop 0
    v_readfirstlane_b32 s26, v2
    s_nop 1
    s_waitcnt lgkmcnt(0)
    s_add_u32 s8, s82, 27262976
    s_addc_u32 s9, s83, 0
    s_and_b32 s9, s9, 0xffff
    s_mov_b32 s10, 7077888
    s_mov_b32 s11, 0x00020000
    s_mov_b32 s12, s76
    s_and_b32 s13, s77, 0xffff
    s_mov_b32 s14, 2211840
    s_mov_b32 s15, 0x00020000
    s_mov_b32 s16, s78
    s_and_b32 s17, s79, 0xffff
    s_mov_b32 s18, 2621440
    s_mov_b32 s19, 0x00020000
    s_add_u32 s20, s82, 20971520
    s_addc_u32 s21, s83, 0
    s_and_b32 s21, s21, 0xffff
    s_mov_b32 s22, 2621440
    s_mov_b32 s23, 0x00020000
    s_and_b32 s29, s2, 7
    s_lshr_b32 s30, s2, 3
    s_mul_i32 s31, s29, 257
    s_lshr_b32 s31, s31, 8
    s_mul_i32 s32, s31, 1
    s_sub_u32 s32, s29, s32
    s_mul_i32 s33, s30, 65
    s_lshr_b32 s33, s33, 9
    s_mul_i32 s34, s33, 8
    s_sub_u32 s34, s30, s34
    s_mul_i32 s24, s31, 4
    s_add_u32 s24, s24, s33
    s_mul_i32 s25, s32, 8
    s_add_u32 s25, s25, s34
    s_mul_i32 s24, s24, 64
    s_mul_i32 s25, s25, 80
    s_cmp_ge_u32 s26, 4
    s_cbranch_scc1 k5_kernel_ld
    s_mul_i32 s27, s26, 16
    s_mov_b32 s28, 0
    v_and_b32 v8, 15, v1
    v_lshrrev_b32 v9, 4, v1
    v_lshrrev_b32 v10, 1, v1
    v_and_b32 v10, 7, v10
    v_xor_b32 v10, v10, v9
    v_lshlrev_b32 v10, 4, v10
    v_add_u32 v11, s27, v8
    v_lshlrev_b32 v11, 7, v11
    v_add_u32 v2, v11, v10
    v_xor_b32 v3, 64, v2
    v_lshrrev_b32 v10, 2, v8
    v_and_b32 v11, 3, v1
    v_and_b32 v12, 1, v9
    v_lshlrev_b32 v12, 2, v12
    v_add_u32 v12, v12, v10
    v_lshrrev_b32 v13, 1, v9
    v_lshl_add_u32 v12, v13, 4, v12
    v_mul_u32_u24 v12, 160, v12
    s_lshl_b32 s29, s28, 1
    v_lshl_add_u32 v13, v11, 3, v12
    v_add_u32 v4, s29, v13
    v_mov_b32 v64, 0
    v_mov_b32 v65, 0
    v_mov_b32 v66, 0
    v_mov_b32 v67, 0
    v_mov_b32 v68, 0
    v_mov_b32 v69, 0
    v_mov_b32 v70, 0
    v_mov_b32 v71, 0
    v_mov_b32 v72, 0
    v_mov_b32 v73, 0
    v_mov_b32 v74, 0
    v_mov_b32 v75, 0
    v_mov_b32 v76, 0
    v_mov_b32 v77, 0
    v_mov_b32 v78, 0
    v_mov_b32 v79, 0
    v_mov_b32 v80, 0
    v_mov_b32 v81, 0
    v_mov_b32 v82, 0
    v_mov_b32 v83, 0
    s_barrier
    v_add_u32 v8, 0, v2
    v_add_u32 v9, 8192, v4
    ds_read_b128 v[16:19], v8 offset:0
    ds_read_b64_tr_b16 v[24:25], v9 offset:0
    ds_read_b64_tr_b16 v[26:27], v9 offset:1280
    ds_read_b64_tr_b16 v[28:29], v9 offset:32
    ds_read_b64_tr_b16 v[30:31], v9 offset:1312
    ds_read_b64_tr_b16 v[32:33], v9 offset:64
    ds_read_b64_tr_b16 v[34:35], v9 offset:1344
    ds_read_b64_tr_b16 v[36:37], v9 offset:96
    ds_read_b64_tr_b16 v[38:39], v9 offset:1376
    ds_read_b64_tr_b16 v[40:41], v9 offset:128
    ds_read_b64_tr_b16 v[42:43], v9 offset:1408
    v_add_u32 v8, 0, v3
    v_add_u32 v9, 8192, v4
    ds_read_b128 v[20:23], v8 offset:0
    ds_read_b64_tr_b16 v[44:45], v9 offset:5120
    ds_read_b64_tr_b16 v[46:47], v9 offset:6400
    ds_read_b64_tr_b16 v[48:49], v9 offset:5152
    ds_read_b64_tr_b16 v[50:51], v9 offset:6432
    ds_read_b64_tr_b16 v[52:53], v9 offset:5184
    ds_read_b64_tr_b16 v[54:55], v9 offset:6464
    ds_read_b64_tr_b16 v[56:57], v9 offset:5216
    ds_read_b64_tr_b16 v[58:59], v9 offset:6496
    ds_read_b64_tr_b16 v[60:61], v9 offset:5248
    ds_read_b64_tr_b16 v[62:63], v9 offset:6528
    s_waitcnt lgkmcnt(11)
    v_mfma_f32_16x16x32_bf16 v[64:67], v[24:27], v[16:19], v[64:67]
    v_mfma_f32_16x16x32_bf16 v[68:71], v[28:31], v[16:19], v[68:71]
    v_mfma_f32_16x16x32_bf16 v[72:75], v[32:35], v[16:19], v[72:75]
    v_mfma_f32_16x16x32_bf16 v[76:79], v[36:39], v[16:19], v[76:79]
    v_mfma_f32_16x16x32_bf16 v[80:83], v[40:43], v[16:19], v[80:83]
    s_waitcnt lgkmcnt(0)
    s_barrier
    v_add_u32 v8, 18432, v2
    v_add_u32 v9, 26624, v4
    ds_read_b128 v[16:19], v8 offset:0
    ds_read_b64_tr_b16 v[24:25], v9 offset:0
    ds_read_b64_tr_b16 v[26:27], v9 offset:1280
    ds_read_b64_tr_b16 v[28:29], v9 offset:32
    ds_read_b64_tr_b16 v[30:31], v9 offset:1312
    ds_read_b64_tr_b16 v[32:33], v9 offset:64
    ds_read_b64_tr_b16 v[34:35], v9 offset:1344
    ds_read_b64_tr_b16 v[36:37], v9 offset:96
    ds_read_b64_tr_b16 v[38:39], v9 offset:1376
    ds_read_b64_tr_b16 v[40:41], v9 offset:128
    ds_read_b64_tr_b16 v[42:43], v9 offset:1408
    v_mfma_f32_16x16x32_bf16 v[64:67], v[44:47], v[20:23], v[64:67]
    v_mfma_f32_16x16x32_bf16 v[68:71], v[48:51], v[20:23], v[68:71]
    v_mfma_f32_16x16x32_bf16 v[72:75], v[52:55], v[20:23], v[72:75]
    v_mfma_f32_16x16x32_bf16 v[76:79], v[56:59], v[20:23], v[76:79]
    v_mfma_f32_16x16x32_bf16 v[80:83], v[60:63], v[20:23], v[80:83]
    v_add_u32 v8, 18432, v3
    v_add_u32 v9, 26624, v4
    ds_read_b128 v[20:23], v8 offset:0
    ds_read_b64_tr_b16 v[44:45], v9 offset:5120
    ds_read_b64_tr_b16 v[46:47], v9 offset:6400
    ds_read_b64_tr_b16 v[48:49], v9 offset:5152
    ds_read_b64_tr_b16 v[50:51], v9 offset:6432
    ds_read_b64_tr_b16 v[52:53], v9 offset:5184
    ds_read_b64_tr_b16 v[54:55], v9 offset:6464
    ds_read_b64_tr_b16 v[56:57], v9 offset:5216
    ds_read_b64_tr_b16 v[58:59], v9 offset:6496
    ds_read_b64_tr_b16 v[60:61], v9 offset:5248
    ds_read_b64_tr_b16 v[62:63], v9 offset:6528
    s_waitcnt lgkmcnt(11)
    v_mfma_f32_16x16x32_bf16 v[64:67], v[24:27], v[16:19], v[64:67]
    v_mfma_f32_16x16x32_bf16 v[68:71], v[28:31], v[16:19], v[68:71]
    v_mfma_f32_16x16x32_bf16 v[72:75], v[32:35], v[16:19], v[72:75]
    v_mfma_f32_16x16x32_bf16 v[76:79], v[36:39], v[16:19], v[76:79]
    v_mfma_f32_16x16x32_bf16 v[80:83], v[40:43], v[16:19], v[80:83]
    s_waitcnt lgkmcnt(0)
    s_barrier
    v_add_u32 v8, 36864, v2
    v_add_u32 v9, 45056, v4
    ds_read_b128 v[16:19], v8 offset:0
    ds_read_b64_tr_b16 v[24:25], v9 offset:0
    ds_read_b64_tr_b16 v[26:27], v9 offset:1280
    ds_read_b64_tr_b16 v[28:29], v9 offset:32
    ds_read_b64_tr_b16 v[30:31], v9 offset:1312
    ds_read_b64_tr_b16 v[32:33], v9 offset:64
    ds_read_b64_tr_b16 v[34:35], v9 offset:1344
    ds_read_b64_tr_b16 v[36:37], v9 offset:96
    ds_read_b64_tr_b16 v[38:39], v9 offset:1376
    ds_read_b64_tr_b16 v[40:41], v9 offset:128
    ds_read_b64_tr_b16 v[42:43], v9 offset:1408
    v_mfma_f32_16x16x32_bf16 v[64:67], v[44:47], v[20:23], v[64:67]
    v_mfma_f32_16x16x32_bf16 v[68:71], v[48:51], v[20:23], v[68:71]
    v_mfma_f32_16x16x32_bf16 v[72:75], v[52:55], v[20:23], v[72:75]
    v_mfma_f32_16x16x32_bf16 v[76:79], v[56:59], v[20:23], v[76:79]
    v_mfma_f32_16x16x32_bf16 v[80:83], v[60:63], v[20:23], v[80:83]
    v_add_u32 v8, 36864, v3
    v_add_u32 v9, 45056, v4
    ds_read_b128 v[20:23], v8 offset:0
    ds_read_b64_tr_b16 v[44:45], v9 offset:5120
    ds_read_b64_tr_b16 v[46:47], v9 offset:6400
    ds_read_b64_tr_b16 v[48:49], v9 offset:5152
    ds_read_b64_tr_b16 v[50:51], v9 offset:6432
    ds_read_b64_tr_b16 v[52:53], v9 offset:5184
    ds_read_b64_tr_b16 v[54:55], v9 offset:6464
    ds_read_b64_tr_b16 v[56:57], v9 offset:5216
    ds_read_b64_tr_b16 v[58:59], v9 offset:6496
    ds_read_b64_tr_b16 v[60:61], v9 offset:5248
    ds_read_b64_tr_b16 v[62:63], v9 offset:6528
    s_waitcnt lgkmcnt(11)
    v_mfma_f32_16x16x32_bf16 v[64:67], v[24:27], v[16:19], v[64:67]
    v_mfma_f32_16x16x32_bf16 v[68:71], v[28:31], v[16:19], v[68:71]
    v_mfma_f32_16x16x32_bf16 v[72:75], v[32:35], v[16:19], v[72:75]
    v_mfma_f32_16x16x32_bf16 v[76:79], v[36:39], v[16:19], v[76:79]
    v_mfma_f32_16x16x32_bf16 v[80:83], v[40:43], v[16:19], v[80:83]
    s_waitcnt lgkmcnt(0)
    s_barrier
    v_add_u32 v8, 55296, v2
    v_add_u32 v9, 63488, v4
    ds_read_b128 v[16:19], v8 offset:0
    ds_read_b64_tr_b16 v[24:25], v9 offset:0
    ds_read_b64_tr_b16 v[26:27], v9 offset:1280
    ds_read_b64_tr_b16 v[28:29], v9 offset:32
    ds_read_b64_tr_b16 v[30:31], v9 offset:1312
    ds_read_b64_tr_b16 v[32:33], v9 offset:64
    ds_read_b64_tr_b16 v[34:35], v9 offset:1344
    ds_read_b64_tr_b16 v[36:37], v9 offset:96
    ds_read_b64_tr_b16 v[38:39], v9 offset:1376
    ds_read_b64_tr_b16 v[40:41], v9 offset:128
    ds_read_b64_tr_b16 v[42:43], v9 offset:1408
    v_mfma_f32_16x16x32_bf16 v[64:67], v[44:47], v[20:23], v[64:67]
    v_mfma_f32_16x16x32_bf16 v[68:71], v[48:51], v[20:23], v[68:71]
    v_mfma_f32_16x16x32_bf16 v[72:75], v[52:55], v[20:23], v[72:75]
    v_mfma_f32_16x16x32_bf16 v[76:79], v[56:59], v[20:23], v[76:79]
    v_mfma_f32_16x16x32_bf16 v[80:83], v[60:63], v[20:23], v[80:83]
    v_add_u32 v8, 55296, v3
    v_add_u32 v9, 63488, v4
    ds_read_b128 v[20:23], v8 offset:0
    ds_read_b64_tr_b16 v[44:45], v9 offset:5120
    ds_read_b64_tr_b16 v[46:47], v9 offset:6400
    ds_read_b64_tr_b16 v[48:49], v9 offset:5152
    ds_read_b64_tr_b16 v[50:51], v9 offset:6432
    ds_read_b64_tr_b16 v[52:53], v9 offset:5184
    ds_read_b64_tr_b16 v[54:55], v9 offset:6464
    ds_read_b64_tr_b16 v[56:57], v9 offset:5216
    ds_read_b64_tr_b16 v[58:59], v9 offset:6496
    ds_read_b64_tr_b16 v[60:61], v9 offset:5248
    ds_read_b64_tr_b16 v[62:63], v9 offset:6528
    s_waitcnt lgkmcnt(11)
    v_mfma_f32_16x16x32_bf16 v[64:67], v[24:27], v[16:19], v[64:67]
    v_mfma_f32_16x16x32_bf16 v[68:71], v[28:31], v[16:19], v[68:71]
    v_mfma_f32_16x16x32_bf16 v[72:75], v[32:35], v[16:19], v[72:75]
    v_mfma_f32_16x16x32_bf16 v[76:79], v[36:39], v[16:19], v[76:79]
    v_mfma_f32_16x16x32_bf16 v[80:83], v[40:43], v[16:19], v[80:83]
    s_waitcnt lgkmcnt(0)
    s_barrier
    v_add_u32 v8, 73728, v2
    v_add_u32 v9, 81920, v4
    ds_read_b128 v[16:19], v8 offset:0
    ds_read_b64_tr_b16 v[24:25], v9 offset:0
    ds_read_b64_tr_b16 v[26:27], v9 offset:1280
    ds_read_b64_tr_b16 v[28:29], v9 offset:32
    ds_read_b64_tr_b16 v[30:31], v9 offset:1312
    ds_read_b64_tr_b16 v[32:33], v9 offset:64
    ds_read_b64_tr_b16 v[34:35], v9 offset:1344
    ds_read_b64_tr_b16 v[36:37], v9 offset:96
    ds_read_b64_tr_b16 v[38:39], v9 offset:1376
    ds_read_b64_tr_b16 v[40:41], v9 offset:128
    ds_read_b64_tr_b16 v[42:43], v9 offset:1408
    v_mfma_f32_16x16x32_bf16 v[64:67], v[44:47], v[20:23], v[64:67]
    v_mfma_f32_16x16x32_bf16 v[68:71], v[48:51], v[20:23], v[68:71]
    v_mfma_f32_16x16x32_bf16 v[72:75], v[52:55], v[20:23], v[72:75]
    v_mfma_f32_16x16x32_bf16 v[76:79], v[56:59], v[20:23], v[76:79]
    v_mfma_f32_16x16x32_bf16 v[80:83], v[60:63], v[20:23], v[80:83]
    v_add_u32 v8, 73728, v3
    v_add_u32 v9, 81920, v4
    ds_read_b128 v[20:23], v8 offset:0
    ds_read_b64_tr_b16 v[44:45], v9 offset:5120
    ds_read_b64_tr_b16 v[46:47], v9 offset:6400
    ds_read_b64_tr_b16 v[48:49], v9 offset:5152
    ds_read_b64_tr_b16 v[50:51], v9 offset:6432
    ds_read_b64_tr_b16 v[52:53], v9 offset:5184
    ds_read_b64_tr_b16 v[54:55], v9 offset:6464
    ds_read_b64_tr_b16 v[56:57], v9 offset:5216
    ds_read_b64_tr_b16 v[58:59], v9 offset:6496
    ds_read_b64_tr_b16 v[60:61], v9 offset:5248
    ds_read_b64_tr_b16 v[62:63], v9 offset:6528
    s_waitcnt lgkmcnt(11)
    v_mfma_f32_16x16x32_bf16 v[64:67], v[24:27], v[16:19], v[64:67]
    v_mfma_f32_16x16x32_bf16 v[68:71], v[28:31], v[16:19], v[68:71]
    v_mfma_f32_16x16x32_bf16 v[72:75], v[32:35], v[16:19], v[72:75]
    v_mfma_f32_16x16x32_bf16 v[76:79], v[36:39], v[16:19], v[76:79]
    v_mfma_f32_16x16x32_bf16 v[80:83], v[40:43], v[16:19], v[80:83]
    s_waitcnt lgkmcnt(0)
    s_barrier
    v_add_u32 v8, 92160, v2
    v_add_u32 v9, 100352, v4
    ds_read_b128 v[16:19], v8 offset:0
    ds_read_b64_tr_b16 v[24:25], v9 offset:0
    ds_read_b64_tr_b16 v[26:27], v9 offset:1280
    ds_read_b64_tr_b16 v[28:29], v9 offset:32
    ds_read_b64_tr_b16 v[30:31], v9 offset:1312
    ds_read_b64_tr_b16 v[32:33], v9 offset:64
    ds_read_b64_tr_b16 v[34:35], v9 offset:1344
    ds_read_b64_tr_b16 v[36:37], v9 offset:96
    ds_read_b64_tr_b16 v[38:39], v9 offset:1376
    ds_read_b64_tr_b16 v[40:41], v9 offset:128
    ds_read_b64_tr_b16 v[42:43], v9 offset:1408
    v_mfma_f32_16x16x32_bf16 v[64:67], v[44:47], v[20:23], v[64:67]
    v_mfma_f32_16x16x32_bf16 v[68:71], v[48:51], v[20:23], v[68:71]
    v_mfma_f32_16x16x32_bf16 v[72:75], v[52:55], v[20:23], v[72:75]
    v_mfma_f32_16x16x32_bf16 v[76:79], v[56:59], v[20:23], v[76:79]
    v_mfma_f32_16x16x32_bf16 v[80:83], v[60:63], v[20:23], v[80:83]
    v_add_u32 v8, 92160, v3
    v_add_u32 v9, 100352, v4
    ds_read_b128 v[20:23], v8 offset:0
    ds_read_b64_tr_b16 v[44:45], v9 offset:5120
    ds_read_b64_tr_b16 v[46:47], v9 offset:6400
    ds_read_b64_tr_b16 v[48:49], v9 offset:5152
    ds_read_b64_tr_b16 v[50:51], v9 offset:6432
    ds_read_b64_tr_b16 v[52:53], v9 offset:5184
    ds_read_b64_tr_b16 v[54:55], v9 offset:6464
    ds_read_b64_tr_b16 v[56:57], v9 offset:5216
    ds_read_b64_tr_b16 v[58:59], v9 offset:6496
    ds_read_b64_tr_b16 v[60:61], v9 offset:5248
    ds_read_b64_tr_b16 v[62:63], v9 offset:6528
    s_waitcnt lgkmcnt(11)
    v_mfma_f32_16x16x32_bf16 v[64:67], v[24:27], v[16:19], v[64:67]
    v_mfma_f32_16x16x32_bf16 v[68:71], v[28:31], v[16:19], v[68:71]
    v_mfma_f32_16x16x32_bf16 v[72:75], v[32:35], v[16:19], v[72:75]
    v_mfma_f32_16x16x32_bf16 v[76:79], v[36:39], v[16:19], v[76:79]
    v_mfma_f32_16x16x32_bf16 v[80:83], v[40:43], v[16:19], v[80:83]
    s_waitcnt lgkmcnt(0)
    s_barrier
    v_add_u32 v8, 0, v2
    v_add_u32 v9, 8192, v4
    ds_read_b128 v[16:19], v8 offset:0
    ds_read_b64_tr_b16 v[24:25], v9 offset:0
    ds_read_b64_tr_b16 v[26:27], v9 offset:1280
    ds_read_b64_tr_b16 v[28:29], v9 offset:32
    ds_read_b64_tr_b16 v[30:31], v9 offset:1312
    ds_read_b64_tr_b16 v[32:33], v9 offset:64
    ds_read_b64_tr_b16 v[34:35], v9 offset:1344
    ds_read_b64_tr_b16 v[36:37], v9 offset:96
    ds_read_b64_tr_b16 v[38:39], v9 offset:1376
    ds_read_b64_tr_b16 v[40:41], v9 offset:128
    ds_read_b64_tr_b16 v[42:43], v9 offset:1408
    v_mfma_f32_16x16x32_bf16 v[64:67], v[44:47], v[20:23], v[64:67]
    v_mfma_f32_16x16x32_bf16 v[68:71], v[48:51], v[20:23], v[68:71]
    v_mfma_f32_16x16x32_bf16 v[72:75], v[52:55], v[20:23], v[72:75]
    v_mfma_f32_16x16x32_bf16 v[76:79], v[56:59], v[20:23], v[76:79]
    v_mfma_f32_16x16x32_bf16 v[80:83], v[60:63], v[20:23], v[80:83]
    v_add_u32 v8, 0, v3
    v_add_u32 v9, 8192, v4
    ds_read_b128 v[20:23], v8 offset:0
    ds_read_b64_tr_b16 v[44:45], v9 offset:5120
    ds_read_b64_tr_b16 v[46:47], v9 offset:6400
    ds_read_b64_tr_b16 v[48:49], v9 offset:5152
    ds_read_b64_tr_b16 v[50:51], v9 offset:6432
    ds_read_b64_tr_b16 v[52:53], v9 offset:5184
    ds_read_b64_tr_b16 v[54:55], v9 offset:6464
    ds_read_b64_tr_b16 v[56:57], v9 offset:5216
    ds_read_b64_tr_b16 v[58:59], v9 offset:6496
    ds_read_b64_tr_b16 v[60:61], v9 offset:5248
    ds_read_b64_tr_b16 v[62:63], v9 offset:6528
    s_waitcnt lgkmcnt(11)
    v_mfma_f32_16x16x32_bf16 v[64:67], v[24:27], v[16:19], v[64:67]
    v_mfma_f32_16x16x32_bf16 v[68:71], v[28:31], v[16:19], v[68:71]
    v_mfma_f32_16x16x32_bf16 v[72:75], v[32:35], v[16:19], v[72:75]
    v_mfma_f32_16x16x32_bf16 v[76:79], v[36:39], v[16:19], v[76:79]
    v_mfma_f32_16x16x32_bf16 v[80:83], v[40:43], v[16:19], v[80:83]
    s_waitcnt lgkmcnt(0)
    s_barrier
    v_add_u32 v8, 18432, v2
    v_add_u32 v9, 26624, v4
    ds_read_b128 v[16:19], v8 offset:0
    ds_read_b64_tr_b16 v[24:25], v9 offset:0
    ds_read_b64_tr_b16 v[26:27], v9 offset:1280
    ds_read_b64_tr_b16 v[28:29], v9 offset:32
    ds_read_b64_tr_b16 v[30:31], v9 offset:1312
    ds_read_b64_tr_b16 v[32:33], v9 offset:64
    ds_read_b64_tr_b16 v[34:35], v9 offset:1344
    ds_read_b64_tr_b16 v[36:37], v9 offset:96
    ds_read_b64_tr_b16 v[38:39], v9 offset:1376
    ds_read_b64_tr_b16 v[40:41], v9 offset:128
    ds_read_b64_tr_b16 v[42:43], v9 offset:1408
    v_mfma_f32_16x16x32_bf16 v[64:67], v[44:47], v[20:23], v[64:67]
    v_mfma_f32_16x16x32_bf16 v[68:71], v[48:51], v[20:23], v[68:71]
    v_mfma_f32_16x16x32_bf16 v[72:75], v[52:55], v[20:23], v[72:75]
    v_mfma_f32_16x16x32_bf16 v[76:79], v[56:59], v[20:23], v[76:79]
    v_mfma_f32_16x16x32_bf16 v[80:83], v[60:63], v[20:23], v[80:83]
    v_add_u32 v8, 18432, v3
    v_add_u32 v9, 26624, v4
    ds_read_b128 v[20:23], v8 offset:0
    ds_read_b64_tr_b16 v[44:45], v9 offset:5120
    ds_read_b64_tr_b16 v[46:47], v9 offset:6400
    ds_read_b64_tr_b16 v[48:49], v9 offset:5152
    ds_read_b64_tr_b16 v[50:51], v9 offset:6432
    ds_read_b64_tr_b16 v[52:53], v9 offset:5184
    ds_read_b64_tr_b16 v[54:55], v9 offset:6464
    ds_read_b64_tr_b16 v[56:57], v9 offset:5216
    ds_read_b64_tr_b16 v[58:59], v9 offset:6496
    ds_read_b64_tr_b16 v[60:61], v9 offset:5248
    ds_read_b64_tr_b16 v[62:63], v9 offset:6528
    s_waitcnt lgkmcnt(11)
    v_mfma_f32_16x16x32_bf16 v[64:67], v[24:27], v[16:19], v[64:67]
    v_mfma_f32_16x16x32_bf16 v[68:71], v[28:31], v[16:19], v[68:71]
    v_mfma_f32_16x16x32_bf16 v[72:75], v[32:35], v[16:19], v[72:75]
    v_mfma_f32_16x16x32_bf16 v[76:79], v[36:39], v[16:19], v[76:79]
    v_mfma_f32_16x16x32_bf16 v[80:83], v[40:43], v[16:19], v[80:83]
    s_waitcnt lgkmcnt(0)
    s_barrier
    v_add_u32 v8, 36864, v2
    v_add_u32 v9, 45056, v4
    ds_read_b128 v[16:19], v8 offset:0
    ds_read_b64_tr_b16 v[24:25], v9 offset:0
    ds_read_b64_tr_b16 v[26:27], v9 offset:1280
    ds_read_b64_tr_b16 v[28:29], v9 offset:32
    ds_read_b64_tr_b16 v[30:31], v9 offset:1312
    ds_read_b64_tr_b16 v[32:33], v9 offset:64
    ds_read_b64_tr_b16 v[34:35], v9 offset:1344
    ds_read_b64_tr_b16 v[36:37], v9 offset:96
    ds_read_b64_tr_b16 v[38:39], v9 offset:1376
    ds_read_b64_tr_b16 v[40:41], v9 offset:128
    ds_read_b64_tr_b16 v[42:43], v9 offset:1408
    v_mfma_f32_16x16x32_bf16 v[64:67], v[44:47], v[20:23], v[64:67]
    v_mfma_f32_16x16x32_bf16 v[68:71], v[48:51], v[20:23], v[68:71]
    v_mfma_f32_16x16x32_bf16 v[72:75], v[52:55], v[20:23], v[72:75]
    v_mfma_f32_16x16x32_bf16 v[76:79], v[56:59], v[20:23], v[76:79]
    v_mfma_f32_16x16x32_bf16 v[80:83], v[60:63], v[20:23], v[80:83]
    v_add_u32 v8, 36864, v3
    v_add_u32 v9, 45056, v4
    ds_read_b128 v[20:23], v8 offset:0
    ds_read_b64_tr_b16 v[44:45], v9 offset:5120
    ds_read_b64_tr_b16 v[46:47], v9 offset:6400
    ds_read_b64_tr_b16 v[48:49], v9 offset:5152
    ds_read_b64_tr_b16 v[50:51], v9 offset:6432
    ds_read_b64_tr_b16 v[52:53], v9 offset:5184
    ds_read_b64_tr_b16 v[54:55], v9 offset:6464
    ds_read_b64_tr_b16 v[56:57], v9 offset:5216
    ds_read_b64_tr_b16 v[58:59], v9 offset:6496
    ds_read_b64_tr_b16 v[60:61], v9 offset:5248
    ds_read_b64_tr_b16 v[62:63], v9 offset:6528
    s_waitcnt lgkmcnt(11)
    v_mfma_f32_16x16x32_bf16 v[64:67], v[24:27], v[16:19], v[64:67]
    v_mfma_f32_16x16x32_bf16 v[68:71], v[28:31], v[16:19], v[68:71]
    v_mfma_f32_16x16x32_bf16 v[72:75], v[32:35], v[16:19], v[72:75]
    v_mfma_f32_16x16x32_bf16 v[76:79], v[36:39], v[16:19], v[76:79]
    v_mfma_f32_16x16x32_bf16 v[80:83], v[40:43], v[16:19], v[80:83]
    s_waitcnt lgkmcnt(0)
    s_barrier
    v_add_u32 v8, 55296, v2
    v_add_u32 v9, 63488, v4
    ds_read_b128 v[16:19], v8 offset:0
    ds_read_b64_tr_b16 v[24:25], v9 offset:0
    ds_read_b64_tr_b16 v[26:27], v9 offset:1280
    ds_read_b64_tr_b16 v[28:29], v9 offset:32
    ds_read_b64_tr_b16 v[30:31], v9 offset:1312
    ds_read_b64_tr_b16 v[32:33], v9 offset:64
    ds_read_b64_tr_b16 v[34:35], v9 offset:1344
    ds_read_b64_tr_b16 v[36:37], v9 offset:96
    ds_read_b64_tr_b16 v[38:39], v9 offset:1376
    ds_read_b64_tr_b16 v[40:41], v9 offset:128
    ds_read_b64_tr_b16 v[42:43], v9 offset:1408
    v_mfma_f32_16x16x32_bf16 v[64:67], v[44:47], v[20:23], v[64:67]
    v_mfma_f32_16x16x32_bf16 v[68:71], v[48:51], v[20:23], v[68:71]
    v_mfma_f32_16x16x32_bf16 v[72:75], v[52:55], v[20:23], v[72:75]
    v_mfma_f32_16x16x32_bf16 v[76:79], v[56:59], v[20:23], v[76:79]
    v_mfma_f32_16x16x32_bf16 v[80:83], v[60:63], v[20:23], v[80:83]
    v_add_u32 v8, 55296, v3
    v_add_u32 v9, 63488, v4
    ds_read_b128 v[20:23], v8 offset:0
    ds_read_b64_tr_b16 v[44:45], v9 offset:5120
    ds_read_b64_tr_b16 v[46:47], v9 offset:6400
    ds_read_b64_tr_b16 v[48:49], v9 offset:5152
    ds_read_b64_tr_b16 v[50:51], v9 offset:6432
    ds_read_b64_tr_b16 v[52:53], v9 offset:5184
    ds_read_b64_tr_b16 v[54:55], v9 offset:6464
    ds_read_b64_tr_b16 v[56:57], v9 offset:5216
    ds_read_b64_tr_b16 v[58:59], v9 offset:6496
    ds_read_b64_tr_b16 v[60:61], v9 offset:5248
    ds_read_b64_tr_b16 v[62:63], v9 offset:6528
    s_waitcnt lgkmcnt(11)
    v_mfma_f32_16x16x32_bf16 v[64:67], v[24:27], v[16:19], v[64:67]
    v_mfma_f32_16x16x32_bf16 v[68:71], v[28:31], v[16:19], v[68:71]
    v_mfma_f32_16x16x32_bf16 v[72:75], v[32:35], v[16:19], v[72:75]
    v_mfma_f32_16x16x32_bf16 v[76:79], v[36:39], v[16:19], v[76:79]
    v_mfma_f32_16x16x32_bf16 v[80:83], v[40:43], v[16:19], v[80:83]
    s_waitcnt lgkmcnt(0)
    s_barrier
    v_add_u32 v8, 73728, v2
    v_add_u32 v9, 81920, v4
    ds_read_b128 v[16:19], v8 offset:0
    ds_read_b64_tr_b16 v[24:25], v9 offset:0
    ds_read_b64_tr_b16 v[26:27], v9 offset:1280
    ds_read_b64_tr_b16 v[28:29], v9 offset:32
    ds_read_b64_tr_b16 v[30:31], v9 offset:1312
    ds_read_b64_tr_b16 v[32:33], v9 offset:64
    ds_read_b64_tr_b16 v[34:35], v9 offset:1344
    ds_read_b64_tr_b16 v[36:37], v9 offset:96
    ds_read_b64_tr_b16 v[38:39], v9 offset:1376
    ds_read_b64_tr_b16 v[40:41], v9 offset:128
    ds_read_b64_tr_b16 v[42:43], v9 offset:1408
    v_mfma_f32_16x16x32_bf16 v[64:67], v[44:47], v[20:23], v[64:67]
    v_mfma_f32_16x16x32_bf16 v[68:71], v[48:51], v[20:23], v[68:71]
    v_mfma_f32_16x16x32_bf16 v[72:75], v[52:55], v[20:23], v[72:75]
    v_mfma_f32_16x16x32_bf16 v[76:79], v[56:59], v[20:23], v[76:79]
    v_mfma_f32_16x16x32_bf16 v[80:83], v[60:63], v[20:23], v[80:83]
    v_add_u32 v8, 73728, v3
    v_add_u32 v9, 81920, v4
    ds_read_b128 v[20:23], v8 offset:0
    ds_read_b64_tr_b16 v[44:45], v9 offset:5120
    ds_read_b64_tr_b16 v[46:47], v9 offset:6400
    ds_read_b64_tr_b16 v[48:49], v9 offset:5152
    ds_read_b64_tr_b16 v[50:51], v9 offset:6432
    ds_read_b64_tr_b16 v[52:53], v9 offset:5184
    ds_read_b64_tr_b16 v[54:55], v9 offset:6464
    ds_read_b64_tr_b16 v[56:57], v9 offset:5216
    ds_read_b64_tr_b16 v[58:59], v9 offset:6496
    ds_read_b64_tr_b16 v[60:61], v9 offset:5248
    ds_read_b64_tr_b16 v[62:63], v9 offset:6528
    s_waitcnt lgkmcnt(11)
    v_mfma_f32_16x16x32_bf16 v[64:67], v[24:27], v[16:19], v[64:67]
    v_mfma_f32_16x16x32_bf16 v[68:71], v[28:31], v[16:19], v[68:71]
    v_mfma_f32_16x16x32_bf16 v[72:75], v[32:35], v[16:19], v[72:75]
    v_mfma_f32_16x16x32_bf16 v[76:79], v[36:39], v[16:19], v[76:79]
    v_mfma_f32_16x16x32_bf16 v[80:83], v[40:43], v[16:19], v[80:83]
    s_waitcnt lgkmcnt(0)
    s_barrier
    v_add_u32 v8, 92160, v2
    v_add_u32 v9, 100352, v4
    ds_read_b128 v[16:19], v8 offset:0
    ds_read_b64_tr_b16 v[24:25], v9 offset:0
    ds_read_b64_tr_b16 v[26:27], v9 offset:1280
    ds_read_b64_tr_b16 v[28:29], v9 offset:32
    ds_read_b64_tr_b16 v[30:31], v9 offset:1312
    ds_read_b64_tr_b16 v[32:33], v9 offset:64
    ds_read_b64_tr_b16 v[34:35], v9 offset:1344
    ds_read_b64_tr_b16 v[36:37], v9 offset:96
    ds_read_b64_tr_b16 v[38:39], v9 offset:1376
    ds_read_b64_tr_b16 v[40:41], v9 offset:128
    ds_read_b64_tr_b16 v[42:43], v9 offset:1408
    v_mfma_f32_16x16x32_bf16 v[64:67], v[44:47], v[20:23], v[64:67]
    v_mfma_f32_16x16x32_bf16 v[68:71], v[48:51], v[20:23], v[68:71]
    v_mfma_f32_16x16x32_bf16 v[72:75], v[52:55], v[20:23], v[72:75]
    v_mfma_f32_16x16x32_bf16 v[76:79], v[56:59], v[20:23], v[76:79]
    v_mfma_f32_16x16x32_bf16 v[80:83], v[60:63], v[20:23], v[80:83]
    v_add_u32 v8, 92160, v3
    v_add_u32 v9, 100352, v4
    ds_read_b128 v[20:23], v8 offset:0
    ds_read_b64_tr_b16 v[44:45], v9 offset:5120
    ds_read_b64_tr_b16 v[46:47], v9 offset:6400
    ds_read_b64_tr_b16 v[48:49], v9 offset:5152
    ds_read_b64_tr_b16 v[50:51], v9 offset:6432
    ds_read_b64_tr_b16 v[52:53], v9 offset:5184
    ds_read_b64_tr_b16 v[54:55], v9 offset:6464
    ds_read_b64_tr_b16 v[56:57], v9 offset:5216
    ds_read_b64_tr_b16 v[58:59], v9 offset:6496
    ds_read_b64_tr_b16 v[60:61], v9 offset:5248
    ds_read_b64_tr_b16 v[62:63], v9 offset:6528
    s_waitcnt lgkmcnt(11)
    v_mfma_f32_16x16x32_bf16 v[64:67], v[24:27], v[16:19], v[64:67]
    v_mfma_f32_16x16x32_bf16 v[68:71], v[28:31], v[16:19], v[68:71]
    v_mfma_f32_16x16x32_bf16 v[72:75], v[32:35], v[16:19], v[72:75]
    v_mfma_f32_16x16x32_bf16 v[76:79], v[36:39], v[16:19], v[76:79]
    v_mfma_f32_16x16x32_bf16 v[80:83], v[40:43], v[16:19], v[80:83]
    s_waitcnt lgkmcnt(0)
    s_barrier
    v_add_u32 v8, 0, v2
    v_add_u32 v9, 8192, v4
    ds_read_b128 v[16:19], v8 offset:0
    ds_read_b64_tr_b16 v[24:25], v9 offset:0
    ds_read_b64_tr_b16 v[26:27], v9 offset:1280
    ds_read_b64_tr_b16 v[28:29], v9 offset:32
    ds_read_b64_tr_b16 v[30:31], v9 offset:1312
    ds_read_b64_tr_b16 v[32:33], v9 offset:64
    ds_read_b64_tr_b16 v[34:35], v9 offset:1344
    ds_read_b64_tr_b16 v[36:37], v9 offset:96
    ds_read_b64_tr_b16 v[38:39], v9 offset:1376
    ds_read_b64_tr_b16 v[40:41], v9 offset:128
    ds_read_b64_tr_b16 v[42:43], v9 offset:1408
    v_mfma_f32_16x16x32_bf16 v[64:67], v[44:47], v[20:23], v[64:67]
    v_mfma_f32_16x16x32_bf16 v[68:71], v[48:51], v[20:23], v[68:71]
    v_mfma_f32_16x16x32_bf16 v[72:75], v[52:55], v[20:23], v[72:75]
    v_mfma_f32_16x16x32_bf16 v[76:79], v[56:59], v[20:23], v[76:79]
    v_mfma_f32_16x16x32_bf16 v[80:83], v[60:63], v[20:23], v[80:83]
    v_add_u32 v8, 0, v3
    v_add_u32 v9, 8192, v4
    ds_read_b128 v[20:23], v8 offset:0
    ds_read_b64_tr_b16 v[44:45], v9 offset:5120
    ds_read_b64_tr_b16 v[46:47], v9 offset:6400
    ds_read_b64_tr_b16 v[48:49], v9 offset:5152
    ds_read_b64_tr_b16 v[50:51], v9 offset:6432
    ds_read_b64_tr_b16 v[52:53], v9 offset:5184
    ds_read_b64_tr_b16 v[54:55], v9 offset:6464
    ds_read_b64_tr_b16 v[56:57], v9 offset:5216
    ds_read_b64_tr_b16 v[58:59], v9 offset:6496
    ds_read_b64_tr_b16 v[60:61], v9 offset:5248
    ds_read_b64_tr_b16 v[62:63], v9 offset:6528
    s_waitcnt lgkmcnt(11)
    v_mfma_f32_16x16x32_bf16 v[64:67], v[24:27], v[16:19], v[64:67]
    v_mfma_f32_16x16x32_bf16 v[68:71], v[28:31], v[16:19], v[68:71]
    v_mfma_f32_16x16x32_bf16 v[72:75], v[32:35], v[16:19], v[72:75]
    v_mfma_f32_16x16x32_bf16 v[76:79], v[36:39], v[16:19], v[76:79]
    v_mfma_f32_16x16x32_bf16 v[80:83], v[40:43], v[16:19], v[80:83]
    s_waitcnt lgkmcnt(0)
    s_barrier
    v_add_u32 v8, 18432, v2
    v_add_u32 v9, 26624, v4
    ds_read_b128 v[16:19], v8 offset:0
    ds_read_b64_tr_b16 v[24:25], v9 offset:0
    ds_read_b64_tr_b16 v[26:27], v9 offset:1280
    ds_read_b64_tr_b16 v[28:29], v9 offset:32
    ds_read_b64_tr_b16 v[30:31], v9 offset:1312
    ds_read_b64_tr_b16 v[32:33], v9 offset:64
    ds_read_b64_tr_b16 v[34:35], v9 offset:1344
    ds_read_b64_tr_b16 v[36:37], v9 offset:96
    ds_read_b64_tr_b16 v[38:39], v9 offset:1376
    ds_read_b64_tr_b16 v[40:41], v9 offset:128
    ds_read_b64_tr_b16 v[42:43], v9 offset:1408
    v_mfma_f32_16x16x32_bf16 v[64:67], v[44:47], v[20:23], v[64:67]
    v_mfma_f32_16x16x32_bf16 v[68:71], v[48:51], v[20:23], v[68:71]
    v_mfma_f32_16x16x32_bf16 v[72:75], v[52:55], v[20:23], v[72:75]
    v_mfma_f32_16x16x32_bf16 v[76:79], v[56:59], v[20:23], v[76:79]
    v_mfma_f32_16x16x32_bf16 v[80:83], v[60:63], v[20:23], v[80:83]
    v_add_u32 v8, 18432, v3
    v_add_u32 v9, 26624, v4
    ds_read_b128 v[20:23], v8 offset:0
    ds_read_b64_tr_b16 v[44:45], v9 offset:5120
    ds_read_b64_tr_b16 v[46:47], v9 offset:6400
    ds_read_b64_tr_b16 v[48:49], v9 offset:5152
    ds_read_b64_tr_b16 v[50:51], v9 offset:6432
    ds_read_b64_tr_b16 v[52:53], v9 offset:5184
    ds_read_b64_tr_b16 v[54:55], v9 offset:6464
    ds_read_b64_tr_b16 v[56:57], v9 offset:5216
    ds_read_b64_tr_b16 v[58:59], v9 offset:6496
    ds_read_b64_tr_b16 v[60:61], v9 offset:5248
    ds_read_b64_tr_b16 v[62:63], v9 offset:6528
    s_waitcnt lgkmcnt(11)
    v_mfma_f32_16x16x32_bf16 v[64:67], v[24:27], v[16:19], v[64:67]
    v_mfma_f32_16x16x32_bf16 v[68:71], v[28:31], v[16:19], v[68:71]
    v_mfma_f32_16x16x32_bf16 v[72:75], v[32:35], v[16:19], v[72:75]
    v_mfma_f32_16x16x32_bf16 v[76:79], v[36:39], v[16:19], v[76:79]
    v_mfma_f32_16x16x32_bf16 v[80:83], v[40:43], v[16:19], v[80:83]
    s_waitcnt lgkmcnt(0)
    s_barrier
    v_add_u32 v8, 36864, v2
    v_add_u32 v9, 45056, v4
    ds_read_b128 v[16:19], v8 offset:0
    ds_read_b64_tr_b16 v[24:25], v9 offset:0
    ds_read_b64_tr_b16 v[26:27], v9 offset:1280
    ds_read_b64_tr_b16 v[28:29], v9 offset:32
    ds_read_b64_tr_b16 v[30:31], v9 offset:1312
    ds_read_b64_tr_b16 v[32:33], v9 offset:64
    ds_read_b64_tr_b16 v[34:35], v9 offset:1344
    ds_read_b64_tr_b16 v[36:37], v9 offset:96
    ds_read_b64_tr_b16 v[38:39], v9 offset:1376
    ds_read_b64_tr_b16 v[40:41], v9 offset:128
    ds_read_b64_tr_b16 v[42:43], v9 offset:1408
    v_mfma_f32_16x16x32_bf16 v[64:67], v[44:47], v[20:23], v[64:67]
    v_mfma_f32_16x16x32_bf16 v[68:71], v[48:51], v[20:23], v[68:71]
    v_mfma_f32_16x16x32_bf16 v[72:75], v[52:55], v[20:23], v[72:75]
    v_mfma_f32_16x16x32_bf16 v[76:79], v[56:59], v[20:23], v[76:79]
    v_mfma_f32_16x16x32_bf16 v[80:83], v[60:63], v[20:23], v[80:83]
    v_add_u32 v8, 36864, v3
    v_add_u32 v9, 45056, v4
    ds_read_b128 v[20:23], v8 offset:0
    ds_read_b64_tr_b16 v[44:45], v9 offset:5120
    ds_read_b64_tr_b16 v[46:47], v9 offset:6400
    ds_read_b64_tr_b16 v[48:49], v9 offset:5152
    ds_read_b64_tr_b16 v[50:51], v9 offset:6432
    ds_read_b64_tr_b16 v[52:53], v9 offset:5184
    ds_read_b64_tr_b16 v[54:55], v9 offset:6464
    ds_read_b64_tr_b16 v[56:57], v9 offset:5216
    ds_read_b64_tr_b16 v[58:59], v9 offset:6496
    ds_read_b64_tr_b16 v[60:61], v9 offset:5248
    ds_read_b64_tr_b16 v[62:63], v9 offset:6528
    s_waitcnt lgkmcnt(11)
    v_mfma_f32_16x16x32_bf16 v[64:67], v[24:27], v[16:19], v[64:67]
    v_mfma_f32_16x16x32_bf16 v[68:71], v[28:31], v[16:19], v[68:71]
    v_mfma_f32_16x16x32_bf16 v[72:75], v[32:35], v[16:19], v[72:75]
    v_mfma_f32_16x16x32_bf16 v[76:79], v[36:39], v[16:19], v[76:79]
    v_mfma_f32_16x16x32_bf16 v[80:83], v[40:43], v[16:19], v[80:83]
    s_waitcnt lgkmcnt(0)
    s_barrier
    v_add_u32 v8, 55296, v2
    v_add_u32 v9, 63488, v4
    ds_read_b128 v[16:19], v8 offset:0
    ds_read_b64_tr_b16 v[24:25], v9 offset:0
    ds_read_b64_tr_b16 v[26:27], v9 offset:1280
    ds_read_b64_tr_b16 v[28:29], v9 offset:32
    ds_read_b64_tr_b16 v[30:31], v9 offset:1312
    ds_read_b64_tr_b16 v[32:33], v9 offset:64
    ds_read_b64_tr_b16 v[34:35], v9 offset:1344
    ds_read_b64_tr_b16 v[36:37], v9 offset:96
    ds_read_b64_tr_b16 v[38:39], v9 offset:1376
    ds_read_b64_tr_b16 v[40:41], v9 offset:128
    ds_read_b64_tr_b16 v[42:43], v9 offset:1408
    v_mfma_f32_16x16x32_bf16 v[64:67], v[44:47], v[20:23], v[64:67]
    v_mfma_f32_16x16x32_bf16 v[68:71], v[48:51], v[20:23], v[68:71]
    v_mfma_f32_16x16x32_bf16 v[72:75], v[52:55], v[20:23], v[72:75]
    v_mfma_f32_16x16x32_bf16 v[76:79], v[56:59], v[20:23], v[76:79]
    v_mfma_f32_16x16x32_bf16 v[80:83], v[60:63], v[20:23], v[80:83]
    v_add_u32 v8, 55296, v3
    v_add_u32 v9, 63488, v4
    ds_read_b128 v[20:23], v8 offset:0
    ds_read_b64_tr_b16 v[44:45], v9 offset:5120
    ds_read_b64_tr_b16 v[46:47], v9 offset:6400
    ds_read_b64_tr_b16 v[48:49], v9 offset:5152
    ds_read_b64_tr_b16 v[50:51], v9 offset:6432
    ds_read_b64_tr_b16 v[52:53], v9 offset:5184
    ds_read_b64_tr_b16 v[54:55], v9 offset:6464
    ds_read_b64_tr_b16 v[56:57], v9 offset:5216
    ds_read_b64_tr_b16 v[58:59], v9 offset:6496
    ds_read_b64_tr_b16 v[60:61], v9 offset:5248
    ds_read_b64_tr_b16 v[62:63], v9 offset:6528
    s_waitcnt lgkmcnt(11)
    v_mfma_f32_16x16x32_bf16 v[64:67], v[24:27], v[16:19], v[64:67]
    v_mfma_f32_16x16x32_bf16 v[68:71], v[28:31], v[16:19], v[68:71]
    v_mfma_f32_16x16x32_bf16 v[72:75], v[32:35], v[16:19], v[72:75]
    v_mfma_f32_16x16x32_bf16 v[76:79], v[36:39], v[16:19], v[76:79]
    v_mfma_f32_16x16x32_bf16 v[80:83], v[40:43], v[16:19], v[80:83]
    s_waitcnt lgkmcnt(0)
    s_barrier
    v_add_u32 v8, 73728, v2
    v_add_u32 v9, 81920, v4
    ds_read_b128 v[16:19], v8 offset:0
    ds_read_b64_tr_b16 v[24:25], v9 offset:0
    ds_read_b64_tr_b16 v[26:27], v9 offset:1280
    ds_read_b64_tr_b16 v[28:29], v9 offset:32
    ds_read_b64_tr_b16 v[30:31], v9 offset:1312
    ds_read_b64_tr_b16 v[32:33], v9 offset:64
    ds_read_b64_tr_b16 v[34:35], v9 offset:1344
    ds_read_b64_tr_b16 v[36:37], v9 offset:96
    ds_read_b64_tr_b16 v[38:39], v9 offset:1376
    ds_read_b64_tr_b16 v[40:41], v9 offset:128
    ds_read_b64_tr_b16 v[42:43], v9 offset:1408
    v_mfma_f32_16x16x32_bf16 v[64:67], v[44:47], v[20:23], v[64:67]
    v_mfma_f32_16x16x32_bf16 v[68:71], v[48:51], v[20:23], v[68:71]
    v_mfma_f32_16x16x32_bf16 v[72:75], v[52:55], v[20:23], v[72:75]
    v_mfma_f32_16x16x32_bf16 v[76:79], v[56:59], v[20:23], v[76:79]
    v_mfma_f32_16x16x32_bf16 v[80:83], v[60:63], v[20:23], v[80:83]
    v_add_u32 v8, 73728, v3
    v_add_u32 v9, 81920, v4
    ds_read_b128 v[20:23], v8 offset:0
    ds_read_b64_tr_b16 v[44:45], v9 offset:5120
    ds_read_b64_tr_b16 v[46:47], v9 offset:6400
    ds_read_b64_tr_b16 v[48:49], v9 offset:5152
    ds_read_b64_tr_b16 v[50:51], v9 offset:6432
    ds_read_b64_tr_b16 v[52:53], v9 offset:5184
    ds_read_b64_tr_b16 v[54:55], v9 offset:6464
    ds_read_b64_tr_b16 v[56:57], v9 offset:5216
    ds_read_b64_tr_b16 v[58:59], v9 offset:6496
    ds_read_b64_tr_b16 v[60:61], v9 offset:5248
    ds_read_b64_tr_b16 v[62:63], v9 offset:6528
    s_waitcnt lgkmcnt(11)
    v_mfma_f32_16x16x32_bf16 v[64:67], v[24:27], v[16:19], v[64:67]
    v_mfma_f32_16x16x32_bf16 v[68:71], v[28:31], v[16:19], v[68:71]
    v_mfma_f32_16x16x32_bf16 v[72:75], v[32:35], v[16:19], v[72:75]
    v_mfma_f32_16x16x32_bf16 v[76:79], v[36:39], v[16:19], v[76:79]
    v_mfma_f32_16x16x32_bf16 v[80:83], v[40:43], v[16:19], v[80:83]
    s_waitcnt lgkmcnt(0)
    s_barrier
    v_add_u32 v8, 92160, v2
    v_add_u32 v9, 100352, v4
    ds_read_b128 v[16:19], v8 offset:0
    ds_read_b64_tr_b16 v[24:25], v9 offset:0
    ds_read_b64_tr_b16 v[26:27], v9 offset:1280
    ds_read_b64_tr_b16 v[28:29], v9 offset:32
    ds_read_b64_tr_b16 v[30:31], v9 offset:1312
    ds_read_b64_tr_b16 v[32:33], v9 offset:64
    ds_read_b64_tr_b16 v[34:35], v9 offset:1344
    ds_read_b64_tr_b16 v[36:37], v9 offset:96
    ds_read_b64_tr_b16 v[38:39], v9 offset:1376
    ds_read_b64_tr_b16 v[40:41], v9 offset:128
    ds_read_b64_tr_b16 v[42:43], v9 offset:1408
    v_mfma_f32_16x16x32_bf16 v[64:67], v[44:47], v[20:23], v[64:67]
    v_mfma_f32_16x16x32_bf16 v[68:71], v[48:51], v[20:23], v[68:71]
    v_mfma_f32_16x16x32_bf16 v[72:75], v[52:55], v[20:23], v[72:75]
    v_mfma_f32_16x16x32_bf16 v[76:79], v[56:59], v[20:23], v[76:79]
    v_mfma_f32_16x16x32_bf16 v[80:83], v[60:63], v[20:23], v[80:83]
    v_add_u32 v8, 92160, v3
    v_add_u32 v9, 100352, v4
    ds_read_b128 v[20:23], v8 offset:0
    ds_read_b64_tr_b16 v[44:45], v9 offset:5120
    ds_read_b64_tr_b16 v[46:47], v9 offset:6400
    ds_read_b64_tr_b16 v[48:49], v9 offset:5152
    ds_read_b64_tr_b16 v[50:51], v9 offset:6432
    ds_read_b64_tr_b16 v[52:53], v9 offset:5184
    ds_read_b64_tr_b16 v[54:55], v9 offset:6464
    ds_read_b64_tr_b16 v[56:57], v9 offset:5216
    ds_read_b64_tr_b16 v[58:59], v9 offset:6496
    ds_read_b64_tr_b16 v[60:61], v9 offset:5248
    ds_read_b64_tr_b16 v[62:63], v9 offset:6528
    s_waitcnt lgkmcnt(11)
    v_mfma_f32_16x16x32_bf16 v[64:67], v[24:27], v[16:19], v[64:67]
    v_mfma_f32_16x16x32_bf16 v[68:71], v[28:31], v[16:19], v[68:71]
    v_mfma_f32_16x16x32_bf16 v[72:75], v[32:35], v[16:19], v[72:75]
    v_mfma_f32_16x16x32_bf16 v[76:79], v[36:39], v[16:19], v[76:79]
    v_mfma_f32_16x16x32_bf16 v[80:83], v[40:43], v[16:19], v[80:83]
    s_waitcnt lgkmcnt(0)
    s_barrier
    v_add_u32 v8, 0, v2
    v_add_u32 v9, 8192, v4
    ds_read_b128 v[16:19], v8 offset:0
    ds_read_b64_tr_b16 v[24:25], v9 offset:0
    ds_read_b64_tr_b16 v[26:27], v9 offset:1280
    ds_read_b64_tr_b16 v[28:29], v9 offset:32
    ds_read_b64_tr_b16 v[30:31], v9 offset:1312
    ds_read_b64_tr_b16 v[32:33], v9 offset:64
    ds_read_b64_tr_b16 v[34:35], v9 offset:1344
    ds_read_b64_tr_b16 v[36:37], v9 offset:96
    ds_read_b64_tr_b16 v[38:39], v9 offset:1376
    ds_read_b64_tr_b16 v[40:41], v9 offset:128
    ds_read_b64_tr_b16 v[42:43], v9 offset:1408
    v_mfma_f32_16x16x32_bf16 v[64:67], v[44:47], v[20:23], v[64:67]
    v_mfma_f32_16x16x32_bf16 v[68:71], v[48:51], v[20:23], v[68:71]
    v_mfma_f32_16x16x32_bf16 v[72:75], v[52:55], v[20:23], v[72:75]
    v_mfma_f32_16x16x32_bf16 v[76:79], v[56:59], v[20:23], v[76:79]
    v_mfma_f32_16x16x32_bf16 v[80:83], v[60:63], v[20:23], v[80:83]
    v_add_u32 v8, 0, v3
    v_add_u32 v9, 8192, v4
    ds_read_b128 v[20:23], v8 offset:0
    ds_read_b64_tr_b16 v[44:45], v9 offset:5120
    ds_read_b64_tr_b16 v[46:47], v9 offset:6400
    ds_read_b64_tr_b16 v[48:49], v9 offset:5152
    ds_read_b64_tr_b16 v[50:51], v9 offset:6432
    ds_read_b64_tr_b16 v[52:53], v9 offset:5184
    ds_read_b64_tr_b16 v[54:55], v9 offset:6464
    ds_read_b64_tr_b16 v[56:57], v9 offset:5216
    ds_read_b64_tr_b16 v[58:59], v9 offset:6496
    ds_read_b64_tr_b16 v[60:61], v9 offset:5248
    ds_read_b64_tr_b16 v[62:63], v9 offset:6528
    s_waitcnt lgkmcnt(11)
    v_mfma_f32_16x16x32_bf16 v[64:67], v[24:27], v[16:19], v[64:67]
    v_mfma_f32_16x16x32_bf16 v[68:71], v[28:31], v[16:19], v[68:71]
    v_mfma_f32_16x16x32_bf16 v[72:75], v[32:35], v[16:19], v[72:75]
    v_mfma_f32_16x16x32_bf16 v[76:79], v[36:39], v[16:19], v[76:79]
    v_mfma_f32_16x16x32_bf16 v[80:83], v[40:43], v[16:19], v[80:83]
    s_waitcnt lgkmcnt(0)
    s_barrier
    v_add_u32 v8, 18432, v2
    v_add_u32 v9, 26624, v4
    ds_read_b128 v[16:19], v8 offset:0
    ds_read_b64_tr_b16 v[24:25], v9 offset:0
    ds_read_b64_tr_b16 v[26:27], v9 offset:1280
    ds_read_b64_tr_b16 v[28:29], v9 offset:32
    ds_read_b64_tr_b16 v[30:31], v9 offset:1312
    ds_read_b64_tr_b16 v[32:33], v9 offset:64
    ds_read_b64_tr_b16 v[34:35], v9 offset:1344
    ds_read_b64_tr_b16 v[36:37], v9 offset:96
    ds_read_b64_tr_b16 v[38:39], v9 offset:1376
    ds_read_b64_tr_b16 v[40:41], v9 offset:128
    ds_read_b64_tr_b16 v[42:43], v9 offset:1408
    v_mfma_f32_16x16x32_bf16 v[64:67], v[44:47], v[20:23], v[64:67]
    v_mfma_f32_16x16x32_bf16 v[68:71], v[48:51], v[20:23], v[68:71]
    v_mfma_f32_16x16x32_bf16 v[72:75], v[52:55], v[20:23], v[72:75]
    v_mfma_f32_16x16x32_bf16 v[76:79], v[56:59], v[20:23], v[76:79]
    v_mfma_f32_16x16x32_bf16 v[80:83], v[60:63], v[20:23], v[80:83]
    v_add_u32 v8, 18432, v3
    v_add_u32 v9, 26624, v4
    ds_read_b128 v[20:23], v8 offset:0
    ds_read_b64_tr_b16 v[44:45], v9 offset:5120
    ds_read_b64_tr_b16 v[46:47], v9 offset:6400
    ds_read_b64_tr_b16 v[48:49], v9 offset:5152
    ds_read_b64_tr_b16 v[50:51], v9 offset:6432
    ds_read_b64_tr_b16 v[52:53], v9 offset:5184
    ds_read_b64_tr_b16 v[54:55], v9 offset:6464
    ds_read_b64_tr_b16 v[56:57], v9 offset:5216
    ds_read_b64_tr_b16 v[58:59], v9 offset:6496
    ds_read_b64_tr_b16 v[60:61], v9 offset:5248
    ds_read_b64_tr_b16 v[62:63], v9 offset:6528
    s_waitcnt lgkmcnt(11)
    v_mfma_f32_16x16x32_bf16 v[64:67], v[24:27], v[16:19], v[64:67]
    v_mfma_f32_16x16x32_bf16 v[68:71], v[28:31], v[16:19], v[68:71]
    v_mfma_f32_16x16x32_bf16 v[72:75], v[32:35], v[16:19], v[72:75]
    v_mfma_f32_16x16x32_bf16 v[76:79], v[36:39], v[16:19], v[76:79]
    v_mfma_f32_16x16x32_bf16 v[80:83], v[40:43], v[16:19], v[80:83]
    s_waitcnt lgkmcnt(0)
    s_barrier
    v_add_u32 v8, 36864, v2
    v_add_u32 v9, 45056, v4
    ds_read_b128 v[16:19], v8 offset:0
    ds_read_b64_tr_b16 v[24:25], v9 offset:0
    ds_read_b64_tr_b16 v[26:27], v9 offset:1280
    ds_read_b64_tr_b16 v[28:29], v9 offset:32
    ds_read_b64_tr_b16 v[30:31], v9 offset:1312
    ds_read_b64_tr_b16 v[32:33], v9 offset:64
    ds_read_b64_tr_b16 v[34:35], v9 offset:1344
    ds_read_b64_tr_b16 v[36:37], v9 offset:96
    ds_read_b64_tr_b16 v[38:39], v9 offset:1376
    ds_read_b64_tr_b16 v[40:41], v9 offset:128
    ds_read_b64_tr_b16 v[42:43], v9 offset:1408
    v_mfma_f32_16x16x32_bf16 v[64:67], v[44:47], v[20:23], v[64:67]
    v_mfma_f32_16x16x32_bf16 v[68:71], v[48:51], v[20:23], v[68:71]
    v_mfma_f32_16x16x32_bf16 v[72:75], v[52:55], v[20:23], v[72:75]
    v_mfma_f32_16x16x32_bf16 v[76:79], v[56:59], v[20:23], v[76:79]
    v_mfma_f32_16x16x32_bf16 v[80:83], v[60:63], v[20:23], v[80:83]
    v_add_u32 v8, 36864, v3
    v_add_u32 v9, 45056, v4
    ds_read_b128 v[20:23], v8 offset:0
    ds_read_b64_tr_b16 v[44:45], v9 offset:5120
    ds_read_b64_tr_b16 v[46:47], v9 offset:6400
    ds_read_b64_tr_b16 v[48:49], v9 offset:5152
    ds_read_b64_tr_b16 v[50:51], v9 offset:6432
    ds_read_b64_tr_b16 v[52:53], v9 offset:5184
    ds_read_b64_tr_b16 v[54:55], v9 offset:6464
    ds_read_b64_tr_b16 v[56:57], v9 offset:5216
    ds_read_b64_tr_b16 v[58:59], v9 offset:6496
    ds_read_b64_tr_b16 v[60:61], v9 offset:5248
    ds_read_b64_tr_b16 v[62:63], v9 offset:6528
    s_waitcnt lgkmcnt(11)
    v_mfma_f32_16x16x32_bf16 v[64:67], v[24:27], v[16:19], v[64:67]
    v_mfma_f32_16x16x32_bf16 v[68:71], v[28:31], v[16:19], v[68:71]
    v_mfma_f32_16x16x32_bf16 v[72:75], v[32:35], v[16:19], v[72:75]
    v_mfma_f32_16x16x32_bf16 v[76:79], v[36:39], v[16:19], v[76:79]
    v_mfma_f32_16x16x32_bf16 v[80:83], v[40:43], v[16:19], v[80:83]
    s_waitcnt lgkmcnt(0)
    s_barrier
    v_add_u32 v8, 55296, v2
    v_add_u32 v9, 63488, v4
    ds_read_b128 v[16:19], v8 offset:0
    ds_read_b64_tr_b16 v[24:25], v9 offset:0
    ds_read_b64_tr_b16 v[26:27], v9 offset:1280
    ds_read_b64_tr_b16 v[28:29], v9 offset:32
    ds_read_b64_tr_b16 v[30:31], v9 offset:1312
    ds_read_b64_tr_b16 v[32:33], v9 offset:64
    ds_read_b64_tr_b16 v[34:35], v9 offset:1344
    ds_read_b64_tr_b16 v[36:37], v9 offset:96
    ds_read_b64_tr_b16 v[38:39], v9 offset:1376
    ds_read_b64_tr_b16 v[40:41], v9 offset:128
    ds_read_b64_tr_b16 v[42:43], v9 offset:1408
    v_mfma_f32_16x16x32_bf16 v[64:67], v[44:47], v[20:23], v[64:67]
    v_mfma_f32_16x16x32_bf16 v[68:71], v[48:51], v[20:23], v[68:71]
    v_mfma_f32_16x16x32_bf16 v[72:75], v[52:55], v[20:23], v[72:75]
    v_mfma_f32_16x16x32_bf16 v[76:79], v[56:59], v[20:23], v[76:79]
    v_mfma_f32_16x16x32_bf16 v[80:83], v[60:63], v[20:23], v[80:83]
    v_add_u32 v8, 55296, v3
    v_add_u32 v9, 63488, v4
    ds_read_b128 v[20:23], v8 offset:0
    ds_read_b64_tr_b16 v[44:45], v9 offset:5120
    ds_read_b64_tr_b16 v[46:47], v9 offset:6400
    ds_read_b64_tr_b16 v[48:49], v9 offset:5152
    ds_read_b64_tr_b16 v[50:51], v9 offset:6432
    ds_read_b64_tr_b16 v[52:53], v9 offset:5184
    ds_read_b64_tr_b16 v[54:55], v9 offset:6464
    ds_read_b64_tr_b16 v[56:57], v9 offset:5216
    ds_read_b64_tr_b16 v[58:59], v9 offset:6496
    ds_read_b64_tr_b16 v[60:61], v9 offset:5248
    ds_read_b64_tr_b16 v[62:63], v9 offset:6528
    s_waitcnt lgkmcnt(11)
    v_mfma_f32_16x16x32_bf16 v[64:67], v[24:27], v[16:19], v[64:67]
    v_mfma_f32_16x16x32_bf16 v[68:71], v[28:31], v[16:19], v[68:71]
    v_mfma_f32_16x16x32_bf16 v[72:75], v[32:35], v[16:19], v[72:75]
    v_mfma_f32_16x16x32_bf16 v[76:79], v[36:39], v[16:19], v[76:79]
    v_mfma_f32_16x16x32_bf16 v[80:83], v[40:43], v[16:19], v[80:83]
    s_waitcnt lgkmcnt(0)
    s_barrier
    v_add_u32 v8, 73728, v2
    v_add_u32 v9, 81920, v4
    ds_read_b128 v[16:19], v8 offset:0
    ds_read_b64_tr_b16 v[24:25], v9 offset:0
    ds_read_b64_tr_b16 v[26:27], v9 offset:1280
    ds_read_b64_tr_b16 v[28:29], v9 offset:32
    ds_read_b64_tr_b16 v[30:31], v9 offset:1312
    ds_read_b64_tr_b16 v[32:33], v9 offset:64
    ds_read_b64_tr_b16 v[34:35], v9 offset:1344
    ds_read_b64_tr_b16 v[36:37], v9 offset:96
    ds_read_b64_tr_b16 v[38:39], v9 offset:1376
    ds_read_b64_tr_b16 v[40:41], v9 offset:128
    ds_read_b64_tr_b16 v[42:43], v9 offset:1408
    v_mfma_f32_16x16x32_bf16 v[64:67], v[44:47], v[20:23], v[64:67]
    v_mfma_f32_16x16x32_bf16 v[68:71], v[48:51], v[20:23], v[68:71]
    v_mfma_f32_16x16x32_bf16 v[72:75], v[52:55], v[20:23], v[72:75]
    v_mfma_f32_16x16x32_bf16 v[76:79], v[56:59], v[20:23], v[76:79]
    v_mfma_f32_16x16x32_bf16 v[80:83], v[60:63], v[20:23], v[80:83]
    v_add_u32 v8, 73728, v3
    v_add_u32 v9, 81920, v4
    ds_read_b128 v[20:23], v8 offset:0
    ds_read_b64_tr_b16 v[44:45], v9 offset:5120
    ds_read_b64_tr_b16 v[46:47], v9 offset:6400
    ds_read_b64_tr_b16 v[48:49], v9 offset:5152
    ds_read_b64_tr_b16 v[50:51], v9 offset:6432
    ds_read_b64_tr_b16 v[52:53], v9 offset:5184
    ds_read_b64_tr_b16 v[54:55], v9 offset:6464
    ds_read_b64_tr_b16 v[56:57], v9 offset:5216
    ds_read_b64_tr_b16 v[58:59], v9 offset:6496
    ds_read_b64_tr_b16 v[60:61], v9 offset:5248
    ds_read_b64_tr_b16 v[62:63], v9 offset:6528
    s_waitcnt lgkmcnt(11)
    v_mfma_f32_16x16x32_bf16 v[64:67], v[24:27], v[16:19], v[64:67]
    v_mfma_f32_16x16x32_bf16 v[68:71], v[28:31], v[16:19], v[68:71]
    v_mfma_f32_16x16x32_bf16 v[72:75], v[32:35], v[16:19], v[72:75]
    v_mfma_f32_16x16x32_bf16 v[76:79], v[36:39], v[16:19], v[76:79]
    v_mfma_f32_16x16x32_bf16 v[80:83], v[40:43], v[16:19], v[80:83]
    s_waitcnt lgkmcnt(0)
    s_barrier
    v_add_u32 v8, 92160, v2
    v_add_u32 v9, 100352, v4
    ds_read_b128 v[16:19], v8 offset:0
    ds_read_b64_tr_b16 v[24:25], v9 offset:0
    ds_read_b64_tr_b16 v[26:27], v9 offset:1280
    ds_read_b64_tr_b16 v[28:29], v9 offset:32
    ds_read_b64_tr_b16 v[30:31], v9 offset:1312
    ds_read_b64_tr_b16 v[32:33], v9 offset:64
    ds_read_b64_tr_b16 v[34:35], v9 offset:1344
    ds_read_b64_tr_b16 v[36:37], v9 offset:96
    ds_read_b64_tr_b16 v[38:39], v9 offset:1376
    ds_read_b64_tr_b16 v[40:41], v9 offset:128
    ds_read_b64_tr_b16 v[42:43], v9 offset:1408
    v_mfma_f32_16x16x32_bf16 v[64:67], v[44:47], v[20:23], v[64:67]
    v_mfma_f32_16x16x32_bf16 v[68:71], v[48:51], v[20:23], v[68:71]
    v_mfma_f32_16x16x32_bf16 v[72:75], v[52:55], v[20:23], v[72:75]
    v_mfma_f32_16x16x32_bf16 v[76:79], v[56:59], v[20:23], v[76:79]
    v_mfma_f32_16x16x32_bf16 v[80:83], v[60:63], v[20:23], v[80:83]
    v_add_u32 v8, 92160, v3
    v_add_u32 v9, 100352, v4
    ds_read_b128 v[20:23], v8 offset:0
    ds_read_b64_tr_b16 v[44:45], v9 offset:5120
    ds_read_b64_tr_b16 v[46:47], v9 offset:6400
    ds_read_b64_tr_b16 v[48:49], v9 offset:5152
    ds_read_b64_tr_b16 v[50:51], v9 offset:6432
    ds_read_b64_tr_b16 v[52:53], v9 offset:5184
    ds_read_b64_tr_b16 v[54:55], v9 offset:6464
    ds_read_b64_tr_b16 v[56:57], v9 offset:5216
    ds_read_b64_tr_b16 v[58:59], v9 offset:6496
    ds_read_b64_tr_b16 v[60:61], v9 offset:5248
    ds_read_b64_tr_b16 v[62:63], v9 offset:6528
    s_waitcnt lgkmcnt(11)
    v_mfma_f32_16x16x32_bf16 v[64:67], v[24:27], v[16:19], v[64:67]
    v_mfma_f32_16x16x32_bf16 v[68:71], v[28:31], v[16:19], v[68:71]
    v_mfma_f32_16x16x32_bf16 v[72:75], v[32:35], v[16:19], v[72:75]
    v_mfma_f32_16x16x32_bf16 v[76:79], v[36:39], v[16:19], v[76:79]
    v_mfma_f32_16x16x32_bf16 v[80:83], v[40:43], v[16:19], v[80:83]
    s_waitcnt lgkmcnt(0)
    s_barrier
    v_add_u32 v8, 0, v2
    v_add_u32 v9, 8192, v4
    ds_read_b128 v[16:19], v8 offset:0
    ds_read_b64_tr_b16 v[24:25], v9 offset:0
    ds_read_b64_tr_b16 v[26:27], v9 offset:1280
    ds_read_b64_tr_b16 v[28:29], v9 offset:32
    ds_read_b64_tr_b16 v[30:31], v9 offset:1312
    ds_read_b64_tr_b16 v[32:33], v9 offset:64
    ds_read_b64_tr_b16 v[34:35], v9 offset:1344
    ds_read_b64_tr_b16 v[36:37], v9 offset:96
    ds_read_b64_tr_b16 v[38:39], v9 offset:1376
    ds_read_b64_tr_b16 v[40:41], v9 offset:128
    ds_read_b64_tr_b16 v[42:43], v9 offset:1408
    v_mfma_f32_16x16x32_bf16 v[64:67], v[44:47], v[20:23], v[64:67]
    v_mfma_f32_16x16x32_bf16 v[68:71], v[48:51], v[20:23], v[68:71]
    v_mfma_f32_16x16x32_bf16 v[72:75], v[52:55], v[20:23], v[72:75]
    v_mfma_f32_16x16x32_bf16 v[76:79], v[56:59], v[20:23], v[76:79]
    v_mfma_f32_16x16x32_bf16 v[80:83], v[60:63], v[20:23], v[80:83]
    v_add_u32 v8, 0, v3
    v_add_u32 v9, 8192, v4
    ds_read_b128 v[20:23], v8 offset:0
    ds_read_b64_tr_b16 v[44:45], v9 offset:5120
    ds_read_b64_tr_b16 v[46:47], v9 offset:6400
    ds_read_b64_tr_b16 v[48:49], v9 offset:5152
    ds_read_b64_tr_b16 v[50:51], v9 offset:6432
    ds_read_b64_tr_b16 v[52:53], v9 offset:5184
    ds_read_b64_tr_b16 v[54:55], v9 offset:6464
    ds_read_b64_tr_b16 v[56:57], v9 offset:5216
    ds_read_b64_tr_b16 v[58:59], v9 offset:6496
    ds_read_b64_tr_b16 v[60:61], v9 offset:5248
    ds_read_b64_tr_b16 v[62:63], v9 offset:6528
    s_waitcnt lgkmcnt(11)
    v_mfma_f32_16x16x32_bf16 v[64:67], v[24:27], v[16:19], v[64:67]
    v_mfma_f32_16x16x32_bf16 v[68:71], v[28:31], v[16:19], v[68:71]
    v_mfma_f32_16x16x32_bf16 v[72:75], v[32:35], v[16:19], v[72:75]
    v_mfma_f32_16x16x32_bf16 v[76:79], v[36:39], v[16:19], v[76:79]
    v_mfma_f32_16x16x32_bf16 v[80:83], v[40:43], v[16:19], v[80:83]
    s_waitcnt lgkmcnt(0)
    s_barrier
    v_add_u32 v8, 18432, v2
    v_add_u32 v9, 26624, v4
    ds_read_b128 v[16:19], v8 offset:0
    ds_read_b64_tr_b16 v[24:25], v9 offset:0
    ds_read_b64_tr_b16 v[26:27], v9 offset:1280
    ds_read_b64_tr_b16 v[28:29], v9 offset:32
    ds_read_b64_tr_b16 v[30:31], v9 offset:1312
    ds_read_b64_tr_b16 v[32:33], v9 offset:64
    ds_read_b64_tr_b16 v[34:35], v9 offset:1344
    ds_read_b64_tr_b16 v[36:37], v9 offset:96
    ds_read_b64_tr_b16 v[38:39], v9 offset:1376
    ds_read_b64_tr_b16 v[40:41], v9 offset:128
    ds_read_b64_tr_b16 v[42:43], v9 offset:1408
    v_mfma_f32_16x16x32_bf16 v[64:67], v[44:47], v[20:23], v[64:67]
    v_mfma_f32_16x16x32_bf16 v[68:71], v[48:51], v[20:23], v[68:71]
    v_mfma_f32_16x16x32_bf16 v[72:75], v[52:55], v[20:23], v[72:75]
    v_mfma_f32_16x16x32_bf16 v[76:79], v[56:59], v[20:23], v[76:79]
    v_mfma_f32_16x16x32_bf16 v[80:83], v[60:63], v[20:23], v[80:83]
    v_add_u32 v8, 18432, v3
    v_add_u32 v9, 26624, v4
    ds_read_b128 v[20:23], v8 offset:0
    ds_read_b64_tr_b16 v[44:45], v9 offset:5120
    ds_read_b64_tr_b16 v[46:47], v9 offset:6400
    ds_read_b64_tr_b16 v[48:49], v9 offset:5152
    ds_read_b64_tr_b16 v[50:51], v9 offset:6432
    ds_read_b64_tr_b16 v[52:53], v9 offset:5184
    ds_read_b64_tr_b16 v[54:55], v9 offset:6464
    ds_read_b64_tr_b16 v[56:57], v9 offset:5216
    ds_read_b64_tr_b16 v[58:59], v9 offset:6496
    ds_read_b64_tr_b16 v[60:61], v9 offset:5248
    ds_read_b64_tr_b16 v[62:63], v9 offset:6528
    s_waitcnt lgkmcnt(11)
    v_mfma_f32_16x16x32_bf16 v[64:67], v[24:27], v[16:19], v[64:67]
    v_mfma_f32_16x16x32_bf16 v[68:71], v[28:31], v[16:19], v[68:71]
    v_mfma_f32_16x16x32_bf16 v[72:75], v[32:35], v[16:19], v[72:75]
    v_mfma_f32_16x16x32_bf16 v[76:79], v[36:39], v[16:19], v[76:79]
    v_mfma_f32_16x16x32_bf16 v[80:83], v[40:43], v[16:19], v[80:83]
    s_waitcnt lgkmcnt(0)
    s_barrier
    v_add_u32 v8, 36864, v2
    v_add_u32 v9, 45056, v4
    ds_read_b128 v[16:19], v8 offset:0
    ds_read_b64_tr_b16 v[24:25], v9 offset:0
    ds_read_b64_tr_b16 v[26:27], v9 offset:1280
    ds_read_b64_tr_b16 v[28:29], v9 offset:32
    ds_read_b64_tr_b16 v[30:31], v9 offset:1312
    ds_read_b64_tr_b16 v[32:33], v9 offset:64
    ds_read_b64_tr_b16 v[34:35], v9 offset:1344
    ds_read_b64_tr_b16 v[36:37], v9 offset:96
    ds_read_b64_tr_b16 v[38:39], v9 offset:1376
    ds_read_b64_tr_b16 v[40:41], v9 offset:128
    ds_read_b64_tr_b16 v[42:43], v9 offset:1408
    v_mfma_f32_16x16x32_bf16 v[64:67], v[44:47], v[20:23], v[64:67]
    v_mfma_f32_16x16x32_bf16 v[68:71], v[48:51], v[20:23], v[68:71]
    v_mfma_f32_16x16x32_bf16 v[72:75], v[52:55], v[20:23], v[72:75]
    v_mfma_f32_16x16x32_bf16 v[76:79], v[56:59], v[20:23], v[76:79]
    v_mfma_f32_16x16x32_bf16 v[80:83], v[60:63], v[20:23], v[80:83]
    v_add_u32 v8, 36864, v3
    v_add_u32 v9, 45056, v4
    ds_read_b128 v[20:23], v8 offset:0
    ds_read_b64_tr_b16 v[44:45], v9 offset:5120
    ds_read_b64_tr_b16 v[46:47], v9 offset:6400
    ds_read_b64_tr_b16 v[48:49], v9 offset:5152
    ds_read_b64_tr_b16 v[50:51], v9 offset:6432
    ds_read_b64_tr_b16 v[52:53], v9 offset:5184
    ds_read_b64_tr_b16 v[54:55], v9 offset:6464
    ds_read_b64_tr_b16 v[56:57], v9 offset:5216
    ds_read_b64_tr_b16 v[58:59], v9 offset:6496
    ds_read_b64_tr_b16 v[60:61], v9 offset:5248
    ds_read_b64_tr_b16 v[62:63], v9 offset:6528
    s_waitcnt lgkmcnt(11)
    v_mfma_f32_16x16x32_bf16 v[64:67], v[24:27], v[16:19], v[64:67]
    v_mfma_f32_16x16x32_bf16 v[68:71], v[28:31], v[16:19], v[68:71]
    v_mfma_f32_16x16x32_bf16 v[72:75], v[32:35], v[16:19], v[72:75]
    v_mfma_f32_16x16x32_bf16 v[76:79], v[36:39], v[16:19], v[76:79]
    v_mfma_f32_16x16x32_bf16 v[80:83], v[40:43], v[16:19], v[80:83]
    s_waitcnt lgkmcnt(0)
    v_mfma_f32_16x16x32_bf16 v[64:67], v[44:47], v[20:23], v[64:67]
    v_mfma_f32_16x16x32_bf16 v[68:71], v[48:51], v[20:23], v[68:71]
    v_mfma_f32_16x16x32_bf16 v[72:75], v[52:55], v[20:23], v[72:75]
    v_mfma_f32_16x16x32_bf16 v[76:79], v[56:59], v[20:23], v[76:79]
    v_mfma_f32_16x16x32_bf16 v[80:83], v[60:63], v[20:23], v[80:83]
    s_nop 15
    s_branch k5_kernel_epi
k5_kernel_ld:
    s_sub_u32 s37, s26, 4
    s_add_u32 s29, s37, 0
    s_and_b32 s32, s29, 1
    s_lshl_b32 s32, s32, 2
    v_lshrrev_b32 v16, 3, v1
    v_lshrrev_b32 v17, 4, v1
    v_add_u32 v17, s32, v17
    v_and_b32 v17, 7, v17
    v_and_b32 v18, 7, v1
    v_xor_b32 v17, v17, v18
    v_lshlrev_b32 v17, 4, v17
    s_lshl_b32 s29, s29, 3
    s_add_u32 s29, s29, s24
    v_add_u32 v16, s29, v16
    s_mov_b32 s30, 3456
    v_mul_lo_u32 v16, v16, s30
    v_add_u32 v10, v16, v17
    s_add_u32 s29, s37, 4
    s_and_b32 s32, s29, 1
    s_lshl_b32 s32, s32, 2
    v_lshrrev_b32 v16, 3, v1
    v_lshrrev_b32 v17, 4, v1
    v_add_u32 v17, s32, v17
    v_and_b32 v17, 7, v17
    v_and_b32 v18, 7, v1
    v_xor_b32 v17, v17, v18
    v_lshlrev_b32 v17, 4, v17
    s_lshl_b32 s29, s29, 3
    s_add_u32 s29, s29, s24
    v_add_u32 v16, s29, v16
    s_mov_b32 s30, 3456
    v_mul_lo_u32 v16, v16, s30
    v_add_u32 v11, v16, v17
    s_lshl_b32 s30, s25, 1
    s_mov_b32 s31, 1280
    s_add_u32 s29, s37, 0
    s_cmp_ge_u32 s29, 10
    s_cselect_b32 s29, s37, s29
    s_lshl_b32 s29, s29, 6
    v_add_u32 v16, s29, v1
    v_mul_u32_u24 v17, 205, v16
    v_lshrrev_b32 v17, 11, v17
    v_mul_u32_u24 v18, 10, v17
    v_sub_u32 v18, v16, v18
    v_and_b32 v19, 0x33, v17
    v_and_b32 v20, 4, v17
    v_lshlrev_b32 v20, 1, v20
    v_or_b32 v19, v19, v20
    v_and_b32 v20, 8, v17
    v_lshrrev_b32 v20, 1, v20
    v_or_b32 v19, v19, v20
    v_mul_lo_u32 v19, v19, s31
    v_lshlrev_b32 v18, 4, v18
    v_add3_u32 v2, v19, v18, s30
    s_add_u32 s29, s37, 4
    s_cmp_ge_u32 s29, 10
    s_cselect_b32 s29, s37, s29
    s_lshl_b32 s29, s29, 6
    v_add_u32 v16, s29, v1
    v_mul_u32_u24 v17, 205, v16
    v_lshrrev_b32 v17, 11, v17
    v_mul_u32_u24 v18, 10, v17
    v_sub_u32 v18, v16, v18
    v_and_b32 v19, 0x33, v17
    v_and_b32 v20, 4, v17
    v_lshlrev_b32 v20, 1, v20
    v_or_b32 v19, v19, v20
    v_and_b32 v20, 8, v17
    v_lshrrev_b32 v20, 1, v20
    v_or_b32 v19, v19, v20
    v_mul_lo_u32 v19, v19, s31
    v_lshlrev_b32 v18, 4, v18
    v_add3_u32 v3, v19, v18, s30
    s_add_u32 s29, s37, 8
    s_cmp_ge_u32 s29, 10
    s_cselect_b32 s29, s37, s29
    s_lshl_b32 s29, s29, 6
    v_add_u32 v16, s29, v1
    v_mul_u32_u24 v17, 205, v16
    v_lshrrev_b32 v17, 11, v17
    v_mul_u32_u24 v18, 10, v17
    v_sub_u32 v18, v16, v18
    v_and_b32 v19, 0x33, v17
    v_and_b32 v20, 4, v17
    v_lshlrev_b32 v20, 1, v20
    v_or_b32 v19, v19, v20
    v_and_b32 v20, 8, v17
    v_lshrrev_b32 v20, 1, v20
    v_or_b32 v19, v19, v20
    v_mul_lo_u32 v19, v19, s31
    v_lshlrev_b32 v18, 4, v18
    v_add3_u32 v4, v19, v18, s30
    s_add_u32 s29, s37, 0
    s_lshl_b32 m0, s29, 10
    s_add_u32 m0, m0, 0
    s_nop 0
    buffer_load_dwordx4 v10, s[8:11], 0 offen lds
    v_add_u32 v10, 128, v10
    s_add_u32 s29, s37, 4
    s_lshl_b32 m0, s29, 10
    s_add_u32 m0, m0, 0
    s_nop 0
    buffer_load_dwordx4 v11, s[8:11], 0 offen lds
    v_add_u32 v11, 128, v11
    s_add_u32 s29, s37, 0
    s_lshl_b32 m0, s29, 10
    s_add_u32 m0, m0, 8192
    s_nop 0
    buffer_load_dwordx4 v2, s[12:15], 0 offen lds
    v_add_u32 v2, 81920, v2
    s_add_u32 s29, s37, 4
    s_lshl_b32 m0, s29, 10
    s_add_u32 m0, m0, 8192
    s_nop 0
    buffer_load_dwordx4 v3, s[12:15], 0 offen lds
    v_add_u32 v3, 81920, v3
    s_add_u32 s29, s37, 8
    s_cmp_ge_u32 s29, 10
    s_cselect_b32 s29, s37, s29
    s_lshl_b32 m0, s29, 10
    s_add_u32 m0, m0, 8192
    s_nop 0
    buffer_load_dwordx4 v4, s[12:15], 0 offen lds
    v_add_u32 v4, 81920, v4
    s_add_u32 s29, s37, 0
    s_lshl_b32 m0, s29, 10
    s_add_u32 m0, m0, 18432
    s_nop 0
    buffer_load_dwordx4 v10, s[8:11], 0 offen lds
    v_add_u32 v10, 128, v10
    s_add_u32 s29, s37, 4
    s_lshl_b32 m0, s29, 10
    s_add_u32 m0, m0, 18432
    s_nop 0
    buffer_load_dwordx4 v11, s[8:11], 0 offen lds
    v_add_u32 v11, 128, v11
    s_add_u32 s29, s37, 0
    s_lshl_b32 m0, s29, 10
    s_add_u32 m0, m0, 26624
    s_nop 0
    buffer_load_dwordx4 v2, s[12:15], 0 offen lds
    v_add_u32 v2, 81920, v2
    s_add_u32 s29, s37, 4
    s_lshl_b32 m0, s29, 10
    s_add_u32 m0, m0, 26624
    s_nop 0
    buffer_load_dwordx4 v3, s[12:15], 0 offen lds
    v_add_u32 v3, 81920, v3
    s_add_u32 s29, s37, 8
    s_cmp_ge_u32 s29, 10
    s_cselect_b32 s29, s37, s29
    s_lshl_b32 m0, s29, 10
    s_add_u32 m0, m0, 26624
    s_nop 0
    buffer_load_dwordx4 v4, s[12:15], 0 offen lds
    v_add_u32 v4, 81920, v4
    s_add_u32 s29, s37, 0
    s_lshl_b32 m0, s29, 10
    s_add_u32 m0, m0, 36864
    s_nop 0
    buffer_load_dwordx4 v10, s[8:11], 0 offen lds
    v_add_u32 v10, 128, v10
    s_add_u32 s29, s37, 4
    s_lshl_b32 m0, s29, 10
    s_add_u32 m0, m0, 36864
    s_nop 0
    buffer_load_dwordx4 v11, s[8:11], 0 offen lds
    v_add_u32 v11, 128, v11
    s_add_u32 s29, s37, 0
    s_lshl_b32 m0, s29, 10
    s_add_u32 m0, m0, 45056
    s_nop 0
    buffer_load_dwordx4 v2, s[12:15], 0 offen lds
    v_add_u32 v2, 81920, v2
    s_add_u32 s29, s37, 4
    s_lshl_b32 m0, s29, 10
    s_add_u32 m0, m0, 45056
    s_nop 0
    buffer_load_dwordx4 v3, s[12:15], 0 offen lds
    v_add_u32 v3, 81920, v3
    s_add_u32 s29, s37, 8
    s_cmp_ge_u32 s29, 10
    s_cselect_b32 s29, s37, s29
    s_lshl_b32 m0, s29, 10
    s_add_u32 m0, m0, 45056
    s_nop 0
    buffer_load_dwordx4 v4, s[12:15], 0 offen lds
    v_add_u32 v4, 81920, v4
    s_add_u32 s29, s37, 0
    s_lshl_b32 m0, s29, 10
    s_add_u32 m0, m0, 55296
    s_nop 0
    buffer_load_dwordx4 v10, s[8:11], 0 offen lds
    v_add_u32 v10, 128, v10
    s_add_u32 s29, s37, 4
    s_lshl_b32 m0, s29, 10
    s_add_u32 m0, m0, 55296
    s_nop 0
    buffer_load_dwordx4 v11, s[8:11], 0 offen lds
    v_add_u32 v11, 128, v11
    s_add_u32 s29, s37, 0
    s_lshl_b32 m0, s29, 10
    s_add_u32 m0, m0, 63488
    s_nop 0
    buffer_load_dwordx4 v2, s[12:15], 0 offen lds
    v_add_u32 v2, 81920, v2
    s_add_u32 s29, s37, 4
    s_lshl_b32 m0, s29, 10
    s_add_u32 m0, m0, 63488
    s_nop 0
    buffer_load_dwordx4 v3, s[12:15], 0 offen lds
    v_add_u32 v3, 81920, v3
    s_add_u32 s29, s37, 8
    s_cmp_ge_u32 s29, 10
    s_cselect_b32 s29, s37, s29
    s_lshl_b32 m0, s29, 10
    s_add_u32 m0, m0, 63488
    s_nop 0
    buffer_load_dwordx4 v4, s[12:15], 0 offen lds
    v_add_u32 v4, 81920, v4
    s_add_u32 s29, s37, 0
    s_lshl_b32 m0, s29, 10
    s_add_u32 m0, m0, 73728
    s_nop 0
    buffer_load_dwordx4 v10, s[8:11], 0 offen lds
    v_add_u32 v10, 128, v10
    s_add_u32 s29, s37, 4
    s_lshl_b32 m0, s29, 10
    s_add_u32 m0, m0, 73728
    s_nop 0
    buffer_load_dwordx4 v11, s[8:11], 0 offen lds
    v_add_u32 v11, 128, v11
    s_add_u32 s29, s37, 0
    s_lshl_b32 m0, s29, 10
    s_add_u32 m0, m0, 81920
    s_nop 0
    buffer_load_dwordx4 v2, s[12:15], 0 offen lds
    v_add_u32 v2, 81920, v2
    s_add_u32 s29, s37, 4
    s_lshl_b32 m0, s29, 10
    s_add_u32 m0, m0, 81920
    s_nop 0
    buffer_load_dwordx4 v3, s[12:15], 0 offen lds
    v_add_u32 v3, 81920, v3
    s_add_u32 s29, s37, 8
    s_cmp_ge_u32 s29, 10
    s_cselect_b32 s29, s37, s29
    s_lshl_b32 m0, s29, 10
    s_add_u32 m0, m0, 81920
    s_nop 0
    buffer_load_dwordx4 v4, s[12:15], 0 offen lds
    v_add_u32 v4, 81920, v4
    s_waitcnt vmcnt(20)
    s_barrier
    s_add_u32 s29, s37, 0
    s_lshl_b32 m0, s29, 10
    s_add_u32 m0, m0, 92160
    s_nop 0
    buffer_load_dwordx4 v10, s[8:11], 0 offen lds
    v_add_u32 v10, 128, v10
    s_add_u32 s29, s37, 4
    s_lshl_b32 m0, s29, 10
    s_add_u32 m0, m0, 92160
    s_nop 0
    buffer_load_dwordx4 v11, s[8:11], 0 offen lds
    v_add_u32 v11, 128, v11
    s_add_u32 s29, s37, 0
    s_lshl_b32 m0, s29, 10
    s_add_u32 m0, m0, 100352
    s_nop 0
    buffer_load_dwordx4 v2, s[12:15], 0 offen lds
    v_add_u32 v2, 81920, v2
    s_add_u32 s29, s37, 4
    s_lshl_b32 m0, s29, 10
    s_add_u32 m0, m0, 100352
    s_nop 0
    buffer_load_dwordx4 v3, s[12:15], 0 offen lds
    v_add_u32 v3, 81920, v3
    s_add_u32 s29, s37, 8
    s_cmp_ge_u32 s29, 10
    s_cselect_b32 s29, s37, s29
    s_lshl_b32 m0, s29, 10
    s_add_u32 m0, m0, 100352
    s_nop 0
    buffer_load_dwordx4 v4, s[12:15], 0 offen lds
    v_add_u32 v4, 81920, v4
    s_waitcnt vmcnt(20)
    s_barrier
    s_add_u32 s29, s37, 0
    s_lshl_b32 m0, s29, 10
    s_add_u32 m0, m0, 0
    s_nop 0
    buffer_load_dwordx4 v10, s[8:11], 0 offen lds
    v_add_u32 v10, 128, v10
    s_add_u32 s29, s37, 4
    s_lshl_b32 m0, s29, 10
    s_add_u32 m0, m0, 0
    s_nop 0
    buffer_load_dwordx4 v11, s[8:11], 0 offen lds
    v_add_u32 v11, 128, v11
    s_add_u32 s29, s37, 0
    s_lshl_b32 m0, s29, 10
    s_add_u32 m0, m0, 8192
    s_nop 0
    buffer_load_dwordx4 v2, s[12:15], 0 offen lds
    v_add_u32 v2, 81920, v2
    s_add_u32 s29, s37, 4
    s_lshl_b32 m0, s29, 10
    s_add_u32 m0, m0, 8192
    s_nop 0
    buffer_load_dwordx4 v3, s[12:15], 0 offen lds
    v_add_u32 v3, 81920, v3
    s_add_u32 s29, s37, 8
    s_cmp_ge_u32 s29, 10
    s_cselect_b32 s29, s37, s29
    s_lshl_b32 m0, s29, 10
    s_add_u32 m0, m0, 8192
    s_nop 0
    buffer_load_dwordx4 v4, s[12:15], 0 offen lds
    v_add_u32 v4, 81920, v4
    s_waitcnt vmcnt(20)
    s_barrier
    s_add_u32 s29, s37, 0
    s_lshl_b32 m0, s29, 10
    s_add_u32 m0, m0, 18432
    s_nop 0
    buffer_load_dwordx4 v10, s[8:11], 0 offen lds
    v_add_u32 v10, 128, v10
    s_add_u32 s29, s37, 4
    s_lshl_b32 m0, s29, 10
    s_add_u32 m0, m0, 18432
    s_nop 0
    buffer_load_dwordx4 v11, s[8:11], 0 offen lds
    v_add_u32 v11, 128, v11
    s_add_u32 s29, s37, 0
    s_lshl_b32 m0, s29, 10
    s_add_u32 m0, m0, 26624
    s_nop 0
    buffer_load_dwordx4 v2, s[12:15], 0 offen lds
    v_add_u32 v2, 81920, v2
    s_add_u32 s29, s37, 4
    s_lshl_b32 m0, s29, 10
    s_add_u32 m0, m0, 26624
    s_nop 0
    buffer_load_dwordx4 v3, s[12:15], 0 offen lds
    v_add_u32 v3, 81920, v3
    s_add_u32 s29, s37, 8
    s_cmp_ge_u32 s29, 10
    s_cselect_b32 s29, s37, s29
    s_lshl_b32 m0, s29, 10
    s_add_u32 m0, m0, 26624
    s_nop 0
    buffer_load_dwordx4 v4, s[12:15], 0 offen lds
    v_add_u32 v4, 81920, v4
    s_waitcnt vmcnt(20)
    s_barrier
    s_add_u32 s29, s37, 0
    s_lshl_b32 m0, s29, 10
    s_add_u32 m0, m0, 36864
    s_nop 0
    buffer_load_dwordx4 v10, s[8:11], 0 offen lds
    v_add_u32 v10, 128, v10
    s_add_u32 s29, s37, 4
    s_lshl_b32 m0, s29, 10
    s_add_u32 m0, m0, 36864
    s_nop 0
    buffer_load_dwordx4 v11, s[8:11], 0 offen lds
    v_add_u32 v11, 128, v11
    s_add_u32 s29, s37, 0
    s_lshl_b32 m0, s29, 10
    s_add_u32 m0, m0, 45056
    s_nop 0
    buffer_load_dwordx4 v2, s[12:15], 0 offen lds
    v_add_u32 v2, 81920, v2
    s_add_u32 s29, s37, 4
    s_lshl_b32 m0, s29, 10
    s_add_u32 m0, m0, 45056
    s_nop 0
    buffer_load_dwordx4 v3, s[12:15], 0 offen lds
    v_add_u32 v3, 81920, v3
    s_add_u32 s29, s37, 8
    s_cmp_ge_u32 s29, 10
    s_cselect_b32 s29, s37, s29
    s_lshl_b32 m0, s29, 10
    s_add_u32 m0, m0, 45056
    s_nop 0
    buffer_load_dwordx4 v4, s[12:15], 0 offen lds
    v_add_u32 v4, 81920, v4
    s_waitcnt vmcnt(20)
    s_barrier
    s_add_u32 s29, s37, 0
    s_lshl_b32 m0, s29, 10
    s_add_u32 m0, m0, 55296
    s_nop 0
    buffer_load_dwordx4 v10, s[8:11], 0 offen lds
    v_add_u32 v10, 128, v10
    s_add_u32 s29, s37, 4
    s_lshl_b32 m0, s29, 10
    s_add_u32 m0, m0, 55296
    s_nop 0
    buffer_load_dwordx4 v11, s[8:11], 0 offen lds
    v_add_u32 v11, 128, v11
    s_add_u32 s29, s37, 0
    s_lshl_b32 m0, s29, 10
    s_add_u32 m0, m0, 63488
    s_nop 0
    buffer_load_dwordx4 v2, s[12:15], 0 offen lds
    v_add_u32 v2, 81920, v2
    s_add_u32 s29, s37, 4
    s_lshl_b32 m0, s29, 10
    s_add_u32 m0, m0, 63488
    s_nop 0
    buffer_load_dwordx4 v3, s[12:15], 0 offen lds
    v_add_u32 v3, 81920, v3
    s_add_u32 s29, s37, 8
    s_cmp_ge_u32 s29, 10
    s_cselect_b32 s29, s37, s29
    s_lshl_b32 m0, s29, 10
    s_add_u32 m0, m0, 63488
    s_nop 0
    buffer_load_dwordx4 v4, s[12:15], 0 offen lds
    v_add_u32 v4, 81920, v4
    s_waitcnt vmcnt(20)
    s_barrier
    s_add_u32 s29, s37, 0
    s_lshl_b32 m0, s29, 10
    s_add_u32 m0, m0, 73728
    s_nop 0
    buffer_load_dwordx4 v10, s[8:11], 0 offen lds
    v_add_u32 v10, 128, v10
    s_add_u32 s29, s37, 4
    s_lshl_b32 m0, s29, 10
    s_add_u32 m0, m0, 73728
    s_nop 0
    buffer_load_dwordx4 v11, s[8:11], 0 offen lds
    v_add_u32 v11, 128, v11
    s_add_u32 s29, s37, 0
    s_lshl_b32 m0, s29, 10
    s_add_u32 m0, m0, 81920
    s_nop 0
    buffer_load_dwordx4 v2, s[12:15], 0 offen lds
    v_add_u32 v2, 81920, v2
    s_add_u32 s29, s37, 4
    s_lshl_b32 m0, s29, 10
    s_add_u32 m0, m0, 81920
    s_nop 0
    buffer_load_dwordx4 v3, s[12:15], 0 offen lds
    v_add_u32 v3, 81920, v3
    s_add_u32 s29, s37, 8
    s_cmp_ge_u32 s29, 10
    s_cselect_b32 s29, s37, s29
    s_lshl_b32 m0, s29, 10
    s_add_u32 m0, m0, 81920
    s_nop 0
    buffer_load_dwordx4 v4, s[12:15], 0 offen lds
    v_add_u32 v4, 81920, v4
    s_waitcnt vmcnt(20)
    s_barrier
    s_add_u32 s29, s37, 0
    s_lshl_b32 m0, s29, 10
    s_add_u32 m0, m0, 92160
    s_nop 0
    buffer_load_dwordx4 v10, s[8:11], 0 offen lds
    v_add_u32 v10, 128, v10
    s_add_u32 s29, s37, 4
    s_lshl_b32 m0, s29, 10
    s_add_u32 m0, m0, 92160
    s_nop 0
    buffer_load_dwordx4 v11, s[8:11], 0 offen lds
    v_add_u32 v11, 128, v11
    s_add_u32 s29, s37, 0
    s_lshl_b32 m0, s29, 10
    s_add_u32 m0, m0, 100352
    s_nop 0
    buffer_load_dwordx4 v2, s[12:15], 0 offen lds
    v_add_u32 v2, 81920, v2
    s_add_u32 s29, s37, 4
    s_lshl_b32 m0, s29, 10
    s_add_u32 m0, m0, 100352
    s_nop 0
    buffer_load_dwordx4 v3, s[12:15], 0 offen lds
    v_add_u32 v3, 81920, v3
    s_add_u32 s29, s37, 8
    s_cmp_ge_u32 s29, 10
    s_cselect_b32 s29, s37, s29
    s_lshl_b32 m0, s29, 10
    s_add_u32 m0, m0, 100352
    s_nop 0
    buffer_load_dwordx4 v4, s[12:15], 0 offen lds
    v_add_u32 v4, 81920, v4
    s_waitcnt vmcnt(20)
    s_barrier
    s_add_u32 s29, s37, 0
    s_lshl_b32 m0, s29, 10
    s_add_u32 m0, m0, 0
    s_nop 0
    buffer_load_dwordx4 v10, s[8:11], 0 offen lds
    v_add_u32 v10, 128, v10
    s_add_u32 s29, s37, 4
    s_lshl_b32 m0, s29, 10
    s_add_u32 m0, m0, 0
    s_nop 0
    buffer_load_dwordx4 v11, s[8:11], 0 offen lds
    v_add_u32 v11, 128, v11
    s_add_u32 s29, s37, 0
    s_lshl_b32 m0, s29, 10
    s_add_u32 m0, m0, 8192
    s_nop 0
    buffer_load_dwordx4 v2, s[12:15], 0 offen lds
    v_add_u32 v2, 81920, v2
    s_add_u32 s29, s37, 4
    s_lshl_b32 m0, s29, 10
    s_add_u32 m0, m0, 8192
    s_nop 0
    buffer_load_dwordx4 v3, s[12:15], 0 offen lds
    v_add_u32 v3, 81920, v3
    s_add_u32 s29, s37, 8
    s_cmp_ge_u32 s29, 10
    s_cselect_b32 s29, s37, s29
    s_lshl_b32 m0, s29, 10
    s_add_u32 m0, m0, 8192
    s_nop 0
    buffer_load_dwordx4 v4, s[12:15], 0 offen lds
    v_add_u32 v4, 81920, v4
    s_waitcnt vmcnt(20)
    s_barrier
    s_add_u32 s29, s37, 0
    s_lshl_b32 m0, s29, 10
    s_add_u32 m0, m0, 18432
    s_nop 0
    buffer_load_dwordx4 v10, s[8:11], 0 offen lds
    v_add_u32 v10, 128, v10
    s_add_u32 s29, s37, 4
    s_lshl_b32 m0, s29, 10
    s_add_u32 m0, m0, 18432
    s_nop 0
    buffer_load_dwordx4 v11, s[8:11], 0 offen lds
    v_add_u32 v11, 128, v11
    s_add_u32 s29, s37, 0
    s_lshl_b32 m0, s29, 10
    s_add_u32 m0, m0, 26624
    s_nop 0
    buffer_load_dwordx4 v2, s[12:15], 0 offen lds
    v_add_u32 v2, 81920, v2
    s_add_u32 s29, s37, 4
    s_lshl_b32 m0, s29, 10
    s_add_u32 m0, m0, 26624
    s_nop 0
    buffer_load_dwordx4 v3, s[12:15], 0 offen lds
    v_add_u32 v3, 81920, v3
    s_add_u32 s29, s37, 8
    s_cmp_ge_u32 s29, 10
    s_cselect_b32 s29, s37, s29
    s_lshl_b32 m0, s29, 10
    s_add_u32 m0, m0, 26624
    s_nop 0
    buffer_load_dwordx4 v4, s[12:15], 0 offen lds
    v_add_u32 v4, 81920, v4
    s_waitcnt vmcnt(20)
    s_barrier
    s_add_u32 s29, s37, 0
    s_lshl_b32 m0, s29, 10
    s_add_u32 m0, m0, 36864
    s_nop 0
    buffer_load_dwordx4 v10, s[8:11], 0 offen lds
    v_add_u32 v10, 128, v10
    s_add_u32 s29, s37, 4
    s_lshl_b32 m0, s29, 10
    s_add_u32 m0, m0, 36864
    s_nop 0
    buffer_load_dwordx4 v11, s[8:11], 0 offen lds
    v_add_u32 v11, 128, v11
    s_add_u32 s29, s37, 0
    s_lshl_b32 m0, s29, 10
    s_add_u32 m0, m0, 45056
    s_nop 0
    buffer_load_dwordx4 v2, s[12:15], 0 offen lds
    v_add_u32 v2, 81920, v2
    s_add_u32 s29, s37, 4
    s_lshl_b32 m0, s29, 10
    s_add_u32 m0, m0, 45056
    s_nop 0
    buffer_load_dwordx4 v3, s[12:15], 0 offen lds
    v_add_u32 v3, 81920, v3
    s_add_u32 s29, s37, 8
    s_cmp_ge_u32 s29, 10
    s_cselect_b32 s29, s37, s29
    s_lshl_b32 m0, s29, 10
    s_add_u32 m0, m0, 45056
    s_nop 0
    buffer_load_dwordx4 v4, s[12:15], 0 offen lds
    v_add_u32 v4, 81920, v4
    s_waitcnt vmcnt(20)
    s_barrier
    s_add_u32 s29, s37, 0
    s_lshl_b32 m0, s29, 10
    s_add_u32 m0, m0, 55296
    s_nop 0
    buffer_load_dwordx4 v10, s[8:11], 0 offen lds
    v_add_u32 v10, 128, v10
    s_add_u32 s29, s37, 4
    s_lshl_b32 m0, s29, 10
    s_add_u32 m0, m0, 55296
    s_nop 0
    buffer_load_dwordx4 v11, s[8:11], 0 offen lds
    v_add_u32 v11, 128, v11
    s_add_u32 s29, s37, 0
    s_lshl_b32 m0, s29, 10
    s_add_u32 m0, m0, 63488
    s_nop 0
    buffer_load_dwordx4 v2, s[12:15], 0 offen lds
    v_add_u32 v2, 81920, v2
    s_add_u32 s29, s37, 4
    s_lshl_b32 m0, s29, 10
    s_add_u32 m0, m0, 63488
    s_nop 0
    buffer_load_dwordx4 v3, s[12:15], 0 offen lds
    v_add_u32 v3, 81920, v3
    s_add_u32 s29, s37, 8
    s_cmp_ge_u32 s29, 10
    s_cselect_b32 s29, s37, s29
    s_lshl_b32 m0, s29, 10
    s_add_u32 m0, m0, 63488
    s_nop 0
    buffer_load_dwordx4 v4, s[12:15], 0 offen lds
    v_add_u32 v4, 81920, v4
    s_waitcnt vmcnt(20)
    s_barrier
    s_add_u32 s29, s37, 0
    s_lshl_b32 m0, s29, 10
    s_add_u32 m0, m0, 73728
    s_nop 0
    buffer_load_dwordx4 v10, s[8:11], 0 offen lds
    v_add_u32 v10, 128, v10
    s_add_u32 s29, s37, 4
    s_lshl_b32 m0, s29, 10
    s_add_u32 m0, m0, 73728
    s_nop 0
    buffer_load_dwordx4 v11, s[8:11], 0 offen lds
    v_add_u32 v11, 128, v11
    s_add_u32 s29, s37, 0
    s_lshl_b32 m0, s29, 10
    s_add_u32 m0, m0, 81920
    s_nop 0
    buffer_load_dwordx4 v2, s[12:15], 0 offen lds
    v_add_u32 v2, 81920, v2
    s_add_u32 s29, s37, 4
    s_lshl_b32 m0, s29, 10
    s_add_u32 m0, m0, 81920
    s_nop 0
    buffer_load_dwordx4 v3, s[12:15], 0 offen lds
    v_add_u32 v3, 81920, v3
    s_add_u32 s29, s37, 8
    s_cmp_ge_u32 s29, 10
    s_cselect_b32 s29, s37, s29
    s_lshl_b32 m0, s29, 10
    s_add_u32 m0, m0, 81920
    s_nop 0
    buffer_load_dwordx4 v4, s[12:15], 0 offen lds
    v_add_u32 v4, 81920, v4
    s_waitcnt vmcnt(20)
    s_barrier
    s_add_u32 s29, s37, 0
    s_lshl_b32 m0, s29, 10
    s_add_u32 m0, m0, 92160
    s_nop 0
    buffer_load_dwordx4 v10, s[8:11], 0 offen lds
    v_add_u32 v10, 128, v10
    s_add_u32 s29, s37, 4
    s_lshl_b32 m0, s29, 10
    s_add_u32 m0, m0, 92160
    s_nop 0
    buffer_load_dwordx4 v11, s[8:11], 0 offen lds
    v_add_u32 v11, 128, v11
    s_add_u32 s29, s37, 0
    s_lshl_b32 m0, s29, 10
    s_add_u32 m0, m0, 100352
    s_nop 0
    buffer_load_dwordx4 v2, s[12:15], 0 offen lds
    v_add_u32 v2, 81920, v2
    s_add_u32 s29, s37, 4
    s_lshl_b32 m0, s29, 10
    s_add_u32 m0, m0, 100352
    s_nop 0
    buffer_load_dwordx4 v3, s[12:15], 0 offen lds
    v_add_u32 v3, 81920, v3
    s_add_u32 s29, s37, 8
    s_cmp_ge_u32 s29, 10
    s_cselect_b32 s29, s37, s29
    s_lshl_b32 m0, s29, 10
    s_add_u32 m0, m0, 100352
    s_nop 0
    buffer_load_dwordx4 v4, s[12:15], 0 offen lds
    v_add_u32 v4, 81920, v4
    s_waitcnt vmcnt(20)
    s_barrier
    s_add_u32 s29, s37, 0
    s_lshl_b32 m0, s29, 10
    s_add_u32 m0, m0, 0
    s_nop 0
    buffer_load_dwordx4 v10, s[8:11], 0 offen lds
    v_add_u32 v10, 128, v10
    s_add_u32 s29, s37, 4
    s_lshl_b32 m0, s29, 10
    s_add_u32 m0, m0, 0
    s_nop 0
    buffer_load_dwordx4 v11, s[8:11], 0 offen lds
    v_add_u32 v11, 128, v11
    s_add_u32 s29, s37, 0
    s_lshl_b32 m0, s29, 10
    s_add_u32 m0, m0, 8192
    s_nop 0
    buffer_load_dwordx4 v2, s[12:15], 0 offen lds
    v_add_u32 v2, 81920, v2
    s_add_u32 s29, s37, 4
    s_lshl_b32 m0, s29, 10
    s_add_u32 m0, m0, 8192
    s_nop 0
    buffer_load_dwordx4 v3, s[12:15], 0 offen lds
    v_add_u32 v3, 81920, v3
    s_add_u32 s29, s37, 8
    s_cmp_ge_u32 s29, 10
    s_cselect_b32 s29, s37, s29
    s_lshl_b32 m0, s29, 10
    s_add_u32 m0, m0, 8192
    s_nop 0
    buffer_load_dwordx4 v4, s[12:15], 0 offen lds
    v_add_u32 v4, 81920, v4
    s_waitcnt vmcnt(20)
    s_barrier
    s_add_u32 s29, s37, 0
    s_lshl_b32 m0, s29, 10
    s_add_u32 m0, m0, 18432
    s_nop 0
    buffer_load_dwordx4 v10, s[8:11], 0 offen lds
    v_add_u32 v10, 128, v10
    s_add_u32 s29, s37, 4
    s_lshl_b32 m0, s29, 10
    s_add_u32 m0, m0, 18432
    s_nop 0
    buffer_load_dwordx4 v11, s[8:11], 0 offen lds
    v_add_u32 v11, 128, v11
    s_add_u32 s29, s37, 0
    s_lshl_b32 m0, s29, 10
    s_add_u32 m0, m0, 26624
    s_nop 0
    buffer_load_dwordx4 v2, s[12:15], 0 offen lds
    v_add_u32 v2, 81920, v2
    s_add_u32 s29, s37, 4
    s_lshl_b32 m0, s29, 10
    s_add_u32 m0, m0, 26624
    s_nop 0
    buffer_load_dwordx4 v3, s[12:15], 0 offen lds
    v_add_u32 v3, 81920, v3
    s_add_u32 s29, s37, 8
    s_cmp_ge_u32 s29, 10
    s_cselect_b32 s29, s37, s29
    s_lshl_b32 m0, s29, 10
    s_add_u32 m0, m0, 26624
    s_nop 0
    buffer_load_dwordx4 v4, s[12:15], 0 offen lds
    v_add_u32 v4, 81920, v4
    s_waitcnt vmcnt(20)
    s_barrier
    s_add_u32 s29, s37, 0
    s_lshl_b32 m0, s29, 10
    s_add_u32 m0, m0, 36864
    s_nop 0
    buffer_load_dwordx4 v10, s[8:11], 0 offen lds
    v_add_u32 v10, 128, v10
    s_add_u32 s29, s37, 4
    s_lshl_b32 m0, s29, 10
    s_add_u32 m0, m0, 36864
    s_nop 0
    buffer_load_dwordx4 v11, s[8:11], 0 offen lds
    v_add_u32 v11, 128, v11
    s_add_u32 s29, s37, 0
    s_lshl_b32 m0, s29, 10
    s_add_u32 m0, m0, 45056
    s_nop 0
    buffer_load_dwordx4 v2, s[12:15], 0 offen lds
    v_add_u32 v2, 81920, v2
    s_add_u32 s29, s37, 4
    s_lshl_b32 m0, s29, 10
    s_add_u32 m0, m0, 45056
    s_nop 0
    buffer_load_dwordx4 v3, s[12:15], 0 offen lds
    v_add_u32 v3, 81920, v3
    s_add_u32 s29, s37, 8
    s_cmp_ge_u32 s29, 10
    s_cselect_b32 s29, s37, s29
    s_lshl_b32 m0, s29, 10
    s_add_u32 m0, m0, 45056
    s_nop 0
    buffer_load_dwordx4 v4, s[12:15], 0 offen lds
    v_add_u32 v4, 81920, v4
    s_waitcnt vmcnt(20)
    s_barrier
    s_add_u32 s29, s37, 0
    s_lshl_b32 m0, s29, 10
    s_add_u32 m0, m0, 55296
    s_nop 0
    buffer_load_dwordx4 v10, s[8:11], 0 offen lds
    v_add_u32 v10, 128, v10
    s_add_u32 s29, s37, 4
    s_lshl_b32 m0, s29, 10
    s_add_u32 m0, m0, 55296
    s_nop 0
    buffer_load_dwordx4 v11, s[8:11], 0 offen lds
    v_add_u32 v11, 128, v11
    s_add_u32 s29, s37, 0
    s_lshl_b32 m0, s29, 10
    s_add_u32 m0, m0, 63488
    s_nop 0
    buffer_load_dwordx4 v2, s[12:15], 0 offen lds
    v_add_u32 v2, 81920, v2
    s_add_u32 s29, s37, 4
    s_lshl_b32 m0, s29, 10
    s_add_u32 m0, m0, 63488
    s_nop 0
    buffer_load_dwordx4 v3, s[12:15], 0 offen lds
    v_add_u32 v3, 81920, v3
    s_add_u32 s29, s37, 8
    s_cmp_ge_u32 s29, 10
    s_cselect_b32 s29, s37, s29
    s_lshl_b32 m0, s29, 10
    s_add_u32 m0, m0, 63488
    s_nop 0
    buffer_load_dwordx4 v4, s[12:15], 0 offen lds
    v_add_u32 v4, 81920, v4
    s_waitcnt vmcnt(20)
    s_barrier
    s_add_u32 s29, s37, 0
    s_lshl_b32 m0, s29, 10
    s_add_u32 m0, m0, 73728
    s_nop 0
    buffer_load_dwordx4 v10, s[8:11], 0 offen lds
    v_add_u32 v10, 128, v10
    s_add_u32 s29, s37, 4
    s_lshl_b32 m0, s29, 10
    s_add_u32 m0, m0, 73728
    s_nop 0
    buffer_load_dwordx4 v11, s[8:11], 0 offen lds
    v_add_u32 v11, 128, v11
    s_add_u32 s29, s37, 0
    s_lshl_b32 m0, s29, 10
    s_add_u32 m0, m0, 81920
    s_nop 0
    buffer_load_dwordx4 v2, s[12:15], 0 offen lds
    v_add_u32 v2, 81920, v2
    s_add_u32 s29, s37, 4
    s_lshl_b32 m0, s29, 10
    s_add_u32 m0, m0, 81920
    s_nop 0
    buffer_load_dwordx4 v3, s[12:15], 0 offen lds
    v_add_u32 v3, 81920, v3
    s_add_u32 s29, s37, 8
    s_cmp_ge_u32 s29, 10
    s_cselect_b32 s29, s37, s29
    s_lshl_b32 m0, s29, 10
    s_add_u32 m0, m0, 81920
    s_nop 0
    buffer_load_dwordx4 v4, s[12:15], 0 offen lds
    v_add_u32 v4, 81920, v4
    s_waitcnt vmcnt(20)
    s_barrier
    s_add_u32 s29, s37, 0
    s_lshl_b32 m0, s29, 10
    s_add_u32 m0, m0, 92160
    s_nop 0
    buffer_load_dwordx4 v10, s[8:11], 0 offen lds
    v_add_u32 v10, 128, v10
    s_add_u32 s29, s37, 4
    s_lshl_b32 m0, s29, 10
    s_add_u32 m0, m0, 92160
    s_nop 0
    buffer_load_dwordx4 v11, s[8:11], 0 offen lds
    v_add_u32 v11, 128, v11
    s_add_u32 s29, s37, 0
    s_lshl_b32 m0, s29, 10
    s_add_u32 m0, m0, 100352
    s_nop 0
    buffer_load_dwordx4 v2, s[12:15], 0 offen lds
    v_add_u32 v2, 81920, v2
    s_add_u32 s29, s37, 4
    s_lshl_b32 m0, s29, 10
    s_add_u32 m0, m0, 100352
    s_nop 0
    buffer_load_dwordx4 v3, s[12:15], 0 offen lds
    v_add_u32 v3, 81920, v3
    s_add_u32 s29, s37, 8
    s_cmp_ge_u32 s29, 10
    s_cselect_b32 s29, s37, s29
    s_lshl_b32 m0, s29, 10
    s_add_u32 m0, m0, 100352
    s_nop 0
    buffer_load_dwordx4 v4, s[12:15], 0 offen lds
    v_add_u32 v4, 81920, v4
    s_waitcnt vmcnt(20)
    s_barrier
    s_add_u32 s29, s37, 0
    s_lshl_b32 m0, s29, 10
    s_add_u32 m0, m0, 0
    s_nop 0
    buffer_load_dwordx4 v10, s[8:11], 0 offen lds
    v_add_u32 v10, 128, v10
    s_add_u32 s29, s37, 4
    s_lshl_b32 m0, s29, 10
    s_add_u32 m0, m0, 0
    s_nop 0
    buffer_load_dwordx4 v11, s[8:11], 0 offen lds
    v_add_u32 v11, 128, v11
    s_add_u32 s29, s37, 0
    s_lshl_b32 m0, s29, 10
    s_add_u32 m0, m0, 8192
    s_nop 0
    buffer_load_dwordx4 v2, s[12:15], 0 offen lds
    v_add_u32 v2, 81920, v2
    s_add_u32 s29, s37, 4
    s_lshl_b32 m0, s29, 10
    s_add_u32 m0, m0, 8192
    s_nop 0
    buffer_load_dwordx4 v3, s[12:15], 0 offen lds
    v_add_u32 v3, 81920, v3
    s_add_u32 s29, s37, 8
    s_cmp_ge_u32 s29, 10
    s_cselect_b32 s29, s37, s29
    s_lshl_b32 m0, s29, 10
    s_add_u32 m0, m0, 8192
    s_nop 0
    buffer_load_dwordx4 v4, s[12:15], 0 offen lds
    v_add_u32 v4, 81920, v4
    s_waitcnt vmcnt(20)
    s_barrier
    s_add_u32 s29, s37, 0
    s_lshl_b32 m0, s29, 10
    s_add_u32 m0, m0, 18432
    s_nop 0
    buffer_load_dwordx4 v10, s[8:11], 0 offen lds
    v_add_u32 v10, 128, v10
    s_add_u32 s29, s37, 4
    s_lshl_b32 m0, s29, 10
    s_add_u32 m0, m0, 18432
    s_nop 0
    buffer_load_dwordx4 v11, s[8:11], 0 offen lds
    v_add_u32 v11, 128, v11
    s_add_u32 s29, s37, 0
    s_lshl_b32 m0, s29, 10
    s_add_u32 m0, m0, 26624
    s_nop 0
    buffer_load_dwordx4 v2, s[12:15], 0 offen lds
    v_add_u32 v2, 81920, v2
    s_add_u32 s29, s37, 4
    s_lshl_b32 m0, s29, 10
    s_add_u32 m0, m0, 26624
    s_nop 0
    buffer_load_dwordx4 v3, s[12:15], 0 offen lds
    v_add_u32 v3, 81920, v3
    s_add_u32 s29, s37, 8
    s_cmp_ge_u32 s29, 10
    s_cselect_b32 s29, s37, s29
    s_lshl_b32 m0, s29, 10
    s_add_u32 m0, m0, 26624
    s_nop 0
    buffer_load_dwordx4 v4, s[12:15], 0 offen lds
    v_add_u32 v4, 81920, v4
    s_waitcnt vmcnt(20)
    s_barrier
    s_add_u32 s29, s37, 0
    s_lshl_b32 m0, s29, 10
    s_add_u32 m0, m0, 36864
    s_nop 0
    buffer_load_dwordx4 v10, s[8:11], 0 offen lds
    v_add_u32 v10, 128, v10
    s_add_u32 s29, s37, 4
    s_lshl_b32 m0, s29, 10
    s_add_u32 m0, m0, 36864
    s_nop 0
    buffer_load_dwordx4 v11, s[8:11], 0 offen lds
    v_add_u32 v11, 128, v11
    s_add_u32 s29, s37, 0
    s_lshl_b32 m0, s29, 10
    s_add_u32 m0, m0, 45056
    s_nop 0
    buffer_load_dwordx4 v2, s[12:15], 0 offen lds
    v_add_u32 v2, 81920, v2
    s_add_u32 s29, s37, 4
    s_lshl_b32 m0, s29, 10
    s_add_u32 m0, m0, 45056
    s_nop 0
    buffer_load_dwordx4 v3, s[12:15], 0 offen lds
    v_add_u32 v3, 81920, v3
    s_add_u32 s29, s37, 8
    s_cmp_ge_u32 s29, 10
    s_cselect_b32 s29, s37, s29
    s_lshl_b32 m0, s29, 10
    s_add_u32 m0, m0, 45056
    s_nop 0
    buffer_load_dwordx4 v4, s[12:15], 0 offen lds
    v_add_u32 v4, 81920, v4
    s_waitcnt vmcnt(20)
    s_barrier
    s_waitcnt vmcnt(15)
    s_barrier
    s_waitcnt vmcnt(10)
    s_barrier
    s_waitcnt vmcnt(5)
    s_barrier
    s_waitcnt vmcnt(0)
    s_barrier
k5_kernel_epi:
    s_barrier
    s_cmp_ge_u32 s26, 4
    s_cbranch_scc1 k5_kernel_e2
    v_and_b32 v8, 15, v1
    v_lshrrev_b32 v9, 4, v1
    v_add_u32 v8, s27, v8
    v_mul_u32_u24 v8, 176, v8
    v_lshlrev_b32 v9, 3, v9
    s_lshl_b32 s29, s28, 1
    v_add3_u32 v8, v8, v9, s29
    v_cvt_pk_bf16_f32 v64, v64, v65
    v_cvt_pk_bf16_f32 v65, v66, v67
    ds_write_b64 v8, v[64:65] offset:0
    v_cvt_pk_bf16_f32 v68, v68, v69
    v_cvt_pk_bf16_f32 v69, v70, v71
    ds_write_b64 v8, v[68:69] offset:32
    v_cvt_pk_bf16_f32 v72, v72, v73
    v_cvt_pk_bf16_f32 v73, v74, v75
    ds_write_b64 v8, v[72:73] offset:64
    v_cvt_pk_bf16_f32 v76, v76, v77
    v_cvt_pk_bf16_f32 v77, v78, v79
    ds_write_b64 v8, v[76:77] offset:96
    v_cvt_pk_bf16_f32 v80, v80, v81
    v_cvt_pk_bf16_f32 v81, v82, v83
    ds_write_b64 v8, v[80:81] offset:128
    s_waitcnt lgkmcnt(0)
k5_kernel_e2:
    s_barrier
    s_mul_i32 s29, s24, 1280
    s_lshl_b32 s30, s25, 1
    s_add_u32 s29, s29, s30
    v_add_u32 v8, 0, v0
    v_mul_u32_u24 v9, 1639, v8
    v_lshrrev_b32 v9, 14, v9
    v_mul_u32_u24 v10, 10, v9
    v_sub_u32 v10, v8, v10
    v_mul_u32_u24 v11, 176, v9
    v_lshl_add_u32 v11, v10, 4, v11
    ds_read_b128 v[16:19], v11 offset:0
    v_mul_u32_u24 v11, 1280, v9
    v_lshl_add_u32 v24, v10, 4, v11
    v_lshlrev_b32 v12, 3, v10
    v_add_u32 v12, s25, v12
    v_cmp_gt_u32 vcc, 640, v8
    s_mov_b64 s[34:35], vcc
    v_cmp_gt_u32 vcc, 640, v12
    s_and_b64 s[34:35], s[34:35], vcc
    v_cndmask_b32 v24, -1, v24, s[34:35]
    buffer_load_dwordx4 v[20:23], v24, s[20:23], s29 offen
    v_add_u32 v8, 512, v0
    v_mul_u32_u24 v9, 1639, v8
    v_lshrrev_b32 v9, 14, v9
    v_mul_u32_u24 v10, 10, v9
    v_sub_u32 v10, v8, v10
    v_mul_u32_u24 v11, 176, v9
    v_lshl_add_u32 v11, v10, 4, v11
    ds_read_b128 v[28:31], v11 offset:0
    v_mul_u32_u24 v11, 1280, v9
    v_lshl_add_u32 v36, v10, 4, v11
    v_lshlrev_b32 v12, 3, v10
    v_add_u32 v12, s25, v12
    v_cmp_gt_u32 vcc, 640, v8
    s_mov_b64 s[34:35], vcc
    v_cmp_gt_u32 vcc, 640, v12
    s_and_b64 s[34:35], s[34:35], vcc
    v_cndmask_b32 v36, -1, v36, s[34:35]
    buffer_load_dwordx4 v[32:35], v36, s[20:23], s29 offen
    s_waitcnt vmcnt(0) lgkmcnt(0)
    v_lshlrev_b32 v8, 16, v16
    v_and_b32 v9, 0xffff0000, v16
    v_lshlrev_b32 v10, 16, v20
    v_and_b32 v11, 0xffff0000, v20
    v_add_f32 v8, v8, v10
    v_add_f32 v9, v9, v11
    v_cvt_pk_bf16_f32 v16, v8, v9
    v_lshlrev_b32 v8, 16, v17
    v_and_b32 v9, 0xffff0000, v17
    v_lshlrev_b32 v10, 16, v21
    v_and_b32 v11, 0xffff0000, v21
    v_add_f32 v8, v8, v10
    v_add_f32 v9, v9, v11
    v_cvt_pk_bf16_f32 v17, v8, v9
    v_lshlrev_b32 v8, 16, v18
    v_and_b32 v9, 0xffff0000, v18
    v_lshlrev_b32 v10, 16, v22
    v_and_b32 v11, 0xffff0000, v22
    v_add_f32 v8, v8, v10
    v_add_f32 v9, v9, v11
    v_cvt_pk_bf16_f32 v18, v8, v9
    v_lshlrev_b32 v8, 16, v19
    v_and_b32 v9, 0xffff0000, v19
    v_lshlrev_b32 v10, 16, v23
    v_and_b32 v11, 0xffff0000, v23
    v_add_f32 v8, v8, v10
    v_add_f32 v9, v9, v11
    v_cvt_pk_bf16_f32 v19, v8, v9
    buffer_store_dwordx4 v[16:19], v24, s[16:19], s29 offen
    v_lshlrev_b32 v8, 16, v28
    v_and_b32 v9, 0xffff0000, v28
    v_lshlrev_b32 v10, 16, v32
    v_and_b32 v11, 0xffff0000, v32
    v_add_f32 v8, v8, v10
    v_add_f32 v9, v9, v11
    v_cvt_pk_bf16_f32 v28, v8, v9
    v_lshlrev_b32 v8, 16, v29
    v_and_b32 v9, 0xffff0000, v29
    v_lshlrev_b32 v10, 16, v33
    v_and_b32 v11, 0xffff0000, v33
    v_add_f32 v8, v8, v10
    v_add_f32 v9, v9, v11
    v_cvt_pk_bf16_f32 v29, v8, v9
    v_lshlrev_b32 v8, 16, v30
    v_and_b32 v9, 0xffff0000, v30
    v_lshlrev_b32 v10, 16, v34
    v_and_b32 v11, 0xffff0000, v34
    v_add_f32 v8, v8, v10
    v_add_f32 v9, v9, v11
    v_cvt_pk_bf16_f32 v30, v8, v9
    v_lshlrev_b32 v8, 16, v31
    v_and_b32 v9, 0xffff0000, v31
    v_lshlrev_b32 v10, 16, v35
    v_and_b32 v11, 0xffff0000, v35
    v_add_f32 v8, v8, v10
    v_add_f32 v9, v9, v11
    v_cvt_pk_bf16_f32 v31, v8, v9
    buffer_store_dwordx4 v[28:31], v36, s[16:19], s29 offen
    s_waitcnt vmcnt(0)
k5_kernel_end:
    s_endpgm

.section .rodata,"a"
.p2align 6
.amdhsa_kernel z_kernel
  .amdhsa_next_free_vgpr 32
  .amdhsa_next_free_sgpr 96
  .amdhsa_accum_offset 32
  .amdhsa_group_segment_fixed_size 0
  .amdhsa_kernarg_size 80
  .amdhsa_user_sgpr_count 2
  .amdhsa_user_sgpr_kernarg_segment_ptr 1
  .amdhsa_system_sgpr_workgroup_id_x 1
.end_amdhsa_kernel
.p2align 6
.amdhsa_kernel k1n_kernel
  .amdhsa_next_free_vgpr 160
  .amdhsa_next_free_sgpr 96
  .amdhsa_accum_offset 160
  .amdhsa_group_segment_fixed_size 0
  .amdhsa_kernarg_size 80
  .amdhsa_user_sgpr_count 2
  .amdhsa_user_sgpr_kernarg_segment_ptr 1
  .amdhsa_system_sgpr_workgroup_id_x 1
.end_amdhsa_kernel
.p2align 6
.amdhsa_kernel k2n_kernel
  .amdhsa_next_free_vgpr 224
  .amdhsa_next_free_sgpr 96
  .amdhsa_accum_offset 160
  .amdhsa_group_segment_fixed_size 0
  .amdhsa_kernarg_size 80
  .amdhsa_user_sgpr_count 2
  .amdhsa_user_sgpr_kernarg_segment_ptr 1
  .amdhsa_system_sgpr_workgroup_id_x 1
.end_amdhsa_kernel
.p2align 6
.amdhsa_kernel k4_kernel
  .amdhsa_next_free_vgpr 144
  .amdhsa_next_free_sgpr 96
  .amdhsa_accum_offset 144
  .amdhsa_group_segment_fixed_size 0
  .amdhsa_kernarg_size 80
  .amdhsa_user_sgpr_count 2
  .amdhsa_user_sgpr_kernarg_segment_ptr 1
  .amdhsa_system_sgpr_workgroup_id_x 1
.end_amdhsa_kernel
.p2align 6
.amdhsa_kernel k5_kernel
  .amdhsa_next_free_vgpr 84
  .amdhsa_next_free_sgpr 96
  .amdhsa_accum_offset 84
  .amdhsa_group_segment_fixed_size 0
  .amdhsa_kernarg_size 80
  .amdhsa_user_sgpr_count 2
  .amdhsa_user_sgpr_kernarg_segment_ptr 1
  .amdhsa_system_sgpr_workgroup_id_x 1
.end_amdhsa_kernel
```
